```python
import torch

def _softmax(x, axis=-1):
    return torch.softmax(x, dim=axis)
def _gelu(x):
    return torch.nn.functional.gelu(x, approximate="tanh")
def _silu(x):
    return torch.nn.functional.silu(x)
def _sigmoid(x):
    return torch.sigmoid(x)
def _layernorm(x, axis=-1, eps=1e-5):
    m = x.mean(dim=axis, keepdim=True)
    v = x.var(dim=axis, keepdim=True, unbiased=False)
    return (x - m) / torch.sqrt(v + eps)
def _scatter_add(tgt, idx, src, axis=0):
    return tgt.clone().index_add_(axis, idx, src)
def _segment_sum(src, seg, n):
    out = torch.zeros((n,) + src.shape[1:], dtype=src.dtype)
    return out.index_add_(0, seg, src)
def _pad(x, pw):
    flat = tuple(v for pair in reversed(pw) for v in pair)
    return torch.nn.functional.pad(x, flat)

kernel_name = 'gated_mix__linear_kernel_hedgehog__glu_gated_geglu__prompt'

def setup_inputs():

    _w = (lambda a: (lambda t: t.to(torch.bfloat16) if t.is_floating_point() else t)(torch.as_tensor(a)))
    def _A_setup():
        B, S, D, H = 1, 2048, 1024, 32
        Dh = D // H
        return {
            "x": _w((lambda *s: torch.randn(*s, dtype=torch.bfloat16) * 0.05)(B, S, D)),
            "wqkv": _w((lambda *s: torch.randn(*s, dtype=torch.bfloat16) * 0.8)(D, 3 * D)),
            "w_phi": _w((lambda *s: torch.randn(*s, dtype=torch.bfloat16) * 0.8)(H, Dh, Dh) * (Dh ** -0.5)),
            "wo": _w((lambda *s: torch.randn(*s, dtype=torch.bfloat16) * 0.05)(D, D)),
        }
    _A_in = _A_setup()

    def _B_setup():
        B, S, Dm, Df = 1, 2048, 1024, 3584
        return {
            "x": _w((lambda *s: torch.randn(*s, dtype=torch.bfloat16) * 0.05)(B, S, Dm)),
            "w_gate": _w((lambda *s: torch.randn(*s, dtype=torch.bfloat16) * 1.6)(Dm, Df) * (Dm ** -0.5)),
            "w_up": _w((lambda *s: torch.randn(*s, dtype=torch.bfloat16) * 1.6)(Dm, Df) * (Dm ** -0.5)),
            "w_down": _w((lambda *s: torch.randn(*s, dtype=torch.bfloat16) * 1.6)(Df, Dm) * (Df ** -0.5)),
        }
    _B_in = _B_setup()

    return {
        "A_x": _A_in["x"],
        "A_wqkv": _A_in["wqkv"],
        "A_w_phi": _A_in["w_phi"],
        "A_wo": _A_in["wo"],
        "B_x": _B_in["x"],
        "B_w_gate": _B_in["w_gate"],
        "B_w_up": _B_in["w_up"],
        "B_w_down": _B_in["w_down"],
        "gate_w": _w((lambda *s: torch.randn(*s, dtype=torch.bfloat16) * 0.05)(1024) * 16.0),
    }

def reference(A_x, A_wqkv, A_w_phi, A_wo, B_x, B_w_gate, B_w_up, B_w_down, gate_w):
    def _A_ref(x, wqkv, w_phi, wo):
        B, S, D = x.shape
        H = 32; Dh = D // H
        qkv = (lambda x, *d: x.permute(*d))((x @ wqkv).reshape(B, S, 3, H, Dh), 2, 0, 3, 1, 4)
        q, k, v = qkv[0], qkv[1], qkv[2]
        pq = torch.einsum("bhsd,hdf->bhsf", q, w_phi)
        pk = torch.einsum("bhsd,hdf->bhsf", k, w_phi)
        phi_q = torch.concatenate([_softmax(pq, axis=-1), _softmax(-pq, axis=-1)], axis=-1)
        phi_k = torch.concatenate([_softmax(pk, axis=-1), _softmax(-pk, axis=-1)], axis=-1)
        kv = torch.einsum("bhsf,bhsd->bhfd", phi_k, v)
        z  = torch.einsum("bhsf->bhf", phi_k)
        num = torch.einsum("bhqf,bhfd->bhqd", phi_q, kv)
        den = torch.einsum("bhqf,bhf->bhq", phi_q, z)[..., None] + 1e-6
        o = num / den
        return (lambda x, *d: x.permute(*d))(o, 0, 2, 1, 3).reshape(B, S, D) @ wo

    def _B_ref(x, w_gate, w_up, w_down):
        g = torch.einsum("bsd,df->bsf", x, w_gate)
        u = torch.einsum("bsd,df->bsf", x, w_up)
        h = _gelu(g) * u
        return torch.einsum("bsf,fd->bsd", h, w_down)

    x = A_x
    g = _sigmoid((x * gate_w).sum(-1, keepdims=True))
    a = _A_ref(x, A_wqkv, A_w_phi, A_wo)
    b = _B_ref(x, B_w_gate, B_w_up, B_w_down)
    return g * a + (1 - g) * b
```

```asm
; @launch kernel=k1_kernel grid=(256,1,1) block=(512,1,1) lds=163840
.amdgcn_target "amdgcn-amd-amdhsa--gfx950"
.text
.globl k1_kernel
.p2align 8
.type k1_kernel,@function
k1_kernel:
s_cmp_lt_u32 s2, 256
s_cbranch_scc1 k1_kernel_go
s_endpgm
k1_kernel_go:
s_load_dwordx4 s[4:7], s[0:1], 0
s_load_dwordx4 s[8:11], s[0:1], 16
s_load_dwordx4 s[12:15], s[0:1], 40
s_load_dwordx2 s[60:61], s[0:1], 56
s_load_dwordx2 s[40:41], s[0:1], 88
s_load_dwordx2 s[28:29], s[0:1], 64
s_load_dwordx2 s[96:97], s[0:1], 80
s_load_dwordx2 s[46:47], s[0:1], 72
s_cmp_ge_u32 s2, 32
s_cbranch_scc1 k1_kernel_noipf
s_getpc_b64 s[20:21]
k1_kernel_pc:
v_lshlrev_b32 v1, 7, v0
s_mov_b32 s22, k1_kernel_typeB-k1_kernel_pc
s_bitcmp1_b32 s2, 0
s_cmov_b32 s22, k1_kernel_a_far-k1_kernel_pc
v_add_u32 v1, s22, v1
v_min_u32 v2, k1_kernel_end-k1_kernel_pc-4, v1
global_load_dword v159, v2, s[20:21]
k1_kernel_noipf:
v_lshrrev_b32 v1, 6, v0
v_and_b32 v0, 63, v0
v_readfirstlane_b32 s87, v1
s_lshr_b32 s91, s2, 3
s_and_b32 s82, s91, 1
s_lshr_b32 s90, s91, 1
s_and_b32 s90, s90, 1
s_and_b32 s85, s2, 6
s_or_b32 s85, s85, s90
s_and_b32 s83, s2, 1
s_lshl_b32 s83, s83, 1
s_add_u32 s83, s83, s82
s_lshr_b32 s86, s2, 5
s_and_b32 s88, s87, 3
s_lshr_b32 s89, s87, 2
v_lshlrev_b32 v171, 4, v0
s_lshl_b32 s90, s85, 2
s_add_u32 s90, s90, s83
s_lshl_b32 s39, s90, 3
s_add_u32 s39, s39, s87
s_lshl_b32 s91, s86, 8
s_add_u32 s39, s39, s91
s_lshl_b32 s91, s39, 11
s_mov_b32 s18, 0x400000
s_mov_b32 s19, 0x00020000
s_mov_b32 s42, 67108864
s_mov_b32 s43, 0x00020000
s_mov_b32 s30, 2048
s_mov_b32 s31, 0x00020000
s_mov_b32 s98, 256
s_mov_b32 s99, 0x00020000
s_mov_b32 s35, 0x00020000
s_mov_b32 s23, 0x00020000
s_mov_b32 s27, 0x00020000
s_waitcnt lgkmcnt(0)
s_mov_b32 s16, s4
s_mov_b32 s17, s5
buffer_load_dwordx4 v[128:131], v171, s[16:19], s91 offen offset:0
buffer_load_dwordx4 v[132:135], v171, s[16:19], s91 offen offset:1024
buffer_load_dwordx4 v[136:139], v171, s[28:31], 0 offen offset:0
buffer_load_dwordx4 v[140:143], v171, s[28:31], 0 offen offset:1024
v_and_b32 v2, 15, v0
v_lshrrev_b32 v3, 4, v0
v_lshrrev_b32 v5, 3, v0
v_and_b32 v6, 7, v0
v_xor_b32 v6, v6, v3
v_lshlrev_b32 v7, 4, v6
v_lshl_add_u32 v164, v5, 11, v7
v_xor_b32 v6, 4, v6
v_lshlrev_b32 v7, 4, v6
v_lshl_add_u32 v165, v5, 11, v7
s_lshl_b32 s90, s86, 19
s_lshl_b32 s91, s87, 16
s_add_u32 s48, s90, s91
s_add_u32 s49, s48, 16384
s_add_u32 s50, s48, 32768
s_add_u32 s51, s48, 49152
s_lshl_b32 s58, s87, 12
s_lshl_b32 s62, s87, 10
s_mul_i32 s57, s87, 768
v_lshrrev_b32 v5, 1, v2
v_xor_b32 v5, v5, v3
s_lshl_b32 s90, s88, 13
v_lshlrev_b32 v6, 7, v2
v_add_u32 v6, s90, v6
v_lshl_add_u32 v160, v5, 4, v6
v_xor_b32 v5, 4, v5
v_lshl_add_u32 v161, v5, 4, v6
v_lshrrev_b32 v5, 5, v0
v_and_b32 v6, 1, v3
v_lshrrev_b32 v7, 2, v0
v_and_b32 v7, 3, v7
v_lshl_add_u32 v7, v6, 2, v7
v_lshrrev_b32 v9, 1, v7
v_lshl_add_u32 v7, v5, 4, v7
v_and_b32 v8, 3, v0
v_lshlrev_b32 v8, 3, v8
s_lshl_b32 s90, s89, 1
s_add_u32 s91, s90, 0
v_xor_b32 v10, s91, v9
v_lshlrev_b32 v10, 5, v10
v_lshl_add_u32 v10, v7, 7, v10
v_add3_u32 v10, v10, v8, 0
v_add_u32 v162, 98304, v10
v_add_u32 v167, 65536, v10
s_add_u32 s91, s90, 1
v_xor_b32 v10, s91, v9
v_lshlrev_b32 v10, 5, v10
v_lshl_add_u32 v10, v7, 7, v10
v_add3_u32 v10, v10, v8, 0
v_add_u32 v163, 98304, v10
v_add_u32 v168, 65536, v10
v_xor_b32 v10, s89, v6
v_lshlrev_b32 v10, 5, v10
v_lshl_add_u32 v10, v7, 6, v10
v_add3_u32 v169, v10, v8, 0
v_add_u32 v169, 102400, v169
s_lshl_b32 s90, s88, 6
v_add_u32 v5, s90, v0
v_lshrrev_b32 v6, 3, v5
v_and_b32 v7, 6, v6
v_and_b32 v166, 7, v5
v_xor_b32 v166, v166, v7
v_lshlrev_b32 v166, 4, v166
v_lshrrev_b32 v7, 1, v6
v_xor_b32 v7, v7, v6
v_and_b32 v7, 4, v7
v_mul_u32_u24 v7, 3, v7
v_xor_b32 v6, v6, v7
v_mul_u32_u24 v6, 7168, v6
v_add_u32 v166, v166, v6
s_cmp_eq_u32 s89, 0
s_cselect_b32 s28, s12, s14
s_cselect_b32 s29, s13, s15
s_mov_b32 s30, 7340032
s_mov_b32 s32, s6
s_mov_b32 s33, s7
s_mov_b32 s34, 6291456
s_mov_b32 s59, 524288
s_mov_b32 s76, 3145728
s_cmp_ge_u32 s2, 64
s_cselect_b32 s32, s12, s32
s_cselect_b32 s33, s13, s33
s_cselect_b32 s34, 7340032, s34
s_cselect_b32 s59, 786432, s59
s_cselect_b32 s76, 2228224, s76
s_cmp_ge_u32 s2, 160
s_cselect_b32 s32, s14, s32
s_cselect_b32 s33, s15, s33
s_cselect_b32 s76, 1441792, s76
s_lshl_b32 s90, s2, 13
s_add_u32 s76, s76, s90
s_mul_i32 s79, s85, 896
s_mul_i32 s90, s87, 48
v_add_u32 v5, s90, v0
s_cmp_lt_u32 s83, 2
s_cbranch_scc1 k1_kernel_typeB
s_lshl_b32 s78, s85, 1
s_add_u32 s78, s78, s82
s_mov_b32 s24, s8
s_mov_b32 s25, s9
s_mov_b32 s26, 65536
v_lshlrev_b32 v4, 8, v3
v_lshl_add_u32 v4, v2, 1, v4
s_lshl_b32 s77, s78, 1
s_add_u32 s77, s77, s89
s_lshl_b32 s90, s77, 11
buffer_load_ushort v108, v4, s[24:27], s90 offen offset:0
buffer_load_ushort v109, v4, s[24:27], s90 offen offset:64
buffer_load_ushort v110, v4, s[24:27], s90 offen offset:128
buffer_load_ushort v111, v4, s[24:27], s90 offen offset:192
buffer_load_ushort v112, v4, s[24:27], s90 offen offset:1024
buffer_load_ushort v113, v4, s[24:27], s90 offen offset:1088
buffer_load_ushort v114, v4, s[24:27], s90 offen offset:1152
buffer_load_ushort v115, v4, s[24:27], s90 offen offset:1216
buffer_load_ushort v116, v4, s[24:27], s90 offen offset:32
buffer_load_ushort v117, v4, s[24:27], s90 offen offset:96
buffer_load_ushort v118, v4, s[24:27], s90 offen offset:160
buffer_load_ushort v119, v4, s[24:27], s90 offen offset:224
buffer_load_ushort v120, v4, s[24:27], s90 offen offset:1056
buffer_load_ushort v121, v4, s[24:27], s90 offen offset:1120
buffer_load_ushort v122, v4, s[24:27], s90 offen offset:1184
buffer_load_ushort v123, v4, s[24:27], s90 offen offset:1248
s_lshl_b32 s52, s78, 7
s_lshl_b32 s90, s82, 7
s_add_u32 s53, s90, s79
s_add_u32 s53, s53, 640
s_mov_b32 s20, s6
s_mov_b32 s21, s7
s_mov_b32 s22, 6291456
v_and_b32 v8, 255, v5
v_lshrrev_b32 v6, 3, v8
v_and_b32 v7, 6, v6
v_and_b32 v170, 7, v8
v_xor_b32 v170, v170, v7
v_lshlrev_b32 v170, 4, v170
v_lshrrev_b32 v7, 1, v6
v_xor_b32 v7, v7, v6
v_and_b32 v7, 4, v7
v_mul_u32_u24 v7, 3, v7
v_xor_b32 v6, v6, v7
v_mul_u32_u24 v6, 6144, v6
v_add_u32 v170, v170, v6
v_lshrrev_b32 v8, 8, v5
v_lshl_add_u32 v170, v8, 11, v170
v_add_u32 v5, 384, v5
v_and_b32 v8, 255, v5
v_lshrrev_b32 v6, 3, v8
v_and_b32 v7, 6, v6
v_and_b32 v169, 7, v8
v_xor_b32 v169, v169, v7
v_lshlrev_b32 v169, 4, v169
v_lshrrev_b32 v7, 1, v6
v_xor_b32 v7, v7, v6
v_and_b32 v7, 4, v7
v_mul_u32_u24 v7, 3, v7
v_xor_b32 v6, v6, v7
v_mul_u32_u24 v6, 6144, v6
v_add_u32 v169, v169, v6
v_lshrrev_b32 v8, 8, v5
v_lshl_add_u32 v169, v8, 11, v169
s_mov_b32 m0, 155648
s_and_b32 s90, s86, 3
s_add_u32 s90, s90, 0
s_mul_i32 s90, s90, 196608
s_add_u32 s90, s90, s52
s_cmp_lt_u32 s86, 4
s_cselect_b32 s91, 0, -1
s_xor_b32 exec_lo, s91, 0xffffff
s_and_b32 exec_hi, s91, 0xffff
buffer_load_dwordx4 v170, s[20:23], s90 offen lds
s_mov_b64 exec, -1
s_mov_b32 m0, 155648
s_and_b32 s90, s86, 3
s_add_u32 s90, s90, 0
s_mul_i32 s90, s90, 196608
s_add_u32 s90, s90, s52
s_cmp_lt_u32 s86, 4
s_cselect_b32 s91, 0, -1
s_xor_b32 exec_lo, s91, 0xffffff
s_and_b32 exec_hi, s91, 0xffff
buffer_load_dwordx4 v169, s[20:23], s90 offen lds
s_mov_b64 exec, -1
s_mov_b32 m0, 155648
s_and_b32 s90, s86, 3
s_add_u32 s90, s90, 0
s_mul_i32 s90, s90, 229376
s_add_u32 s90, s90, s53
s_cmp_lt_u32 s86, 4
s_cselect_b32 exec_lo, -1, 0
s_cselect_b32 exec_hi, 0, -1
buffer_load_dwordx4 v166, s[28:31], s90 offen lds
s_mov_b64 exec, -1
s_mov_b32 m0, 155648
s_lshr_b32 s91, s2, 3
s_and_b32 s90, s91, 1
s_add_u32 s90, s90, 0
s_lshl_b32 s90, s90, 7
s_and_b32 s91, s91, 2
s_lshl_b32 s91, s91, 14
s_add_u32 s90, s90, s91
s_add_u32 s90, s90, s48
buffer_load_dwordx4 v164, s[16:19], s90 offen lds
s_mov_b32 m0, 155648
s_lshr_b32 s91, s2, 3
s_and_b32 s90, s91, 1
s_add_u32 s90, s90, 0
s_lshl_b32 s90, s90, 7
s_and_b32 s91, s91, 2
s_lshl_b32 s91, s91, 14
s_add_u32 s90, s90, s91
s_add_u32 s90, s90, s49
buffer_load_dwordx4 v165, s[16:19], s90 offen lds
s_add_u32 m0, s58, 0
s_nop 0
buffer_load_dwordx4 v164, s[16:19], s48 offen lds
s_add_u32 m0, s58, 1024
s_add_u32 s48, s48, 128
buffer_load_dwordx4 v165, s[16:19], s49 offen lds
s_add_u32 m0, s58, 2048
s_add_u32 s49, s49, 128
buffer_load_dwordx4 v164, s[16:19], s50 offen lds
s_add_u32 m0, s58, 3072
s_add_u32 s50, s50, 128
buffer_load_dwordx4 v165, s[16:19], s51 offen lds
s_add_u32 m0, s57, 98304
s_add_u32 s51, s51, 128
s_mov_b32 exec_hi, 0xffff
buffer_load_dwordx4 v170, s[20:23], s52 offen lds
s_mov_b32 exec_hi, -1
s_add_u32 m0, s57, 104448
s_mov_b32 exec_hi, 0xffff
buffer_load_dwordx4 v169, s[20:23], s52 offen lds
s_mov_b32 exec_hi, -1
s_add_u32 m0, s62, 65536
s_add_u32 s52, s52, 196608
buffer_load_dwordx4 v166, s[28:31], s53 offen lds
s_add_u32 m0, s57, 110592
s_add_u32 s53, s53, 229376
s_mov_b32 exec_hi, 0xffff
buffer_load_dwordx4 v170, s[20:23], s52 offen lds
s_mov_b32 exec_hi, -1
s_add_u32 m0, s57, 116736
s_mov_b32 exec_hi, 0xffff
buffer_load_dwordx4 v169, s[20:23], s52 offen lds
s_mov_b32 exec_hi, -1
s_add_u32 m0, s62, 73728
s_add_u32 s52, s52, 196608
buffer_load_dwordx4 v166, s[28:31], s53 offen lds
s_branch k1_kernel_a_far
k1_kernel_typeB:
s_mul_i32 s90, s82, 384
s_add_u32 s53, s90, s79
s_add_u32 s53, s53, 128
s_mov_b32 s52, s79
s_mov_b32 s20, s12
s_mov_b32 s21, s13
s_mov_b32 s22, 7340032
s_mov_b32 s24, s14
s_mov_b32 s25, s15
s_mov_b32 s26, 7340032
v_lshrrev_b32 v6, 3, v5
v_and_b32 v7, 6, v6
v_and_b32 v170, 7, v5
v_xor_b32 v170, v170, v7
v_lshlrev_b32 v170, 4, v170
v_lshrrev_b32 v7, 1, v6
v_xor_b32 v7, v7, v6
v_and_b32 v7, 4, v7
v_mul_u32_u24 v7, 3, v7
v_xor_b32 v6, v6, v7
v_mul_u32_u24 v6, 7168, v6
v_add_u32 v170, v170, v6
v_add_u32 v170, s90, v170
v_subrev_u32 v8, 256, v5
v_lshrrev_b32 v6, 2, v8
v_lshrrev_b32 v7, 1, v6
v_and_b32 v7, 2, v7
v_and_b32 v8, 3, v8
v_xor_b32 v8, v8, v7
v_lshlrev_b32 v8, 4, v8
v_and_b32 v6, 31, v6
v_lshrrev_b32 v7, 1, v6
v_xor_b32 v7, v7, v6
v_and_b32 v7, 4, v7
v_mul_u32_u24 v7, 3, v7
v_xor_b32 v6, v6, v7
v_mul_u32_u24 v6, 7168, v6
s_lshl_b32 s90, s82, 6
s_add_u32 s90, s90, 256
v_add3_u32 v8, v8, v6, s90
v_cmp_gt_u32 vcc, 256, v5
s_nop 1
v_cndmask_b32 v170, v8, v170, vcc
s_mov_b32 m0, 155648
s_and_b32 s90, s86, 3
s_add_u32 s90, s90, 0
s_mul_i32 s90, s90, 229376
s_add_u32 s90, s90, s52
s_cmp_lt_u32 s86, 4
s_cselect_b32 s91, 0, -1
s_xor_b32 exec_lo, s91, 0xffffff
s_and_b32 exec_hi, s91, 0xffff
buffer_load_dwordx4 v170, s[20:23], s90 offen lds
s_mov_b64 exec, -1
s_mov_b32 m0, 155648
s_and_b32 s90, s86, 3
s_add_u32 s90, s90, 0
s_mul_i32 s90, s90, 229376
s_add_u32 s90, s90, s52
s_cmp_lt_u32 s86, 4
s_cselect_b32 s91, 0, -1
s_xor_b32 exec_lo, s91, 0xffffff
s_and_b32 exec_hi, s91, 0xffff
buffer_load_dwordx4 v170, s[24:27], s90 offen lds
s_mov_b64 exec, -1
s_mov_b32 m0, 155648
s_and_b32 s90, s86, 3
s_add_u32 s90, s90, 0
s_mul_i32 s90, s90, 229376
s_add_u32 s90, s90, s53
s_cmp_lt_u32 s86, 4
s_cselect_b32 exec_lo, -1, 0
s_cselect_b32 exec_hi, 0, -1
buffer_load_dwordx4 v166, s[28:31], s90 offen lds
s_mov_b64 exec, -1
s_mov_b32 m0, 155648
s_lshr_b32 s91, s2, 3
s_and_b32 s90, s91, 1
s_add_u32 s90, s90, 0
s_lshl_b32 s90, s90, 7
s_and_b32 s91, s91, 2
s_lshl_b32 s91, s91, 14
s_add_u32 s90, s90, s91
s_add_u32 s90, s90, s48
buffer_load_dwordx4 v164, s[16:19], s90 offen lds
s_mov_b32 m0, 155648
s_lshr_b32 s91, s2, 3
s_and_b32 s90, s91, 1
s_add_u32 s90, s90, 0
s_lshl_b32 s90, s90, 7
s_and_b32 s91, s91, 2
s_lshl_b32 s91, s91, 14
s_add_u32 s90, s90, s91
s_add_u32 s90, s90, s49
buffer_load_dwordx4 v165, s[16:19], s90 offen lds
s_add_u32 m0, s58, 0
s_nop 0
buffer_load_dwordx4 v164, s[16:19], s48 offen lds
s_add_u32 m0, s58, 1024
s_add_u32 s48, s48, 128
buffer_load_dwordx4 v165, s[16:19], s49 offen lds
s_add_u32 m0, s58, 2048
s_add_u32 s49, s49, 128
buffer_load_dwordx4 v164, s[16:19], s50 offen lds
s_add_u32 m0, s58, 3072
s_add_u32 s50, s50, 128
buffer_load_dwordx4 v165, s[16:19], s51 offen lds
s_add_u32 m0, s57, 98304
s_add_u32 s51, s51, 128
s_mov_b32 exec_hi, 0xffff
buffer_load_dwordx4 v170, s[20:23], s52 offen lds
s_mov_b32 exec_hi, -1
s_add_u32 m0, s57, 104448
s_mov_b32 exec_hi, 0xffff
buffer_load_dwordx4 v170, s[24:27], s52 offen lds
s_mov_b32 exec_hi, -1
s_add_u32 m0, s62, 65536
s_add_u32 s52, s52, 229376
buffer_load_dwordx4 v166, s[28:31], s53 offen lds
s_add_u32 m0, s57, 110592
s_add_u32 s53, s53, 229376
s_mov_b32 exec_hi, 0xffff
buffer_load_dwordx4 v170, s[20:23], s52 offen lds
s_mov_b32 exec_hi, -1
s_add_u32 m0, s57, 116736
s_mov_b32 exec_hi, 0xffff
buffer_load_dwordx4 v170, s[24:27], s52 offen lds
s_mov_b32 exec_hi, -1
s_add_u32 m0, s62, 73728
s_add_u32 s52, s52, 229376
buffer_load_dwordx4 v166, s[28:31], s53 offen lds
s_mov_b32 s8, 0xbdd2d3e8
s_mov_b32 vcc_lo, s89
s_mov_b32 vcc_hi, 0
s_mov_b32 s9, 0x3fb8aa3b
s_and_b32 s6, s2, 6
s_lshl_b32 s6, s6, 1
s_lshr_b32 s7, s2, 3
s_and_b32 s7, s7, 3
s_add_u32 s4, s6, s7
s_lshr_b32 s5, s2, 5
s_lshl_b32 s63, s89, 12
s_lshl_b32 s64, s88, 14
s_lshl_b32 s6, s5, 8
s_add_u32 s64, s64, s6
s_xor_b32 s7, s89, 0
s_lshl_b32 s7, s7, 7
s_add_u32 s64, s64, s7
s_add_u32 s64, s64, 0
s_add_u32 s95, s6, 0
s_lshl_b32 s67, s87, 14
s_add_u32 s67, s67, s95
s_add_u32 s67, s67, 393216
s_lshl_b32 s6, s4, 3
s_lshl_b32 s7, s88, 1
s_add_u32 s6, s6, s7
s_add_u32 s90, s6, s89
s_xor_b32 s91, s90, 1
s_lshl_b32 s7, s89, 10
s_mul_i32 s54, s90, 147456
s_add_u32 s54, s54, s7
s_add_u32 s68, s54, 0
s_add_u32 s54, s54, 120832
s_mul_i32 s55, s91, 147456
s_add_u32 s55, s55, s7
s_add_u32 s69, s55, 0
s_add_u32 s55, s55, 120832
s_lshl_b32 s70, s90, 6
s_add_u32 s70, s70, 29360128
s_lshl_b32 s7, s90, 15
s_add_u32 s95, s95, s7
s_lshr_b32 s71, s4, 1
s_lshl_b32 s71, s71, 7
s_add_u32 s66, s71, 30426112
s_add_u32 s71, s71, 30408704
s_lshl_b32 s6, s4, 3
s_add_u32 s6, s6, s5
s_lshl_b32 s56, s6, 7
s_add_u32 s56, s56, 30409728
s_add_u32 s80, s56, 0
s_lshl_b32 s6, s6, 16
s_add_u32 s6, s6, 33554432
s_and_b32 s7, s90, 7
s_lshl_b32 s7, s7, 12
s_add_u32 s6, s6, s7
s_add_u32 s45, s6, 0
s_add_u32 s44, s6, 32768
s_lshl_b32 s81, s85, 2
s_add_u32 s81, s81, s83
s_lshl_b32 s81, s81, 2
s_lshl_b32 s7, s86, 7
s_add_u32 s81, s81, s7
s_add_u32 s81, s81, 30426112
s_lshl_b32 s6, s86, 4
s_lshl_b32 s7, s88, 2
s_add_u32 s6, s6, s7
s_mul_i32 s6, s6, 147456
s_mul_i32 s7, s85, 14336
s_add_u32 s7, s7, s6
s_lshl_b32 s90, s89, 10
s_mul_i32 s91, s82, 6144
s_add_u32 s92, s7, s91
s_add_u32 s92, s92, s90
s_add_u32 s94, s92, 2048
s_lshl_b32 s91, s82, 10
s_add_u32 s93, s7, s91
s_add_u32 s93, s93, 4096
s_mul_i32 s91, s89, 294912
s_add_u32 s93, s93, s91
s_lshl_b32 s74, s88, 12
s_add_u32 s74, s74, 147456
s_lshl_b32 s91, s89, 11
s_add_u32 s75, s74, s91
s_lshl_b32 s91, s89, 3
s_add_u32 s74, s74, s91
v_mov_b32 v4, 0
v_mov_b32 v5, 0
v_mov_b32 v6, 0
v_mov_b32 v7, 0
s_mov_b32 s6, s81
s_cmp_eq_u32 s88, 1
s_cselect_b32 s6, s80, s6
s_mov_b64 exec, 1
buffer_store_dword v4, off, s[40:43], s6 sc1
s_mov_b64 exec, -1
v_lshrrev_b32 v9, 3, v0
v_and_b32 v175, 6, v9
v_and_b32 v8, 7, v0
v_xor_b32 v8, v8, v175
v_lshlrev_b32 v8, 4, v8
v_lshl_add_u32 v175, v9, 11, v8
s_waitcnt vmcnt(16)
v_lshlrev_b32 v146, 16, v128
v_lshlrev_b32 v147, 16, v136
v_and_b32 v148, 0xffff0000, v128
v_and_b32 v149, 0xffff0000, v136
v_mul_f32 v172, v146, v147
v_mul_f32 v145, v148, v149
v_lshlrev_b32 v146, 16, v129
v_lshlrev_b32 v147, 16, v137
v_and_b32 v148, 0xffff0000, v129
v_and_b32 v149, 0xffff0000, v137
v_fmac_f32 v172, v146, v147
v_fmac_f32 v145, v148, v149
v_lshlrev_b32 v146, 16, v130
v_lshlrev_b32 v147, 16, v138
v_and_b32 v148, 0xffff0000, v130
v_and_b32 v149, 0xffff0000, v138
v_fmac_f32 v172, v146, v147
v_fmac_f32 v145, v148, v149
v_lshlrev_b32 v146, 16, v131
v_lshlrev_b32 v147, 16, v139
v_and_b32 v148, 0xffff0000, v131
v_and_b32 v149, 0xffff0000, v139
v_fmac_f32 v172, v146, v147
v_fmac_f32 v145, v148, v149
v_lshlrev_b32 v146, 16, v132
v_lshlrev_b32 v147, 16, v140
v_and_b32 v148, 0xffff0000, v132
v_and_b32 v149, 0xffff0000, v140
v_fmac_f32 v172, v146, v147
v_fmac_f32 v145, v148, v149
v_lshlrev_b32 v146, 16, v133
v_lshlrev_b32 v147, 16, v141
v_and_b32 v148, 0xffff0000, v133
v_and_b32 v149, 0xffff0000, v141
v_fmac_f32 v172, v146, v147
v_fmac_f32 v145, v148, v149
v_lshlrev_b32 v146, 16, v134
v_lshlrev_b32 v147, 16, v142
v_and_b32 v148, 0xffff0000, v134
v_and_b32 v149, 0xffff0000, v142
v_fmac_f32 v172, v146, v147
v_fmac_f32 v145, v148, v149
v_lshlrev_b32 v146, 16, v135
v_lshlrev_b32 v147, 16, v143
v_and_b32 v148, 0xffff0000, v135
v_and_b32 v149, 0xffff0000, v143
v_fmac_f32 v172, v146, v147
v_fmac_f32 v145, v148, v149
v_add_f32 v172, v172, v145
s_nop 1
v_add_f32_dpp v172, v172, v172 row_ror:8 row_mask:0xf bank_mask:0xf
s_nop 1
v_add_f32_dpp v172, v172, v172 row_ror:4 row_mask:0xf bank_mask:0xf
s_nop 1
v_add_f32_dpp v172, v172, v172 row_ror:2 row_mask:0xf bank_mask:0xf
s_nop 1
v_add_f32_dpp v172, v172, v172 row_ror:1 row_mask:0xf bank_mask:0xf
v_mov_b32 v146, v172
s_nop 1
v_permlane16_swap_b32 v172, v146
v_add_f32 v172, v172, v146
v_mov_b32 v146, v172
s_nop 1
v_permlane32_swap_b32 v172, v146
v_add_f32 v172, v172, v146
v_cvt_pk_bf16_f32 v172, v172, v172
v_lshlrev_b32 v172, 16, v172
v_mul_f32 v172, 0xbfb8aa3b, v172
v_exp_f32 v172, v172
s_nop 0
v_add_f32 v172, 1.0, v172
v_rcp_f32 v172, v172
s_nop 0
v_cvt_pk_bf16_f32 v172, v172, v172
v_lshlrev_b32 v172, 16, v172
s_lshl_b32 s90, s39, 2
s_add_u32 s90, s90, 29360128
v_sub_f32 v146, 1.0, v172
s_lshr_b32 s91, s39, 6
v_cvt_pk_bf16_f32 v146, v146, v146
s_lshl_b32 s91, s91, 8
v_lshlrev_b32 v146, 16, v146
s_and_b32 s100, s39, 15
v_max_f32 v146, 0x21800000, v146
s_lshl_b32 s100, s100, 4
v_rcp_f32 v147, v146
s_add_u32 s91, s91, s100
s_bfe_u32 s100, s39, 0x20004
s_lshl_b32 s100, s100, 2
v_mul_f32 v172, v172, v147
s_add_u32 s91, s91, s100
s_add_u32 s91, s91, 29368320
v_mov_b32 v174, v146
s_mov_b64 exec, 1
buffer_store_dword v174, off, s[40:43], s90 sc1
buffer_store_dword v172, off, s[40:43], s91 sc1
s_mov_b64 exec, -1
s_waitcnt vmcnt(6) lgkmcnt(0)
s_barrier
ds_read_b128 a[0:3], v160 offset:0
ds_read_b128 a[4:7], v160 offset:2048
ds_read_b128 a[8:11], v160 offset:4096
ds_read_b128 a[12:15], v160 offset:6144
ds_read_b64_tr_b16 a[32:33], v162 offset:0
ds_read_b64_tr_b16 a[34:35], v162 offset:1024
ds_read_b64_tr_b16 a[36:37], v163 offset:0
ds_read_b64_tr_b16 a[38:39], v163 offset:1024
ds_read_b64_tr_b16 a[40:41], v169 offset:0
ds_read_b64_tr_b16 a[42:43], v169 offset:512
ds_read_b64_tr_b16 a[44:45], v162 offset:6144
ds_read_b64_tr_b16 a[46:47], v162 offset:7168
ds_read_b64_tr_b16 a[48:49], v163 offset:6144
ds_read_b64_tr_b16 a[50:51], v163 offset:7168
ds_read_b64_tr_b16 a[52:53], v169 offset:6144
ds_read_b64_tr_b16 a[54:55], v169 offset:6656
ds_read_b64_tr_b16 a[56:57], v167 offset:0
ds_read_b64_tr_b16 a[58:59], v167 offset:1024
ds_read_b64_tr_b16 a[60:61], v168 offset:0
ds_read_b64_tr_b16 a[62:63], v168 offset:1024
ds_read_b64_tr_b16 a[64:65], v167 offset:4096
ds_read_b64_tr_b16 a[66:67], v167 offset:5120
ds_read_b64_tr_b16 a[68:69], v168 offset:4096
ds_read_b64_tr_b16 a[70:71], v168 offset:5120
s_waitcnt vmcnt(3) lgkmcnt(0)
s_barrier
s_setprio 3
v_mfma_f32_16x16x32_bf16 v[0:3], a[32:35], a[0:3], 0
ds_read_b128 a[16:19], v161 offset:0
v_mfma_f32_16x16x32_bf16 v[24:27], a[32:35], a[4:7], 0
ds_read_b128 a[20:23], v161 offset:2048
s_add_u32 m0, s58, 32768
s_add_u32 s53, s53, 229376
buffer_load_dwordx4 v164, s[16:19], s48 offen lds
v_mfma_f32_16x16x32_bf16 v[48:51], a[32:35], a[8:11], 0
ds_read_b128 a[24:27], v161 offset:4096
v_mfma_f32_16x16x32_bf16 v[72:75], a[32:35], a[12:15], 0
ds_read_b128 a[28:31], v161 offset:6144
ds_read_b64_tr_b16 a[32:33], v162 offset:12288
v_mfma_f32_16x16x32_bf16 v[4:7], a[36:39], a[0:3], 0
ds_read_b64_tr_b16 a[72:73], v167 offset:12288
ds_read_b64_tr_b16 a[34:35], v162 offset:13312
s_add_u32 m0, s58, 33792
s_add_u32 s48, s48, 128
buffer_load_dwordx4 v165, s[16:19], s49 offen lds
v_mfma_f32_16x16x32_bf16 v[28:31], a[36:39], a[4:7], 0
ds_read_b64_tr_b16 a[74:75], v167 offset:13312
v_mfma_f32_16x16x32_bf16 v[52:55], a[36:39], a[8:11], 0
ds_read_b64_tr_b16 a[76:77], v168 offset:12288
v_mfma_f32_16x16x32_bf16 v[76:79], a[36:39], a[12:15], 0
ds_read_b64_tr_b16 a[78:79], v168 offset:13312
ds_read_b64_tr_b16 a[36:37], v163 offset:12288
v_mfma_f32_16x16x32_bf16 v[8:11], a[40:43], a[0:3], 0
ds_read_b64_tr_b16 a[38:39], v163 offset:13312
s_add_u32 m0, s58, 34816
s_add_u32 s49, s49, 128
buffer_load_dwordx4 v164, s[16:19], s50 offen lds
v_mfma_f32_16x16x32_bf16 v[32:35], a[40:43], a[4:7], 0
s_setprio 2
v_mfma_f32_16x16x32_bf16 v[56:59], a[40:43], a[8:11], 0
v_mfma_f32_16x16x32_bf16 v[80:83], a[40:43], a[12:15], 0
ds_read_b64_tr_b16 a[40:41], v169 offset:12288
v_mfma_f32_16x16x32_bf16 v[12:15], a[44:47], a[0:3], 0
ds_read_b64_tr_b16 a[42:43], v169 offset:12800
s_add_u32 m0, s58, 35840
s_add_u32 s50, s50, 128
buffer_load_dwordx4 v165, s[16:19], s51 offen lds
v_mfma_f32_16x16x32_bf16 v[36:39], a[44:47], a[4:7], 0
v_mfma_f32_16x16x32_bf16 v[60:63], a[44:47], a[8:11], 0
v_mfma_f32_16x16x32_bf16 v[84:87], a[44:47], a[12:15], 0
ds_read_b64_tr_b16 a[44:45], v162 offset:18432
v_mfma_f32_16x16x32_bf16 v[16:19], a[48:51], a[0:3], 0
ds_read_b64_tr_b16 a[46:47], v162 offset:19456
s_add_u32 m0, s57, 122880
s_add_u32 s51, s51, 128
s_mov_b32 exec_hi, 0xffff
buffer_load_dwordx4 v170, s[20:23], s52 offen lds
s_mov_b32 exec_hi, -1
v_mfma_f32_16x16x32_bf16 v[40:43], a[48:51], a[4:7], 0
v_mfma_f32_16x16x32_bf16 v[64:67], a[48:51], a[8:11], 0
v_mfma_f32_16x16x32_bf16 v[88:91], a[48:51], a[12:15], 0
ds_read_b64_tr_b16 a[48:49], v163 offset:18432
s_setprio 1
v_mfma_f32_16x16x32_bf16 v[20:23], a[52:55], a[0:3], 0
ds_read_b64_tr_b16 a[50:51], v163 offset:19456
s_add_u32 m0, s57, 129024
s_mov_b32 exec_hi, 0xffff
buffer_load_dwordx4 v170, s[24:27], s52 offen lds
s_mov_b32 exec_hi, -1
v_mfma_f32_16x16x32_bf16 v[44:47], a[52:55], a[4:7], 0
v_mfma_f32_16x16x32_bf16 v[68:71], a[52:55], a[8:11], 0
v_mfma_f32_16x16x32_bf16 v[92:95], a[52:55], a[12:15], 0
ds_read_b64_tr_b16 a[52:53], v169 offset:18432
s_add_u32 m0, s62, 81920
s_add_u32 s52, s52, 229376
buffer_load_dwordx4 v166, s[28:31], s53 offen lds
v_mfma_f32_16x16x32_bf16 v[96:99], a[56:59], a[0:3], 0
ds_read_b64_tr_b16 a[54:55], v169 offset:18944
v_mfma_f32_16x16x32_bf16 v[112:115], a[56:59], a[4:7], 0
v_mfma_f32_16x16x32_bf16 v[128:131], a[56:59], a[8:11], 0
v_mfma_f32_16x16x32_bf16 v[144:147], a[56:59], a[12:15], 0
ds_read_b64_tr_b16 a[56:57], v167 offset:8192
s_add_u32 m0, s57, 135168
s_add_u32 s53, s53, 229376
s_mov_b32 exec_hi, 0xffff
buffer_load_dwordx4 v170, s[20:23], s52 offen lds
s_mov_b32 exec_hi, -1
v_mfma_f32_16x16x32_bf16 v[100:103], a[60:63], a[0:3], 0
ds_read_b64_tr_b16 a[58:59], v167 offset:9216
v_mfma_f32_16x16x32_bf16 v[116:119], a[60:63], a[4:7], 0
s_setprio 0
v_mfma_f32_16x16x32_bf16 v[132:135], a[60:63], a[8:11], 0
v_mfma_f32_16x16x32_bf16 v[148:151], a[60:63], a[12:15], 0
ds_read_b64_tr_b16 a[60:61], v168 offset:8192
s_add_u32 m0, s57, 141312
s_mov_b32 exec_hi, 0xffff
buffer_load_dwordx4 v170, s[24:27], s52 offen lds
s_mov_b32 exec_hi, -1
v_mfma_f32_16x16x32_bf16 v[104:107], a[64:67], a[0:3], 0
ds_read_b64_tr_b16 a[62:63], v168 offset:9216
v_mfma_f32_16x16x32_bf16 v[120:123], a[64:67], a[4:7], 0
v_mfma_f32_16x16x32_bf16 v[136:139], a[64:67], a[8:11], 0
v_mfma_f32_16x16x32_bf16 v[152:155], a[64:67], a[12:15], 0
s_add_u32 m0, s62, 90112
s_add_u32 s52, s52, 229376
buffer_load_dwordx4 v166, s[28:31], s53 offen lds
v_mfma_f32_16x16x32_bf16 v[108:111], a[68:71], a[0:3], 0
v_mfma_f32_16x16x32_bf16 v[124:127], a[68:71], a[4:7], 0
v_mfma_f32_16x16x32_bf16 v[140:143], a[68:71], a[8:11], 0
v_mfma_f32_16x16x32_bf16 v[156:159], a[68:71], a[12:15], 0
s_waitcnt vmcnt(3) lgkmcnt(0)
s_barrier
s_setprio 3
v_mfma_f32_16x16x32_bf16 v[0:3], a[32:35], a[16:19], v[0:3]
ds_read_b128 a[0:3], v160 offset:32768
v_mfma_f32_16x16x32_bf16 v[24:27], a[32:35], a[20:23], v[24:27]
ds_read_b128 a[4:7], v160 offset:34816
s_add_u32 m0, s57, 98304
s_add_u32 s53, s53, 229376
s_mov_b32 exec_hi, 0xffff
buffer_load_dwordx4 v170, s[20:23], s52 offen lds
s_mov_b32 exec_hi, -1
v_mfma_f32_16x16x32_bf16 v[48:51], a[32:35], a[24:27], v[48:51]
ds_read_b128 a[8:11], v160 offset:36864
v_mfma_f32_16x16x32_bf16 v[72:75], a[32:35], a[28:31], v[72:75]
ds_read_b128 a[12:15], v160 offset:38912
ds_read_b64_tr_b16 a[32:33], v162 offset:24576
v_mfma_f32_16x16x32_bf16 v[4:7], a[36:39], a[16:19], v[4:7]
ds_read_b64_tr_b16 a[64:65], v167 offset:20480
ds_read_b64_tr_b16 a[34:35], v162 offset:25600
s_add_u32 m0, s57, 104448
s_mov_b32 exec_hi, 0xffff
buffer_load_dwordx4 v170, s[24:27], s52 offen lds
s_mov_b32 exec_hi, -1
v_mfma_f32_16x16x32_bf16 v[28:31], a[36:39], a[20:23], v[28:31]
ds_read_b64_tr_b16 a[66:67], v167 offset:21504
v_mfma_f32_16x16x32_bf16 v[52:55], a[36:39], a[24:27], v[52:55]
ds_read_b64_tr_b16 a[68:69], v168 offset:20480
v_mfma_f32_16x16x32_bf16 v[76:79], a[36:39], a[28:31], v[76:79]
ds_read_b64_tr_b16 a[70:71], v168 offset:21504
ds_read_b64_tr_b16 a[36:37], v163 offset:24576
s_add_u32 m0, s62, 65536
s_add_u32 s52, s52, 229376
buffer_load_dwordx4 v166, s[28:31], s53 offen lds
v_mfma_f32_16x16x32_bf16 v[8:11], a[40:43], a[16:19], v[8:11]
ds_read_b64_tr_b16 a[38:39], v163 offset:25600
v_mfma_f32_16x16x32_bf16 v[32:35], a[40:43], a[20:23], v[32:35]
s_setprio 2
v_mfma_f32_16x16x32_bf16 v[56:59], a[40:43], a[24:27], v[56:59]
v_mfma_f32_16x16x32_bf16 v[80:83], a[40:43], a[28:31], v[80:83]
ds_read_b64_tr_b16 a[40:41], v169 offset:24576
s_add_u32 m0, s58, 0
s_add_u32 s53, s53, 229376
buffer_load_dwordx4 v164, s[16:19], s48 offen lds
v_mfma_f32_16x16x32_bf16 v[12:15], a[44:47], a[16:19], v[12:15]
ds_read_b64_tr_b16 a[42:43], v169 offset:25088
v_mfma_f32_16x16x32_bf16 v[36:39], a[44:47], a[20:23], v[36:39]
v_mfma_f32_16x16x32_bf16 v[60:63], a[44:47], a[24:27], v[60:63]
s_add_u32 m0, s58, 1024
s_add_u32 s48, s48, 128
buffer_load_dwordx4 v165, s[16:19], s49 offen lds
v_mfma_f32_16x16x32_bf16 v[84:87], a[44:47], a[28:31], v[84:87]
ds_read_b64_tr_b16 a[44:45], v162 offset:30720
v_mfma_f32_16x16x32_bf16 v[16:19], a[48:51], a[16:19], v[16:19]
ds_read_b64_tr_b16 a[46:47], v162 offset:31744
v_mfma_f32_16x16x32_bf16 v[40:43], a[48:51], a[20:23], v[40:43]
v_mfma_f32_16x16x32_bf16 v[64:67], a[48:51], a[24:27], v[64:67]
s_add_u32 m0, s58, 2048
s_add_u32 s49, s49, 128
buffer_load_dwordx4 v164, s[16:19], s50 offen lds
v_mfma_f32_16x16x32_bf16 v[88:91], a[48:51], a[28:31], v[88:91]
ds_read_b64_tr_b16 a[48:49], v163 offset:30720
s_setprio 1
v_mfma_f32_16x16x32_bf16 v[20:23], a[52:55], a[16:19], v[20:23]
ds_read_b64_tr_b16 a[50:51], v163 offset:31744
v_mfma_f32_16x16x32_bf16 v[44:47], a[52:55], a[20:23], v[44:47]
s_add_u32 m0, s58, 3072
s_add_u32 s50, s50, 128
buffer_load_dwordx4 v165, s[16:19], s51 offen lds
v_mfma_f32_16x16x32_bf16 v[68:71], a[52:55], a[24:27], v[68:71]
v_mfma_f32_16x16x32_bf16 v[92:95], a[52:55], a[28:31], v[92:95]
ds_read_b64_tr_b16 a[52:53], v169 offset:30720
v_mfma_f32_16x16x32_bf16 v[96:99], a[56:59], a[16:19], v[96:99]
ds_read_b64_tr_b16 a[54:55], v169 offset:31232
v_mfma_f32_16x16x32_bf16 v[112:115], a[56:59], a[20:23], v[112:115]
s_add_u32 m0, s57, 110592
s_add_u32 s51, s51, 128
s_mov_b32 exec_hi, 0xffff
buffer_load_dwordx4 v170, s[20:23], s52 offen lds
s_mov_b32 exec_hi, -1
v_mfma_f32_16x16x32_bf16 v[128:131], a[56:59], a[24:27], v[128:131]
v_mfma_f32_16x16x32_bf16 v[144:147], a[56:59], a[28:31], v[144:147]
ds_read_b64_tr_b16 a[56:57], v167 offset:16384
v_mfma_f32_16x16x32_bf16 v[100:103], a[60:63], a[16:19], v[100:103]
ds_read_b64_tr_b16 a[58:59], v167 offset:17408
s_add_u32 m0, s57, 116736
s_mov_b32 exec_hi, 0xffff
buffer_load_dwordx4 v170, s[24:27], s52 offen lds
s_mov_b32 exec_hi, -1
v_mfma_f32_16x16x32_bf16 v[116:119], a[60:63], a[20:23], v[116:119]
s_setprio 0
v_mfma_f32_16x16x32_bf16 v[132:135], a[60:63], a[24:27], v[132:135]
v_mfma_f32_16x16x32_bf16 v[148:151], a[60:63], a[28:31], v[148:151]
ds_read_b64_tr_b16 a[60:61], v168 offset:16384
v_mfma_f32_16x16x32_bf16 v[104:107], a[72:75], a[16:19], v[104:107]
ds_read_b64_tr_b16 a[62:63], v168 offset:17408
s_add_u32 m0, s62, 73728
s_add_u32 s52, s52, 229376
buffer_load_dwordx4 v166, s[28:31], s53 offen lds
v_mfma_f32_16x16x32_bf16 v[120:123], a[72:75], a[20:23], v[120:123]
v_mfma_f32_16x16x32_bf16 v[136:139], a[72:75], a[24:27], v[136:139]
v_mfma_f32_16x16x32_bf16 v[152:155], a[72:75], a[28:31], v[152:155]
v_lshlrev_b32 v173, 3, v171
s_cmp_lg_u32 s87, 0
s_cbranch_scc1 k1_kernel_b_1
s_mov_b32 m0, 155648
s_nop 0
buffer_load_dword v173, s[32:35], s76 offen lds
k1_kernel_b_1:
s_add_u32 s76, s76, s59
v_mfma_f32_16x16x32_bf16 v[108:111], a[76:79], a[16:19], v[108:111]
v_mfma_f32_16x16x32_bf16 v[124:127], a[76:79], a[20:23], v[124:127]
v_mfma_f32_16x16x32_bf16 v[140:143], a[76:79], a[24:27], v[140:143]
v_mfma_f32_16x16x32_bf16 v[156:159], a[76:79], a[28:31], v[156:159]
s_waitcnt vmcnt(10) lgkmcnt(0)
s_barrier
s_setprio 3
v_mfma_f32_16x16x32_bf16 v[0:3], a[32:35], a[0:3], v[0:3]
ds_read_b128 a[16:19], v161 offset:32768
v_mfma_f32_16x16x32_bf16 v[24:27], a[32:35], a[4:7], v[24:27]
ds_read_b128 a[20:23], v161 offset:34816
s_add_u32 m0, s57, 122880
s_add_u32 s53, s53, 229376
s_mov_b32 exec_hi, 0xffff
buffer_load_dwordx4 v170, s[20:23], s52 offen lds
s_mov_b32 exec_hi, -1
v_mfma_f32_16x16x32_bf16 v[48:51], a[32:35], a[8:11], v[48:51]
ds_read_b128 a[24:27], v161 offset:36864
v_mfma_f32_16x16x32_bf16 v[72:75], a[32:35], a[12:15], v[72:75]
ds_read_b128 a[28:31], v161 offset:38912
ds_read_b64_tr_b16 a[32:33], v162 offset:36864
v_mfma_f32_16x16x32_bf16 v[4:7], a[36:39], a[0:3], v[4:7]
ds_read_b64_tr_b16 a[72:73], v167 offset:28672
ds_read_b64_tr_b16 a[34:35], v162 offset:37888
v_mfma_f32_16x16x32_bf16 v[28:31], a[36:39], a[4:7], v[28:31]
ds_read_b64_tr_b16 a[74:75], v167 offset:29696
v_mfma_f32_16x16x32_bf16 v[52:55], a[36:39], a[8:11], v[52:55]
ds_read_b64_tr_b16 a[76:77], v168 offset:28672
v_mfma_f32_16x16x32_bf16 v[76:79], a[36:39], a[12:15], v[76:79]
ds_read_b64_tr_b16 a[78:79], v168 offset:29696
ds_read_b64_tr_b16 a[36:37], v163 offset:36864
v_mfma_f32_16x16x32_bf16 v[8:11], a[40:43], a[0:3], v[8:11]
ds_read_b64_tr_b16 a[38:39], v163 offset:37888
v_mfma_f32_16x16x32_bf16 v[32:35], a[40:43], a[4:7], v[32:35]
s_setprio 2
v_mfma_f32_16x16x32_bf16 v[56:59], a[40:43], a[8:11], v[56:59]
v_mfma_f32_16x16x32_bf16 v[80:83], a[40:43], a[12:15], v[80:83]
ds_read_b64_tr_b16 a[40:41], v169 offset:36864
v_mfma_f32_16x16x32_bf16 v[12:15], a[44:47], a[0:3], v[12:15]
ds_read_b64_tr_b16 a[42:43], v169 offset:37376
v_mfma_f32_16x16x32_bf16 v[36:39], a[44:47], a[4:7], v[36:39]
s_add_u32 m0, s57, 129024
s_mov_b32 exec_hi, 0xffff
buffer_load_dwordx4 v170, s[24:27], s52 offen lds
s_mov_b32 exec_hi, -1
v_mfma_f32_16x16x32_bf16 v[60:63], a[44:47], a[8:11], v[60:63]
v_mfma_f32_16x16x32_bf16 v[84:87], a[44:47], a[12:15], v[84:87]
ds_read_b64_tr_b16 a[44:45], v162 offset:43008
v_mfma_f32_16x16x32_bf16 v[16:19], a[48:51], a[0:3], v[16:19]
ds_read_b64_tr_b16 a[46:47], v162 offset:44032
v_mfma_f32_16x16x32_bf16 v[40:43], a[48:51], a[4:7], v[40:43]
v_mfma_f32_16x16x32_bf16 v[64:67], a[48:51], a[8:11], v[64:67]
v_mfma_f32_16x16x32_bf16 v[88:91], a[48:51], a[12:15], v[88:91]
ds_read_b64_tr_b16 a[48:49], v163 offset:43008
s_setprio 1
v_mfma_f32_16x16x32_bf16 v[20:23], a[52:55], a[0:3], v[20:23]
ds_read_b64_tr_b16 a[50:51], v163 offset:44032
v_mfma_f32_16x16x32_bf16 v[44:47], a[52:55], a[4:7], v[44:47]
v_mfma_f32_16x16x32_bf16 v[68:71], a[52:55], a[8:11], v[68:71]
v_mfma_f32_16x16x32_bf16 v[92:95], a[52:55], a[12:15], v[92:95]
ds_read_b64_tr_b16 a[52:53], v169 offset:43008
v_mfma_f32_16x16x32_bf16 v[96:99], a[56:59], a[0:3], v[96:99]
ds_read_b64_tr_b16 a[54:55], v169 offset:43520
v_mfma_f32_16x16x32_bf16 v[112:115], a[56:59], a[4:7], v[112:115]
v_mfma_f32_16x16x32_bf16 v[128:131], a[56:59], a[8:11], v[128:131]
s_add_u32 m0, s62, 81920
s_add_u32 s52, s52, 229376
buffer_load_dwordx4 v166, s[28:31], s53 offen lds
v_mfma_f32_16x16x32_bf16 v[144:147], a[56:59], a[12:15], v[144:147]
ds_read_b64_tr_b16 a[56:57], v167 offset:24576
v_mfma_f32_16x16x32_bf16 v[100:103], a[60:63], a[0:3], v[100:103]
ds_read_b64_tr_b16 a[58:59], v167 offset:25600
v_mfma_f32_16x16x32_bf16 v[116:119], a[60:63], a[4:7], v[116:119]
s_setprio 0
v_mfma_f32_16x16x32_bf16 v[132:135], a[60:63], a[8:11], v[132:135]
v_mfma_f32_16x16x32_bf16 v[148:151], a[60:63], a[12:15], v[148:151]
ds_read_b64_tr_b16 a[60:61], v168 offset:24576
v_mfma_f32_16x16x32_bf16 v[104:107], a[64:67], a[0:3], v[104:107]
ds_read_b64_tr_b16 a[62:63], v168 offset:25600
v_mfma_f32_16x16x32_bf16 v[120:123], a[64:67], a[4:7], v[120:123]
v_mfma_f32_16x16x32_bf16 v[136:139], a[64:67], a[8:11], v[136:139]
v_mfma_f32_16x16x32_bf16 v[152:155], a[64:67], a[12:15], v[152:155]
v_mfma_f32_16x16x32_bf16 v[108:111], a[68:71], a[0:3], v[108:111]
v_mfma_f32_16x16x32_bf16 v[124:127], a[68:71], a[4:7], v[124:127]
v_mfma_f32_16x16x32_bf16 v[140:143], a[68:71], a[8:11], v[140:143]
v_mfma_f32_16x16x32_bf16 v[156:159], a[68:71], a[12:15], v[156:159]
s_waitcnt vmcnt(6) lgkmcnt(0)
s_barrier
s_setprio 3
v_mfma_f32_16x16x32_bf16 v[0:3], a[32:35], a[16:19], v[0:3]
ds_read_b128 a[0:3], v160 offset:0
v_mfma_f32_16x16x32_bf16 v[24:27], a[32:35], a[20:23], v[24:27]
ds_read_b128 a[4:7], v160 offset:2048
s_add_u32 m0, s58, 32768
s_add_u32 s53, s53, 229376
buffer_load_dwordx4 v164, s[16:19], s48 offen lds
v_mfma_f32_16x16x32_bf16 v[48:51], a[32:35], a[24:27], v[48:51]
ds_read_b128 a[8:11], v160 offset:4096
v_mfma_f32_16x16x32_bf16 v[72:75], a[32:35], a[28:31], v[72:75]
ds_read_b128 a[12:15], v160 offset:6144
ds_read_b64_tr_b16 a[32:33], v162 offset:0
v_mfma_f32_16x16x32_bf16 v[4:7], a[36:39], a[16:19], v[4:7]
ds_read_b64_tr_b16 a[64:65], v167 offset:4096
ds_read_b64_tr_b16 a[34:35], v162 offset:1024
v_mfma_f32_16x16x32_bf16 v[28:31], a[36:39], a[20:23], v[28:31]
ds_read_b64_tr_b16 a[66:67], v167 offset:5120
v_mfma_f32_16x16x32_bf16 v[52:55], a[36:39], a[24:27], v[52:55]
ds_read_b64_tr_b16 a[68:69], v168 offset:4096
s_add_u32 m0, s58, 33792
s_add_u32 s48, s48, 128
buffer_load_dwordx4 v165, s[16:19], s49 offen lds
v_mfma_f32_16x16x32_bf16 v[76:79], a[36:39], a[28:31], v[76:79]
ds_read_b64_tr_b16 a[70:71], v168 offset:5120
ds_read_b64_tr_b16 a[36:37], v163 offset:0
v_mfma_f32_16x16x32_bf16 v[8:11], a[40:43], a[16:19], v[8:11]
ds_read_b64_tr_b16 a[38:39], v163 offset:1024
v_mfma_f32_16x16x32_bf16 v[32:35], a[40:43], a[20:23], v[32:35]
s_setprio 2
v_mfma_f32_16x16x32_bf16 v[56:59], a[40:43], a[24:27], v[56:59]
v_mfma_f32_16x16x32_bf16 v[80:83], a[40:43], a[28:31], v[80:83]
ds_read_b64_tr_b16 a[40:41], v169 offset:0
s_add_u32 m0, s58, 34816
s_add_u32 s49, s49, 128
buffer_load_dwordx4 v164, s[16:19], s50 offen lds
v_mfma_f32_16x16x32_bf16 v[12:15], a[44:47], a[16:19], v[12:15]
ds_read_b64_tr_b16 a[42:43], v169 offset:512
v_mfma_f32_16x16x32_bf16 v[36:39], a[44:47], a[20:23], v[36:39]
v_mfma_f32_16x16x32_bf16 v[60:63], a[44:47], a[24:27], v[60:63]
v_mfma_f32_16x16x32_bf16 v[84:87], a[44:47], a[28:31], v[84:87]
ds_read_b64_tr_b16 a[44:45], v162 offset:6144
v_mfma_f32_16x16x32_bf16 v[16:19], a[48:51], a[16:19], v[16:19]
ds_read_b64_tr_b16 a[46:47], v162 offset:7168
v_mfma_f32_16x16x32_bf16 v[40:43], a[48:51], a[20:23], v[40:43]
s_add_u32 m0, s58, 35840
s_add_u32 s50, s50, 128
buffer_load_dwordx4 v165, s[16:19], s51 offen lds
v_mfma_f32_16x16x32_bf16 v[64:67], a[48:51], a[24:27], v[64:67]
v_mfma_f32_16x16x32_bf16 v[88:91], a[48:51], a[28:31], v[88:91]
ds_read_b64_tr_b16 a[48:49], v163 offset:6144
s_setprio 1
v_mfma_f32_16x16x32_bf16 v[20:23], a[52:55], a[16:19], v[20:23]
ds_read_b64_tr_b16 a[50:51], v163 offset:7168
v_mfma_f32_16x16x32_bf16 v[44:47], a[52:55], a[20:23], v[44:47]
v_mfma_f32_16x16x32_bf16 v[68:71], a[52:55], a[24:27], v[68:71]
s_add_u32 m0, s57, 135168
s_add_u32 s51, s51, 128
s_mov_b32 exec_hi, 0xffff
buffer_load_dwordx4 v170, s[20:23], s52 offen lds
s_mov_b32 exec_hi, -1
v_mfma_f32_16x16x32_bf16 v[92:95], a[52:55], a[28:31], v[92:95]
ds_read_b64_tr_b16 a[52:53], v169 offset:6144
v_mfma_f32_16x16x32_bf16 v[96:99], a[56:59], a[16:19], v[96:99]
ds_read_b64_tr_b16 a[54:55], v169 offset:6656
v_mfma_f32_16x16x32_bf16 v[112:115], a[56:59], a[20:23], v[112:115]
v_mfma_f32_16x16x32_bf16 v[128:131], a[56:59], a[24:27], v[128:131]
v_mfma_f32_16x16x32_bf16 v[144:147], a[56:59], a[28:31], v[144:147]
ds_read_b64_tr_b16 a[56:57], v167 offset:0
v_mfma_f32_16x16x32_bf16 v[100:103], a[60:63], a[16:19], v[100:103]
ds_read_b64_tr_b16 a[58:59], v167 offset:1024
s_add_u32 m0, s57, 141312
s_mov_b32 exec_hi, 0xffff
buffer_load_dwordx4 v170, s[24:27], s52 offen lds
s_mov_b32 exec_hi, -1
v_mfma_f32_16x16x32_bf16 v[116:119], a[60:63], a[20:23], v[116:119]
s_setprio 0
v_mfma_f32_16x16x32_bf16 v[132:135], a[60:63], a[24:27], v[132:135]
v_mfma_f32_16x16x32_bf16 v[148:151], a[60:63], a[28:31], v[148:151]
ds_read_b64_tr_b16 a[60:61], v168 offset:0
v_mfma_f32_16x16x32_bf16 v[104:107], a[72:75], a[16:19], v[104:107]
ds_read_b64_tr_b16 a[62:63], v168 offset:1024
v_mfma_f32_16x16x32_bf16 v[120:123], a[72:75], a[20:23], v[120:123]
s_add_u32 m0, s62, 90112
s_add_u32 s52, s52, 229376
buffer_load_dwordx4 v166, s[28:31], s53 offen lds
v_mfma_f32_16x16x32_bf16 v[136:139], a[72:75], a[24:27], v[136:139]
v_mfma_f32_16x16x32_bf16 v[152:155], a[72:75], a[28:31], v[152:155]
v_mfma_f32_16x16x32_bf16 v[108:111], a[76:79], a[16:19], v[108:111]
v_mfma_f32_16x16x32_bf16 v[124:127], a[76:79], a[20:23], v[124:127]
v_mfma_f32_16x16x32_bf16 v[140:143], a[76:79], a[24:27], v[140:143]
v_mfma_f32_16x16x32_bf16 v[156:159], a[76:79], a[28:31], v[156:159]
s_waitcnt vmcnt(10) lgkmcnt(0)
s_barrier
s_setprio 3
v_mfma_f32_16x16x32_bf16 v[0:3], a[32:35], a[0:3], v[0:3]
ds_read_b128 a[16:19], v161 offset:0
v_mfma_f32_16x16x32_bf16 v[24:27], a[32:35], a[4:7], v[24:27]
ds_read_b128 a[20:23], v161 offset:2048
s_add_u32 m0, s57, 98304
s_add_u32 s53, s53, 229376
s_mov_b32 exec_hi, 0xffff
buffer_load_dwordx4 v170, s[20:23], s52 offen lds
s_mov_b32 exec_hi, -1
v_mfma_f32_16x16x32_bf16 v[48:51], a[32:35], a[8:11], v[48:51]
ds_read_b128 a[24:27], v161 offset:4096
v_mfma_f32_16x16x32_bf16 v[72:75], a[32:35], a[12:15], v[72:75]
ds_read_b128 a[28:31], v161 offset:6144
ds_read_b64_tr_b16 a[32:33], v162 offset:12288
v_mfma_f32_16x16x32_bf16 v[4:7], a[36:39], a[0:3], v[4:7]
ds_read_b64_tr_b16 a[72:73], v167 offset:12288
ds_read_b64_tr_b16 a[34:35], v162 offset:13312
v_mfma_f32_16x16x32_bf16 v[28:31], a[36:39], a[4:7], v[28:31]
ds_read_b64_tr_b16 a[74:75], v167 offset:13312
v_mfma_f32_16x16x32_bf16 v[52:55], a[36:39], a[8:11], v[52:55]
ds_read_b64_tr_b16 a[76:77], v168 offset:12288
v_mfma_f32_16x16x32_bf16 v[76:79], a[36:39], a[12:15], v[76:79]
ds_read_b64_tr_b16 a[78:79], v168 offset:13312
ds_read_b64_tr_b16 a[36:37], v163 offset:12288
v_mfma_f32_16x16x32_bf16 v[8:11], a[40:43], a[0:3], v[8:11]
ds_read_b64_tr_b16 a[38:39], v163 offset:13312
v_mfma_f32_16x16x32_bf16 v[32:35], a[40:43], a[4:7], v[32:35]
s_setprio 2
v_mfma_f32_16x16x32_bf16 v[56:59], a[40:43], a[8:11], v[56:59]
s_add_u32 m0, s57, 104448
s_mov_b32 exec_hi, 0xffff
buffer_load_dwordx4 v170, s[24:27], s52 offen lds
s_mov_b32 exec_hi, -1
v_mfma_f32_16x16x32_bf16 v[80:83], a[40:43], a[12:15], v[80:83]
ds_read_b64_tr_b16 a[40:41], v169 offset:12288
v_mfma_f32_16x16x32_bf16 v[12:15], a[44:47], a[0:3], v[12:15]
ds_read_b64_tr_b16 a[42:43], v169 offset:12800
v_mfma_f32_16x16x32_bf16 v[36:39], a[44:47], a[4:7], v[36:39]
v_mfma_f32_16x16x32_bf16 v[60:63], a[44:47], a[8:11], v[60:63]
v_mfma_f32_16x16x32_bf16 v[84:87], a[44:47], a[12:15], v[84:87]
ds_read_b64_tr_b16 a[44:45], v162 offset:18432
v_mfma_f32_16x16x32_bf16 v[16:19], a[48:51], a[0:3], v[16:19]
ds_read_b64_tr_b16 a[46:47], v162 offset:19456
v_mfma_f32_16x16x32_bf16 v[40:43], a[48:51], a[4:7], v[40:43]
v_mfma_f32_16x16x32_bf16 v[64:67], a[48:51], a[8:11], v[64:67]
v_mfma_f32_16x16x32_bf16 v[88:91], a[48:51], a[12:15], v[88:91]
ds_read_b64_tr_b16 a[48:49], v163 offset:18432
s_setprio 1
v_mfma_f32_16x16x32_bf16 v[20:23], a[52:55], a[0:3], v[20:23]
ds_read_b64_tr_b16 a[50:51], v163 offset:19456
s_add_u32 m0, s62, 65536
s_add_u32 s52, s52, 229376
buffer_load_dwordx4 v166, s[28:31], s53 offen lds
v_mfma_f32_16x16x32_bf16 v[44:47], a[52:55], a[4:7], v[44:47]
v_mfma_f32_16x16x32_bf16 v[68:71], a[52:55], a[8:11], v[68:71]
v_mfma_f32_16x16x32_bf16 v[92:95], a[52:55], a[12:15], v[92:95]
ds_read_b64_tr_b16 a[52:53], v169 offset:18432
v_mfma_f32_16x16x32_bf16 v[96:99], a[56:59], a[0:3], v[96:99]
ds_read_b64_tr_b16 a[54:55], v169 offset:18944
v_mfma_f32_16x16x32_bf16 v[112:115], a[56:59], a[4:7], v[112:115]
v_mfma_f32_16x16x32_bf16 v[128:131], a[56:59], a[8:11], v[128:131]
v_mfma_f32_16x16x32_bf16 v[144:147], a[56:59], a[12:15], v[144:147]
ds_read_b64_tr_b16 a[56:57], v167 offset:8192
v_mfma_f32_16x16x32_bf16 v[100:103], a[60:63], a[0:3], v[100:103]
ds_read_b64_tr_b16 a[58:59], v167 offset:9216
v_mfma_f32_16x16x32_bf16 v[116:119], a[60:63], a[4:7], v[116:119]
s_cmp_lg_u32 s87, 1
s_cbranch_scc1 k1_kernel_b_2
s_mov_b32 m0, 155648
s_nop 0
buffer_load_dword v173, s[32:35], s76 offen lds
k1_kernel_b_2:
s_add_u32 s76, s76, s59
s_setprio 0
v_mfma_f32_16x16x32_bf16 v[132:135], a[60:63], a[8:11], v[132:135]
v_mfma_f32_16x16x32_bf16 v[148:151], a[60:63], a[12:15], v[148:151]
ds_read_b64_tr_b16 a[60:61], v168 offset:8192
v_mfma_f32_16x16x32_bf16 v[104:107], a[64:67], a[0:3], v[104:107]
ds_read_b64_tr_b16 a[62:63], v168 offset:9216
v_mfma_f32_16x16x32_bf16 v[120:123], a[64:67], a[4:7], v[120:123]
v_mfma_f32_16x16x32_bf16 v[136:139], a[64:67], a[8:11], v[136:139]
v_mfma_f32_16x16x32_bf16 v[152:155], a[64:67], a[12:15], v[152:155]
v_mfma_f32_16x16x32_bf16 v[108:111], a[68:71], a[0:3], v[108:111]
v_mfma_f32_16x16x32_bf16 v[124:127], a[68:71], a[4:7], v[124:127]
v_mfma_f32_16x16x32_bf16 v[140:143], a[68:71], a[8:11], v[140:143]
v_mfma_f32_16x16x32_bf16 v[156:159], a[68:71], a[12:15], v[156:159]
s_waitcnt vmcnt(6) lgkmcnt(0)
s_barrier
s_setprio 3
v_mfma_f32_16x16x32_bf16 v[0:3], a[32:35], a[16:19], v[0:3]
ds_read_b128 a[0:3], v160 offset:32768
v_mfma_f32_16x16x32_bf16 v[24:27], a[32:35], a[20:23], v[24:27]
ds_read_b128 a[4:7], v160 offset:34816
s_add_u32 m0, s58, 0
s_add_u32 s53, s53, 229376
buffer_load_dwordx4 v164, s[16:19], s48 offen lds
v_mfma_f32_16x16x32_bf16 v[48:51], a[32:35], a[24:27], v[48:51]
ds_read_b128 a[8:11], v160 offset:36864
v_mfma_f32_16x16x32_bf16 v[72:75], a[32:35], a[28:31], v[72:75]
ds_read_b128 a[12:15], v160 offset:38912
ds_read_b64_tr_b16 a[32:33], v162 offset:24576
v_mfma_f32_16x16x32_bf16 v[4:7], a[36:39], a[16:19], v[4:7]
ds_read_b64_tr_b16 a[64:65], v167 offset:20480
ds_read_b64_tr_b16 a[34:35], v162 offset:25600
v_mfma_f32_16x16x32_bf16 v[28:31], a[36:39], a[20:23], v[28:31]
ds_read_b64_tr_b16 a[66:67], v167 offset:21504
v_mfma_f32_16x16x32_bf16 v[52:55], a[36:39], a[24:27], v[52:55]
ds_read_b64_tr_b16 a[68:69], v168 offset:20480
s_add_u32 m0, s58, 1024
s_add_u32 s48, s48, 128
buffer_load_dwordx4 v165, s[16:19], s49 offen lds
v_mfma_f32_16x16x32_bf16 v[76:79], a[36:39], a[28:31], v[76:79]
ds_read_b64_tr_b16 a[70:71], v168 offset:21504
ds_read_b64_tr_b16 a[36:37], v163 offset:24576
v_mfma_f32_16x16x32_bf16 v[8:11], a[40:43], a[16:19], v[8:11]
ds_read_b64_tr_b16 a[38:39], v163 offset:25600
v_mfma_f32_16x16x32_bf16 v[32:35], a[40:43], a[20:23], v[32:35]
s_setprio 2
v_mfma_f32_16x16x32_bf16 v[56:59], a[40:43], a[24:27], v[56:59]
v_mfma_f32_16x16x32_bf16 v[80:83], a[40:43], a[28:31], v[80:83]
ds_read_b64_tr_b16 a[40:41], v169 offset:24576
s_add_u32 m0, s58, 2048
s_add_u32 s49, s49, 128
buffer_load_dwordx4 v164, s[16:19], s50 offen lds
v_mfma_f32_16x16x32_bf16 v[12:15], a[44:47], a[16:19], v[12:15]
ds_read_b64_tr_b16 a[42:43], v169 offset:25088
v_mfma_f32_16x16x32_bf16 v[36:39], a[44:47], a[20:23], v[36:39]
v_mfma_f32_16x16x32_bf16 v[60:63], a[44:47], a[24:27], v[60:63]
v_mfma_f32_16x16x32_bf16 v[84:87], a[44:47], a[28:31], v[84:87]
ds_read_b64_tr_b16 a[44:45], v162 offset:30720
v_mfma_f32_16x16x32_bf16 v[16:19], a[48:51], a[16:19], v[16:19]
ds_read_b64_tr_b16 a[46:47], v162 offset:31744
v_mfma_f32_16x16x32_bf16 v[40:43], a[48:51], a[20:23], v[40:43]
s_add_u32 m0, s58, 3072
s_add_u32 s50, s50, 128
buffer_load_dwordx4 v165, s[16:19], s51 offen lds
v_mfma_f32_16x16x32_bf16 v[64:67], a[48:51], a[24:27], v[64:67]
v_mfma_f32_16x16x32_bf16 v[88:91], a[48:51], a[28:31], v[88:91]
ds_read_b64_tr_b16 a[48:49], v163 offset:30720
s_setprio 1
v_mfma_f32_16x16x32_bf16 v[20:23], a[52:55], a[16:19], v[20:23]
ds_read_b64_tr_b16 a[50:51], v163 offset:31744
v_mfma_f32_16x16x32_bf16 v[44:47], a[52:55], a[20:23], v[44:47]
v_mfma_f32_16x16x32_bf16 v[68:71], a[52:55], a[24:27], v[68:71]
s_add_u32 m0, s57, 110592
s_add_u32 s51, s51, 128
s_mov_b32 exec_hi, 0xffff
buffer_load_dwordx4 v170, s[20:23], s52 offen lds
s_mov_b32 exec_hi, -1
v_mfma_f32_16x16x32_bf16 v[92:95], a[52:55], a[28:31], v[92:95]
ds_read_b64_tr_b16 a[52:53], v169 offset:30720
v_mfma_f32_16x16x32_bf16 v[96:99], a[56:59], a[16:19], v[96:99]
ds_read_b64_tr_b16 a[54:55], v169 offset:31232
v_mfma_f32_16x16x32_bf16 v[112:115], a[56:59], a[20:23], v[112:115]
v_mfma_f32_16x16x32_bf16 v[128:131], a[56:59], a[24:27], v[128:131]
v_mfma_f32_16x16x32_bf16 v[144:147], a[56:59], a[28:31], v[144:147]
ds_read_b64_tr_b16 a[56:57], v167 offset:16384
v_mfma_f32_16x16x32_bf16 v[100:103], a[60:63], a[16:19], v[100:103]
ds_read_b64_tr_b16 a[58:59], v167 offset:17408
s_add_u32 m0, s57, 116736
s_mov_b32 exec_hi, 0xffff
buffer_load_dwordx4 v170, s[24:27], s52 offen lds
s_mov_b32 exec_hi, -1
v_mfma_f32_16x16x32_bf16 v[116:119], a[60:63], a[20:23], v[116:119]
s_setprio 0
v_mfma_f32_16x16x32_bf16 v[132:135], a[60:63], a[24:27], v[132:135]
v_mfma_f32_16x16x32_bf16 v[148:151], a[60:63], a[28:31], v[148:151]
ds_read_b64_tr_b16 a[60:61], v168 offset:16384
v_mfma_f32_16x16x32_bf16 v[104:107], a[72:75], a[16:19], v[104:107]
ds_read_b64_tr_b16 a[62:63], v168 offset:17408
v_mfma_f32_16x16x32_bf16 v[120:123], a[72:75], a[20:23], v[120:123]
s_add_u32 m0, s62, 73728
s_add_u32 s52, s52, 229376
buffer_load_dwordx4 v166, s[28:31], s53 offen lds
v_mfma_f32_16x16x32_bf16 v[136:139], a[72:75], a[24:27], v[136:139]
v_mfma_f32_16x16x32_bf16 v[152:155], a[72:75], a[28:31], v[152:155]
v_mfma_f32_16x16x32_bf16 v[108:111], a[76:79], a[16:19], v[108:111]
v_mfma_f32_16x16x32_bf16 v[124:127], a[76:79], a[20:23], v[124:127]
v_mfma_f32_16x16x32_bf16 v[140:143], a[76:79], a[24:27], v[140:143]
v_mfma_f32_16x16x32_bf16 v[156:159], a[76:79], a[28:31], v[156:159]
s_waitcnt vmcnt(10) lgkmcnt(0)
s_barrier
s_setprio 3
v_mfma_f32_16x16x32_bf16 v[0:3], a[32:35], a[0:3], v[0:3]
ds_read_b128 a[16:19], v161 offset:32768
v_mfma_f32_16x16x32_bf16 v[24:27], a[32:35], a[4:7], v[24:27]
ds_read_b128 a[20:23], v161 offset:34816
s_add_u32 m0, s57, 122880
s_add_u32 s53, s53, 229376
s_mov_b32 exec_hi, 0xffff
buffer_load_dwordx4 v170, s[20:23], s52 offen lds
s_mov_b32 exec_hi, -1
v_mfma_f32_16x16x32_bf16 v[48:51], a[32:35], a[8:11], v[48:51]
ds_read_b128 a[24:27], v161 offset:36864
v_mfma_f32_16x16x32_bf16 v[72:75], a[32:35], a[12:15], v[72:75]
ds_read_b128 a[28:31], v161 offset:38912
ds_read_b64_tr_b16 a[32:33], v162 offset:36864
v_mfma_f32_16x16x32_bf16 v[4:7], a[36:39], a[0:3], v[4:7]
ds_read_b64_tr_b16 a[72:73], v167 offset:28672
ds_read_b64_tr_b16 a[34:35], v162 offset:37888
v_mfma_f32_16x16x32_bf16 v[28:31], a[36:39], a[4:7], v[28:31]
ds_read_b64_tr_b16 a[74:75], v167 offset:29696
v_mfma_f32_16x16x32_bf16 v[52:55], a[36:39], a[8:11], v[52:55]
ds_read_b64_tr_b16 a[76:77], v168 offset:28672
v_mfma_f32_16x16x32_bf16 v[76:79], a[36:39], a[12:15], v[76:79]
ds_read_b64_tr_b16 a[78:79], v168 offset:29696
ds_read_b64_tr_b16 a[36:37], v163 offset:36864
v_mfma_f32_16x16x32_bf16 v[8:11], a[40:43], a[0:3], v[8:11]
ds_read_b64_tr_b16 a[38:39], v163 offset:37888
v_mfma_f32_16x16x32_bf16 v[32:35], a[40:43], a[4:7], v[32:35]
s_setprio 2
v_mfma_f32_16x16x32_bf16 v[56:59], a[40:43], a[8:11], v[56:59]
v_mfma_f32_16x16x32_bf16 v[80:83], a[40:43], a[12:15], v[80:83]
ds_read_b64_tr_b16 a[40:41], v169 offset:36864
v_mfma_f32_16x16x32_bf16 v[12:15], a[44:47], a[0:3], v[12:15]
ds_read_b64_tr_b16 a[42:43], v169 offset:37376
v_mfma_f32_16x16x32_bf16 v[36:39], a[44:47], a[4:7], v[36:39]
s_add_u32 m0, s57, 129024
s_mov_b32 exec_hi, 0xffff
buffer_load_dwordx4 v170, s[24:27], s52 offen lds
s_mov_b32 exec_hi, -1
v_mfma_f32_16x16x32_bf16 v[60:63], a[44:47], a[8:11], v[60:63]
v_mfma_f32_16x16x32_bf16 v[84:87], a[44:47], a[12:15], v[84:87]
ds_read_b64_tr_b16 a[44:45], v162 offset:43008
v_mfma_f32_16x16x32_bf16 v[16:19], a[48:51], a[0:3], v[16:19]
ds_read_b64_tr_b16 a[46:47], v162 offset:44032
v_mfma_f32_16x16x32_bf16 v[40:43], a[48:51], a[4:7], v[40:43]
v_mfma_f32_16x16x32_bf16 v[64:67], a[48:51], a[8:11], v[64:67]
v_mfma_f32_16x16x32_bf16 v[88:91], a[48:51], a[12:15], v[88:91]
ds_read_b64_tr_b16 a[48:49], v163 offset:43008
s_setprio 1
v_mfma_f32_16x16x32_bf16 v[20:23], a[52:55], a[0:3], v[20:23]
ds_read_b64_tr_b16 a[50:51], v163 offset:44032
v_mfma_f32_16x16x32_bf16 v[44:47], a[52:55], a[4:7], v[44:47]
v_mfma_f32_16x16x32_bf16 v[68:71], a[52:55], a[8:11], v[68:71]
v_mfma_f32_16x16x32_bf16 v[92:95], a[52:55], a[12:15], v[92:95]
ds_read_b64_tr_b16 a[52:53], v169 offset:43008
v_mfma_f32_16x16x32_bf16 v[96:99], a[56:59], a[0:3], v[96:99]
ds_read_b64_tr_b16 a[54:55], v169 offset:43520
v_mfma_f32_16x16x32_bf16 v[112:115], a[56:59], a[4:7], v[112:115]
v_mfma_f32_16x16x32_bf16 v[128:131], a[56:59], a[8:11], v[128:131]
s_add_u32 m0, s62, 81920
s_add_u32 s52, s52, 229376
buffer_load_dwordx4 v166, s[28:31], s53 offen lds
v_mfma_f32_16x16x32_bf16 v[144:147], a[56:59], a[12:15], v[144:147]
ds_read_b64_tr_b16 a[56:57], v167 offset:24576
v_mfma_f32_16x16x32_bf16 v[100:103], a[60:63], a[0:3], v[100:103]
ds_read_b64_tr_b16 a[58:59], v167 offset:25600
v_mfma_f32_16x16x32_bf16 v[116:119], a[60:63], a[4:7], v[116:119]
s_setprio 0
v_mfma_f32_16x16x32_bf16 v[132:135], a[60:63], a[8:11], v[132:135]
v_mfma_f32_16x16x32_bf16 v[148:151], a[60:63], a[12:15], v[148:151]
ds_read_b64_tr_b16 a[60:61], v168 offset:24576
v_mfma_f32_16x16x32_bf16 v[104:107], a[64:67], a[0:3], v[104:107]
ds_read_b64_tr_b16 a[62:63], v168 offset:25600
v_mfma_f32_16x16x32_bf16 v[120:123], a[64:67], a[4:7], v[120:123]
v_mfma_f32_16x16x32_bf16 v[136:139], a[64:67], a[8:11], v[136:139]
v_mfma_f32_16x16x32_bf16 v[152:155], a[64:67], a[12:15], v[152:155]
v_mfma_f32_16x16x32_bf16 v[108:111], a[68:71], a[0:3], v[108:111]
v_mfma_f32_16x16x32_bf16 v[124:127], a[68:71], a[4:7], v[124:127]
v_mfma_f32_16x16x32_bf16 v[140:143], a[68:71], a[8:11], v[140:143]
v_mfma_f32_16x16x32_bf16 v[156:159], a[68:71], a[12:15], v[156:159]
s_waitcnt vmcnt(6) lgkmcnt(0)
s_barrier
s_setprio 3
v_mfma_f32_16x16x32_bf16 v[0:3], a[32:35], a[16:19], v[0:3]
ds_read_b128 a[0:3], v160 offset:0
v_mfma_f32_16x16x32_bf16 v[24:27], a[32:35], a[20:23], v[24:27]
ds_read_b128 a[4:7], v160 offset:2048
s_add_u32 m0, s58, 32768
s_add_u32 s53, s53, 229376
buffer_load_dwordx4 v164, s[16:19], s48 offen lds
v_mfma_f32_16x16x32_bf16 v[48:51], a[32:35], a[24:27], v[48:51]
ds_read_b128 a[8:11], v160 offset:4096
v_mfma_f32_16x16x32_bf16 v[72:75], a[32:35], a[28:31], v[72:75]
ds_read_b128 a[12:15], v160 offset:6144
ds_read_b64_tr_b16 a[32:33], v162 offset:0
v_mfma_f32_16x16x32_bf16 v[4:7], a[36:39], a[16:19], v[4:7]
ds_read_b64_tr_b16 a[64:65], v167 offset:4096
ds_read_b64_tr_b16 a[34:35], v162 offset:1024
v_mfma_f32_16x16x32_bf16 v[28:31], a[36:39], a[20:23], v[28:31]
ds_read_b64_tr_b16 a[66:67], v167 offset:5120
s_add_u32 m0, s58, 33792
s_add_u32 s48, s48, 128
buffer_load_dwordx4 v165, s[16:19], s49 offen lds
v_mfma_f32_16x16x32_bf16 v[52:55], a[36:39], a[24:27], v[52:55]
ds_read_b64_tr_b16 a[68:69], v168 offset:4096
v_mfma_f32_16x16x32_bf16 v[76:79], a[36:39], a[28:31], v[76:79]
ds_read_b64_tr_b16 a[70:71], v168 offset:5120
ds_read_b64_tr_b16 a[36:37], v163 offset:0
v_mfma_f32_16x16x32_bf16 v[8:11], a[40:43], a[16:19], v[8:11]
ds_read_b64_tr_b16 a[38:39], v163 offset:1024
v_mfma_f32_16x16x32_bf16 v[32:35], a[40:43], a[20:23], v[32:35]
s_setprio 2
v_mfma_f32_16x16x32_bf16 v[56:59], a[40:43], a[24:27], v[56:59]
s_add_u32 m0, s58, 34816
s_add_u32 s49, s49, 128
buffer_load_dwordx4 v164, s[16:19], s50 offen lds
v_mfma_f32_16x16x32_bf16 v[80:83], a[40:43], a[28:31], v[80:83]
ds_read_b64_tr_b16 a[40:41], v169 offset:0
v_mfma_f32_16x16x32_bf16 v[12:15], a[44:47], a[16:19], v[12:15]
ds_read_b64_tr_b16 a[42:43], v169 offset:512
v_mfma_f32_16x16x32_bf16 v[36:39], a[44:47], a[20:23], v[36:39]
v_mfma_f32_16x16x32_bf16 v[60:63], a[44:47], a[24:27], v[60:63]
v_mfma_f32_16x16x32_bf16 v[84:87], a[44:47], a[28:31], v[84:87]
ds_read_b64_tr_b16 a[44:45], v162 offset:6144
s_add_u32 m0, s58, 35840
s_add_u32 s50, s50, 128
buffer_load_dwordx4 v165, s[16:19], s51 offen lds
v_mfma_f32_16x16x32_bf16 v[16:19], a[48:51], a[16:19], v[16:19]
ds_read_b64_tr_b16 a[46:47], v162 offset:7168
v_mfma_f32_16x16x32_bf16 v[40:43], a[48:51], a[20:23], v[40:43]
v_mfma_f32_16x16x32_bf16 v[64:67], a[48:51], a[24:27], v[64:67]
v_mfma_f32_16x16x32_bf16 v[88:91], a[48:51], a[28:31], v[88:91]
ds_read_b64_tr_b16 a[48:49], v163 offset:6144
s_setprio 1
v_mfma_f32_16x16x32_bf16 v[20:23], a[52:55], a[16:19], v[20:23]
ds_read_b64_tr_b16 a[50:51], v163 offset:7168
s_add_u32 m0, s57, 135168
s_add_u32 s51, s51, 128
s_mov_b32 exec_hi, 0xffff
buffer_load_dwordx4 v170, s[20:23], s52 offen lds
s_mov_b32 exec_hi, -1
v_mfma_f32_16x16x32_bf16 v[44:47], a[52:55], a[20:23], v[44:47]
v_mfma_f32_16x16x32_bf16 v[68:71], a[52:55], a[24:27], v[68:71]
v_mfma_f32_16x16x32_bf16 v[92:95], a[52:55], a[28:31], v[92:95]
ds_read_b64_tr_b16 a[52:53], v169 offset:6144
v_mfma_f32_16x16x32_bf16 v[96:99], a[56:59], a[16:19], v[96:99]
ds_read_b64_tr_b16 a[54:55], v169 offset:6656
s_add_u32 m0, s57, 141312
s_mov_b32 exec_hi, 0xffff
buffer_load_dwordx4 v170, s[24:27], s52 offen lds
s_mov_b32 exec_hi, -1
v_mfma_f32_16x16x32_bf16 v[112:115], a[56:59], a[20:23], v[112:115]
v_mfma_f32_16x16x32_bf16 v[128:131], a[56:59], a[24:27], v[128:131]
v_mfma_f32_16x16x32_bf16 v[144:147], a[56:59], a[28:31], v[144:147]
ds_read_b64_tr_b16 a[56:57], v167 offset:0
v_mfma_f32_16x16x32_bf16 v[100:103], a[60:63], a[16:19], v[100:103]
ds_read_b64_tr_b16 a[58:59], v167 offset:1024
v_mfma_f32_16x16x32_bf16 v[116:119], a[60:63], a[20:23], v[116:119]
s_add_u32 m0, s62, 90112
s_add_u32 s52, s52, 229376
buffer_load_dwordx4 v166, s[28:31], s53 offen lds
s_setprio 0
v_mfma_f32_16x16x32_bf16 v[132:135], a[60:63], a[24:27], v[132:135]
v_mfma_f32_16x16x32_bf16 v[148:151], a[60:63], a[28:31], v[148:151]
ds_read_b64_tr_b16 a[60:61], v168 offset:0
v_mfma_f32_16x16x32_bf16 v[104:107], a[72:75], a[16:19], v[104:107]
ds_read_b64_tr_b16 a[62:63], v168 offset:1024
v_mfma_f32_16x16x32_bf16 v[120:123], a[72:75], a[20:23], v[120:123]
v_mfma_f32_16x16x32_bf16 v[136:139], a[72:75], a[24:27], v[136:139]
s_cmp_lg_u32 s87, 2
s_cbranch_scc1 k1_kernel_b_3
s_mov_b32 m0, 155648
s_nop 0
buffer_load_dword v173, s[32:35], s76 offen lds
k1_kernel_b_3:
s_add_u32 s76, s76, s59
v_mfma_f32_16x16x32_bf16 v[152:155], a[72:75], a[28:31], v[152:155]
v_mfma_f32_16x16x32_bf16 v[108:111], a[76:79], a[16:19], v[108:111]
v_mfma_f32_16x16x32_bf16 v[124:127], a[76:79], a[20:23], v[124:127]
v_mfma_f32_16x16x32_bf16 v[140:143], a[76:79], a[24:27], v[140:143]
v_mfma_f32_16x16x32_bf16 v[156:159], a[76:79], a[28:31], v[156:159]
s_waitcnt vmcnt(10) lgkmcnt(0)
s_barrier
s_setprio 3
v_mfma_f32_16x16x32_bf16 v[0:3], a[32:35], a[0:3], v[0:3]
ds_read_b128 a[16:19], v161 offset:0
v_mfma_f32_16x16x32_bf16 v[24:27], a[32:35], a[4:7], v[24:27]
ds_read_b128 a[20:23], v161 offset:2048
s_add_u32 m0, s57, 98304
s_add_u32 s53, s53, 3440640
s_mov_b32 exec_hi, 0xffff
buffer_load_dwordx4 v170, s[20:23], s52 offen lds
s_mov_b32 exec_hi, -1
v_mfma_f32_16x16x32_bf16 v[48:51], a[32:35], a[8:11], v[48:51]
ds_read_b128 a[24:27], v161 offset:4096
v_mfma_f32_16x16x32_bf16 v[72:75], a[32:35], a[12:15], v[72:75]
ds_read_b128 a[28:31], v161 offset:6144
ds_read_b64_tr_b16 a[32:33], v162 offset:12288
v_mfma_f32_16x16x32_bf16 v[4:7], a[36:39], a[0:3], v[4:7]
ds_read_b64_tr_b16 a[72:73], v167 offset:12288
ds_read_b64_tr_b16 a[34:35], v162 offset:13312
v_mfma_f32_16x16x32_bf16 v[28:31], a[36:39], a[4:7], v[28:31]
ds_read_b64_tr_b16 a[74:75], v167 offset:13312
v_mfma_f32_16x16x32_bf16 v[52:55], a[36:39], a[8:11], v[52:55]
ds_read_b64_tr_b16 a[76:77], v168 offset:12288
v_mfma_f32_16x16x32_bf16 v[76:79], a[36:39], a[12:15], v[76:79]
ds_read_b64_tr_b16 a[78:79], v168 offset:13312
ds_read_b64_tr_b16 a[36:37], v163 offset:12288
v_mfma_f32_16x16x32_bf16 v[8:11], a[40:43], a[0:3], v[8:11]
ds_read_b64_tr_b16 a[38:39], v163 offset:13312
v_mfma_f32_16x16x32_bf16 v[32:35], a[40:43], a[4:7], v[32:35]
s_setprio 2
v_mfma_f32_16x16x32_bf16 v[56:59], a[40:43], a[8:11], v[56:59]
v_mfma_f32_16x16x32_bf16 v[80:83], a[40:43], a[12:15], v[80:83]
ds_read_b64_tr_b16 a[40:41], v169 offset:12288
v_mfma_f32_16x16x32_bf16 v[12:15], a[44:47], a[0:3], v[12:15]
ds_read_b64_tr_b16 a[42:43], v169 offset:12800
v_mfma_f32_16x16x32_bf16 v[36:39], a[44:47], a[4:7], v[36:39]
v_mfma_f32_16x16x32_bf16 v[60:63], a[44:47], a[8:11], v[60:63]
v_mfma_f32_16x16x32_bf16 v[84:87], a[44:47], a[12:15], v[84:87]
ds_read_b64_tr_b16 a[44:45], v162 offset:18432
v_mfma_f32_16x16x32_bf16 v[16:19], a[48:51], a[0:3], v[16:19]
ds_read_b64_tr_b16 a[46:47], v162 offset:19456
v_mfma_f32_16x16x32_bf16 v[40:43], a[48:51], a[4:7], v[40:43]
v_mfma_f32_16x16x32_bf16 v[64:67], a[48:51], a[8:11], v[64:67]
v_mfma_f32_16x16x32_bf16 v[88:91], a[48:51], a[12:15], v[88:91]
ds_read_b64_tr_b16 a[48:49], v163 offset:18432
s_setprio 1
v_mfma_f32_16x16x32_bf16 v[20:23], a[52:55], a[0:3], v[20:23]
ds_read_b64_tr_b16 a[50:51], v163 offset:19456
s_add_u32 m0, s57, 104448
s_mov_b32 exec_hi, 0xffff
buffer_load_dwordx4 v170, s[24:27], s52 offen lds
s_mov_b32 exec_hi, -1
v_mfma_f32_16x16x32_bf16 v[44:47], a[52:55], a[4:7], v[44:47]
v_mfma_f32_16x16x32_bf16 v[68:71], a[52:55], a[8:11], v[68:71]
v_mfma_f32_16x16x32_bf16 v[92:95], a[52:55], a[12:15], v[92:95]
ds_read_b64_tr_b16 a[52:53], v169 offset:18432
v_mfma_f32_16x16x32_bf16 v[96:99], a[56:59], a[0:3], v[96:99]
ds_read_b64_tr_b16 a[54:55], v169 offset:18944
v_mfma_f32_16x16x32_bf16 v[112:115], a[56:59], a[4:7], v[112:115]
v_mfma_f32_16x16x32_bf16 v[128:131], a[56:59], a[8:11], v[128:131]
v_mfma_f32_16x16x32_bf16 v[144:147], a[56:59], a[12:15], v[144:147]
ds_read_b64_tr_b16 a[56:57], v167 offset:8192
v_mfma_f32_16x16x32_bf16 v[100:103], a[60:63], a[0:3], v[100:103]
ds_read_b64_tr_b16 a[58:59], v167 offset:9216
v_mfma_f32_16x16x32_bf16 v[116:119], a[60:63], a[4:7], v[116:119]
s_setprio 0
v_mfma_f32_16x16x32_bf16 v[132:135], a[60:63], a[8:11], v[132:135]
v_mfma_f32_16x16x32_bf16 v[148:151], a[60:63], a[12:15], v[148:151]
ds_read_b64_tr_b16 a[60:61], v168 offset:8192
v_mfma_f32_16x16x32_bf16 v[104:107], a[64:67], a[0:3], v[104:107]
ds_read_b64_tr_b16 a[62:63], v168 offset:9216
v_mfma_f32_16x16x32_bf16 v[120:123], a[64:67], a[4:7], v[120:123]
v_mfma_f32_16x16x32_bf16 v[136:139], a[64:67], a[8:11], v[136:139]
v_mfma_f32_16x16x32_bf16 v[152:155], a[64:67], a[12:15], v[152:155]
v_mfma_f32_16x16x32_bf16 v[108:111], a[68:71], a[0:3], v[108:111]
v_mfma_f32_16x16x32_bf16 v[124:127], a[68:71], a[4:7], v[124:127]
v_mfma_f32_16x16x32_bf16 v[140:143], a[68:71], a[8:11], v[140:143]
v_mfma_f32_16x16x32_bf16 v[156:159], a[68:71], a[12:15], v[156:159]
s_waitcnt vmcnt(5) lgkmcnt(0)
s_barrier
s_cmp_lg_u32 s87, 0
s_cbranch_scc1 k1_kernel_b_cnt_sg
v_mov_b32 v174, 1
s_mov_b64 exec, 1
s_and_b32 s90, s2, 63
s_lshl_b32 s90, s90, 2
buffer_atomic_add v174, off, s[96:99], s90 sc1
s_mov_b64 exec, -1
k1_kernel_b_cnt_sg:
s_setprio 3
v_mfma_f32_16x16x32_bf16 v[0:3], a[32:35], a[16:19], v[0:3]
ds_read_b128 a[0:3], v160 offset:32768
v_mfma_f32_16x16x32_bf16 v[24:27], a[32:35], a[20:23], v[24:27]
ds_read_b128 a[4:7], v160 offset:34816
s_add_u32 m0, s58, 0
s_add_u32 s52, s52, 229376
buffer_load_dwordx4 v164, s[16:19], s48 offen lds
v_mfma_f32_16x16x32_bf16 v[48:51], a[32:35], a[24:27], v[48:51]
ds_read_b128 a[8:11], v160 offset:36864
v_mfma_f32_16x16x32_bf16 v[72:75], a[32:35], a[28:31], v[72:75]
ds_read_b128 a[12:15], v160 offset:38912
ds_read_b64_tr_b16 a[32:33], v162 offset:24576
v_mfma_f32_16x16x32_bf16 v[4:7], a[36:39], a[16:19], v[4:7]
ds_read_b64_tr_b16 a[64:65], v167 offset:20480
ds_read_b64_tr_b16 a[34:35], v162 offset:25600
v_mfma_f32_16x16x32_bf16 v[28:31], a[36:39], a[20:23], v[28:31]
ds_read_b64_tr_b16 a[66:67], v167 offset:21504
v_mfma_f32_16x16x32_bf16 v[52:55], a[36:39], a[24:27], v[52:55]
ds_read_b64_tr_b16 a[68:69], v168 offset:20480
v_mfma_f32_16x16x32_bf16 v[76:79], a[36:39], a[28:31], v[76:79]
ds_read_b64_tr_b16 a[70:71], v168 offset:21504
ds_read_b64_tr_b16 a[36:37], v163 offset:24576
s_add_u32 m0, s58, 1024
s_add_u32 s48, s48, 128
buffer_load_dwordx4 v165, s[16:19], s49 offen lds
v_mfma_f32_16x16x32_bf16 v[8:11], a[40:43], a[16:19], v[8:11]
ds_read_b64_tr_b16 a[38:39], v163 offset:25600
v_mfma_f32_16x16x32_bf16 v[32:35], a[40:43], a[20:23], v[32:35]
s_setprio 2
v_mfma_f32_16x16x32_bf16 v[56:59], a[40:43], a[24:27], v[56:59]
v_mfma_f32_16x16x32_bf16 v[80:83], a[40:43], a[28:31], v[80:83]
ds_read_b64_tr_b16 a[40:41], v169 offset:24576
v_mfma_f32_16x16x32_bf16 v[12:15], a[44:47], a[16:19], v[12:15]
ds_read_b64_tr_b16 a[42:43], v169 offset:25088
v_mfma_f32_16x16x32_bf16 v[36:39], a[44:47], a[20:23], v[36:39]
s_add_u32 m0, s58, 2048
s_add_u32 s49, s49, 128
buffer_load_dwordx4 v164, s[16:19], s50 offen lds
v_mfma_f32_16x16x32_bf16 v[60:63], a[44:47], a[24:27], v[60:63]
v_mfma_f32_16x16x32_bf16 v[84:87], a[44:47], a[28:31], v[84:87]
ds_read_b64_tr_b16 a[44:45], v162 offset:30720
v_mfma_f32_16x16x32_bf16 v[16:19], a[48:51], a[16:19], v[16:19]
ds_read_b64_tr_b16 a[46:47], v162 offset:31744
v_mfma_f32_16x16x32_bf16 v[40:43], a[48:51], a[20:23], v[40:43]
v_mfma_f32_16x16x32_bf16 v[64:67], a[48:51], a[24:27], v[64:67]
v_mfma_f32_16x16x32_bf16 v[88:91], a[48:51], a[28:31], v[88:91]
ds_read_b64_tr_b16 a[48:49], v163 offset:30720
s_setprio 1
v_mfma_f32_16x16x32_bf16 v[20:23], a[52:55], a[16:19], v[20:23]
ds_read_b64_tr_b16 a[50:51], v163 offset:31744
s_add_u32 m0, s58, 3072
s_add_u32 s50, s50, 128
buffer_load_dwordx4 v165, s[16:19], s51 offen lds
v_mfma_f32_16x16x32_bf16 v[44:47], a[52:55], a[20:23], v[44:47]
v_mfma_f32_16x16x32_bf16 v[68:71], a[52:55], a[24:27], v[68:71]
v_mfma_f32_16x16x32_bf16 v[92:95], a[52:55], a[28:31], v[92:95]
ds_read_b64_tr_b16 a[52:53], v169 offset:30720
v_mfma_f32_16x16x32_bf16 v[96:99], a[56:59], a[16:19], v[96:99]
ds_read_b64_tr_b16 a[54:55], v169 offset:31232
v_mfma_f32_16x16x32_bf16 v[112:115], a[56:59], a[20:23], v[112:115]
v_mfma_f32_16x16x32_bf16 v[128:131], a[56:59], a[24:27], v[128:131]
s_add_u32 m0, s57, 110592
s_add_u32 s51, s51, 128
s_mov_b32 exec_hi, 0xffff
buffer_load_dwordx4 v170, s[20:23], s52 offen lds
s_mov_b32 exec_hi, -1
v_mfma_f32_16x16x32_bf16 v[144:147], a[56:59], a[28:31], v[144:147]
ds_read_b64_tr_b16 a[56:57], v167 offset:16384
v_mfma_f32_16x16x32_bf16 v[100:103], a[60:63], a[16:19], v[100:103]
ds_read_b64_tr_b16 a[58:59], v167 offset:17408
v_mfma_f32_16x16x32_bf16 v[116:119], a[60:63], a[20:23], v[116:119]
s_setprio 0
v_mfma_f32_16x16x32_bf16 v[132:135], a[60:63], a[24:27], v[132:135]
v_mfma_f32_16x16x32_bf16 v[148:151], a[60:63], a[28:31], v[148:151]
ds_read_b64_tr_b16 a[60:61], v168 offset:16384
v_mfma_f32_16x16x32_bf16 v[104:107], a[72:75], a[16:19], v[104:107]
ds_read_b64_tr_b16 a[62:63], v168 offset:17408
s_add_u32 m0, s57, 116736
s_mov_b32 exec_hi, 0xffff
buffer_load_dwordx4 v170, s[24:27], s52 offen lds
s_mov_b32 exec_hi, -1
v_mfma_f32_16x16x32_bf16 v[120:123], a[72:75], a[20:23], v[120:123]
v_mfma_f32_16x16x32_bf16 v[136:139], a[72:75], a[24:27], v[136:139]
v_mfma_f32_16x16x32_bf16 v[152:155], a[72:75], a[28:31], v[152:155]
v_mfma_f32_16x16x32_bf16 v[108:111], a[76:79], a[16:19], v[108:111]
v_mfma_f32_16x16x32_bf16 v[124:127], a[76:79], a[20:23], v[124:127]
v_mfma_f32_16x16x32_bf16 v[140:143], a[76:79], a[24:27], v[140:143]
v_mfma_f32_16x16x32_bf16 v[156:159], a[76:79], a[28:31], v[156:159]
s_waitcnt vmcnt(8) lgkmcnt(0)
s_barrier
s_setprio 3
v_mfma_f32_16x16x32_bf16 v[0:3], a[32:35], a[0:3], v[0:3]
ds_read_b128 a[16:19], v161 offset:32768
v_mfma_f32_16x16x32_bf16 v[24:27], a[32:35], a[4:7], v[24:27]
ds_read_b128 a[20:23], v161 offset:34816
s_add_u32 m0, s57, 122880
s_add_u32 s52, s52, 229376
s_mov_b32 exec_hi, 0xffff
buffer_load_dwordx4 v170, s[20:23], s52 offen lds
s_mov_b32 exec_hi, -1
v_mfma_f32_16x16x32_bf16 v[48:51], a[32:35], a[8:11], v[48:51]
ds_read_b128 a[24:27], v161 offset:36864
v_mfma_f32_16x16x32_bf16 v[72:75], a[32:35], a[12:15], v[72:75]
ds_read_b128 a[28:31], v161 offset:38912
ds_read_b64_tr_b16 a[32:33], v162 offset:36864
v_mfma_f32_16x16x32_bf16 v[4:7], a[36:39], a[0:3], v[4:7]
ds_read_b64_tr_b16 a[72:73], v167 offset:28672
ds_read_b64_tr_b16 a[34:35], v162 offset:37888
v_mfma_f32_16x16x32_bf16 v[28:31], a[36:39], a[4:7], v[28:31]
ds_read_b64_tr_b16 a[74:75], v167 offset:29696
v_mfma_f32_16x16x32_bf16 v[52:55], a[36:39], a[8:11], v[52:55]
ds_read_b64_tr_b16 a[76:77], v168 offset:28672
v_mfma_f32_16x16x32_bf16 v[76:79], a[36:39], a[12:15], v[76:79]
ds_read_b64_tr_b16 a[78:79], v168 offset:29696
ds_read_b64_tr_b16 a[36:37], v163 offset:36864
v_mfma_f32_16x16x32_bf16 v[8:11], a[40:43], a[0:3], v[8:11]
ds_read_b64_tr_b16 a[38:39], v163 offset:37888
v_mfma_f32_16x16x32_bf16 v[32:35], a[40:43], a[4:7], v[32:35]
s_setprio 2
v_mfma_f32_16x16x32_bf16 v[56:59], a[40:43], a[8:11], v[56:59]
v_mfma_f32_16x16x32_bf16 v[80:83], a[40:43], a[12:15], v[80:83]
ds_read_b64_tr_b16 a[40:41], v169 offset:36864
v_mfma_f32_16x16x32_bf16 v[12:15], a[44:47], a[0:3], v[12:15]
ds_read_b64_tr_b16 a[42:43], v169 offset:37376
v_mfma_f32_16x16x32_bf16 v[36:39], a[44:47], a[4:7], v[36:39]
s_add_u32 m0, s57, 129024
s_mov_b32 exec_hi, 0xffff
buffer_load_dwordx4 v170, s[24:27], s52 offen lds
s_mov_b32 exec_hi, -1
v_mfma_f32_16x16x32_bf16 v[60:63], a[44:47], a[8:11], v[60:63]
v_mfma_f32_16x16x32_bf16 v[84:87], a[44:47], a[12:15], v[84:87]
ds_read_b64_tr_b16 a[44:45], v162 offset:43008
v_mfma_f32_16x16x32_bf16 v[16:19], a[48:51], a[0:3], v[16:19]
ds_read_b64_tr_b16 a[46:47], v162 offset:44032
v_mfma_f32_16x16x32_bf16 v[40:43], a[48:51], a[4:7], v[40:43]
v_mfma_f32_16x16x32_bf16 v[64:67], a[48:51], a[8:11], v[64:67]
v_mfma_f32_16x16x32_bf16 v[88:91], a[48:51], a[12:15], v[88:91]
ds_read_b64_tr_b16 a[48:49], v163 offset:43008
s_setprio 1
v_mfma_f32_16x16x32_bf16 v[20:23], a[52:55], a[0:3], v[20:23]
ds_read_b64_tr_b16 a[50:51], v163 offset:44032
v_mfma_f32_16x16x32_bf16 v[44:47], a[52:55], a[4:7], v[44:47]
v_mfma_f32_16x16x32_bf16 v[68:71], a[52:55], a[8:11], v[68:71]
v_mfma_f32_16x16x32_bf16 v[92:95], a[52:55], a[12:15], v[92:95]
ds_read_b64_tr_b16 a[52:53], v169 offset:43008
v_mfma_f32_16x16x32_bf16 v[96:99], a[56:59], a[0:3], v[96:99]
ds_read_b64_tr_b16 a[54:55], v169 offset:43520
v_mfma_f32_16x16x32_bf16 v[112:115], a[56:59], a[4:7], v[112:115]
v_mfma_f32_16x16x32_bf16 v[128:131], a[56:59], a[8:11], v[128:131]
s_cmp_lg_u32 s87, 3
s_cbranch_scc1 k1_kernel_b_4
s_mov_b32 m0, 155648
s_nop 0
buffer_load_dword v173, s[32:35], s76 offen lds
k1_kernel_b_4:
s_add_u32 s76, s76, s59
v_mfma_f32_16x16x32_bf16 v[144:147], a[56:59], a[12:15], v[144:147]
ds_read_b64_tr_b16 a[56:57], v167 offset:24576
v_mfma_f32_16x16x32_bf16 v[100:103], a[60:63], a[0:3], v[100:103]
ds_read_b64_tr_b16 a[58:59], v167 offset:25600
v_mfma_f32_16x16x32_bf16 v[116:119], a[60:63], a[4:7], v[116:119]
s_setprio 0
v_mfma_f32_16x16x32_bf16 v[132:135], a[60:63], a[8:11], v[132:135]
v_mfma_f32_16x16x32_bf16 v[148:151], a[60:63], a[12:15], v[148:151]
ds_read_b64_tr_b16 a[60:61], v168 offset:24576
v_mfma_f32_16x16x32_bf16 v[104:107], a[64:67], a[0:3], v[104:107]
ds_read_b64_tr_b16 a[62:63], v168 offset:25600
v_mfma_f32_16x16x32_bf16 v[120:123], a[64:67], a[4:7], v[120:123]
v_mfma_f32_16x16x32_bf16 v[136:139], a[64:67], a[8:11], v[136:139]
v_mfma_f32_16x16x32_bf16 v[152:155], a[64:67], a[12:15], v[152:155]
v_mfma_f32_16x16x32_bf16 v[108:111], a[68:71], a[0:3], v[108:111]
v_mfma_f32_16x16x32_bf16 v[124:127], a[68:71], a[4:7], v[124:127]
v_mfma_f32_16x16x32_bf16 v[140:143], a[68:71], a[8:11], v[140:143]
v_mfma_f32_16x16x32_bf16 v[156:159], a[68:71], a[12:15], v[156:159]
s_waitcnt vmcnt(4) lgkmcnt(0)
s_barrier
s_setprio 3
v_mfma_f32_16x16x32_bf16 v[0:3], a[32:35], a[16:19], v[0:3]
ds_read_b128 a[0:3], v160 offset:0
v_mfma_f32_16x16x32_bf16 v[24:27], a[32:35], a[20:23], v[24:27]
ds_read_b128 a[4:7], v160 offset:2048
s_add_u32 m0, s58, 32768
s_add_u32 s52, s52, 229376
buffer_load_dwordx4 v164, s[16:19], s48 offen lds
v_mfma_f32_16x16x32_bf16 v[48:51], a[32:35], a[24:27], v[48:51]
ds_read_b128 a[8:11], v160 offset:4096
v_mfma_f32_16x16x32_bf16 v[72:75], a[32:35], a[28:31], v[72:75]
ds_read_b128 a[12:15], v160 offset:6144
ds_read_b64_tr_b16 a[32:33], v162 offset:0
v_mfma_f32_16x16x32_bf16 v[4:7], a[36:39], a[16:19], v[4:7]
ds_read_b64_tr_b16 a[34:35], v162 offset:1024
v_mfma_f32_16x16x32_bf16 v[28:31], a[36:39], a[20:23], v[28:31]
v_mfma_f32_16x16x32_bf16 v[52:55], a[36:39], a[24:27], v[52:55]
v_mfma_f32_16x16x32_bf16 v[76:79], a[36:39], a[28:31], v[76:79]
ds_read_b64_tr_b16 a[36:37], v163 offset:0
s_add_u32 m0, s58, 33792
s_add_u32 s48, s48, 128
buffer_load_dwordx4 v165, s[16:19], s49 offen lds
v_mfma_f32_16x16x32_bf16 v[8:11], a[40:43], a[16:19], v[8:11]
ds_read_b64_tr_b16 a[38:39], v163 offset:1024
v_mfma_f32_16x16x32_bf16 v[32:35], a[40:43], a[20:23], v[32:35]
s_setprio 2
v_mfma_f32_16x16x32_bf16 v[56:59], a[40:43], a[24:27], v[56:59]
v_mfma_f32_16x16x32_bf16 v[80:83], a[40:43], a[28:31], v[80:83]
ds_read_b64_tr_b16 a[40:41], v169 offset:0
v_mfma_f32_16x16x32_bf16 v[12:15], a[44:47], a[16:19], v[12:15]
ds_read_b64_tr_b16 a[42:43], v169 offset:512
v_mfma_f32_16x16x32_bf16 v[36:39], a[44:47], a[20:23], v[36:39]
s_add_u32 m0, s58, 34816
s_add_u32 s49, s49, 128
buffer_load_dwordx4 v164, s[16:19], s50 offen lds
v_mfma_f32_16x16x32_bf16 v[60:63], a[44:47], a[24:27], v[60:63]
v_mfma_f32_16x16x32_bf16 v[84:87], a[44:47], a[28:31], v[84:87]
ds_read_b64_tr_b16 a[44:45], v162 offset:6144
v_mfma_f32_16x16x32_bf16 v[16:19], a[48:51], a[16:19], v[16:19]
ds_read_b64_tr_b16 a[46:47], v162 offset:7168
v_mfma_f32_16x16x32_bf16 v[40:43], a[48:51], a[20:23], v[40:43]
v_mfma_f32_16x16x32_bf16 v[64:67], a[48:51], a[24:27], v[64:67]
v_mfma_f32_16x16x32_bf16 v[88:91], a[48:51], a[28:31], v[88:91]
ds_read_b64_tr_b16 a[48:49], v163 offset:6144
s_setprio 1
v_mfma_f32_16x16x32_bf16 v[20:23], a[52:55], a[16:19], v[20:23]
ds_read_b64_tr_b16 a[50:51], v163 offset:7168
s_add_u32 m0, s58, 35840
s_add_u32 s50, s50, 128
buffer_load_dwordx4 v165, s[16:19], s51 offen lds
v_mfma_f32_16x16x32_bf16 v[44:47], a[52:55], a[20:23], v[44:47]
v_mfma_f32_16x16x32_bf16 v[68:71], a[52:55], a[24:27], v[68:71]
v_mfma_f32_16x16x32_bf16 v[92:95], a[52:55], a[28:31], v[92:95]
ds_read_b64_tr_b16 a[52:53], v169 offset:6144
v_mfma_f32_16x16x32_bf16 v[96:99], a[56:59], a[16:19], v[96:99]
ds_read_b64_tr_b16 a[54:55], v169 offset:6656
v_mfma_f32_16x16x32_bf16 v[112:115], a[56:59], a[20:23], v[112:115]
v_mfma_f32_16x16x32_bf16 v[128:131], a[56:59], a[24:27], v[128:131]
s_add_u32 m0, s57, 135168
s_add_u32 s51, s51, 128
s_mov_b32 exec_hi, 0xffff
buffer_load_dwordx4 v170, s[20:23], s52 offen lds
s_mov_b32 exec_hi, -1
v_mfma_f32_16x16x32_bf16 v[144:147], a[56:59], a[28:31], v[144:147]
v_mfma_f32_16x16x32_bf16 v[100:103], a[60:63], a[16:19], v[100:103]
v_mfma_f32_16x16x32_bf16 v[116:119], a[60:63], a[20:23], v[116:119]
s_setprio 0
v_mfma_f32_16x16x32_bf16 v[132:135], a[60:63], a[24:27], v[132:135]
v_mfma_f32_16x16x32_bf16 v[148:151], a[60:63], a[28:31], v[148:151]
v_mfma_f32_16x16x32_bf16 v[104:107], a[72:75], a[16:19], v[104:107]
s_add_u32 m0, s57, 141312
s_mov_b32 exec_hi, 0xffff
buffer_load_dwordx4 v170, s[24:27], s52 offen lds
s_mov_b32 exec_hi, -1
v_mfma_f32_16x16x32_bf16 v[120:123], a[72:75], a[20:23], v[120:123]
v_mfma_f32_16x16x32_bf16 v[136:139], a[72:75], a[24:27], v[136:139]
v_mfma_f32_16x16x32_bf16 v[152:155], a[72:75], a[28:31], v[152:155]
v_mfma_f32_16x16x32_bf16 v[108:111], a[76:79], a[16:19], v[108:111]
v_mfma_f32_16x16x32_bf16 v[124:127], a[76:79], a[20:23], v[124:127]
v_mfma_f32_16x16x32_bf16 v[140:143], a[76:79], a[24:27], v[140:143]
v_mfma_f32_16x16x32_bf16 v[156:159], a[76:79], a[28:31], v[156:159]
s_waitcnt vmcnt(8) lgkmcnt(0)
s_barrier
s_setprio 3
v_mfma_f32_16x16x32_bf16 v[0:3], a[32:35], a[0:3], v[0:3]
ds_read_b128 a[16:19], v161 offset:0
v_mfma_f32_16x16x32_bf16 v[24:27], a[32:35], a[4:7], v[24:27]
ds_read_b128 a[20:23], v161 offset:2048
v_mfma_f32_16x16x32_bf16 v[48:51], a[32:35], a[8:11], v[48:51]
ds_read_b128 a[24:27], v161 offset:4096
s_add_u32 m0, s58, 65536
s_add_u32 s52, s52, 229376
buffer_load_dwordx4 v164, s[16:19], s48 offen lds
v_mfma_f32_16x16x32_bf16 v[72:75], a[32:35], a[12:15], v[72:75]
ds_read_b128 a[28:31], v161 offset:6144
v_mfma_f32_16x16x32_bf16 v[4:7], a[36:39], a[0:3], v[4:7]
v_mfma_f32_16x16x32_bf16 v[28:31], a[36:39], a[4:7], v[28:31]
ds_read_b64_tr_b16 a[56:57], v162 offset:12288
s_add_u32 m0, s58, 66560
s_add_u32 s48, s48, 128
buffer_load_dwordx4 v165, s[16:19], s49 offen lds
s_setprio 2
v_mfma_f32_16x16x32_bf16 v[52:55], a[36:39], a[8:11], v[52:55]
ds_read_b64_tr_b16 a[58:59], v162 offset:13312
v_mfma_f32_16x16x32_bf16 v[76:79], a[36:39], a[12:15], v[76:79]
ds_read_b64_tr_b16 a[60:61], v163 offset:12288
v_mfma_f32_16x16x32_bf16 v[8:11], a[40:43], a[0:3], v[8:11]
v_mfma_f32_16x16x32_bf16 v[32:35], a[40:43], a[4:7], v[32:35]
ds_read_b64_tr_b16 a[62:63], v163 offset:13312
s_add_u32 m0, s58, 67584
s_add_u32 s49, s49, 128
buffer_load_dwordx4 v164, s[16:19], s50 offen lds
v_mfma_f32_16x16x32_bf16 v[56:59], a[40:43], a[8:11], v[56:59]
ds_read_b64_tr_b16 a[64:65], v169 offset:12288
v_mfma_f32_16x16x32_bf16 v[80:83], a[40:43], a[12:15], v[80:83]
ds_read_b64_tr_b16 a[66:67], v169 offset:12800
s_setprio 1
v_mfma_f32_16x16x32_bf16 v[12:15], a[44:47], a[0:3], v[12:15]
s_add_u32 m0, s58, 68608
s_add_u32 s50, s50, 128
buffer_load_dwordx4 v165, s[16:19], s51 offen lds
v_mfma_f32_16x16x32_bf16 v[36:39], a[44:47], a[4:7], v[36:39]
ds_read_b64_tr_b16 a[68:69], v162 offset:18432
v_mfma_f32_16x16x32_bf16 v[60:63], a[44:47], a[8:11], v[60:63]
ds_read_b64_tr_b16 a[70:71], v162 offset:19456
v_mfma_f32_16x16x32_bf16 v[84:87], a[44:47], a[12:15], v[84:87]
ds_read_b64_tr_b16 a[72:73], v163 offset:18432
v_mfma_f32_16x16x32_bf16 v[16:19], a[48:51], a[0:3], v[16:19]
s_add_u32 m0, s57, 98304
s_add_u32 s51, s51, 128
s_mov_b32 exec_hi, 0xffff
buffer_load_dwordx4 v170, s[20:23], s52 offen lds
s_mov_b32 exec_hi, -1
v_mfma_f32_16x16x32_bf16 v[40:43], a[48:51], a[4:7], v[40:43]
ds_read_b64_tr_b16 a[74:75], v163 offset:19456
s_setprio 0
v_mfma_f32_16x16x32_bf16 v[64:67], a[48:51], a[8:11], v[64:67]
ds_read_b64_tr_b16 a[76:77], v169 offset:18432
v_mfma_f32_16x16x32_bf16 v[88:91], a[48:51], a[12:15], v[88:91]
ds_read_b64_tr_b16 a[78:79], v169 offset:18944
s_add_u32 m0, s57, 104448
s_mov_b32 exec_hi, 0xffff
buffer_load_dwordx4 v170, s[24:27], s52 offen lds
s_mov_b32 exec_hi, -1
v_mfma_f32_16x16x32_bf16 v[20:23], a[52:55], a[0:3], v[20:23]
v_mfma_f32_16x16x32_bf16 v[44:47], a[52:55], a[4:7], v[44:47]
v_mfma_f32_16x16x32_bf16 v[68:71], a[52:55], a[8:11], v[68:71]
v_mfma_f32_16x16x32_bf16 v[92:95], a[52:55], a[12:15], v[92:95]
s_waitcnt vmcnt(8) lgkmcnt(0)
s_barrier
s_setprio 3
v_mfma_f32_16x16x32_bf16 v[0:3], a[56:59], a[16:19], v[0:3]
ds_read_b128 a[0:3], v160 offset:32768
v_mfma_f32_16x16x32_bf16 v[24:27], a[56:59], a[20:23], v[24:27]
ds_read_b128 a[4:7], v160 offset:34816
v_mfma_f32_16x16x32_bf16 v[48:51], a[56:59], a[24:27], v[48:51]
ds_read_b128 a[8:11], v160 offset:36864
s_add_u32 m0, s58, 0
s_add_u32 s52, s52, 229376
buffer_load_dwordx4 v164, s[16:19], s48 offen lds
v_mfma_f32_16x16x32_bf16 v[72:75], a[56:59], a[28:31], v[72:75]
ds_read_b128 a[12:15], v160 offset:38912
v_mfma_f32_16x16x32_bf16 v[4:7], a[60:63], a[16:19], v[4:7]
v_mfma_f32_16x16x32_bf16 v[28:31], a[60:63], a[20:23], v[28:31]
ds_read_b64_tr_b16 a[32:33], v162 offset:24576
s_setprio 2
v_mfma_f32_16x16x32_bf16 v[52:55], a[60:63], a[24:27], v[52:55]
ds_read_b64_tr_b16 a[34:35], v162 offset:25600
s_add_u32 m0, s58, 1024
s_add_u32 s48, s48, 128
buffer_load_dwordx4 v165, s[16:19], s49 offen lds
v_mfma_f32_16x16x32_bf16 v[76:79], a[60:63], a[28:31], v[76:79]
ds_read_b64_tr_b16 a[36:37], v163 offset:24576
v_mfma_f32_16x16x32_bf16 v[8:11], a[64:67], a[16:19], v[8:11]
v_mfma_f32_16x16x32_bf16 v[32:35], a[64:67], a[20:23], v[32:35]
ds_read_b64_tr_b16 a[38:39], v163 offset:25600
v_mfma_f32_16x16x32_bf16 v[56:59], a[64:67], a[24:27], v[56:59]
ds_read_b64_tr_b16 a[40:41], v169 offset:24576
s_add_u32 m0, s57, 110592
s_add_u32 s49, s49, 128
s_mov_b32 exec_hi, 0xffff
buffer_load_dwordx4 v170, s[20:23], s52 offen lds
s_mov_b32 exec_hi, -1
v_mfma_f32_16x16x32_bf16 v[80:83], a[64:67], a[28:31], v[80:83]
ds_read_b64_tr_b16 a[42:43], v169 offset:25088
s_setprio 1
v_mfma_f32_16x16x32_bf16 v[12:15], a[68:71], a[16:19], v[12:15]
v_mfma_f32_16x16x32_bf16 v[36:39], a[68:71], a[20:23], v[36:39]
ds_read_b64_tr_b16 a[44:45], v162 offset:30720
v_mfma_f32_16x16x32_bf16 v[60:63], a[68:71], a[24:27], v[60:63]
ds_read_b64_tr_b16 a[46:47], v162 offset:31744
s_add_u32 m0, s57, 116736
s_mov_b32 exec_hi, 0xffff
buffer_load_dwordx4 v170, s[24:27], s52 offen lds
s_mov_b32 exec_hi, -1
v_mfma_f32_16x16x32_bf16 v[84:87], a[68:71], a[28:31], v[84:87]
ds_read_b64_tr_b16 a[48:49], v163 offset:30720
v_mfma_f32_16x16x32_bf16 v[16:19], a[72:75], a[16:19], v[16:19]
v_mfma_f32_16x16x32_bf16 v[40:43], a[72:75], a[20:23], v[40:43]
ds_read_b64_tr_b16 a[50:51], v163 offset:31744
s_setprio 0
v_mfma_f32_16x16x32_bf16 v[64:67], a[72:75], a[24:27], v[64:67]
ds_read_b64_tr_b16 a[52:53], v169 offset:30720
s_cmp_lg_u32 s87, 4
s_cbranch_scc1 k1_kernel_b_5
s_mov_b32 m0, 155648
s_nop 0
buffer_load_dword v173, s[32:35], s76 offen lds
k1_kernel_b_5:
s_add_u32 s76, s76, s59
v_mfma_f32_16x16x32_bf16 v[88:91], a[72:75], a[28:31], v[88:91]
ds_read_b64_tr_b16 a[54:55], v169 offset:31232
v_mfma_f32_16x16x32_bf16 v[20:23], a[76:79], a[16:19], v[20:23]
v_mfma_f32_16x16x32_bf16 v[44:47], a[76:79], a[20:23], v[44:47]
v_mfma_f32_16x16x32_bf16 v[68:71], a[76:79], a[24:27], v[68:71]
v_mfma_f32_16x16x32_bf16 v[92:95], a[76:79], a[28:31], v[92:95]
s_waitcnt vmcnt(10) lgkmcnt(0)
s_barrier
s_setprio 3
v_mfma_f32_16x16x32_bf16 v[0:3], a[32:35], a[0:3], v[0:3]
ds_read_b128 a[16:19], v161 offset:32768
v_mfma_f32_16x16x32_bf16 v[24:27], a[32:35], a[4:7], v[24:27]
ds_read_b128 a[20:23], v161 offset:34816
v_mfma_f32_16x16x32_bf16 v[48:51], a[32:35], a[8:11], v[48:51]
ds_read_b128 a[24:27], v161 offset:36864
s_add_u32 m0, s58, 2048
s_add_u32 s52, s52, 229376
buffer_load_dwordx4 v164, s[16:19], s50 offen lds
v_mfma_f32_16x16x32_bf16 v[72:75], a[32:35], a[12:15], v[72:75]
ds_read_b128 a[28:31], v161 offset:38912
v_mfma_f32_16x16x32_bf16 v[4:7], a[36:39], a[0:3], v[4:7]
v_mfma_f32_16x16x32_bf16 v[28:31], a[36:39], a[4:7], v[28:31]
ds_read_b64_tr_b16 a[56:57], v162 offset:36864
s_setprio 2
v_mfma_f32_16x16x32_bf16 v[52:55], a[36:39], a[8:11], v[52:55]
ds_read_b64_tr_b16 a[58:59], v162 offset:37888
v_mfma_f32_16x16x32_bf16 v[76:79], a[36:39], a[12:15], v[76:79]
ds_read_b64_tr_b16 a[60:61], v163 offset:36864
s_add_u32 m0, s58, 3072
s_add_u32 s50, s50, 128
buffer_load_dwordx4 v165, s[16:19], s51 offen lds
v_mfma_f32_16x16x32_bf16 v[8:11], a[40:43], a[0:3], v[8:11]
v_mfma_f32_16x16x32_bf16 v[32:35], a[40:43], a[4:7], v[32:35]
ds_read_b64_tr_b16 a[62:63], v163 offset:37888
v_mfma_f32_16x16x32_bf16 v[56:59], a[40:43], a[8:11], v[56:59]
ds_read_b64_tr_b16 a[64:65], v169 offset:36864
v_mfma_f32_16x16x32_bf16 v[80:83], a[40:43], a[12:15], v[80:83]
ds_read_b64_tr_b16 a[66:67], v169 offset:37376
s_setprio 1
v_mfma_f32_16x16x32_bf16 v[12:15], a[44:47], a[0:3], v[12:15]
s_add_u32 m0, s57, 122880
s_add_u32 s51, s51, 128
s_mov_b32 exec_hi, 0xffff
buffer_load_dwordx4 v170, s[20:23], s52 offen lds
s_mov_b32 exec_hi, -1
v_mfma_f32_16x16x32_bf16 v[36:39], a[44:47], a[4:7], v[36:39]
ds_read_b64_tr_b16 a[68:69], v162 offset:43008
v_mfma_f32_16x16x32_bf16 v[60:63], a[44:47], a[8:11], v[60:63]
ds_read_b64_tr_b16 a[70:71], v162 offset:44032
v_mfma_f32_16x16x32_bf16 v[84:87], a[44:47], a[12:15], v[84:87]
ds_read_b64_tr_b16 a[72:73], v163 offset:43008
v_mfma_f32_16x16x32_bf16 v[16:19], a[48:51], a[0:3], v[16:19]
v_mfma_f32_16x16x32_bf16 v[40:43], a[48:51], a[4:7], v[40:43]
ds_read_b64_tr_b16 a[74:75], v163 offset:44032
s_add_u32 m0, s57, 129024
s_mov_b32 exec_hi, 0xffff
buffer_load_dwordx4 v170, s[24:27], s52 offen lds
s_mov_b32 exec_hi, -1
s_setprio 0
v_mfma_f32_16x16x32_bf16 v[64:67], a[48:51], a[8:11], v[64:67]
ds_read_b64_tr_b16 a[76:77], v169 offset:43008
v_mfma_f32_16x16x32_bf16 v[88:91], a[48:51], a[12:15], v[88:91]
ds_read_b64_tr_b16 a[78:79], v169 offset:43520
v_mfma_f32_16x16x32_bf16 v[20:23], a[52:55], a[0:3], v[20:23]
v_mfma_f32_16x16x32_bf16 v[44:47], a[52:55], a[4:7], v[44:47]
v_mfma_f32_16x16x32_bf16 v[68:71], a[52:55], a[8:11], v[68:71]
v_mfma_f32_16x16x32_bf16 v[92:95], a[52:55], a[12:15], v[92:95]
s_waitcnt vmcnt(8) lgkmcnt(0)
s_barrier
s_setprio 3
v_mfma_f32_16x16x32_bf16 v[0:3], a[56:59], a[16:19], v[0:3]
v_add_u32 v160, 0x8000, v160
v_mfma_f32_16x16x32_bf16 v[24:27], a[56:59], a[20:23], v[24:27]
ds_read_b128 a[0:3], v160 offset:32768
v_mfma_f32_16x16x32_bf16 v[48:51], a[56:59], a[24:27], v[48:51]
ds_read_b128 a[4:7], v160 offset:34816
s_add_u32 m0, s58, 32768
s_add_u32 s52, s52, 229376
buffer_load_dwordx4 v164, s[16:19], s48 offen lds
v_mfma_f32_16x16x32_bf16 v[72:75], a[56:59], a[28:31], v[72:75]
ds_read_b128 a[8:11], v160 offset:36864
v_mfma_f32_16x16x32_bf16 v[4:7], a[60:63], a[16:19], v[4:7]
ds_read_b128 a[12:15], v160 offset:38912
v_mfma_f32_16x16x32_bf16 v[28:31], a[60:63], a[20:23], v[28:31]
s_setprio 2
v_mfma_f32_16x16x32_bf16 v[52:55], a[60:63], a[24:27], v[52:55]
ds_read_b64_tr_b16 a[32:33], v162 offset:0
v_mfma_f32_16x16x32_bf16 v[76:79], a[60:63], a[28:31], v[76:79]
ds_read_b64_tr_b16 a[34:35], v162 offset:1024
s_add_u32 m0, s58, 33792
s_add_u32 s48, s48, 128
buffer_load_dwordx4 v165, s[16:19], s49 offen lds
v_mfma_f32_16x16x32_bf16 v[8:11], a[64:67], a[16:19], v[8:11]
ds_read_b64_tr_b16 a[36:37], v163 offset:0
v_mfma_f32_16x16x32_bf16 v[32:35], a[64:67], a[20:23], v[32:35]
ds_read_b64_tr_b16 a[38:39], v163 offset:1024
v_mfma_f32_16x16x32_bf16 v[56:59], a[64:67], a[24:27], v[56:59]
v_mfma_f32_16x16x32_bf16 v[80:83], a[64:67], a[28:31], v[80:83]
ds_read_b64_tr_b16 a[40:41], v169 offset:0
s_setprio 1
v_mfma_f32_16x16x32_bf16 v[12:15], a[68:71], a[16:19], v[12:15]
ds_read_b64_tr_b16 a[42:43], v169 offset:512
s_add_u32 m0, s57, 135168
s_add_u32 s49, s49, 128
s_mov_b32 exec_hi, 0xffff
buffer_load_dwordx4 v170, s[20:23], s52 offen lds
s_mov_b32 exec_hi, -1
v_mfma_f32_16x16x32_bf16 v[36:39], a[68:71], a[20:23], v[36:39]
ds_read_b64_tr_b16 a[44:45], v162 offset:6144
v_mfma_f32_16x16x32_bf16 v[60:63], a[68:71], a[24:27], v[60:63]
ds_read_b64_tr_b16 a[46:47], v162 offset:7168
v_mfma_f32_16x16x32_bf16 v[84:87], a[68:71], a[28:31], v[84:87]
v_mfma_f32_16x16x32_bf16 v[16:19], a[72:75], a[16:19], v[16:19]
ds_read_b64_tr_b16 a[48:49], v163 offset:6144
v_mfma_f32_16x16x32_bf16 v[40:43], a[72:75], a[20:23], v[40:43]
ds_read_b64_tr_b16 a[50:51], v163 offset:7168
s_add_u32 m0, s57, 141312
s_mov_b32 exec_hi, 0xffff
buffer_load_dwordx4 v170, s[24:27], s52 offen lds
s_mov_b32 exec_hi, -1
s_setprio 0
v_mfma_f32_16x16x32_bf16 v[64:67], a[72:75], a[24:27], v[64:67]
ds_read_b64_tr_b16 a[52:53], v169 offset:6144
v_mfma_f32_16x16x32_bf16 v[88:91], a[72:75], a[28:31], v[88:91]
ds_read_b64_tr_b16 a[54:55], v169 offset:6656
v_mfma_f32_16x16x32_bf16 v[20:23], a[76:79], a[16:19], v[20:23]
v_mfma_f32_16x16x32_bf16 v[44:47], a[76:79], a[20:23], v[44:47]
v_mfma_f32_16x16x32_bf16 v[68:71], a[76:79], a[24:27], v[68:71]
v_mfma_f32_16x16x32_bf16 v[92:95], a[76:79], a[28:31], v[92:95]
s_waitcnt vmcnt(8) lgkmcnt(0)
s_barrier
s_setprio 3
v_mfma_f32_16x16x32_bf16 v[0:3], a[32:35], a[0:3], v[0:3]
v_add_u32 v161, 0x8000, v161
v_mfma_f32_16x16x32_bf16 v[24:27], a[32:35], a[4:7], v[24:27]
ds_read_b128 a[16:19], v161 offset:32768
v_mfma_f32_16x16x32_bf16 v[48:51], a[32:35], a[8:11], v[48:51]
ds_read_b128 a[20:23], v161 offset:34816
s_add_u32 m0, s58, 34816
s_add_u32 s52, s52, 229376
buffer_load_dwordx4 v164, s[16:19], s50 offen lds
v_mfma_f32_16x16x32_bf16 v[72:75], a[32:35], a[12:15], v[72:75]
ds_read_b128 a[24:27], v161 offset:36864
v_mfma_f32_16x16x32_bf16 v[4:7], a[36:39], a[0:3], v[4:7]
ds_read_b128 a[28:31], v161 offset:38912
v_mfma_f32_16x16x32_bf16 v[28:31], a[36:39], a[4:7], v[28:31]
s_setprio 2
v_mfma_f32_16x16x32_bf16 v[52:55], a[36:39], a[8:11], v[52:55]
ds_read_b64_tr_b16 a[56:57], v162 offset:12288
s_add_u32 m0, s58, 35840
s_add_u32 s50, s50, 128
buffer_load_dwordx4 v165, s[16:19], s51 offen lds
v_mfma_f32_16x16x32_bf16 v[76:79], a[36:39], a[12:15], v[76:79]
ds_read_b64_tr_b16 a[58:59], v162 offset:13312
v_mfma_f32_16x16x32_bf16 v[8:11], a[40:43], a[0:3], v[8:11]
ds_read_b64_tr_b16 a[60:61], v163 offset:12288
v_mfma_f32_16x16x32_bf16 v[32:35], a[40:43], a[4:7], v[32:35]
ds_read_b64_tr_b16 a[62:63], v163 offset:13312
v_mfma_f32_16x16x32_bf16 v[56:59], a[40:43], a[8:11], v[56:59]
s_add_u32 m0, s57, 98304
s_add_u32 s51, s51, 128
s_mov_b32 exec_hi, 0xffff
buffer_load_dwordx4 v170, s[20:23], s52 offen lds
s_mov_b32 exec_hi, -1
v_mfma_f32_16x16x32_bf16 v[80:83], a[40:43], a[12:15], v[80:83]
ds_read_b64_tr_b16 a[64:65], v169 offset:12288
s_setprio 1
v_mfma_f32_16x16x32_bf16 v[12:15], a[44:47], a[0:3], v[12:15]
ds_read_b64_tr_b16 a[66:67], v169 offset:12800
v_mfma_f32_16x16x32_bf16 v[36:39], a[44:47], a[4:7], v[36:39]
ds_read_b64_tr_b16 a[68:69], v162 offset:18432
v_mfma_f32_16x16x32_bf16 v[60:63], a[44:47], a[8:11], v[60:63]
ds_read_b64_tr_b16 a[70:71], v162 offset:19456
s_add_u32 m0, s57, 104448
s_mov_b32 exec_hi, 0xffff
buffer_load_dwordx4 v170, s[24:27], s52 offen lds
s_mov_b32 exec_hi, -1
v_mfma_f32_16x16x32_bf16 v[84:87], a[44:47], a[12:15], v[84:87]
v_mfma_f32_16x16x32_bf16 v[16:19], a[48:51], a[0:3], v[16:19]
ds_read_b64_tr_b16 a[72:73], v163 offset:18432
v_mfma_f32_16x16x32_bf16 v[40:43], a[48:51], a[4:7], v[40:43]
ds_read_b64_tr_b16 a[74:75], v163 offset:19456
s_setprio 0
v_mfma_f32_16x16x32_bf16 v[64:67], a[48:51], a[8:11], v[64:67]
ds_read_b64_tr_b16 a[76:77], v169 offset:18432
s_cmp_lg_u32 s87, 5
s_cbranch_scc1 k1_kernel_b_6
s_mov_b32 m0, 155648
s_nop 0
buffer_load_dword v173, s[32:35], s76 offen lds
k1_kernel_b_6:
s_add_u32 s76, s76, s59
v_mfma_f32_16x16x32_bf16 v[88:91], a[48:51], a[12:15], v[88:91]
ds_read_b64_tr_b16 a[78:79], v169 offset:18944
v_mfma_f32_16x16x32_bf16 v[20:23], a[52:55], a[0:3], v[20:23]
v_mfma_f32_16x16x32_bf16 v[44:47], a[52:55], a[4:7], v[44:47]
v_mfma_f32_16x16x32_bf16 v[68:71], a[52:55], a[8:11], v[68:71]
v_mfma_f32_16x16x32_bf16 v[92:95], a[52:55], a[12:15], v[92:95]
s_waitcnt vmcnt(8) lgkmcnt(0)
s_barrier
s_setprio 3
v_mfma_f32_16x16x32_bf16 v[0:3], a[56:59], a[16:19], v[0:3]
v_subrev_u32 v160, 0x8000, v160
v_mfma_f32_16x16x32_bf16 v[24:27], a[56:59], a[20:23], v[24:27]
ds_read_b128 a[0:3], v160 offset:0
v_mfma_f32_16x16x32_bf16 v[48:51], a[56:59], a[24:27], v[48:51]
ds_read_b128 a[4:7], v160 offset:2048
s_add_u32 m0, s58, 65536
s_add_u32 s52, s52, 229376
buffer_load_dwordx4 v164, s[16:19], s48 offen lds
v_mfma_f32_16x16x32_bf16 v[72:75], a[56:59], a[28:31], v[72:75]
ds_read_b128 a[8:11], v160 offset:4096
v_mfma_f32_16x16x32_bf16 v[4:7], a[60:63], a[16:19], v[4:7]
ds_read_b128 a[12:15], v160 offset:6144
v_mfma_f32_16x16x32_bf16 v[28:31], a[60:63], a[20:23], v[28:31]
s_setprio 2
v_mfma_f32_16x16x32_bf16 v[52:55], a[60:63], a[24:27], v[52:55]
ds_read_b64_tr_b16 a[32:33], v162 offset:24576
v_mfma_f32_16x16x32_bf16 v[76:79], a[60:63], a[28:31], v[76:79]
ds_read_b64_tr_b16 a[34:35], v162 offset:25600
s_add_u32 m0, s58, 66560
s_add_u32 s48, s48, 128
buffer_load_dwordx4 v165, s[16:19], s49 offen lds
v_mfma_f32_16x16x32_bf16 v[8:11], a[64:67], a[16:19], v[8:11]
ds_read_b64_tr_b16 a[36:37], v163 offset:24576
v_mfma_f32_16x16x32_bf16 v[32:35], a[64:67], a[20:23], v[32:35]
ds_read_b64_tr_b16 a[38:39], v163 offset:25600
v_mfma_f32_16x16x32_bf16 v[56:59], a[64:67], a[24:27], v[56:59]
v_mfma_f32_16x16x32_bf16 v[80:83], a[64:67], a[28:31], v[80:83]
ds_read_b64_tr_b16 a[40:41], v169 offset:24576
s_setprio 1
v_mfma_f32_16x16x32_bf16 v[12:15], a[68:71], a[16:19], v[12:15]
ds_read_b64_tr_b16 a[42:43], v169 offset:25088
s_add_u32 m0, s57, 110592
s_add_u32 s49, s49, 128
s_mov_b32 exec_hi, 0xffff
buffer_load_dwordx4 v170, s[20:23], s52 offen lds
s_mov_b32 exec_hi, -1
v_mfma_f32_16x16x32_bf16 v[36:39], a[68:71], a[20:23], v[36:39]
ds_read_b64_tr_b16 a[44:45], v162 offset:30720
v_mfma_f32_16x16x32_bf16 v[60:63], a[68:71], a[24:27], v[60:63]
ds_read_b64_tr_b16 a[46:47], v162 offset:31744
v_mfma_f32_16x16x32_bf16 v[84:87], a[68:71], a[28:31], v[84:87]
v_mfma_f32_16x16x32_bf16 v[16:19], a[72:75], a[16:19], v[16:19]
ds_read_b64_tr_b16 a[48:49], v163 offset:30720
v_mfma_f32_16x16x32_bf16 v[40:43], a[72:75], a[20:23], v[40:43]
ds_read_b64_tr_b16 a[50:51], v163 offset:31744
s_add_u32 m0, s57, 116736
s_mov_b32 exec_hi, 0xffff
buffer_load_dwordx4 v170, s[24:27], s52 offen lds
s_mov_b32 exec_hi, -1
s_setprio 0
v_mfma_f32_16x16x32_bf16 v[64:67], a[72:75], a[24:27], v[64:67]
ds_read_b64_tr_b16 a[52:53], v169 offset:30720
v_mfma_f32_16x16x32_bf16 v[88:91], a[72:75], a[28:31], v[88:91]
ds_read_b64_tr_b16 a[54:55], v169 offset:31232
v_mfma_f32_16x16x32_bf16 v[20:23], a[76:79], a[16:19], v[20:23]
v_mfma_f32_16x16x32_bf16 v[44:47], a[76:79], a[20:23], v[44:47]
v_mfma_f32_16x16x32_bf16 v[68:71], a[76:79], a[24:27], v[68:71]
v_mfma_f32_16x16x32_bf16 v[92:95], a[76:79], a[28:31], v[92:95]
s_waitcnt vmcnt(8) lgkmcnt(0)
s_barrier
s_setprio 3
v_mfma_f32_16x16x32_bf16 v[0:3], a[32:35], a[0:3], v[0:3]
v_subrev_u32 v161, 0x8000, v161
v_mfma_f32_16x16x32_bf16 v[24:27], a[32:35], a[4:7], v[24:27]
ds_read_b128 a[16:19], v161 offset:0
v_mfma_f32_16x16x32_bf16 v[48:51], a[32:35], a[8:11], v[48:51]
ds_read_b128 a[20:23], v161 offset:2048
s_add_u32 m0, s58, 67584
s_add_u32 s52, s52, 229376
buffer_load_dwordx4 v164, s[16:19], s50 offen lds
v_mfma_f32_16x16x32_bf16 v[72:75], a[32:35], a[12:15], v[72:75]
ds_read_b128 a[24:27], v161 offset:4096
v_mfma_f32_16x16x32_bf16 v[4:7], a[36:39], a[0:3], v[4:7]
ds_read_b128 a[28:31], v161 offset:6144
v_mfma_f32_16x16x32_bf16 v[28:31], a[36:39], a[4:7], v[28:31]
s_setprio 2
v_mfma_f32_16x16x32_bf16 v[52:55], a[36:39], a[8:11], v[52:55]
ds_read_b64_tr_b16 a[56:57], v162 offset:36864
s_add_u32 m0, s58, 68608
s_add_u32 s50, s50, 128
buffer_load_dwordx4 v165, s[16:19], s51 offen lds
v_mfma_f32_16x16x32_bf16 v[76:79], a[36:39], a[12:15], v[76:79]
ds_read_b64_tr_b16 a[58:59], v162 offset:37888
v_mfma_f32_16x16x32_bf16 v[8:11], a[40:43], a[0:3], v[8:11]
ds_read_b64_tr_b16 a[60:61], v163 offset:36864
v_mfma_f32_16x16x32_bf16 v[32:35], a[40:43], a[4:7], v[32:35]
ds_read_b64_tr_b16 a[62:63], v163 offset:37888
v_mfma_f32_16x16x32_bf16 v[56:59], a[40:43], a[8:11], v[56:59]
s_add_u32 m0, s57, 122880
s_add_u32 s51, s51, 128
s_mov_b32 exec_hi, 0xffff
buffer_load_dwordx4 v170, s[20:23], s52 offen lds
s_mov_b32 exec_hi, -1
v_mfma_f32_16x16x32_bf16 v[80:83], a[40:43], a[12:15], v[80:83]
ds_read_b64_tr_b16 a[64:65], v169 offset:36864
s_setprio 1
v_mfma_f32_16x16x32_bf16 v[12:15], a[44:47], a[0:3], v[12:15]
ds_read_b64_tr_b16 a[66:67], v169 offset:37376
v_mfma_f32_16x16x32_bf16 v[36:39], a[44:47], a[4:7], v[36:39]
ds_read_b64_tr_b16 a[68:69], v162 offset:43008
v_mfma_f32_16x16x32_bf16 v[60:63], a[44:47], a[8:11], v[60:63]
ds_read_b64_tr_b16 a[70:71], v162 offset:44032
s_add_u32 m0, s57, 129024
s_mov_b32 exec_hi, 0xffff
buffer_load_dwordx4 v170, s[24:27], s52 offen lds
s_mov_b32 exec_hi, -1
v_mfma_f32_16x16x32_bf16 v[84:87], a[44:47], a[12:15], v[84:87]
v_mfma_f32_16x16x32_bf16 v[16:19], a[48:51], a[0:3], v[16:19]
ds_read_b64_tr_b16 a[72:73], v163 offset:43008
v_mfma_f32_16x16x32_bf16 v[40:43], a[48:51], a[4:7], v[40:43]
ds_read_b64_tr_b16 a[74:75], v163 offset:44032
s_setprio 0
v_mfma_f32_16x16x32_bf16 v[64:67], a[48:51], a[8:11], v[64:67]
ds_read_b64_tr_b16 a[76:77], v169 offset:43008
s_lshl_b32 s76, s2, 13
s_mov_b32 s32, s60
s_mov_b32 s33, s61
s_mov_b32 s34, 7340032
s_mov_b32 s59, 2097152
s_cmp_lg_u32 s87, 6
s_cbranch_scc1 k1_kernel_b_7
s_mov_b32 m0, 155648
s_nop 0
buffer_load_dword v173, s[32:35], s76 offen lds
k1_kernel_b_7:
s_add_u32 s76, s76, s59
v_mfma_f32_16x16x32_bf16 v[88:91], a[48:51], a[12:15], v[88:91]
ds_read_b64_tr_b16 a[78:79], v169 offset:43520
v_mfma_f32_16x16x32_bf16 v[20:23], a[52:55], a[0:3], v[20:23]
v_mfma_f32_16x16x32_bf16 v[44:47], a[52:55], a[4:7], v[44:47]
v_mfma_f32_16x16x32_bf16 v[68:71], a[52:55], a[8:11], v[68:71]
v_mfma_f32_16x16x32_bf16 v[92:95], a[52:55], a[12:15], v[92:95]
s_waitcnt vmcnt(8) lgkmcnt(0)
s_barrier
s_setprio 3
v_mfma_f32_16x16x32_bf16 v[0:3], a[56:59], a[16:19], v[0:3]
ds_read_b128 a[0:3], v160 offset:32768
v_mfma_f32_16x16x32_bf16 v[24:27], a[56:59], a[20:23], v[24:27]
ds_read_b128 a[4:7], v160 offset:34816
v_mfma_f32_16x16x32_bf16 v[48:51], a[56:59], a[24:27], v[48:51]
ds_read_b128 a[8:11], v160 offset:36864
s_add_u32 m0, s58, 0
s_add_u32 s52, s52, 229376
buffer_load_dwordx4 v164, s[16:19], s48 offen lds
v_mfma_f32_16x16x32_bf16 v[72:75], a[56:59], a[28:31], v[72:75]
ds_read_b128 a[12:15], v160 offset:38912
v_mfma_f32_16x16x32_bf16 v[4:7], a[60:63], a[16:19], v[4:7]
v_mfma_f32_16x16x32_bf16 v[28:31], a[60:63], a[20:23], v[28:31]
ds_read_b64_tr_b16 a[32:33], v162 offset:0
s_setprio 2
v_mfma_f32_16x16x32_bf16 v[52:55], a[60:63], a[24:27], v[52:55]
ds_read_b64_tr_b16 a[34:35], v162 offset:1024
v_mfma_f32_16x16x32_bf16 v[76:79], a[60:63], a[28:31], v[76:79]
ds_read_b64_tr_b16 a[36:37], v163 offset:0
s_add_u32 m0, s58, 1024
s_add_u32 s48, s48, 128
buffer_load_dwordx4 v165, s[16:19], s49 offen lds
v_mfma_f32_16x16x32_bf16 v[8:11], a[64:67], a[16:19], v[8:11]
v_mfma_f32_16x16x32_bf16 v[32:35], a[64:67], a[20:23], v[32:35]
ds_read_b64_tr_b16 a[38:39], v163 offset:1024
v_mfma_f32_16x16x32_bf16 v[56:59], a[64:67], a[24:27], v[56:59]
ds_read_b64_tr_b16 a[40:41], v169 offset:0
v_mfma_f32_16x16x32_bf16 v[80:83], a[64:67], a[28:31], v[80:83]
ds_read_b64_tr_b16 a[42:43], v169 offset:512
s_setprio 1
v_mfma_f32_16x16x32_bf16 v[12:15], a[68:71], a[16:19], v[12:15]
s_add_u32 m0, s57, 135168
s_add_u32 s49, s49, 128
s_mov_b32 exec_hi, 0xffff
buffer_load_dwordx4 v170, s[20:23], s52 offen lds
s_mov_b32 exec_hi, -1
v_mfma_f32_16x16x32_bf16 v[36:39], a[68:71], a[20:23], v[36:39]
ds_read_b64_tr_b16 a[44:45], v162 offset:6144
v_mfma_f32_16x16x32_bf16 v[60:63], a[68:71], a[24:27], v[60:63]
ds_read_b64_tr_b16 a[46:47], v162 offset:7168
v_mfma_f32_16x16x32_bf16 v[84:87], a[68:71], a[28:31], v[84:87]
ds_read_b64_tr_b16 a[48:49], v163 offset:6144
v_mfma_f32_16x16x32_bf16 v[16:19], a[72:75], a[16:19], v[16:19]
v_mfma_f32_16x16x32_bf16 v[40:43], a[72:75], a[20:23], v[40:43]
ds_read_b64_tr_b16 a[50:51], v163 offset:7168
s_add_u32 m0, s57, 141312
s_mov_b32 exec_hi, 0xffff
buffer_load_dwordx4 v170, s[24:27], s52 offen lds
s_mov_b32 exec_hi, -1
s_setprio 0
v_mfma_f32_16x16x32_bf16 v[64:67], a[72:75], a[24:27], v[64:67]
ds_read_b64_tr_b16 a[52:53], v169 offset:6144
v_mfma_f32_16x16x32_bf16 v[88:91], a[72:75], a[28:31], v[88:91]
ds_read_b64_tr_b16 a[54:55], v169 offset:6656
v_mfma_f32_16x16x32_bf16 v[20:23], a[76:79], a[16:19], v[20:23]
v_mfma_f32_16x16x32_bf16 v[44:47], a[76:79], a[20:23], v[44:47]
v_mfma_f32_16x16x32_bf16 v[68:71], a[76:79], a[24:27], v[68:71]
v_mfma_f32_16x16x32_bf16 v[92:95], a[76:79], a[28:31], v[92:95]
s_waitcnt vmcnt(8) lgkmcnt(0)
s_barrier
s_setprio 3
v_mfma_f32_16x16x32_bf16 v[0:3], a[32:35], a[0:3], v[0:3]
ds_read_b128 a[16:19], v161 offset:32768
v_mfma_f32_16x16x32_bf16 v[24:27], a[32:35], a[4:7], v[24:27]
ds_read_b128 a[20:23], v161 offset:34816
v_mfma_f32_16x16x32_bf16 v[48:51], a[32:35], a[8:11], v[48:51]
ds_read_b128 a[24:27], v161 offset:36864
s_add_u32 m0, s58, 2048
s_add_u32 s52, s52, 229376
buffer_load_dwordx4 v164, s[16:19], s50 offen lds
v_mfma_f32_16x16x32_bf16 v[72:75], a[32:35], a[12:15], v[72:75]
ds_read_b128 a[28:31], v161 offset:38912
v_mfma_f32_16x16x32_bf16 v[4:7], a[36:39], a[0:3], v[4:7]
v_mfma_f32_16x16x32_bf16 v[28:31], a[36:39], a[4:7], v[28:31]
ds_read_b64_tr_b16 a[56:57], v162 offset:12288
s_setprio 2
v_mfma_f32_16x16x32_bf16 v[52:55], a[36:39], a[8:11], v[52:55]
ds_read_b64_tr_b16 a[58:59], v162 offset:13312
s_add_u32 m0, s58, 3072
s_add_u32 s50, s50, 128
buffer_load_dwordx4 v165, s[16:19], s51 offen lds
v_mfma_f32_16x16x32_bf16 v[76:79], a[36:39], a[12:15], v[76:79]
ds_read_b64_tr_b16 a[60:61], v163 offset:12288
v_mfma_f32_16x16x32_bf16 v[8:11], a[40:43], a[0:3], v[8:11]
v_mfma_f32_16x16x32_bf16 v[32:35], a[40:43], a[4:7], v[32:35]
ds_read_b64_tr_b16 a[62:63], v163 offset:13312
v_mfma_f32_16x16x32_bf16 v[56:59], a[40:43], a[8:11], v[56:59]
ds_read_b64_tr_b16 a[64:65], v169 offset:12288
s_add_u32 m0, s57, 98304
s_add_u32 s51, s51, 128
s_mov_b32 exec_hi, 0xffff
buffer_load_dwordx4 v170, s[20:23], s52 offen lds
s_mov_b32 exec_hi, -1
v_mfma_f32_16x16x32_bf16 v[80:83], a[40:43], a[12:15], v[80:83]
ds_read_b64_tr_b16 a[66:67], v169 offset:12800
s_setprio 1
v_mfma_f32_16x16x32_bf16 v[12:15], a[44:47], a[0:3], v[12:15]
v_mfma_f32_16x16x32_bf16 v[36:39], a[44:47], a[4:7], v[36:39]
ds_read_b64_tr_b16 a[68:69], v162 offset:18432
v_mfma_f32_16x16x32_bf16 v[60:63], a[44:47], a[8:11], v[60:63]
ds_read_b64_tr_b16 a[70:71], v162 offset:19456
s_add_u32 m0, s57, 104448
s_mov_b32 exec_hi, 0xffff
buffer_load_dwordx4 v170, s[24:27], s52 offen lds
s_mov_b32 exec_hi, -1
v_mfma_f32_16x16x32_bf16 v[84:87], a[44:47], a[12:15], v[84:87]
ds_read_b64_tr_b16 a[72:73], v163 offset:18432
v_mfma_f32_16x16x32_bf16 v[16:19], a[48:51], a[0:3], v[16:19]
v_mfma_f32_16x16x32_bf16 v[40:43], a[48:51], a[4:7], v[40:43]
ds_read_b64_tr_b16 a[74:75], v163 offset:19456
s_setprio 0
v_mfma_f32_16x16x32_bf16 v[64:67], a[48:51], a[8:11], v[64:67]
ds_read_b64_tr_b16 a[76:77], v169 offset:18432
s_cmp_lg_u32 s87, 7
s_cbranch_scc1 k1_kernel_b_8
s_mov_b32 m0, 155648
s_nop 0
buffer_load_dword v173, s[32:35], s76 offen lds
k1_kernel_b_8:
s_add_u32 s76, s76, s59
v_mfma_f32_16x16x32_bf16 v[88:91], a[48:51], a[12:15], v[88:91]
ds_read_b64_tr_b16 a[78:79], v169 offset:18944
v_mfma_f32_16x16x32_bf16 v[20:23], a[52:55], a[0:3], v[20:23]
v_mfma_f32_16x16x32_bf16 v[44:47], a[52:55], a[4:7], v[44:47]
v_mfma_f32_16x16x32_bf16 v[68:71], a[52:55], a[8:11], v[68:71]
v_mfma_f32_16x16x32_bf16 v[92:95], a[52:55], a[12:15], v[92:95]
s_waitcnt vmcnt(8) lgkmcnt(0)
s_barrier
s_setprio 3
v_mfma_f32_16x16x32_bf16 v[0:3], a[56:59], a[16:19], v[0:3]
v_add_u32 v160, 0x8000, v160
v_mfma_f32_16x16x32_bf16 v[24:27], a[56:59], a[20:23], v[24:27]
ds_read_b128 a[0:3], v160 offset:32768
v_mfma_f32_16x16x32_bf16 v[48:51], a[56:59], a[24:27], v[48:51]
ds_read_b128 a[4:7], v160 offset:34816
s_add_u32 m0, s58, 32768
s_add_u32 s52, s52, 229376
buffer_load_dwordx4 v164, s[16:19], s48 offen lds
v_mfma_f32_16x16x32_bf16 v[72:75], a[56:59], a[28:31], v[72:75]
ds_read_b128 a[8:11], v160 offset:36864
v_mfma_f32_16x16x32_bf16 v[4:7], a[60:63], a[16:19], v[4:7]
ds_read_b128 a[12:15], v160 offset:38912
v_mfma_f32_16x16x32_bf16 v[28:31], a[60:63], a[20:23], v[28:31]
s_setprio 2
v_mfma_f32_16x16x32_bf16 v[52:55], a[60:63], a[24:27], v[52:55]
ds_read_b64_tr_b16 a[32:33], v162 offset:24576
v_mfma_f32_16x16x32_bf16 v[76:79], a[60:63], a[28:31], v[76:79]
ds_read_b64_tr_b16 a[34:35], v162 offset:25600
s_add_u32 m0, s58, 33792
s_add_u32 s48, s48, 128
buffer_load_dwordx4 v165, s[16:19], s49 offen lds
v_mfma_f32_16x16x32_bf16 v[8:11], a[64:67], a[16:19], v[8:11]
ds_read_b64_tr_b16 a[36:37], v163 offset:24576
v_mfma_f32_16x16x32_bf16 v[32:35], a[64:67], a[20:23], v[32:35]
ds_read_b64_tr_b16 a[38:39], v163 offset:25600
v_mfma_f32_16x16x32_bf16 v[56:59], a[64:67], a[24:27], v[56:59]
v_mfma_f32_16x16x32_bf16 v[80:83], a[64:67], a[28:31], v[80:83]
ds_read_b64_tr_b16 a[40:41], v169 offset:24576
s_setprio 1
v_mfma_f32_16x16x32_bf16 v[12:15], a[68:71], a[16:19], v[12:15]
ds_read_b64_tr_b16 a[42:43], v169 offset:25088
s_add_u32 m0, s57, 110592
s_add_u32 s49, s49, 128
s_mov_b32 exec_hi, 0xffff
buffer_load_dwordx4 v170, s[20:23], s52 offen lds
s_mov_b32 exec_hi, -1
v_mfma_f32_16x16x32_bf16 v[36:39], a[68:71], a[20:23], v[36:39]
ds_read_b64_tr_b16 a[44:45], v162 offset:30720
v_mfma_f32_16x16x32_bf16 v[60:63], a[68:71], a[24:27], v[60:63]
ds_read_b64_tr_b16 a[46:47], v162 offset:31744
v_mfma_f32_16x16x32_bf16 v[84:87], a[68:71], a[28:31], v[84:87]
v_mfma_f32_16x16x32_bf16 v[16:19], a[72:75], a[16:19], v[16:19]
ds_read_b64_tr_b16 a[48:49], v163 offset:30720
v_mfma_f32_16x16x32_bf16 v[40:43], a[72:75], a[20:23], v[40:43]
ds_read_b64_tr_b16 a[50:51], v163 offset:31744
s_add_u32 m0, s57, 116736
s_mov_b32 exec_hi, 0xffff
buffer_load_dwordx4 v170, s[24:27], s52 offen lds
s_mov_b32 exec_hi, -1
s_setprio 0
v_mfma_f32_16x16x32_bf16 v[64:67], a[72:75], a[24:27], v[64:67]
ds_read_b64_tr_b16 a[52:53], v169 offset:30720
v_mfma_f32_16x16x32_bf16 v[88:91], a[72:75], a[28:31], v[88:91]
ds_read_b64_tr_b16 a[54:55], v169 offset:31232
v_mfma_f32_16x16x32_bf16 v[20:23], a[76:79], a[16:19], v[20:23]
v_mfma_f32_16x16x32_bf16 v[44:47], a[76:79], a[20:23], v[44:47]
v_mfma_f32_16x16x32_bf16 v[68:71], a[76:79], a[24:27], v[68:71]
v_mfma_f32_16x16x32_bf16 v[92:95], a[76:79], a[28:31], v[92:95]
s_waitcnt vmcnt(8) lgkmcnt(0)
s_barrier
s_setprio 3
v_mfma_f32_16x16x32_bf16 v[0:3], a[32:35], a[0:3], v[0:3]
v_add_u32 v161, 0x8000, v161
v_mfma_f32_16x16x32_bf16 v[24:27], a[32:35], a[4:7], v[24:27]
ds_read_b128 a[16:19], v161 offset:32768
v_mfma_f32_16x16x32_bf16 v[48:51], a[32:35], a[8:11], v[48:51]
ds_read_b128 a[20:23], v161 offset:34816
s_add_u32 m0, s58, 34816
s_add_u32 s52, s52, 229376
buffer_load_dwordx4 v164, s[16:19], s50 offen lds
v_mfma_f32_16x16x32_bf16 v[72:75], a[32:35], a[12:15], v[72:75]
ds_read_b128 a[24:27], v161 offset:36864
v_mfma_f32_16x16x32_bf16 v[4:7], a[36:39], a[0:3], v[4:7]
ds_read_b128 a[28:31], v161 offset:38912
v_mfma_f32_16x16x32_bf16 v[28:31], a[36:39], a[4:7], v[28:31]
s_setprio 2
v_mfma_f32_16x16x32_bf16 v[52:55], a[36:39], a[8:11], v[52:55]
ds_read_b64_tr_b16 a[56:57], v162 offset:36864
s_add_u32 m0, s58, 35840
s_add_u32 s50, s50, 128
buffer_load_dwordx4 v165, s[16:19], s51 offen lds
v_mfma_f32_16x16x32_bf16 v[76:79], a[36:39], a[12:15], v[76:79]
ds_read_b64_tr_b16 a[58:59], v162 offset:37888
v_mfma_f32_16x16x32_bf16 v[8:11], a[40:43], a[0:3], v[8:11]
ds_read_b64_tr_b16 a[60:61], v163 offset:36864
v_mfma_f32_16x16x32_bf16 v[32:35], a[40:43], a[4:7], v[32:35]
ds_read_b64_tr_b16 a[62:63], v163 offset:37888
v_mfma_f32_16x16x32_bf16 v[56:59], a[40:43], a[8:11], v[56:59]
s_add_u32 m0, s57, 122880
s_add_u32 s51, s51, 128
s_mov_b32 exec_hi, 0xffff
buffer_load_dwordx4 v170, s[20:23], s52 offen lds
s_mov_b32 exec_hi, -1
v_mfma_f32_16x16x32_bf16 v[80:83], a[40:43], a[12:15], v[80:83]
ds_read_b64_tr_b16 a[64:65], v169 offset:36864
s_setprio 1
v_mfma_f32_16x16x32_bf16 v[12:15], a[44:47], a[0:3], v[12:15]
ds_read_b64_tr_b16 a[66:67], v169 offset:37376
v_mfma_f32_16x16x32_bf16 v[36:39], a[44:47], a[4:7], v[36:39]
ds_read_b64_tr_b16 a[68:69], v162 offset:43008
v_mfma_f32_16x16x32_bf16 v[60:63], a[44:47], a[8:11], v[60:63]
ds_read_b64_tr_b16 a[70:71], v162 offset:44032
s_add_u32 m0, s57, 129024
s_mov_b32 exec_hi, 0xffff
buffer_load_dwordx4 v170, s[24:27], s52 offen lds
s_mov_b32 exec_hi, -1
v_mfma_f32_16x16x32_bf16 v[84:87], a[44:47], a[12:15], v[84:87]
v_mfma_f32_16x16x32_bf16 v[16:19], a[48:51], a[0:3], v[16:19]
ds_read_b64_tr_b16 a[72:73], v163 offset:43008
v_mfma_f32_16x16x32_bf16 v[40:43], a[48:51], a[4:7], v[40:43]
ds_read_b64_tr_b16 a[74:75], v163 offset:44032
s_setprio 0
v_mfma_f32_16x16x32_bf16 v[64:67], a[48:51], a[8:11], v[64:67]
ds_read_b64_tr_b16 a[76:77], v169 offset:43008
s_cmp_lg_u32 s87, 0
s_cbranch_scc1 k1_kernel_b_9
s_mov_b32 m0, 155648
s_nop 0
buffer_load_dword v173, s[32:35], s76 offen lds
k1_kernel_b_9:
s_add_u32 s76, s76, s59
v_mfma_f32_16x16x32_bf16 v[88:91], a[48:51], a[12:15], v[88:91]
ds_read_b64_tr_b16 a[78:79], v169 offset:43520
v_mfma_f32_16x16x32_bf16 v[20:23], a[52:55], a[0:3], v[20:23]
v_mfma_f32_16x16x32_bf16 v[44:47], a[52:55], a[4:7], v[44:47]
v_mfma_f32_16x16x32_bf16 v[68:71], a[52:55], a[8:11], v[68:71]
v_mfma_f32_16x16x32_bf16 v[92:95], a[52:55], a[12:15], v[92:95]
s_waitcnt vmcnt(8) lgkmcnt(0)
s_barrier
s_setprio 3
v_mfma_f32_16x16x32_bf16 v[0:3], a[56:59], a[16:19], v[0:3]
v_subrev_u32 v160, 0x8000, v160
v_mfma_f32_16x16x32_bf16 v[24:27], a[56:59], a[20:23], v[24:27]
ds_read_b128 a[0:3], v160 offset:0
v_mfma_f32_16x16x32_bf16 v[48:51], a[56:59], a[24:27], v[48:51]
ds_read_b128 a[4:7], v160 offset:2048
s_add_u32 m0, s58, 65536
s_add_u32 s52, s52, 229376
buffer_load_dwordx4 v164, s[16:19], s48 offen lds
v_mfma_f32_16x16x32_bf16 v[72:75], a[56:59], a[28:31], v[72:75]
ds_read_b128 a[8:11], v160 offset:4096
v_mfma_f32_16x16x32_bf16 v[4:7], a[60:63], a[16:19], v[4:7]
ds_read_b128 a[12:15], v160 offset:6144
v_mfma_f32_16x16x32_bf16 v[28:31], a[60:63], a[20:23], v[28:31]
s_setprio 2
v_mfma_f32_16x16x32_bf16 v[52:55], a[60:63], a[24:27], v[52:55]
ds_read_b64_tr_b16 a[32:33], v162 offset:0
v_mfma_f32_16x16x32_bf16 v[76:79], a[60:63], a[28:31], v[76:79]
ds_read_b64_tr_b16 a[34:35], v162 offset:1024
s_add_u32 m0, s58, 66560
s_add_u32 s48, s48, 128
buffer_load_dwordx4 v165, s[16:19], s49 offen lds
v_mfma_f32_16x16x32_bf16 v[8:11], a[64:67], a[16:19], v[8:11]
ds_read_b64_tr_b16 a[36:37], v163 offset:0
v_mfma_f32_16x16x32_bf16 v[32:35], a[64:67], a[20:23], v[32:35]
ds_read_b64_tr_b16 a[38:39], v163 offset:1024
v_mfma_f32_16x16x32_bf16 v[56:59], a[64:67], a[24:27], v[56:59]
v_mfma_f32_16x16x32_bf16 v[80:83], a[64:67], a[28:31], v[80:83]
ds_read_b64_tr_b16 a[40:41], v169 offset:0
s_setprio 1
v_mfma_f32_16x16x32_bf16 v[12:15], a[68:71], a[16:19], v[12:15]
ds_read_b64_tr_b16 a[42:43], v169 offset:512
s_add_u32 m0, s57, 135168
s_add_u32 s49, s49, 128
s_mov_b32 exec_hi, 0xffff
buffer_load_dwordx4 v170, s[20:23], s52 offen lds
s_mov_b32 exec_hi, -1
v_mfma_f32_16x16x32_bf16 v[36:39], a[68:71], a[20:23], v[36:39]
ds_read_b64_tr_b16 a[44:45], v162 offset:6144
v_mfma_f32_16x16x32_bf16 v[60:63], a[68:71], a[24:27], v[60:63]
ds_read_b64_tr_b16 a[46:47], v162 offset:7168
v_mfma_f32_16x16x32_bf16 v[84:87], a[68:71], a[28:31], v[84:87]
v_mfma_f32_16x16x32_bf16 v[16:19], a[72:75], a[16:19], v[16:19]
ds_read_b64_tr_b16 a[48:49], v163 offset:6144
v_mfma_f32_16x16x32_bf16 v[40:43], a[72:75], a[20:23], v[40:43]
ds_read_b64_tr_b16 a[50:51], v163 offset:7168
s_add_u32 m0, s57, 141312
s_mov_b32 exec_hi, 0xffff
buffer_load_dwordx4 v170, s[24:27], s52 offen lds
s_mov_b32 exec_hi, -1
s_setprio 0
v_mfma_f32_16x16x32_bf16 v[64:67], a[72:75], a[24:27], v[64:67]
ds_read_b64_tr_b16 a[52:53], v169 offset:6144
v_mfma_f32_16x16x32_bf16 v[88:91], a[72:75], a[28:31], v[88:91]
ds_read_b64_tr_b16 a[54:55], v169 offset:6656
v_mfma_f32_16x16x32_bf16 v[20:23], a[76:79], a[16:19], v[20:23]
v_mfma_f32_16x16x32_bf16 v[44:47], a[76:79], a[20:23], v[44:47]
v_mfma_f32_16x16x32_bf16 v[68:71], a[76:79], a[24:27], v[68:71]
v_mfma_f32_16x16x32_bf16 v[92:95], a[76:79], a[28:31], v[92:95]
s_waitcnt vmcnt(8) lgkmcnt(0)
s_barrier
s_setprio 3
v_mfma_f32_16x16x32_bf16 v[0:3], a[32:35], a[0:3], v[0:3]
v_subrev_u32 v161, 0x8000, v161
v_mfma_f32_16x16x32_bf16 v[24:27], a[32:35], a[4:7], v[24:27]
ds_read_b128 a[16:19], v161 offset:0
v_mfma_f32_16x16x32_bf16 v[48:51], a[32:35], a[8:11], v[48:51]
ds_read_b128 a[20:23], v161 offset:2048
s_add_u32 m0, s58, 67584
s_add_u32 s52, s52, 229376
buffer_load_dwordx4 v164, s[16:19], s50 offen lds
v_mfma_f32_16x16x32_bf16 v[72:75], a[32:35], a[12:15], v[72:75]
ds_read_b128 a[24:27], v161 offset:4096
v_mfma_f32_16x16x32_bf16 v[4:7], a[36:39], a[0:3], v[4:7]
ds_read_b128 a[28:31], v161 offset:6144
v_mfma_f32_16x16x32_bf16 v[28:31], a[36:39], a[4:7], v[28:31]
s_setprio 2
v_mfma_f32_16x16x32_bf16 v[52:55], a[36:39], a[8:11], v[52:55]
ds_read_b64_tr_b16 a[56:57], v162 offset:12288
s_add_u32 m0, s58, 68608
s_add_u32 s50, s50, 128
buffer_load_dwordx4 v165, s[16:19], s51 offen lds
v_mfma_f32_16x16x32_bf16 v[76:79], a[36:39], a[12:15], v[76:79]
ds_read_b64_tr_b16 a[58:59], v162 offset:13312
v_mfma_f32_16x16x32_bf16 v[8:11], a[40:43], a[0:3], v[8:11]
ds_read_b64_tr_b16 a[60:61], v163 offset:12288
v_mfma_f32_16x16x32_bf16 v[32:35], a[40:43], a[4:7], v[32:35]
ds_read_b64_tr_b16 a[62:63], v163 offset:13312
v_mfma_f32_16x16x32_bf16 v[56:59], a[40:43], a[8:11], v[56:59]
s_add_u32 m0, s57, 98304
s_add_u32 s51, s51, 128
s_mov_b32 exec_hi, 0xffff
buffer_load_dwordx4 v170, s[20:23], s52 offen lds
s_mov_b32 exec_hi, -1
v_mfma_f32_16x16x32_bf16 v[80:83], a[40:43], a[12:15], v[80:83]
ds_read_b64_tr_b16 a[64:65], v169 offset:12288
s_setprio 1
v_mfma_f32_16x16x32_bf16 v[12:15], a[44:47], a[0:3], v[12:15]
ds_read_b64_tr_b16 a[66:67], v169 offset:12800
v_mfma_f32_16x16x32_bf16 v[36:39], a[44:47], a[4:7], v[36:39]
ds_read_b64_tr_b16 a[68:69], v162 offset:18432
v_mfma_f32_16x16x32_bf16 v[60:63], a[44:47], a[8:11], v[60:63]
ds_read_b64_tr_b16 a[70:71], v162 offset:19456
s_add_u32 m0, s57, 104448
s_mov_b32 exec_hi, 0xffff
buffer_load_dwordx4 v170, s[24:27], s52 offen lds
s_mov_b32 exec_hi, -1
v_mfma_f32_16x16x32_bf16 v[84:87], a[44:47], a[12:15], v[84:87]
v_mfma_f32_16x16x32_bf16 v[16:19], a[48:51], a[0:3], v[16:19]
ds_read_b64_tr_b16 a[72:73], v163 offset:18432
v_mfma_f32_16x16x32_bf16 v[40:43], a[48:51], a[4:7], v[40:43]
ds_read_b64_tr_b16 a[74:75], v163 offset:19456
s_setprio 0
v_mfma_f32_16x16x32_bf16 v[64:67], a[48:51], a[8:11], v[64:67]
ds_read_b64_tr_b16 a[76:77], v169 offset:18432
s_cmp_lg_u32 s87, 1
s_cbranch_scc1 k1_kernel_b_10
s_mov_b32 m0, 155648
s_nop 0
buffer_load_dword v173, s[32:35], s76 offen lds
k1_kernel_b_10:
s_add_u32 s76, s76, s59
v_mfma_f32_16x16x32_bf16 v[88:91], a[48:51], a[12:15], v[88:91]
ds_read_b64_tr_b16 a[78:79], v169 offset:18944
v_mfma_f32_16x16x32_bf16 v[20:23], a[52:55], a[0:3], v[20:23]
v_mfma_f32_16x16x32_bf16 v[44:47], a[52:55], a[4:7], v[44:47]
v_mfma_f32_16x16x32_bf16 v[68:71], a[52:55], a[8:11], v[68:71]
v_mfma_f32_16x16x32_bf16 v[92:95], a[52:55], a[12:15], v[92:95]
s_waitcnt vmcnt(8) lgkmcnt(0)
s_barrier
s_setprio 3
v_mfma_f32_16x16x32_bf16 v[0:3], a[56:59], a[16:19], v[0:3]
ds_read_b128 a[0:3], v160 offset:32768
v_mfma_f32_16x16x32_bf16 v[24:27], a[56:59], a[20:23], v[24:27]
ds_read_b128 a[4:7], v160 offset:34816
v_mfma_f32_16x16x32_bf16 v[48:51], a[56:59], a[24:27], v[48:51]
ds_read_b128 a[8:11], v160 offset:36864
s_add_u32 m0, s58, 0
s_add_u32 s52, s52, 229376
buffer_load_dwordx4 v164, s[16:19], s48 offen lds
v_mfma_f32_16x16x32_bf16 v[72:75], a[56:59], a[28:31], v[72:75]
ds_read_b128 a[12:15], v160 offset:38912
v_mfma_f32_16x16x32_bf16 v[4:7], a[60:63], a[16:19], v[4:7]
v_mfma_f32_16x16x32_bf16 v[28:31], a[60:63], a[20:23], v[28:31]
ds_read_b64_tr_b16 a[32:33], v162 offset:24576
s_setprio 2
v_mfma_f32_16x16x32_bf16 v[52:55], a[60:63], a[24:27], v[52:55]
ds_read_b64_tr_b16 a[34:35], v162 offset:25600
v_mfma_f32_16x16x32_bf16 v[76:79], a[60:63], a[28:31], v[76:79]
ds_read_b64_tr_b16 a[36:37], v163 offset:24576
s_add_u32 m0, s58, 1024
s_sub_u32 s48, s48, 1152
buffer_load_dwordx4 v165, s[16:19], s49 offen lds
v_mfma_f32_16x16x32_bf16 v[8:11], a[64:67], a[16:19], v[8:11]
v_mfma_f32_16x16x32_bf16 v[32:35], a[64:67], a[20:23], v[32:35]
ds_read_b64_tr_b16 a[38:39], v163 offset:25600
v_mfma_f32_16x16x32_bf16 v[56:59], a[64:67], a[24:27], v[56:59]
ds_read_b64_tr_b16 a[40:41], v169 offset:24576
v_mfma_f32_16x16x32_bf16 v[80:83], a[64:67], a[28:31], v[80:83]
ds_read_b64_tr_b16 a[42:43], v169 offset:25088
s_setprio 1
v_mfma_f32_16x16x32_bf16 v[12:15], a[68:71], a[16:19], v[12:15]
s_add_u32 m0, s57, 110592
s_sub_u32 s49, s49, 1152
s_mov_b32 exec_hi, 0xffff
buffer_load_dwordx4 v170, s[20:23], s52 offen lds
s_mov_b32 exec_hi, -1
v_mfma_f32_16x16x32_bf16 v[36:39], a[68:71], a[20:23], v[36:39]
ds_read_b64_tr_b16 a[44:45], v162 offset:30720
v_mfma_f32_16x16x32_bf16 v[60:63], a[68:71], a[24:27], v[60:63]
ds_read_b64_tr_b16 a[46:47], v162 offset:31744
v_mfma_f32_16x16x32_bf16 v[84:87], a[68:71], a[28:31], v[84:87]
ds_read_b64_tr_b16 a[48:49], v163 offset:30720
v_mfma_f32_16x16x32_bf16 v[16:19], a[72:75], a[16:19], v[16:19]
v_mfma_f32_16x16x32_bf16 v[40:43], a[72:75], a[20:23], v[40:43]
ds_read_b64_tr_b16 a[50:51], v163 offset:31744
s_add_u32 m0, s57, 116736
s_mov_b32 exec_hi, 0xffff
buffer_load_dwordx4 v170, s[24:27], s52 offen lds
s_mov_b32 exec_hi, -1
s_setprio 0
v_mfma_f32_16x16x32_bf16 v[64:67], a[72:75], a[24:27], v[64:67]
ds_read_b64_tr_b16 a[52:53], v169 offset:30720
v_mfma_f32_16x16x32_bf16 v[88:91], a[72:75], a[28:31], v[88:91]
ds_read_b64_tr_b16 a[54:55], v169 offset:31232
v_mfma_f32_16x16x32_bf16 v[20:23], a[76:79], a[16:19], v[20:23]
v_mfma_f32_16x16x32_bf16 v[44:47], a[76:79], a[20:23], v[44:47]
v_mfma_f32_16x16x32_bf16 v[68:71], a[76:79], a[24:27], v[68:71]
v_mfma_f32_16x16x32_bf16 v[92:95], a[76:79], a[28:31], v[92:95]
s_waitcnt vmcnt(8) lgkmcnt(0)
s_barrier
s_setprio 3
v_mfma_f32_16x16x32_bf16 v[0:3], a[32:35], a[0:3], v[0:3]
ds_read_b128 a[16:19], v161 offset:32768
v_mfma_f32_16x16x32_bf16 v[24:27], a[32:35], a[4:7], v[24:27]
ds_read_b128 a[20:23], v161 offset:34816
v_mfma_f32_16x16x32_bf16 v[48:51], a[32:35], a[8:11], v[48:51]
ds_read_b128 a[24:27], v161 offset:36864
s_add_u32 m0, s58, 2048
s_add_u32 s52, s52, 229376
buffer_load_dwordx4 v164, s[16:19], s50 offen lds
v_mfma_f32_16x16x32_bf16 v[72:75], a[32:35], a[12:15], v[72:75]
ds_read_b128 a[28:31], v161 offset:38912
v_mfma_f32_16x16x32_bf16 v[4:7], a[36:39], a[0:3], v[4:7]
v_mfma_f32_16x16x32_bf16 v[28:31], a[36:39], a[4:7], v[28:31]
ds_read_b64_tr_b16 a[56:57], v162 offset:36864
s_setprio 2
v_mfma_f32_16x16x32_bf16 v[52:55], a[36:39], a[8:11], v[52:55]
ds_read_b64_tr_b16 a[58:59], v162 offset:37888
s_add_u32 m0, s58, 3072
s_sub_u32 s50, s50, 1152
buffer_load_dwordx4 v165, s[16:19], s51 offen lds
v_mfma_f32_16x16x32_bf16 v[76:79], a[36:39], a[12:15], v[76:79]
ds_read_b64_tr_b16 a[60:61], v163 offset:36864
v_mfma_f32_16x16x32_bf16 v[8:11], a[40:43], a[0:3], v[8:11]
v_mfma_f32_16x16x32_bf16 v[32:35], a[40:43], a[4:7], v[32:35]
ds_read_b64_tr_b16 a[62:63], v163 offset:37888
v_mfma_f32_16x16x32_bf16 v[56:59], a[40:43], a[8:11], v[56:59]
ds_read_b64_tr_b16 a[64:65], v169 offset:36864
s_add_u32 m0, s57, 122880
s_sub_u32 s51, s51, 1152
s_mov_b32 exec_hi, 0xffff
buffer_load_dwordx4 v170, s[20:23], s52 offen lds
s_mov_b32 exec_hi, -1
v_mfma_f32_16x16x32_bf16 v[80:83], a[40:43], a[12:15], v[80:83]
ds_read_b64_tr_b16 a[66:67], v169 offset:37376
s_setprio 1
v_mfma_f32_16x16x32_bf16 v[12:15], a[44:47], a[0:3], v[12:15]
v_mfma_f32_16x16x32_bf16 v[36:39], a[44:47], a[4:7], v[36:39]
ds_read_b64_tr_b16 a[68:69], v162 offset:43008
v_mfma_f32_16x16x32_bf16 v[60:63], a[44:47], a[8:11], v[60:63]
ds_read_b64_tr_b16 a[70:71], v162 offset:44032
s_add_u32 m0, s57, 129024
s_mov_b32 exec_hi, 0xffff
buffer_load_dwordx4 v170, s[24:27], s52 offen lds
s_mov_b32 exec_hi, -1
v_mfma_f32_16x16x32_bf16 v[84:87], a[44:47], a[12:15], v[84:87]
ds_read_b64_tr_b16 a[72:73], v163 offset:43008
v_mfma_f32_16x16x32_bf16 v[16:19], a[48:51], a[0:3], v[16:19]
v_mfma_f32_16x16x32_bf16 v[40:43], a[48:51], a[4:7], v[40:43]
ds_read_b64_tr_b16 a[74:75], v163 offset:44032
s_setprio 0
v_mfma_f32_16x16x32_bf16 v[64:67], a[48:51], a[8:11], v[64:67]
ds_read_b64_tr_b16 a[76:77], v169 offset:43008
s_lshl_b32 s76, s2, 13
s_mov_b32 s32, s10
s_mov_b32 s33, s11
s_mov_b32 s34, 2097152
s_cmp_lg_u32 s87, 2
s_cbranch_scc1 k1_kernel_b_11
s_mov_b32 m0, 155648
s_nop 0
buffer_load_dword v173, s[32:35], s76 offen lds
k1_kernel_b_11:
s_add_u32 s76, s76, s59
v_mfma_f32_16x16x32_bf16 v[88:91], a[48:51], a[12:15], v[88:91]
ds_read_b64_tr_b16 a[78:79], v169 offset:43520
v_mfma_f32_16x16x32_bf16 v[20:23], a[52:55], a[0:3], v[20:23]
v_mfma_f32_16x16x32_bf16 v[44:47], a[52:55], a[4:7], v[44:47]
v_mfma_f32_16x16x32_bf16 v[68:71], a[52:55], a[8:11], v[68:71]
v_mfma_f32_16x16x32_bf16 v[92:95], a[52:55], a[12:15], v[92:95]
s_waitcnt vmcnt(8) lgkmcnt(0)
s_barrier
s_setprio 3
v_mfma_f32_16x16x32_bf16 v[0:3], a[56:59], a[16:19], v[0:3]
v_add_u32 v160, 0x8000, v160
v_mfma_f32_16x16x32_bf16 v[24:27], a[56:59], a[20:23], v[24:27]
ds_read_b128 a[0:3], v160 offset:32768
v_mfma_f32_16x16x32_bf16 v[48:51], a[56:59], a[24:27], v[48:51]
ds_read_b128 a[4:7], v160 offset:34816
s_add_u32 m0, s57, 135168
s_add_u32 s52, s52, 229376
s_mov_b32 exec_hi, 0xffff
buffer_load_dwordx4 v170, s[20:23], s52 offen lds
s_mov_b32 exec_hi, -1
v_mfma_f32_16x16x32_bf16 v[72:75], a[56:59], a[28:31], v[72:75]
ds_read_b128 a[8:11], v160 offset:36864
v_mfma_f32_16x16x32_bf16 v[4:7], a[60:63], a[16:19], v[4:7]
ds_read_b128 a[12:15], v160 offset:38912
v_mfma_f32_16x16x32_bf16 v[28:31], a[60:63], a[20:23], v[28:31]
s_setprio 2
v_mfma_f32_16x16x32_bf16 v[52:55], a[60:63], a[24:27], v[52:55]
ds_read_b64_tr_b16 a[32:33], v162 offset:0
v_mfma_f32_16x16x32_bf16 v[76:79], a[60:63], a[28:31], v[76:79]
ds_read_b64_tr_b16 a[34:35], v162 offset:1024
v_mfma_f32_16x16x32_bf16 v[8:11], a[64:67], a[16:19], v[8:11]
ds_read_b64_tr_b16 a[36:37], v163 offset:0
v_mfma_f32_16x16x32_bf16 v[32:35], a[64:67], a[20:23], v[32:35]
ds_read_b64_tr_b16 a[38:39], v163 offset:1024
s_add_u32 m0, s57, 141312
s_mov_b32 exec_hi, 0xffff
buffer_load_dwordx4 v170, s[24:27], s52 offen lds
s_mov_b32 exec_hi, -1
v_mfma_f32_16x16x32_bf16 v[56:59], a[64:67], a[24:27], v[56:59]
v_mfma_f32_16x16x32_bf16 v[80:83], a[64:67], a[28:31], v[80:83]
ds_read_b64_tr_b16 a[40:41], v169 offset:0
s_setprio 1
v_mfma_f32_16x16x32_bf16 v[12:15], a[68:71], a[16:19], v[12:15]
ds_read_b64_tr_b16 a[42:43], v169 offset:512
v_mfma_f32_16x16x32_bf16 v[36:39], a[68:71], a[20:23], v[36:39]
ds_read_b64_tr_b16 a[44:45], v162 offset:6144
v_mfma_f32_16x16x32_bf16 v[60:63], a[68:71], a[24:27], v[60:63]
ds_read_b64_tr_b16 a[46:47], v162 offset:7168
v_mfma_f32_16x16x32_bf16 v[84:87], a[68:71], a[28:31], v[84:87]
v_mfma_f32_16x16x32_bf16 v[16:19], a[72:75], a[16:19], v[16:19]
ds_read_b64_tr_b16 a[48:49], v163 offset:6144
s_mov_b32 s32, s46
s_mov_b32 s33, s47
s_mov_b32 s34, 0x400000
s_cmp_lg_u32 s87, 5
s_cbranch_scc1 k1_kernel_b_12
s_mov_b32 m0, 155648
s_nop 0
buffer_load_dword off, s[32:35], s95 lds
k1_kernel_b_12:
v_mfma_f32_16x16x32_bf16 v[40:43], a[72:75], a[20:23], v[40:43]
ds_read_b64_tr_b16 a[50:51], v163 offset:7168
s_setprio 0
v_mfma_f32_16x16x32_bf16 v[64:67], a[72:75], a[24:27], v[64:67]
ds_read_b64_tr_b16 a[52:53], v169 offset:6144
v_mfma_f32_16x16x32_bf16 v[88:91], a[72:75], a[28:31], v[88:91]
ds_read_b64_tr_b16 a[54:55], v169 offset:6656
v_mfma_f32_16x16x32_bf16 v[20:23], a[76:79], a[16:19], v[20:23]
v_mfma_f32_16x16x32_bf16 v[44:47], a[76:79], a[20:23], v[44:47]
v_mfma_f32_16x16x32_bf16 v[68:71], a[76:79], a[24:27], v[68:71]
v_mfma_f32_16x16x32_bf16 v[92:95], a[76:79], a[28:31], v[92:95]
s_waitcnt vmcnt(6) lgkmcnt(0)
s_barrier
s_setprio 3
v_mfma_f32_16x16x32_bf16 v[0:3], a[32:35], a[0:3], v[0:3]
v_add_u32 v161, 0x8000, v161
v_mfma_f32_16x16x32_bf16 v[24:27], a[32:35], a[4:7], v[24:27]
ds_read_b128 a[16:19], v161 offset:32768
v_mfma_f32_16x16x32_bf16 v[48:51], a[32:35], a[8:11], v[48:51]
ds_read_b128 a[20:23], v161 offset:34816
s_add_u32 m0, s62, 98304
s_add_u32 s52, s52, 229376
buffer_load_dwordx4 v166, s[28:31], s53 offen lds
v_mfma_f32_16x16x32_bf16 v[72:75], a[32:35], a[12:15], v[72:75]
ds_read_b128 a[24:27], v161 offset:36864
v_mfma_f32_16x16x32_bf16 v[4:7], a[36:39], a[0:3], v[4:7]
ds_read_b128 a[28:31], v161 offset:38912
v_mfma_f32_16x16x32_bf16 v[28:31], a[36:39], a[4:7], v[28:31]
s_setprio 2
v_mfma_f32_16x16x32_bf16 v[52:55], a[36:39], a[8:11], v[52:55]
ds_read_b64_tr_b16 a[56:57], v162 offset:12288
v_mfma_f32_16x16x32_bf16 v[76:79], a[36:39], a[12:15], v[76:79]
ds_read_b64_tr_b16 a[58:59], v162 offset:13312
v_mfma_f32_16x16x32_bf16 v[8:11], a[40:43], a[0:3], v[8:11]
ds_read_b64_tr_b16 a[60:61], v163 offset:12288
v_mfma_f32_16x16x32_bf16 v[32:35], a[40:43], a[4:7], v[32:35]
ds_read_b64_tr_b16 a[62:63], v163 offset:13312
v_mfma_f32_16x16x32_bf16 v[56:59], a[40:43], a[8:11], v[56:59]
v_mfma_f32_16x16x32_bf16 v[80:83], a[40:43], a[12:15], v[80:83]
ds_read_b64_tr_b16 a[64:65], v169 offset:12288
s_setprio 1
v_mfma_f32_16x16x32_bf16 v[12:15], a[44:47], a[0:3], v[12:15]
ds_read_b64_tr_b16 a[66:67], v169 offset:12800
v_mfma_f32_16x16x32_bf16 v[36:39], a[44:47], a[4:7], v[36:39]
ds_read_b64_tr_b16 a[68:69], v162 offset:18432
v_mfma_f32_16x16x32_bf16 v[60:63], a[44:47], a[8:11], v[60:63]
ds_read_b64_tr_b16 a[70:71], v162 offset:19456
v_mfma_f32_16x16x32_bf16 v[84:87], a[44:47], a[12:15], v[84:87]
v_mfma_f32_16x16x32_bf16 v[16:19], a[48:51], a[0:3], v[16:19]
ds_read_b64_tr_b16 a[72:73], v163 offset:18432
v_mfma_f32_16x16x32_bf16 v[40:43], a[48:51], a[4:7], v[40:43]
ds_read_b64_tr_b16 a[74:75], v163 offset:19456
s_setprio 0
v_mfma_f32_16x16x32_bf16 v[64:67], a[48:51], a[8:11], v[64:67]
ds_read_b64_tr_b16 a[76:77], v169 offset:18432
v_mfma_f32_16x16x32_bf16 v[88:91], a[48:51], a[12:15], v[88:91]
ds_read_b64_tr_b16 a[78:79], v169 offset:18944
v_mfma_f32_16x16x32_bf16 v[20:23], a[52:55], a[0:3], v[20:23]
v_mfma_f32_16x16x32_bf16 v[44:47], a[52:55], a[4:7], v[44:47]
v_mfma_f32_16x16x32_bf16 v[68:71], a[52:55], a[8:11], v[68:71]
v_mfma_f32_16x16x32_bf16 v[92:95], a[52:55], a[12:15], v[92:95]
s_waitcnt vmcnt(3) lgkmcnt(0)
s_barrier
s_cmp_lg_u32 s87, 0
s_cbranch_scc1 k1_kernel_b_c_pi
v_lshrrev_b32 v172, 2, v171
buffer_load_dword v172, v172, s[96:99], 0 offen sc1
k1_kernel_b_c_pi:
s_setprio 3
v_mfma_f32_16x16x32_bf16 v[0:3], a[56:59], a[16:19], v[0:3]
v_subrev_u32 v160, 0x8000, v160
s_mov_b32 s32, s60
v_mfma_f32_16x16x32_bf16 v[24:27], a[56:59], a[20:23], v[24:27]
ds_read_b128 a[0:3], v160 offset:0
v_mfma_f32_16x16x32_bf16 v[48:51], a[56:59], a[24:27], v[48:51]
ds_read_b128 a[4:7], v160 offset:2048
s_mov_b32 s33, s61
s_add_u32 m0, s62, 106496
s_add_u32 s53, s53, 229376
buffer_load_dwordx4 v166, s[28:31], s53 offen lds
v_mfma_f32_16x16x32_bf16 v[72:75], a[56:59], a[28:31], v[72:75]
ds_read_b128 a[8:11], v160 offset:4096
v_mfma_f32_16x16x32_bf16 v[4:7], a[60:63], a[16:19], v[4:7]
ds_read_b128 a[12:15], v160 offset:6144
s_mov_b32 s34, 7340032
v_mfma_f32_16x16x32_bf16 v[28:31], a[60:63], a[20:23], v[28:31]
s_setprio 2
v_mfma_f32_16x16x32_bf16 v[52:55], a[60:63], a[24:27], v[52:55]
ds_read_b64_tr_b16 a[32:33], v162 offset:24576
s_mov_b32 s20, s10
v_mfma_f32_16x16x32_bf16 v[76:79], a[60:63], a[28:31], v[76:79]
ds_read_b64_tr_b16 a[34:35], v162 offset:25600
v_mfma_f32_16x16x32_bf16 v[8:11], a[64:67], a[16:19], v[8:11]
ds_read_b64_tr_b16 a[36:37], v163 offset:24576
s_mov_b32 s21, s11
v_mfma_f32_16x16x32_bf16 v[32:35], a[64:67], a[20:23], v[32:35]
ds_read_b64_tr_b16 a[38:39], v163 offset:25600
v_mfma_f32_16x16x32_bf16 v[56:59], a[64:67], a[24:27], v[56:59]
s_mov_b32 s22, 2097152
v_mfma_f32_16x16x32_bf16 v[80:83], a[64:67], a[28:31], v[80:83]
ds_read_b64_tr_b16 a[40:41], v169 offset:24576
s_setprio 1
v_mfma_f32_16x16x32_bf16 v[12:15], a[68:71], a[16:19], v[12:15]
ds_read_b64_tr_b16 a[42:43], v169 offset:25088
s_mov_b32 s24, s46
s_add_u32 m0, s62, 114688
s_add_u32 s53, s53, 229376
buffer_load_dwordx4 v166, s[28:31], s53 offen lds
v_mfma_f32_16x16x32_bf16 v[36:39], a[68:71], a[20:23], v[36:39]
ds_read_b64_tr_b16 a[44:45], v162 offset:30720
v_mfma_f32_16x16x32_bf16 v[60:63], a[68:71], a[24:27], v[60:63]
ds_read_b64_tr_b16 a[46:47], v162 offset:31744
s_mov_b32 s25, s47
v_mfma_f32_16x16x32_bf16 v[84:87], a[68:71], a[28:31], v[84:87]
v_mfma_f32_16x16x32_bf16 v[16:19], a[72:75], a[16:19], v[16:19]
ds_read_b64_tr_b16 a[48:49], v163 offset:30720
s_mov_b32 s26, 0x400000
v_mfma_f32_16x16x32_bf16 v[40:43], a[72:75], a[20:23], v[40:43]
ds_read_b64_tr_b16 a[50:51], v163 offset:31744
s_setprio 0
v_mfma_f32_16x16x32_bf16 v[64:67], a[72:75], a[24:27], v[64:67]
ds_read_b64_tr_b16 a[52:53], v169 offset:30720
s_mov_b32 s27, 0x00020000
v_mfma_f32_16x16x32_bf16 v[88:91], a[72:75], a[28:31], v[88:91]
ds_read_b64_tr_b16 a[54:55], v169 offset:31232
v_mfma_f32_16x16x32_bf16 v[20:23], a[76:79], a[16:19], v[20:23]
v_mfma_f32_16x16x32_bf16 v[44:47], a[76:79], a[20:23], v[44:47]
v_mfma_f32_16x16x32_bf16 v[68:71], a[76:79], a[24:27], v[68:71]
v_mfma_f32_16x16x32_bf16 v[92:95], a[76:79], a[28:31], v[92:95]
s_waitcnt vmcnt(3) lgkmcnt(0)
s_barrier
s_setprio 3
v_mfma_f32_16x16x32_bf16 v[0:3], a[32:35], a[0:3], v[0:3]
v_subrev_u32 v161, 0x8000, v161
v_mfma_f32_16x16x32_bf16 v[24:27], a[32:35], a[4:7], v[24:27]
ds_read_b128 a[16:19], v161 offset:0
v_mfma_f32_16x16x32_bf16 v[48:51], a[32:35], a[8:11], v[48:51]
ds_read_b128 a[20:23], v161 offset:2048
s_add_u32 m0, s62, 122880
s_add_u32 s53, s53, 229376
buffer_load_dwordx4 v166, s[28:31], s53 offen lds
v_mfma_f32_16x16x32_bf16 v[72:75], a[32:35], a[12:15], v[72:75]
ds_read_b128 a[24:27], v161 offset:4096
v_mfma_f32_16x16x32_bf16 v[4:7], a[36:39], a[0:3], v[4:7]
ds_read_b128 a[28:31], v161 offset:6144
v_mfma_f32_16x16x32_bf16 v[28:31], a[36:39], a[4:7], v[28:31]
s_setprio 2
v_mfma_f32_16x16x32_bf16 v[52:55], a[36:39], a[8:11], v[52:55]
ds_read_b64_tr_b16 a[56:57], v162 offset:36864
v_mfma_f32_16x16x32_bf16 v[76:79], a[36:39], a[12:15], v[76:79]
ds_read_b64_tr_b16 a[58:59], v162 offset:37888
v_mfma_f32_16x16x32_bf16 v[8:11], a[40:43], a[0:3], v[8:11]
ds_read_b64_tr_b16 a[60:61], v163 offset:36864
v_mfma_f32_16x16x32_bf16 v[32:35], a[40:43], a[4:7], v[32:35]
ds_read_b64_tr_b16 a[62:63], v163 offset:37888
v_mfma_f32_16x16x32_bf16 v[56:59], a[40:43], a[8:11], v[56:59]
v_mfma_f32_16x16x32_bf16 v[80:83], a[40:43], a[12:15], v[80:83]
ds_read_b64_tr_b16 a[64:65], v169 offset:36864
s_setprio 1
v_mfma_f32_16x16x32_bf16 v[12:15], a[44:47], a[0:3], v[12:15]
ds_read_b64_tr_b16 a[66:67], v169 offset:37376
v_mfma_f32_16x16x32_bf16 v[36:39], a[44:47], a[4:7], v[36:39]
ds_read_b64_tr_b16 a[68:69], v162 offset:43008
v_mfma_f32_16x16x32_bf16 v[60:63], a[44:47], a[8:11], v[60:63]
ds_read_b64_tr_b16 a[70:71], v162 offset:44032
v_mfma_f32_16x16x32_bf16 v[84:87], a[44:47], a[12:15], v[84:87]
v_mfma_f32_16x16x32_bf16 v[16:19], a[48:51], a[0:3], v[16:19]
ds_read_b64_tr_b16 a[72:73], v163 offset:43008
v_mfma_f32_16x16x32_bf16 v[40:43], a[48:51], a[4:7], v[40:43]
ds_read_b64_tr_b16 a[74:75], v163 offset:44032
s_setprio 0
v_mfma_f32_16x16x32_bf16 v[64:67], a[48:51], a[8:11], v[64:67]
ds_read_b64_tr_b16 a[76:77], v169 offset:43008
v_mfma_f32_16x16x32_bf16 v[88:91], a[48:51], a[12:15], v[88:91]
ds_read_b64_tr_b16 a[78:79], v169 offset:43520
v_mfma_f32_16x16x32_bf16 v[20:23], a[52:55], a[0:3], v[20:23]
v_mfma_f32_16x16x32_bf16 v[44:47], a[52:55], a[4:7], v[44:47]
v_mfma_f32_16x16x32_bf16 v[68:71], a[52:55], a[8:11], v[68:71]
v_mfma_f32_16x16x32_bf16 v[92:95], a[52:55], a[12:15], v[92:95]
s_waitcnt vmcnt(3) lgkmcnt(0)
s_cmp_lg_u32 s87, 0
s_cbranch_scc1 k1_kernel_b_c_pc_rdy
s_waitcnt vmcnt(3)
v_cmp_le_u32 s[100:101], 4, v172
s_nop 0
s_cmp_eq_u64 s[100:101], -1
s_cbranch_scc1 k1_kernel_b_c_pc_rdy
s_mov_b32 s91, 40000
k1_kernel_b_c_pc_spin:
s_sleep 2
v_lshrrev_b32 v172, 2, v171
buffer_load_dword v172, v172, s[96:99], 0 offen sc1
s_waitcnt vmcnt(0)
v_cmp_le_u32 s[100:101], 4, v172
s_nop 0
s_cmp_eq_u64 s[100:101], -1
s_cbranch_scc1 k1_kernel_b_c_pc_rdy
s_sub_u32 s91, s91, 1
s_cmp_lg_u32 s91, 0
s_cbranch_scc1 k1_kernel_b_c_pc_spin
s_nop 0
k1_kernel_b_c_pc_rdy:
s_barrier
s_setprio 3
v_mfma_f32_16x16x32_bf16 v[0:3], a[56:59], a[16:19], v[0:3]
ds_read_b128 a[0:3], v160 offset:32768
v_mfma_f32_16x16x32_bf16 v[24:27], a[56:59], a[20:23], v[24:27]
ds_read_b128 a[4:7], v160 offset:34816
v_mfma_f32_16x16x32_bf16 v[48:51], a[56:59], a[24:27], v[48:51]
s_add_u32 m0, s62, 131072
s_add_u32 s53, s53, 229376
buffer_load_dwordx4 v166, s[28:31], s53 offen lds
v_mfma_f32_16x16x32_bf16 v[72:75], a[56:59], a[28:31], v[72:75]
ds_read_b128 a[8:11], v160 offset:36864
v_mfma_f32_16x16x32_bf16 v[4:7], a[60:63], a[16:19], v[4:7]
v_mfma_f32_16x16x32_bf16 v[28:31], a[60:63], a[20:23], v[28:31]
ds_read_b128 a[12:15], v160 offset:38912
s_setprio 2
v_mfma_f32_16x16x32_bf16 v[52:55], a[60:63], a[24:27], v[52:55]
v_mfma_f32_16x16x32_bf16 v[76:79], a[60:63], a[28:31], v[76:79]
ds_read_b64_tr_b16 a[32:33], v162 offset:0
v_mfma_f32_16x16x32_bf16 v[8:11], a[64:67], a[16:19], v[8:11]
ds_read_b64_tr_b16 a[34:35], v162 offset:1024
v_mfma_f32_16x16x32_bf16 v[32:35], a[64:67], a[20:23], v[32:35]
v_mfma_f32_16x16x32_bf16 v[56:59], a[64:67], a[24:27], v[56:59]
ds_read_b64_tr_b16 a[36:37], v163 offset:0
v_mfma_f32_16x16x32_bf16 v[80:83], a[64:67], a[28:31], v[80:83]
s_setprio 1
v_mfma_f32_16x16x32_bf16 v[12:15], a[68:71], a[16:19], v[12:15]
ds_read_b64_tr_b16 a[38:39], v163 offset:1024
s_add_u32 m0, s62, 139264
s_add_u32 s53, s53, 229376
buffer_load_dwordx4 v166, s[28:31], s53 offen lds
v_mfma_f32_16x16x32_bf16 v[36:39], a[68:71], a[20:23], v[36:39]
v_mfma_f32_16x16x32_bf16 v[60:63], a[68:71], a[24:27], v[60:63]
ds_read_b64_tr_b16 a[40:41], v162 offset:4096
v_mfma_f32_16x16x32_bf16 v[84:87], a[68:71], a[28:31], v[84:87]
ds_read_b64_tr_b16 a[42:43], v162 offset:5120
v_mfma_f32_16x16x32_bf16 v[16:19], a[72:75], a[16:19], v[16:19]
v_mfma_f32_16x16x32_bf16 v[40:43], a[72:75], a[20:23], v[40:43]
ds_read_b64_tr_b16 a[44:45], v163 offset:4096
s_setprio 0
v_mfma_f32_16x16x32_bf16 v[64:67], a[72:75], a[24:27], v[64:67]
v_mfma_f32_16x16x32_bf16 v[88:91], a[72:75], a[28:31], v[88:91]
ds_read_b64_tr_b16 a[46:47], v163 offset:5120
v_mfma_f32_16x16x32_bf16 v[20:23], a[76:79], a[16:19], v[20:23]
v_mfma_f32_16x16x32_bf16 v[44:47], a[76:79], a[20:23], v[44:47]
v_mfma_f32_16x16x32_bf16 v[68:71], a[76:79], a[24:27], v[68:71]
v_mfma_f32_16x16x32_bf16 v[92:95], a[76:79], a[28:31], v[92:95]
s_waitcnt vmcnt(4) lgkmcnt(0)
s_barrier
s_setprio 3
v_mfma_f32_16x16x32_bf16 v[96:99], a[32:35], a[0:3], v[96:99]
ds_read_b128 a[16:19], v161 offset:32768
v_mov_b32 v173, 0xc0135761
v_mul_f32 v167, v8, v8
v_mul_f32 v168, v9, v9
v_mul_f32 v169, v10, v10
v_mul_f32 v170, v11, v11
v_fma_f32 v167, v167, s8, v173
v_mfma_f32_16x16x32_bf16 v[112:115], a[32:35], a[4:7], v[112:115]
ds_read_b128 a[20:23], v161 offset:34816
v_fma_f32 v168, v168, s8, v173
v_fma_f32 v169, v169, s8, v173
v_fma_f32 v170, v170, s8, v173
v_mul_f32 v167, v167, v8
v_mul_f32 v168, v168, v9
v_mul_f32 v169, v169, v10
v_mfma_f32_16x16x32_bf16 v[128:131], a[32:35], a[8:11], v[128:131]
ds_read_b128 a[24:27], v161 offset:36864
s_add_u32 m0, s62, 98304
s_sub_u32 s53, s53, 4358144
buffer_load_dwordx4 v166, s[28:31], s53 offen lds
v_mul_f32 v170, v170, v11
v_exp_f32 v167, v167
v_mul_f32 v8, v8, v20
v_exp_f32 v168, v168
v_mfma_f32_16x16x32_bf16 v[144:147], a[32:35], a[12:15], v[144:147]
ds_read_b128 a[28:31], v161 offset:38912
v_mul_f32 v9, v9, v21
v_exp_f32 v169, v169
v_mul_f32 v10, v10, v22
v_exp_f32 v170, v170
s_setprio 2
v_mfma_f32_16x16x32_bf16 v[100:103], a[36:39], a[0:3], v[100:103]
ds_read_b64_tr_b16 a[56:57], v162 offset:8192
v_mul_f32 v11, v11, v23
v_add_f32 v167, 1.0, v167
v_add_f32 v168, 1.0, v168
v_add_f32 v169, 1.0, v169
v_add_f32 v170, 1.0, v170
v_rcp_f32 v167, v167
v_mfma_f32_16x16x32_bf16 v[116:119], a[36:39], a[4:7], v[116:119]
ds_read_b64_tr_b16 a[58:59], v162 offset:9216
v_rcp_f32 v168, v168
v_rcp_f32 v169, v169
v_rcp_f32 v170, v170
v_mfma_f32_16x16x32_bf16 v[132:135], a[36:39], a[8:11], v[132:135]
ds_read_b64_tr_b16 a[60:61], v163 offset:8192
v_mul_f32 v8, v8, v167
v_mul_f32 v9, v9, v168
v_mul_f32 v10, v10, v169
v_mul_f32 v11, v11, v170
v_cvt_pk_bf16_f32 v20, v8, v9
v_cvt_pk_bf16_f32 v21, v10, v11
v_mfma_f32_16x16x32_bf16 v[148:151], a[36:39], a[12:15], v[148:151]
ds_read_b64_tr_b16 a[62:63], v163 offset:9216
v_add_u32 v8, s74, v171
v_add_u32 v9, s75, v171
ds_write_b64 v8, v[20:21] offset:0
v_mul_f32 v167, v32, v32
v_mul_f32 v168, v33, v33
v_mul_f32 v169, v34, v34
s_setprio 1
v_mfma_f32_16x16x32_bf16 v[104:107], a[40:43], a[0:3], v[104:107]
ds_read_b64_tr_b16 a[64:65], v162 offset:12288
v_mul_f32 v170, v35, v35
v_fma_f32 v167, v167, s8, v173
v_fma_f32 v168, v168, s8, v173
v_fma_f32 v169, v169, s8, v173
v_fma_f32 v170, v170, s8, v173
v_mul_f32 v167, v167, v32
v_mfma_f32_16x16x32_bf16 v[120:123], a[40:43], a[4:7], v[120:123]
ds_read_b64_tr_b16 a[66:67], v162 offset:13312
v_mul_f32 v168, v168, v33
v_mul_f32 v169, v169, v34
v_mul_f32 v170, v170, v35
v_exp_f32 v167, v167
v_mul_f32 v32, v32, v44
v_mfma_f32_16x16x32_bf16 v[136:139], a[40:43], a[8:11], v[136:139]
ds_read_b64_tr_b16 a[68:69], v163 offset:12288
v_exp_f32 v168, v168
v_mul_f32 v33, v33, v45
v_exp_f32 v169, v169
v_mul_f32 v34, v34, v46
v_mfma_f32_16x16x32_bf16 v[152:155], a[40:43], a[12:15], v[152:155]
ds_read_b64_tr_b16 a[70:71], v163 offset:13312
v_exp_f32 v170, v170
v_mul_f32 v35, v35, v47
v_add_f32 v167, 1.0, v167
v_add_f32 v168, 1.0, v168
v_add_f32 v169, 1.0, v169
s_setprio 0
v_mfma_f32_16x16x32_bf16 v[108:111], a[44:47], a[0:3], v[108:111]
v_add_f32 v170, 1.0, v170
v_rcp_f32 v167, v167
v_rcp_f32 v168, v168
v_rcp_f32 v169, v169
v_mfma_f32_16x16x32_bf16 v[124:127], a[44:47], a[4:7], v[124:127]
v_rcp_f32 v170, v170
v_mul_f32 v32, v32, v167
v_mul_f32 v33, v33, v168
v_mul_f32 v34, v34, v169
v_mul_f32 v35, v35, v170
v_mfma_f32_16x16x32_bf16 v[140:143], a[44:47], a[8:11], v[140:143]
v_cvt_pk_bf16_f32 v44, v32, v33
v_cvt_pk_bf16_f32 v45, v34, v35
ds_write_b64 v8, v[44:45] offset:1024
v_mul_f32 v167, v56, v56
v_mul_f32 v168, v57, v57
v_mul_f32 v169, v58, v58
v_mfma_f32_16x16x32_bf16 v[156:159], a[44:47], a[12:15], v[156:159]
v_mul_f32 v170, v59, v59
v_fma_f32 v167, v167, s8, v173
v_fma_f32 v168, v168, s8, v173
v_fma_f32 v169, v169, s8, v173
v_fma_f32 v170, v170, s8, v173
v_mul_f32 v167, v167, v56
s_waitcnt vmcnt(4) lgkmcnt(0)
s_barrier
s_setprio 3
v_mfma_f32_16x16x32_bf16 v[96:99], a[56:59], a[16:19], v[96:99]
v_add_u32 v160, 0x8000, v160
v_mul_f32 v168, v168, v57
v_mul_f32 v169, v169, v58
v_mul_f32 v170, v170, v59
v_exp_f32 v167, v167
v_mul_f32 v56, v56, v68
v_mfma_f32_16x16x32_bf16 v[112:115], a[56:59], a[20:23], v[112:115]
ds_read_b128 a[0:3], v160 offset:32768
v_exp_f32 v168, v168
v_mul_f32 v57, v57, v69
v_exp_f32 v169, v169
v_mul_f32 v58, v58, v70
v_mfma_f32_16x16x32_bf16 v[128:131], a[56:59], a[24:27], v[128:131]
ds_read_b128 a[4:7], v160 offset:34816
s_add_u32 m0, s58, 32768
s_add_u32 s53, s53, 229376
buffer_load_dwordx4 v164, s[16:19], s48 offen lds
v_exp_f32 v170, v170
v_mul_f32 v59, v59, v71
v_add_f32 v167, 1.0, v167
v_add_f32 v168, 1.0, v168
v_add_f32 v169, 1.0, v169
v_mfma_f32_16x16x32_bf16 v[144:147], a[56:59], a[28:31], v[144:147]
ds_read_b128 a[8:11], v160 offset:36864
v_add_f32 v170, 1.0, v170
v_rcp_f32 v167, v167
v_rcp_f32 v168, v168
v_rcp_f32 v169, v169
s_setprio 2
v_mfma_f32_16x16x32_bf16 v[100:103], a[60:63], a[16:19], v[100:103]
ds_read_b128 a[12:15], v160 offset:38912
v_rcp_f32 v170, v170
v_mul_f32 v56, v56, v167
v_mul_f32 v57, v57, v168
v_mul_f32 v58, v58, v169
v_mul_f32 v59, v59, v170
v_mfma_f32_16x16x32_bf16 v[116:119], a[60:63], a[20:23], v[116:119]
ds_read_b64_tr_b16 a[32:33], v162 offset:16384
v_cvt_pk_bf16_f32 v68, v56, v57
v_cvt_pk_bf16_f32 v69, v58, v59
ds_write_b64 v8, v[68:69] offset:2048
v_mul_f32 v167, v80, v80
v_mul_f32 v168, v81, v81
v_mul_f32 v169, v82, v82
v_mfma_f32_16x16x32_bf16 v[132:135], a[60:63], a[24:27], v[132:135]
ds_read_b64_tr_b16 a[34:35], v162 offset:17408
s_add_u32 m0, s58, 33792
s_add_u32 s48, s48, 128
buffer_load_dwordx4 v165, s[16:19], s49 offen lds
v_mul_f32 v170, v83, v83
v_fma_f32 v167, v167, s8, v173
v_fma_f32 v168, v168, s8, v173
v_fma_f32 v169, v169, s8, v173
v_fma_f32 v170, v170, s8, v173
v_mul_f32 v167, v167, v80
v_mfma_f32_16x16x32_bf16 v[148:151], a[60:63], a[28:31], v[148:151]
ds_read_b64_tr_b16 a[36:37], v163 offset:16384
v_mul_f32 v168, v168, v81
v_mul_f32 v169, v169, v82
v_mul_f32 v170, v170, v83
v_exp_f32 v167, v167
v_mul_f32 v80, v80, v92
s_setprio 1
v_mfma_f32_16x16x32_bf16 v[104:107], a[64:67], a[16:19], v[104:107]
ds_read_b64_tr_b16 a[38:39], v163 offset:17408
v_exp_f32 v168, v168
v_mul_f32 v81, v81, v93
v_exp_f32 v169, v169
v_mul_f32 v82, v82, v94
v_mfma_f32_16x16x32_bf16 v[120:123], a[64:67], a[20:23], v[120:123]
ds_read_b64_tr_b16 a[40:41], v162 offset:20480
v_exp_f32 v170, v170
v_mul_f32 v83, v83, v95
v_add_f32 v167, 1.0, v167
v_add_f32 v168, 1.0, v168
v_add_f32 v169, 1.0, v169
v_mfma_f32_16x16x32_bf16 v[136:139], a[64:67], a[24:27], v[136:139]
ds_read_b64_tr_b16 a[42:43], v162 offset:21504
s_add_u32 m0, s62, 106496
s_add_u32 s49, s49, 128
buffer_load_dwordx4 v166, s[28:31], s53 offen lds
v_add_f32 v170, 1.0, v170
v_rcp_f32 v167, v167
v_rcp_f32 v168, v168
v_rcp_f32 v169, v169
v_mfma_f32_16x16x32_bf16 v[152:155], a[64:67], a[28:31], v[152:155]
ds_read_b64_tr_b16 a[44:45], v163 offset:20480
v_rcp_f32 v170, v170
v_mul_f32 v80, v80, v167
v_mul_f32 v81, v81, v168
v_mul_f32 v82, v82, v169
v_mul_f32 v83, v83, v170
s_setprio 0
v_mfma_f32_16x16x32_bf16 v[108:111], a[68:71], a[16:19], v[108:111]
ds_read_b64_tr_b16 a[46:47], v163 offset:21504
v_cvt_pk_bf16_f32 v92, v80, v81
v_cvt_pk_bf16_f32 v93, v82, v83
ds_write_b64 v8, v[92:93] offset:3072
v_mul_f32 v167, v0, v0
v_mul_f32 v168, v1, v1
v_mul_f32 v169, v2, v2
v_mfma_f32_16x16x32_bf16 v[124:127], a[68:71], a[20:23], v[124:127]
v_mul_f32 v170, v3, v3
v_fma_f32 v167, v167, s8, v173
v_fma_f32 v168, v168, s8, v173
v_fma_f32 v169, v169, s8, v173
v_fma_f32 v170, v170, s8, v173
v_mul_f32 v167, v167, v0
v_mfma_f32_16x16x32_bf16 v[140:143], a[68:71], a[24:27], v[140:143]
v_mul_f32 v168, v168, v1
v_mul_f32 v169, v169, v2
v_mul_f32 v170, v170, v3
v_exp_f32 v167, v167
v_mul_f32 v0, v0, v12
v_mfma_f32_16x16x32_bf16 v[156:159], a[68:71], a[28:31], v[156:159]
v_exp_f32 v168, v168
v_mul_f32 v1, v1, v13
v_exp_f32 v169, v169
v_mul_f32 v2, v2, v14
s_waitcnt vmcnt(6) lgkmcnt(0)
s_barrier
s_setprio 3
v_mfma_f32_16x16x32_bf16 v[96:99], a[32:35], a[0:3], v[96:99]
v_add_u32 v161, 0x8000, v161
v_exp_f32 v170, v170
v_mul_f32 v3, v3, v15
v_add_f32 v167, 1.0, v167
v_add_f32 v168, 1.0, v168
v_add_f32 v169, 1.0, v169
v_mfma_f32_16x16x32_bf16 v[112:115], a[32:35], a[4:7], v[112:115]
ds_read_b128 a[16:19], v161 offset:32768
v_add_f32 v170, 1.0, v170
v_rcp_f32 v167, v167
v_rcp_f32 v168, v168
v_rcp_f32 v169, v169
v_mfma_f32_16x16x32_bf16 v[128:131], a[32:35], a[8:11], v[128:131]
ds_read_b128 a[20:23], v161 offset:34816
s_add_u32 m0, s58, 34816
s_add_u32 s53, s53, 229376
buffer_load_dwordx4 v164, s[16:19], s50 offen lds
v_rcp_f32 v170, v170
v_mul_f32 v0, v0, v167
v_mul_f32 v1, v1, v168
v_mul_f32 v2, v2, v169
v_mul_f32 v3, v3, v170
v_mfma_f32_16x16x32_bf16 v[144:147], a[32:35], a[12:15], v[144:147]
ds_read_b128 a[24:27], v161 offset:36864
v_cvt_pk_bf16_f32 v12, v0, v1
v_cvt_pk_bf16_f32 v13, v2, v3
v_mul_f32 v167, v4, v4
v_mul_f32 v168, v5, v5
v_mul_f32 v169, v6, v6
v_mul_f32 v170, v7, v7
s_setprio 2
v_mfma_f32_16x16x32_bf16 v[100:103], a[36:39], a[0:3], v[100:103]
ds_read_b128 a[28:31], v161 offset:38912
v_fma_f32 v167, v167, s8, v173
v_fma_f32 v168, v168, s8, v173
v_fma_f32 v169, v169, s8, v173
v_fma_f32 v170, v170, s8, v173
v_mul_f32 v167, v167, v4
v_mul_f32 v168, v168, v5
v_mfma_f32_16x16x32_bf16 v[116:119], a[36:39], a[4:7], v[116:119]
ds_read_b64_tr_b16 a[56:57], v162 offset:24576
v_mul_f32 v169, v169, v6
v_mul_f32 v170, v170, v7
v_exp_f32 v167, v167
v_mul_f32 v4, v4, v16
v_exp_f32 v168, v168
v_mfma_f32_16x16x32_bf16 v[132:135], a[36:39], a[8:11], v[132:135]
ds_read_b64_tr_b16 a[58:59], v162 offset:25600
s_add_u32 m0, s58, 35840
s_add_u32 s50, s50, 128
buffer_load_dwordx4 v165, s[16:19], s51 offen lds
v_mul_f32 v5, v5, v17
v_exp_f32 v169, v169
v_mul_f32 v6, v6, v18
v_exp_f32 v170, v170
v_mfma_f32_16x16x32_bf16 v[148:151], a[36:39], a[12:15], v[148:151]
ds_read_b64_tr_b16 a[60:61], v163 offset:24576
v_mul_f32 v7, v7, v19
v_add_f32 v167, 1.0, v167
v_add_f32 v168, 1.0, v168
v_add_f32 v169, 1.0, v169
v_add_f32 v170, 1.0, v170
v_rcp_f32 v167, v167
s_setprio 1
v_mfma_f32_16x16x32_bf16 v[104:107], a[40:43], a[0:3], v[104:107]
ds_read_b64_tr_b16 a[62:63], v163 offset:25600
v_rcp_f32 v168, v168
v_rcp_f32 v169, v169
v_rcp_f32 v170, v170
v_mfma_f32_16x16x32_bf16 v[120:123], a[40:43], a[4:7], v[120:123]
ds_read_b64_tr_b16 a[64:65], v162 offset:28672
v_mul_f32 v4, v4, v167
v_mul_f32 v5, v5, v168
v_mul_f32 v6, v6, v169
v_mul_f32 v7, v7, v170
v_cvt_pk_bf16_f32 v14, v4, v5
v_cvt_pk_bf16_f32 v15, v6, v7
v_mfma_f32_16x16x32_bf16 v[136:139], a[40:43], a[8:11], v[136:139]
ds_read_b64_tr_b16 a[66:67], v162 offset:29696
s_add_u32 m0, s62, 114688
s_add_u32 s51, s51, 128
buffer_load_dwordx4 v166, s[28:31], s53 offen lds
buffer_store_dwordx4 v[12:15], v171, s[40:43], s92 offen sc1
s_add_u32 s92, s92, 147456
v_mul_f32 v167, v24, v24
v_mul_f32 v168, v25, v25
v_mul_f32 v169, v26, v26
v_mul_f32 v170, v27, v27
v_fma_f32 v167, v167, s8, v173
v_mfma_f32_16x16x32_bf16 v[152:155], a[40:43], a[12:15], v[152:155]
ds_read_b64_tr_b16 a[68:69], v163 offset:28672
v_fma_f32 v168, v168, s8, v173
v_fma_f32 v169, v169, s8, v173
v_fma_f32 v170, v170, s8, v173
v_mul_f32 v167, v167, v24
v_mul_f32 v168, v168, v25
v_mul_f32 v169, v169, v26
s_setprio 0
v_mfma_f32_16x16x32_bf16 v[108:111], a[44:47], a[0:3], v[108:111]
ds_read_b64_tr_b16 a[70:71], v163 offset:29696
v_mul_f32 v170, v170, v27
v_exp_f32 v167, v167
v_mul_f32 v24, v24, v36
v_exp_f32 v168, v168
v_mfma_f32_16x16x32_bf16 v[124:127], a[44:47], a[4:7], v[124:127]
v_mul_f32 v25, v25, v37
v_exp_f32 v169, v169
v_mul_f32 v26, v26, v38
v_exp_f32 v170, v170
v_mfma_f32_16x16x32_bf16 v[140:143], a[44:47], a[8:11], v[140:143]
v_mul_f32 v27, v27, v39
v_add_f32 v167, 1.0, v167
v_add_f32 v168, 1.0, v168
v_add_f32 v169, 1.0, v169
v_add_f32 v170, 1.0, v170
v_rcp_f32 v167, v167
v_mfma_f32_16x16x32_bf16 v[156:159], a[44:47], a[12:15], v[156:159]
v_rcp_f32 v168, v168
v_rcp_f32 v169, v169
v_rcp_f32 v170, v170
s_waitcnt vmcnt(9) lgkmcnt(0)
s_barrier
s_setprio 3
v_mfma_f32_16x16x32_bf16 v[96:99], a[56:59], a[16:19], v[96:99]
v_subrev_u32 v160, 0x8000, v160
v_mul_f32 v24, v24, v167
v_mul_f32 v25, v25, v168
v_mul_f32 v26, v26, v169
v_mul_f32 v27, v27, v170
v_cvt_pk_bf16_f32 v36, v24, v25
v_cvt_pk_bf16_f32 v37, v26, v27
v_mfma_f32_16x16x32_bf16 v[112:115], a[56:59], a[20:23], v[112:115]
ds_read_b128 a[0:3], v160 offset:0
v_mul_f32 v167, v28, v28
v_mul_f32 v168, v29, v29
v_mul_f32 v169, v30, v30
v_mul_f32 v170, v31, v31
v_fma_f32 v167, v167, s8, v173
v_fma_f32 v168, v168, s8, v173
v_mfma_f32_16x16x32_bf16 v[128:131], a[56:59], a[24:27], v[128:131]
ds_read_b128 a[4:7], v160 offset:2048
s_add_u32 m0, s58, 65536
s_add_u32 s53, s53, 229376
buffer_load_dwordx4 v164, s[16:19], s48 offen lds
v_fma_f32 v169, v169, s8, v173
v_fma_f32 v170, v170, s8, v173
v_mul_f32 v167, v167, v28
v_mul_f32 v168, v168, v29
v_mul_f32 v169, v169, v30
v_mul_f32 v170, v170, v31
v_mfma_f32_16x16x32_bf16 v[144:147], a[56:59], a[28:31], v[144:147]
ds_read_b128 a[8:11], v160 offset:4096
v_exp_f32 v167, v167
v_mul_f32 v28, v28, v40
v_exp_f32 v168, v168
v_mul_f32 v29, v29, v41
s_setprio 2
v_mfma_f32_16x16x32_bf16 v[100:103], a[60:63], a[16:19], v[100:103]
ds_read_b128 a[12:15], v160 offset:6144
v_exp_f32 v169, v169
v_mul_f32 v30, v30, v42
v_exp_f32 v170, v170
v_mul_f32 v31, v31, v43
v_mfma_f32_16x16x32_bf16 v[116:119], a[60:63], a[20:23], v[116:119]
ds_read_b64_tr_b16 a[32:33], v162 offset:32768
v_add_f32 v167, 1.0, v167
v_add_f32 v168, 1.0, v168
v_add_f32 v169, 1.0, v169
v_add_f32 v170, 1.0, v170
v_rcp_f32 v167, v167
v_mfma_f32_16x16x32_bf16 v[132:135], a[60:63], a[24:27], v[132:135]
ds_read_b64_tr_b16 a[34:35], v162 offset:33792
s_add_u32 m0, s58, 66560
s_add_u32 s48, s48, 128
buffer_load_dwordx4 v165, s[16:19], s49 offen lds
v_rcp_f32 v168, v168
v_rcp_f32 v169, v169
v_rcp_f32 v170, v170
v_mfma_f32_16x16x32_bf16 v[148:151], a[60:63], a[28:31], v[148:151]
ds_read_b64_tr_b16 a[36:37], v163 offset:32768
v_mul_f32 v28, v28, v167
v_mul_f32 v29, v29, v168
v_mul_f32 v30, v30, v169
v_mul_f32 v31, v31, v170
v_cvt_pk_bf16_f32 v38, v28, v29
v_cvt_pk_bf16_f32 v39, v30, v31
s_setprio 1
v_mfma_f32_16x16x32_bf16 v[104:107], a[64:67], a[16:19], v[104:107]
ds_read_b64_tr_b16 a[38:39], v163 offset:33792
buffer_store_dwordx4 v[36:39], v171, s[40:43], s92 offen sc1
s_add_u32 s92, s92, 147456
ds_read_b128 v[32:35], v9 offset:0
ds_read_b128 v[56:59], v9 offset:1024
v_mul_f32 v167, v48, v48
v_mul_f32 v168, v49, v49
v_mul_f32 v169, v50, v50
v_mfma_f32_16x16x32_bf16 v[120:123], a[64:67], a[20:23], v[120:123]
ds_read_b64_tr_b16 a[40:41], v162 offset:36864
v_mul_f32 v170, v51, v51
v_fma_f32 v167, v167, s8, v173
v_fma_f32 v168, v168, s8, v173
v_fma_f32 v169, v169, s8, v173
v_fma_f32 v170, v170, s8, v173
v_mul_f32 v167, v167, v48
v_mfma_f32_16x16x32_bf16 v[136:139], a[64:67], a[24:27], v[136:139]
ds_read_b64_tr_b16 a[42:43], v162 offset:37888
s_add_u32 m0, s62, 122880
s_add_u32 s49, s49, 128
buffer_load_dwordx4 v166, s[28:31], s53 offen lds
v_mul_f32 v168, v168, v49
v_mul_f32 v169, v169, v50
v_mul_f32 v170, v170, v51
v_exp_f32 v167, v167
v_mul_f32 v48, v48, v60
v_mfma_f32_16x16x32_bf16 v[152:155], a[64:67], a[28:31], v[152:155]
ds_read_b64_tr_b16 a[44:45], v163 offset:36864
v_exp_f32 v168, v168
v_mul_f32 v49, v49, v61
v_exp_f32 v169, v169
v_mul_f32 v50, v50, v62
s_setprio 0
v_mfma_f32_16x16x32_bf16 v[108:111], a[68:71], a[16:19], v[108:111]
ds_read_b64_tr_b16 a[46:47], v163 offset:37888
v_exp_f32 v170, v170
v_mul_f32 v51, v51, v63
v_add_f32 v167, 1.0, v167
v_add_f32 v168, 1.0, v168
v_add_f32 v169, 1.0, v169
v_mfma_f32_16x16x32_bf16 v[124:127], a[68:71], a[20:23], v[124:127]
v_add_f32 v170, 1.0, v170
v_rcp_f32 v167, v167
v_rcp_f32 v168, v168
v_rcp_f32 v169, v169
v_mfma_f32_16x16x32_bf16 v[140:143], a[68:71], a[24:27], v[140:143]
v_rcp_f32 v170, v170
v_mul_f32 v48, v48, v167
v_mul_f32 v49, v49, v168
v_mul_f32 v50, v50, v169
v_mul_f32 v51, v51, v170
v_mfma_f32_16x16x32_bf16 v[156:159], a[68:71], a[28:31], v[156:159]
v_cvt_pk_bf16_f32 v60, v48, v49
v_cvt_pk_bf16_f32 v61, v50, v51
v_mul_f32 v167, v52, v52
v_mul_f32 v168, v53, v53
v_mul_f32 v169, v54, v54
v_mul_f32 v170, v55, v55
s_waitcnt vmcnt(12) lgkmcnt(0)
s_barrier
s_setprio 3
v_mfma_f32_16x16x32_bf16 v[96:99], a[32:35], a[0:3], v[96:99]
v_subrev_u32 v161, 0x8000, v161
v_fma_f32 v167, v167, s8, v173
v_fma_f32 v168, v168, s8, v173
v_fma_f32 v169, v169, s8, v173
v_fma_f32 v170, v170, s8, v173
v_mul_f32 v167, v167, v52
v_mul_f32 v168, v168, v53
v_mfma_f32_16x16x32_bf16 v[112:115], a[32:35], a[4:7], v[112:115]
ds_read_b128 a[16:19], v161 offset:0
v_mul_f32 v169, v169, v54
v_mul_f32 v170, v170, v55
v_exp_f32 v167, v167
v_mul_f32 v52, v52, v64
v_exp_f32 v168, v168
v_mfma_f32_16x16x32_bf16 v[128:131], a[32:35], a[8:11], v[128:131]
ds_read_b128 a[20:23], v161 offset:2048
s_add_u32 m0, s58, 67584
s_add_u32 s53, s53, 229376
buffer_load_dwordx4 v164, s[16:19], s50 offen lds
v_mul_f32 v53, v53, v65
v_exp_f32 v169, v169
v_mul_f32 v54, v54, v66
v_exp_f32 v170, v170
v_mfma_f32_16x16x32_bf16 v[144:147], a[32:35], a[12:15], v[144:147]
ds_read_b128 a[24:27], v161 offset:4096
v_mul_f32 v55, v55, v67
v_add_f32 v167, 1.0, v167
v_add_f32 v168, 1.0, v168
v_add_f32 v169, 1.0, v169
v_add_f32 v170, 1.0, v170
v_rcp_f32 v167, v167
s_setprio 2
v_mfma_f32_16x16x32_bf16 v[100:103], a[36:39], a[0:3], v[100:103]
ds_read_b128 a[28:31], v161 offset:6144
v_rcp_f32 v168, v168
v_rcp_f32 v169, v169
v_rcp_f32 v170, v170
v_mfma_f32_16x16x32_bf16 v[116:119], a[36:39], a[4:7], v[116:119]
ds_read_b64_tr_b16 a[56:57], v162 offset:40960
v_mul_f32 v52, v52, v167
v_mul_f32 v53, v53, v168
v_mul_f32 v54, v54, v169
v_mul_f32 v55, v55, v170
v_cvt_pk_bf16_f32 v62, v52, v53
v_cvt_pk_bf16_f32 v63, v54, v55
v_mfma_f32_16x16x32_bf16 v[132:135], a[36:39], a[8:11], v[132:135]
ds_read_b64_tr_b16 a[58:59], v162 offset:41984
s_add_u32 m0, s58, 68608
s_add_u32 s50, s50, 128
buffer_load_dwordx4 v165, s[16:19], s51 offen lds
buffer_store_dwordx4 v[60:63], v171, s[40:43], s92 offen sc1
s_add_u32 s92, s92, 147456
s_waitcnt lgkmcnt(10)
buffer_store_dwordx4 v[32:35], v171, s[40:43], s93 offen sc1
s_add_u32 s93, s93, 147456
buffer_store_dwordx4 v[56:59], v171, s[40:43], s93 offen sc1
v_mul_f32 v167, v72, v72
v_mul_f32 v168, v73, v73
v_mfma_f32_16x16x32_bf16 v[148:151], a[36:39], a[12:15], v[148:151]
ds_read_b64_tr_b16 a[60:61], v163 offset:40960
v_mul_f32 v169, v74, v74
v_mul_f32 v170, v75, v75
v_fma_f32 v167, v167, s8, v173
v_fma_f32 v168, v168, s8, v173
v_fma_f32 v169, v169, s8, v173
v_fma_f32 v170, v170, s8, v173
s_setprio 1
v_mfma_f32_16x16x32_bf16 v[104:107], a[40:43], a[0:3], v[104:107]
ds_read_b64_tr_b16 a[62:63], v163 offset:41984
v_mul_f32 v167, v167, v72
v_mul_f32 v168, v168, v73
v_mul_f32 v169, v169, v74
v_mul_f32 v170, v170, v75
v_exp_f32 v167, v167
v_mfma_f32_16x16x32_bf16 v[120:123], a[40:43], a[4:7], v[120:123]
ds_read_b64_tr_b16 a[64:65], v162 offset:45056
v_mul_f32 v72, v72, v84
v_exp_f32 v168, v168
v_mul_f32 v73, v73, v85
v_exp_f32 v169, v169
v_mfma_f32_16x16x32_bf16 v[136:139], a[40:43], a[8:11], v[136:139]
ds_read_b64_tr_b16 a[66:67], v162 offset:46080
s_add_u32 m0, s62, 131072
s_add_u32 s51, s51, 128
buffer_load_dwordx4 v166, s[28:31], s53 offen lds
v_mul_f32 v74, v74, v86
v_exp_f32 v170, v170
v_mul_f32 v75, v75, v87
v_add_f32 v167, 1.0, v167
v_add_f32 v168, 1.0, v168
v_mfma_f32_16x16x32_bf16 v[152:155], a[40:43], a[12:15], v[152:155]
ds_read_b64_tr_b16 a[68:69], v163 offset:45056
v_add_f32 v169, 1.0, v169
v_add_f32 v170, 1.0, v170
v_rcp_f32 v167, v167
v_rcp_f32 v168, v168
s_setprio 0
v_mfma_f32_16x16x32_bf16 v[108:111], a[44:47], a[0:3], v[108:111]
ds_read_b64_tr_b16 a[70:71], v163 offset:46080
v_rcp_f32 v169, v169
v_rcp_f32 v170, v170
v_mul_f32 v72, v72, v167
v_mul_f32 v73, v73, v168
v_mfma_f32_16x16x32_bf16 v[124:127], a[44:47], a[4:7], v[124:127]
v_mul_f32 v74, v74, v169
v_mul_f32 v75, v75, v170
v_cvt_pk_bf16_f32 v84, v72, v73
v_cvt_pk_bf16_f32 v85, v74, v75
v_mul_f32 v167, v76, v76
v_mul_f32 v168, v77, v77
v_mfma_f32_16x16x32_bf16 v[140:143], a[44:47], a[8:11], v[140:143]
v_mul_f32 v169, v78, v78
v_mul_f32 v170, v79, v79
v_fma_f32 v167, v167, s8, v173
v_fma_f32 v168, v168, s8, v173
v_fma_f32 v169, v169, s8, v173
v_fma_f32 v170, v170, s8, v173
v_mfma_f32_16x16x32_bf16 v[156:159], a[44:47], a[12:15], v[156:159]
v_mul_f32 v167, v167, v76
v_mul_f32 v168, v168, v77
v_mul_f32 v169, v169, v78
v_mul_f32 v170, v170, v79
v_exp_f32 v167, v167
s_waitcnt vmcnt(12) lgkmcnt(0)
s_barrier
s_setprio 3
v_mfma_f32_16x16x32_bf16 v[96:99], a[56:59], a[16:19], v[96:99]
ds_read_b128 a[0:3], v160 offset:32768
v_mul_f32 v76, v76, v88
v_exp_f32 v168, v168
v_mul_f32 v77, v77, v89
v_exp_f32 v169, v169
v_mfma_f32_16x16x32_bf16 v[112:115], a[56:59], a[20:23], v[112:115]
ds_read_b128 a[4:7], v160 offset:34816
v_mul_f32 v78, v78, v90
v_exp_f32 v170, v170
v_mul_f32 v79, v79, v91
v_add_f32 v167, 1.0, v167
v_add_f32 v168, 1.0, v168
v_mfma_f32_16x16x32_bf16 v[128:131], a[56:59], a[24:27], v[128:131]
ds_read_b128 a[8:11], v160 offset:36864
s_add_u32 m0, s58, 0
s_add_u32 s53, s53, 229376
buffer_load_dwordx4 v164, s[16:19], s48 offen lds
v_add_f32 v169, 1.0, v169
v_add_f32 v170, 1.0, v170
v_rcp_f32 v167, v167
v_rcp_f32 v168, v168
v_mfma_f32_16x16x32_bf16 v[144:147], a[56:59], a[28:31], v[144:147]
ds_read_b128 a[12:15], v160 offset:38912
v_rcp_f32 v169, v169
v_rcp_f32 v170, v170
v_mul_f32 v76, v76, v167
v_mul_f32 v77, v77, v168
s_setprio 2
v_mfma_f32_16x16x32_bf16 v[100:103], a[60:63], a[16:19], v[100:103]
ds_read_b64_tr_b16 a[32:33], v162 offset:0
v_mul_f32 v78, v78, v169
v_mul_f32 v79, v79, v170
v_cvt_pk_bf16_f32 v86, v76, v77
v_cvt_pk_bf16_f32 v87, v78, v79
buffer_store_dwordx4 v[84:87], v171, s[40:43], s92 offen sc1
v_mfma_f32_16x16x32_bf16 v[116:119], a[60:63], a[20:23], v[116:119]
ds_read_b64_tr_b16 a[34:35], v162 offset:1024
v_mfma_f32_16x16x32_bf16 v[132:135], a[60:63], a[24:27], v[132:135]
ds_read_b64_tr_b16 a[36:37], v163 offset:0
s_add_u32 m0, s58, 1024
s_add_u32 s48, s48, 128
buffer_load_dwordx4 v165, s[16:19], s49 offen lds
v_mfma_f32_16x16x32_bf16 v[148:151], a[60:63], a[28:31], v[148:151]
ds_read_b64_tr_b16 a[38:39], v163 offset:1024
s_setprio 1
v_mfma_f32_16x16x32_bf16 v[104:107], a[64:67], a[16:19], v[104:107]
ds_read_b64_tr_b16 a[40:41], v162 offset:4096
v_mfma_f32_16x16x32_bf16 v[120:123], a[64:67], a[20:23], v[120:123]
ds_read_b64_tr_b16 a[42:43], v162 offset:5120
v_mfma_f32_16x16x32_bf16 v[136:139], a[64:67], a[24:27], v[136:139]
ds_read_b64_tr_b16 a[44:45], v163 offset:4096
s_add_u32 m0, s62, 139264
s_add_u32 s49, s49, 128
buffer_load_dwordx4 v166, s[28:31], s53 offen lds
v_mfma_f32_16x16x32_bf16 v[152:155], a[64:67], a[28:31], v[152:155]
ds_read_b64_tr_b16 a[46:47], v163 offset:5120
s_setprio 0
v_mfma_f32_16x16x32_bf16 v[108:111], a[68:71], a[16:19], v[108:111]
v_mfma_f32_16x16x32_bf16 v[124:127], a[68:71], a[20:23], v[124:127]
v_mfma_f32_16x16x32_bf16 v[140:143], a[68:71], a[24:27], v[140:143]
v_mfma_f32_16x16x32_bf16 v[156:159], a[68:71], a[28:31], v[156:159]
s_waitcnt vmcnt(16) lgkmcnt(0)
s_barrier
s_setprio 3
v_mfma_f32_16x16x32_bf16 v[96:99], a[32:35], a[0:3], v[96:99]
ds_read_b128 a[16:19], v161 offset:32768
v_mfma_f32_16x16x32_bf16 v[112:115], a[32:35], a[4:7], v[112:115]
ds_read_b128 a[20:23], v161 offset:34816
v_mfma_f32_16x16x32_bf16 v[128:131], a[32:35], a[8:11], v[128:131]
ds_read_b128 a[24:27], v161 offset:36864
s_add_u32 m0, s58, 2048
s_add_u32 s53, s53, 229376
buffer_load_dwordx4 v164, s[16:19], s50 offen lds
v_mfma_f32_16x16x32_bf16 v[144:147], a[32:35], a[12:15], v[144:147]
ds_read_b128 a[28:31], v161 offset:38912
s_setprio 2
v_mfma_f32_16x16x32_bf16 v[100:103], a[36:39], a[0:3], v[100:103]
ds_read_b64_tr_b16 a[56:57], v162 offset:8192
v_mfma_f32_16x16x32_bf16 v[116:119], a[36:39], a[4:7], v[116:119]
ds_read_b64_tr_b16 a[58:59], v162 offset:9216
v_mfma_f32_16x16x32_bf16 v[132:135], a[36:39], a[8:11], v[132:135]
ds_read_b64_tr_b16 a[60:61], v163 offset:8192
s_add_u32 m0, s58, 3072
s_add_u32 s50, s50, 128
buffer_load_dwordx4 v165, s[16:19], s51 offen lds
v_mfma_f32_16x16x32_bf16 v[148:151], a[36:39], a[12:15], v[148:151]
ds_read_b64_tr_b16 a[62:63], v163 offset:9216
s_setprio 1
v_mfma_f32_16x16x32_bf16 v[104:107], a[40:43], a[0:3], v[104:107]
ds_read_b64_tr_b16 a[64:65], v162 offset:12288
v_mfma_f32_16x16x32_bf16 v[120:123], a[40:43], a[4:7], v[120:123]
ds_read_b64_tr_b16 a[66:67], v162 offset:13312
v_mfma_f32_16x16x32_bf16 v[136:139], a[40:43], a[8:11], v[136:139]
ds_read_b64_tr_b16 a[68:69], v163 offset:12288
s_add_u32 m0, s62, 98304
s_add_u32 s51, s51, 128
buffer_load_dwordx4 v166, s[28:31], s53 offen lds
v_mfma_f32_16x16x32_bf16 v[152:155], a[40:43], a[12:15], v[152:155]
ds_read_b64_tr_b16 a[70:71], v163 offset:13312
s_setprio 0
v_mfma_f32_16x16x32_bf16 v[108:111], a[44:47], a[0:3], v[108:111]
v_mfma_f32_16x16x32_bf16 v[124:127], a[44:47], a[4:7], v[124:127]
v_mfma_f32_16x16x32_bf16 v[140:143], a[44:47], a[8:11], v[140:143]
v_mfma_f32_16x16x32_bf16 v[156:159], a[44:47], a[12:15], v[156:159]
s_waitcnt vmcnt(11) lgkmcnt(0)
s_barrier
s_setprio 3
v_mfma_f32_16x16x32_bf16 v[96:99], a[56:59], a[16:19], v[96:99]
v_add_u32 v160, 0x8000, v160
v_mfma_f32_16x16x32_bf16 v[112:115], a[56:59], a[20:23], v[112:115]
ds_read_b128 a[0:3], v160 offset:32768
v_mfma_f32_16x16x32_bf16 v[128:131], a[56:59], a[24:27], v[128:131]
ds_read_b128 a[4:7], v160 offset:34816
s_add_u32 m0, s58, 32768
s_add_u32 s53, s53, 229376
buffer_load_dwordx4 v164, s[16:19], s48 offen lds
v_mfma_f32_16x16x32_bf16 v[144:147], a[56:59], a[28:31], v[144:147]
ds_read_b128 a[8:11], v160 offset:36864
s_setprio 2
v_mfma_f32_16x16x32_bf16 v[100:103], a[60:63], a[16:19], v[100:103]
ds_read_b128 a[12:15], v160 offset:38912
v_mfma_f32_16x16x32_bf16 v[116:119], a[60:63], a[20:23], v[116:119]
ds_read_b64_tr_b16 a[32:33], v162 offset:16384
v_mfma_f32_16x16x32_bf16 v[132:135], a[60:63], a[24:27], v[132:135]
ds_read_b64_tr_b16 a[34:35], v162 offset:17408
s_add_u32 m0, s58, 33792
s_add_u32 s48, s48, 128
buffer_load_dwordx4 v165, s[16:19], s49 offen lds
v_mfma_f32_16x16x32_bf16 v[148:151], a[60:63], a[28:31], v[148:151]
ds_read_b64_tr_b16 a[36:37], v163 offset:16384
s_setprio 1
v_mfma_f32_16x16x32_bf16 v[104:107], a[64:67], a[16:19], v[104:107]
ds_read_b64_tr_b16 a[38:39], v163 offset:17408
v_mfma_f32_16x16x32_bf16 v[120:123], a[64:67], a[20:23], v[120:123]
ds_read_b64_tr_b16 a[40:41], v162 offset:20480
v_mfma_f32_16x16x32_bf16 v[136:139], a[64:67], a[24:27], v[136:139]
ds_read_b64_tr_b16 a[42:43], v162 offset:21504
s_add_u32 m0, s62, 106496
s_add_u32 s49, s49, 128
buffer_load_dwordx4 v166, s[28:31], s53 offen lds
v_mfma_f32_16x16x32_bf16 v[152:155], a[64:67], a[28:31], v[152:155]
ds_read_b64_tr_b16 a[44:45], v163 offset:20480
s_setprio 0
v_mfma_f32_16x16x32_bf16 v[108:111], a[68:71], a[16:19], v[108:111]
ds_read_b64_tr_b16 a[46:47], v163 offset:21504
v_mfma_f32_16x16x32_bf16 v[124:127], a[68:71], a[20:23], v[124:127]
v_mfma_f32_16x16x32_bf16 v[140:143], a[68:71], a[24:27], v[140:143]
v_mfma_f32_16x16x32_bf16 v[156:159], a[68:71], a[28:31], v[156:159]
s_waitcnt vmcnt(14) lgkmcnt(0)
s_barrier
s_setprio 3
v_mfma_f32_16x16x32_bf16 v[96:99], a[32:35], a[0:3], v[96:99]
v_add_u32 v161, 0x8000, v161
v_mfma_f32_16x16x32_bf16 v[112:115], a[32:35], a[4:7], v[112:115]
ds_read_b128 a[16:19], v161 offset:32768
v_mfma_f32_16x16x32_bf16 v[128:131], a[32:35], a[8:11], v[128:131]
ds_read_b128 a[20:23], v161 offset:34816
s_add_u32 m0, s58, 34816
s_add_u32 s53, s53, 229376
buffer_load_dwordx4 v164, s[16:19], s50 offen lds
v_mfma_f32_16x16x32_bf16 v[144:147], a[32:35], a[12:15], v[144:147]
ds_read_b128 a[24:27], v161 offset:36864
s_setprio 2
v_mfma_f32_16x16x32_bf16 v[100:103], a[36:39], a[0:3], v[100:103]
ds_read_b128 a[28:31], v161 offset:38912
v_mfma_f32_16x16x32_bf16 v[116:119], a[36:39], a[4:7], v[116:119]
ds_read_b64_tr_b16 a[56:57], v162 offset:24576
v_mfma_f32_16x16x32_bf16 v[132:135], a[36:39], a[8:11], v[132:135]
ds_read_b64_tr_b16 a[58:59], v162 offset:25600
s_add_u32 m0, s58, 35840
s_add_u32 s50, s50, 128
buffer_load_dwordx4 v165, s[16:19], s51 offen lds
v_mfma_f32_16x16x32_bf16 v[148:151], a[36:39], a[12:15], v[148:151]
ds_read_b64_tr_b16 a[60:61], v163 offset:24576
s_setprio 1
v_mfma_f32_16x16x32_bf16 v[104:107], a[40:43], a[0:3], v[104:107]
ds_read_b64_tr_b16 a[62:63], v163 offset:25600
v_mfma_f32_16x16x32_bf16 v[120:123], a[40:43], a[4:7], v[120:123]
ds_read_b64_tr_b16 a[64:65], v162 offset:28672
v_mfma_f32_16x16x32_bf16 v[136:139], a[40:43], a[8:11], v[136:139]
ds_read_b64_tr_b16 a[66:67], v162 offset:29696
s_add_u32 m0, s62, 114688
s_add_u32 s51, s51, 128
buffer_load_dwordx4 v166, s[28:31], s53 offen lds
v_mfma_f32_16x16x32_bf16 v[152:155], a[40:43], a[12:15], v[152:155]
ds_read_b64_tr_b16 a[68:69], v163 offset:28672
s_setprio 0
v_mfma_f32_16x16x32_bf16 v[108:111], a[44:47], a[0:3], v[108:111]
ds_read_b64_tr_b16 a[70:71], v163 offset:29696
v_mfma_f32_16x16x32_bf16 v[124:127], a[44:47], a[4:7], v[124:127]
v_mfma_f32_16x16x32_bf16 v[140:143], a[44:47], a[8:11], v[140:143]
v_mfma_f32_16x16x32_bf16 v[156:159], a[44:47], a[12:15], v[156:159]
s_waitcnt vmcnt(7) lgkmcnt(0)
s_barrier
s_cmp_lg_u32 s87, 0
s_cbranch_scc1 k1_kernel_b_h1_sg
v_mov_b32 v174, 1
s_mov_b64 exec, 1
buffer_store_dword v174, off, s[40:43], s81 sc1
s_mov_b64 exec, -1
k1_kernel_b_h1_sg:
s_setprio 3
v_mfma_f32_16x16x32_bf16 v[96:99], a[56:59], a[16:19], v[96:99]
v_subrev_u32 v160, 0x8000, v160
v_mfma_f32_16x16x32_bf16 v[112:115], a[56:59], a[20:23], v[112:115]
ds_read_b128 a[0:3], v160 offset:0
v_mfma_f32_16x16x32_bf16 v[128:131], a[56:59], a[24:27], v[128:131]
ds_read_b128 a[4:7], v160 offset:2048
s_add_u32 m0, s58, 65536
s_add_u32 s53, s53, 229376
buffer_load_dwordx4 v164, s[16:19], s48 offen lds
v_mfma_f32_16x16x32_bf16 v[144:147], a[56:59], a[28:31], v[144:147]
ds_read_b128 a[8:11], v160 offset:4096
s_setprio 2
v_mfma_f32_16x16x32_bf16 v[100:103], a[60:63], a[16:19], v[100:103]
ds_read_b128 a[12:15], v160 offset:6144
v_mfma_f32_16x16x32_bf16 v[116:119], a[60:63], a[20:23], v[116:119]
ds_read_b64_tr_b16 a[32:33], v162 offset:32768
v_mfma_f32_16x16x32_bf16 v[132:135], a[60:63], a[24:27], v[132:135]
ds_read_b64_tr_b16 a[34:35], v162 offset:33792
s_add_u32 m0, s58, 66560
s_add_u32 s48, s48, 128
buffer_load_dwordx4 v165, s[16:19], s49 offen lds
v_mfma_f32_16x16x32_bf16 v[148:151], a[60:63], a[28:31], v[148:151]
ds_read_b64_tr_b16 a[36:37], v163 offset:32768
s_setprio 1
v_mfma_f32_16x16x32_bf16 v[104:107], a[64:67], a[16:19], v[104:107]
ds_read_b64_tr_b16 a[38:39], v163 offset:33792
v_mfma_f32_16x16x32_bf16 v[120:123], a[64:67], a[20:23], v[120:123]
ds_read_b64_tr_b16 a[40:41], v162 offset:36864
v_mfma_f32_16x16x32_bf16 v[136:139], a[64:67], a[24:27], v[136:139]
ds_read_b64_tr_b16 a[42:43], v162 offset:37888
s_add_u32 m0, s62, 122880
s_add_u32 s49, s49, 128
buffer_load_dwordx4 v166, s[28:31], s53 offen lds
v_mfma_f32_16x16x32_bf16 v[152:155], a[64:67], a[28:31], v[152:155]
ds_read_b64_tr_b16 a[44:45], v163 offset:36864
s_setprio 0
v_mfma_f32_16x16x32_bf16 v[108:111], a[68:71], a[16:19], v[108:111]
ds_read_b64_tr_b16 a[46:47], v163 offset:37888
v_mfma_f32_16x16x32_bf16 v[124:127], a[68:71], a[20:23], v[124:127]
v_mfma_f32_16x16x32_bf16 v[140:143], a[68:71], a[24:27], v[140:143]
v_mfma_f32_16x16x32_bf16 v[156:159], a[68:71], a[28:31], v[156:159]
s_waitcnt vmcnt(10) lgkmcnt(0)
s_barrier
s_setprio 3
v_mfma_f32_16x16x32_bf16 v[96:99], a[32:35], a[0:3], v[96:99]
v_subrev_u32 v161, 0x8000, v161
v_mfma_f32_16x16x32_bf16 v[112:115], a[32:35], a[4:7], v[112:115]
ds_read_b128 a[16:19], v161 offset:0
v_mfma_f32_16x16x32_bf16 v[128:131], a[32:35], a[8:11], v[128:131]
ds_read_b128 a[20:23], v161 offset:2048
s_add_u32 m0, s58, 67584
s_add_u32 s53, s53, 229376
buffer_load_dwordx4 v164, s[16:19], s50 offen lds
v_mfma_f32_16x16x32_bf16 v[144:147], a[32:35], a[12:15], v[144:147]
ds_read_b128 a[24:27], v161 offset:4096
s_setprio 2
v_mfma_f32_16x16x32_bf16 v[100:103], a[36:39], a[0:3], v[100:103]
ds_read_b128 a[28:31], v161 offset:6144
v_mfma_f32_16x16x32_bf16 v[116:119], a[36:39], a[4:7], v[116:119]
ds_read_b64_tr_b16 a[56:57], v162 offset:40960
v_mfma_f32_16x16x32_bf16 v[132:135], a[36:39], a[8:11], v[132:135]
ds_read_b64_tr_b16 a[58:59], v162 offset:41984
s_add_u32 m0, s58, 68608
s_add_u32 s50, s50, 128
buffer_load_dwordx4 v165, s[16:19], s51 offen lds
v_mfma_f32_16x16x32_bf16 v[148:151], a[36:39], a[12:15], v[148:151]
ds_read_b64_tr_b16 a[60:61], v163 offset:40960
s_setprio 1
v_mfma_f32_16x16x32_bf16 v[104:107], a[40:43], a[0:3], v[104:107]
ds_read_b64_tr_b16 a[62:63], v163 offset:41984
v_mfma_f32_16x16x32_bf16 v[120:123], a[40:43], a[4:7], v[120:123]
ds_read_b64_tr_b16 a[64:65], v162 offset:45056
v_mfma_f32_16x16x32_bf16 v[136:139], a[40:43], a[8:11], v[136:139]
ds_read_b64_tr_b16 a[66:67], v162 offset:46080
s_add_u32 m0, s62, 131072
s_add_u32 s51, s51, 128
buffer_load_dwordx4 v166, s[28:31], s53 offen lds
v_mfma_f32_16x16x32_bf16 v[152:155], a[40:43], a[12:15], v[152:155]
ds_read_b64_tr_b16 a[68:69], v163 offset:45056
s_setprio 0
v_mfma_f32_16x16x32_bf16 v[108:111], a[44:47], a[0:3], v[108:111]
ds_read_b64_tr_b16 a[70:71], v163 offset:46080
v_mfma_f32_16x16x32_bf16 v[124:127], a[44:47], a[4:7], v[124:127]
v_mfma_f32_16x16x32_bf16 v[140:143], a[44:47], a[8:11], v[140:143]
v_mfma_f32_16x16x32_bf16 v[156:159], a[44:47], a[12:15], v[156:159]
s_waitcnt vmcnt(7) lgkmcnt(0)
s_barrier
s_setprio 3
v_mfma_f32_16x16x32_bf16 v[96:99], a[56:59], a[16:19], v[96:99]
ds_read_b128 a[0:3], v160 offset:32768
v_mfma_f32_16x16x32_bf16 v[112:115], a[56:59], a[20:23], v[112:115]
ds_read_b128 a[4:7], v160 offset:34816
v_mfma_f32_16x16x32_bf16 v[128:131], a[56:59], a[24:27], v[128:131]
ds_read_b128 a[8:11], v160 offset:36864
s_add_u32 m0, s58, 0
s_add_u32 s53, s53, 229376
buffer_load_dwordx4 v164, s[16:19], s48 offen lds
v_mfma_f32_16x16x32_bf16 v[144:147], a[56:59], a[28:31], v[144:147]
ds_read_b128 a[12:15], v160 offset:38912
s_setprio 2
v_mfma_f32_16x16x32_bf16 v[100:103], a[60:63], a[16:19], v[100:103]
ds_read_b64_tr_b16 a[32:33], v162 offset:0
v_mfma_f32_16x16x32_bf16 v[116:119], a[60:63], a[20:23], v[116:119]
ds_read_b64_tr_b16 a[34:35], v162 offset:1024
v_mfma_f32_16x16x32_bf16 v[132:135], a[60:63], a[24:27], v[132:135]
ds_read_b64_tr_b16 a[36:37], v163 offset:0
s_add_u32 m0, s58, 1024
s_add_u32 s48, s48, 128
buffer_load_dwordx4 v165, s[16:19], s49 offen lds
v_mfma_f32_16x16x32_bf16 v[148:151], a[60:63], a[28:31], v[148:151]
ds_read_b64_tr_b16 a[38:39], v163 offset:1024
s_setprio 1
v_mfma_f32_16x16x32_bf16 v[104:107], a[64:67], a[16:19], v[104:107]
ds_read_b64_tr_b16 a[40:41], v162 offset:4096
v_mfma_f32_16x16x32_bf16 v[120:123], a[64:67], a[20:23], v[120:123]
ds_read_b64_tr_b16 a[42:43], v162 offset:5120
v_mfma_f32_16x16x32_bf16 v[136:139], a[64:67], a[24:27], v[136:139]
ds_read_b64_tr_b16 a[44:45], v163 offset:4096
s_add_u32 m0, s62, 139264
s_add_u32 s49, s49, 128
buffer_load_dwordx4 v166, s[28:31], s53 offen lds
v_mfma_f32_16x16x32_bf16 v[152:155], a[64:67], a[28:31], v[152:155]
ds_read_b64_tr_b16 a[46:47], v163 offset:5120
s_setprio 0
v_mfma_f32_16x16x32_bf16 v[108:111], a[68:71], a[16:19], v[108:111]
v_mfma_f32_16x16x32_bf16 v[124:127], a[68:71], a[20:23], v[124:127]
v_mfma_f32_16x16x32_bf16 v[140:143], a[68:71], a[24:27], v[140:143]
v_mfma_f32_16x16x32_bf16 v[156:159], a[68:71], a[28:31], v[156:159]
s_waitcnt vmcnt(10) lgkmcnt(0)
s_barrier
s_setprio 3
v_mfma_f32_16x16x32_bf16 v[96:99], a[32:35], a[0:3], v[96:99]
ds_read_b128 a[16:19], v161 offset:32768
v_mfma_f32_16x16x32_bf16 v[112:115], a[32:35], a[4:7], v[112:115]
ds_read_b128 a[20:23], v161 offset:34816
v_mfma_f32_16x16x32_bf16 v[128:131], a[32:35], a[8:11], v[128:131]
ds_read_b128 a[24:27], v161 offset:36864
s_add_u32 m0, s58, 2048
s_add_u32 s53, s53, 229376
buffer_load_dwordx4 v164, s[16:19], s50 offen lds
v_mfma_f32_16x16x32_bf16 v[144:147], a[32:35], a[12:15], v[144:147]
ds_read_b128 a[28:31], v161 offset:38912
s_setprio 2
v_mfma_f32_16x16x32_bf16 v[100:103], a[36:39], a[0:3], v[100:103]
ds_read_b64_tr_b16 a[56:57], v162 offset:8192
v_mfma_f32_16x16x32_bf16 v[116:119], a[36:39], a[4:7], v[116:119]
ds_read_b64_tr_b16 a[58:59], v162 offset:9216
v_mfma_f32_16x16x32_bf16 v[132:135], a[36:39], a[8:11], v[132:135]
ds_read_b64_tr_b16 a[60:61], v163 offset:8192
s_add_u32 m0, s58, 3072
s_add_u32 s50, s50, 128
buffer_load_dwordx4 v165, s[16:19], s51 offen lds
v_mfma_f32_16x16x32_bf16 v[148:151], a[36:39], a[12:15], v[148:151]
ds_read_b64_tr_b16 a[62:63], v163 offset:9216
s_setprio 1
v_mfma_f32_16x16x32_bf16 v[104:107], a[40:43], a[0:3], v[104:107]
ds_read_b64_tr_b16 a[64:65], v162 offset:12288
v_mfma_f32_16x16x32_bf16 v[120:123], a[40:43], a[4:7], v[120:123]
ds_read_b64_tr_b16 a[66:67], v162 offset:13312
v_mfma_f32_16x16x32_bf16 v[136:139], a[40:43], a[8:11], v[136:139]
ds_read_b64_tr_b16 a[68:69], v163 offset:12288
s_add_u32 m0, s62, 98304
s_add_u32 s51, s51, 128
buffer_load_dwordx4 v166, s[28:31], s53 offen lds
v_mfma_f32_16x16x32_bf16 v[152:155], a[40:43], a[12:15], v[152:155]
ds_read_b64_tr_b16 a[70:71], v163 offset:13312
s_setprio 0
v_mfma_f32_16x16x32_bf16 v[108:111], a[44:47], a[0:3], v[108:111]
v_mfma_f32_16x16x32_bf16 v[124:127], a[44:47], a[4:7], v[124:127]
v_mfma_f32_16x16x32_bf16 v[140:143], a[44:47], a[8:11], v[140:143]
v_mfma_f32_16x16x32_bf16 v[156:159], a[44:47], a[12:15], v[156:159]
s_waitcnt vmcnt(7) lgkmcnt(0)
s_barrier
s_setprio 3
v_mfma_f32_16x16x32_bf16 v[96:99], a[56:59], a[16:19], v[96:99]
v_add_u32 v160, 0x8000, v160
v_mfma_f32_16x16x32_bf16 v[112:115], a[56:59], a[20:23], v[112:115]
ds_read_b128 a[0:3], v160 offset:32768
v_mfma_f32_16x16x32_bf16 v[128:131], a[56:59], a[24:27], v[128:131]
ds_read_b128 a[4:7], v160 offset:34816
s_add_u32 m0, s58, 32768
s_add_u32 s53, s53, 229376
buffer_load_dwordx4 v164, s[16:19], s48 offen lds
v_mfma_f32_16x16x32_bf16 v[144:147], a[56:59], a[28:31], v[144:147]
ds_read_b128 a[8:11], v160 offset:36864
s_setprio 2
v_mfma_f32_16x16x32_bf16 v[100:103], a[60:63], a[16:19], v[100:103]
ds_read_b128 a[12:15], v160 offset:38912
v_mfma_f32_16x16x32_bf16 v[116:119], a[60:63], a[20:23], v[116:119]
ds_read_b64_tr_b16 a[32:33], v162 offset:16384
v_mfma_f32_16x16x32_bf16 v[132:135], a[60:63], a[24:27], v[132:135]
ds_read_b64_tr_b16 a[34:35], v162 offset:17408
s_add_u32 m0, s58, 33792
s_add_u32 s48, s48, 0
buffer_load_dwordx4 v165, s[16:19], s49 offen lds
v_mfma_f32_16x16x32_bf16 v[148:151], a[60:63], a[28:31], v[148:151]
ds_read_b64_tr_b16 a[36:37], v163 offset:16384
s_setprio 1
v_mfma_f32_16x16x32_bf16 v[104:107], a[64:67], a[16:19], v[104:107]
ds_read_b64_tr_b16 a[38:39], v163 offset:17408
v_mfma_f32_16x16x32_bf16 v[120:123], a[64:67], a[20:23], v[120:123]
ds_read_b64_tr_b16 a[40:41], v162 offset:20480
v_mfma_f32_16x16x32_bf16 v[136:139], a[64:67], a[24:27], v[136:139]
ds_read_b64_tr_b16 a[42:43], v162 offset:21504
s_add_u32 m0, s62, 106496
s_add_u32 s49, s49, 0
buffer_load_dwordx4 v166, s[28:31], s53 offen lds
v_mfma_f32_16x16x32_bf16 v[152:155], a[64:67], a[28:31], v[152:155]
ds_read_b64_tr_b16 a[44:45], v163 offset:20480
s_setprio 0
v_mfma_f32_16x16x32_bf16 v[108:111], a[68:71], a[16:19], v[108:111]
ds_read_b64_tr_b16 a[46:47], v163 offset:21504
v_mfma_f32_16x16x32_bf16 v[124:127], a[68:71], a[20:23], v[124:127]
v_mfma_f32_16x16x32_bf16 v[140:143], a[68:71], a[24:27], v[140:143]
v_mfma_f32_16x16x32_bf16 v[156:159], a[68:71], a[28:31], v[156:159]
s_waitcnt vmcnt(10) lgkmcnt(0)
s_barrier
s_cmp_lg_u32 s87, 0
s_cbranch_scc1 k1_kernel_b_g1_pi
v_lshrrev_b32 v172, 4, v171
v_min_u32 v172, 9, v172
v_and_b32 v174, 1, v172
v_lshlrev_b32 v172, 3, v172
v_lshlrev_b32 v174, 2, v174
v_sub_u32 v172, v172, v174
buffer_load_dword v172, v172, s[40:43], s66 offen offset:0 sc1
k1_kernel_b_g1_pi:
s_setprio 3
v_mfma_f32_16x16x32_bf16 v[96:99], a[32:35], a[0:3], v[96:99]
v_add_u32 v161, 0x8000, v161
v_mfma_f32_16x16x32_bf16 v[112:115], a[32:35], a[4:7], v[112:115]
ds_read_b128 a[16:19], v161 offset:32768
v_mfma_f32_16x16x32_bf16 v[128:131], a[32:35], a[8:11], v[128:131]
ds_read_b128 a[20:23], v161 offset:34816
s_add_u32 m0, s58, 34816
s_add_u32 s53, s53, 0
buffer_load_dwordx4 v164, s[16:19], s50 offen lds
v_mfma_f32_16x16x32_bf16 v[144:147], a[32:35], a[12:15], v[144:147]
ds_read_b128 a[24:27], v161 offset:36864
s_setprio 2
v_mfma_f32_16x16x32_bf16 v[100:103], a[36:39], a[0:3], v[100:103]
ds_read_b128 a[28:31], v161 offset:38912
v_mfma_f32_16x16x32_bf16 v[116:119], a[36:39], a[4:7], v[116:119]
ds_read_b64_tr_b16 a[56:57], v162 offset:24576
v_mfma_f32_16x16x32_bf16 v[132:135], a[36:39], a[8:11], v[132:135]
ds_read_b64_tr_b16 a[58:59], v162 offset:25600
v_mfma_f32_16x16x32_bf16 v[148:151], a[36:39], a[12:15], v[148:151]
ds_read_b64_tr_b16 a[60:61], v163 offset:24576
s_setprio 1
v_mfma_f32_16x16x32_bf16 v[104:107], a[40:43], a[0:3], v[104:107]
ds_read_b64_tr_b16 a[62:63], v163 offset:25600
s_add_u32 m0, s58, 35840
s_add_u32 s50, s50, 0
buffer_load_dwordx4 v165, s[16:19], s51 offen lds
v_mfma_f32_16x16x32_bf16 v[120:123], a[40:43], a[4:7], v[120:123]
ds_read_b64_tr_b16 a[64:65], v162 offset:28672
v_mfma_f32_16x16x32_bf16 v[136:139], a[40:43], a[8:11], v[136:139]
ds_read_b64_tr_b16 a[66:67], v162 offset:29696
v_mfma_f32_16x16x32_bf16 v[152:155], a[40:43], a[12:15], v[152:155]
ds_read_b64_tr_b16 a[68:69], v163 offset:28672
s_setprio 0
v_mfma_f32_16x16x32_bf16 v[108:111], a[44:47], a[0:3], v[108:111]
ds_read_b64_tr_b16 a[70:71], v163 offset:29696
v_mfma_f32_16x16x32_bf16 v[124:127], a[44:47], a[4:7], v[124:127]
v_mfma_f32_16x16x32_bf16 v[140:143], a[44:47], a[8:11], v[140:143]
v_mfma_f32_16x16x32_bf16 v[156:159], a[44:47], a[12:15], v[156:159]
s_waitcnt vmcnt(6) lgkmcnt(0)
s_barrier
s_setprio 3
v_mfma_f32_16x16x32_bf16 v[96:99], a[56:59], a[16:19], v[96:99]
v_subrev_u32 v160, 0x8000, v160
v_mfma_f32_16x16x32_bf16 v[112:115], a[56:59], a[20:23], v[112:115]
ds_read_b128 a[0:3], v160 offset:0
v_mfma_f32_16x16x32_bf16 v[128:131], a[56:59], a[24:27], v[128:131]
ds_read_b128 a[4:7], v160 offset:2048
s_add_u32 m0, s62, 65536
s_add_u32 s51, s51, 0
buffer_load_dwordx4 v175, s[32:35], s64 offen lds
v_mfma_f32_16x16x32_bf16 v[144:147], a[56:59], a[28:31], v[144:147]
ds_read_b128 a[8:11], v160 offset:4096
s_setprio 2
v_mfma_f32_16x16x32_bf16 v[100:103], a[60:63], a[16:19], v[100:103]
ds_read_b128 a[12:15], v160 offset:6144
v_mfma_f32_16x16x32_bf16 v[116:119], a[60:63], a[20:23], v[116:119]
ds_read_b64_tr_b16 a[32:33], v162 offset:32768
v_mfma_f32_16x16x32_bf16 v[132:135], a[60:63], a[24:27], v[132:135]
ds_read_b64_tr_b16 a[34:35], v162 offset:33792
v_mfma_f32_16x16x32_bf16 v[148:151], a[60:63], a[28:31], v[148:151]
ds_read_b64_tr_b16 a[36:37], v163 offset:32768
s_setprio 1
v_mfma_f32_16x16x32_bf16 v[104:107], a[64:67], a[16:19], v[104:107]
ds_read_b64_tr_b16 a[38:39], v163 offset:33792
s_add_u32 m0, s62, 73728
s_add_u32 s64, s64, 65536
buffer_load_dwordx4 v175, s[32:35], s64 offen lds
v_mfma_f32_16x16x32_bf16 v[120:123], a[64:67], a[20:23], v[120:123]
ds_read_b64_tr_b16 a[40:41], v162 offset:36864
v_mfma_f32_16x16x32_bf16 v[136:139], a[64:67], a[24:27], v[136:139]
ds_read_b64_tr_b16 a[42:43], v162 offset:37888
v_mfma_f32_16x16x32_bf16 v[152:155], a[64:67], a[28:31], v[152:155]
ds_read_b64_tr_b16 a[44:45], v163 offset:36864
s_setprio 0
v_mfma_f32_16x16x32_bf16 v[108:111], a[68:71], a[16:19], v[108:111]
ds_read_b64_tr_b16 a[46:47], v163 offset:37888
v_mfma_f32_16x16x32_bf16 v[124:127], a[68:71], a[20:23], v[124:127]
v_mfma_f32_16x16x32_bf16 v[140:143], a[68:71], a[24:27], v[140:143]
v_mfma_f32_16x16x32_bf16 v[156:159], a[68:71], a[28:31], v[156:159]
s_waitcnt vmcnt(8) lgkmcnt(0)
s_cmp_lg_u32 s87, 0
s_cbranch_scc1 k1_kernel_b_g1_pc_rdy
s_waitcnt vmcnt(4)
v_cmp_le_u32 s[100:101], 1, v172
s_nop 0
s_cmp_eq_u64 s[100:101], -1
s_cbranch_scc1 k1_kernel_b_g1_pc_rdy
s_mov_b32 s91, 40000
k1_kernel_b_g1_pc_spin:
s_sleep 2
v_lshrrev_b32 v172, 4, v171
v_min_u32 v172, 9, v172
v_and_b32 v174, 1, v172
v_lshlrev_b32 v172, 3, v172
v_lshlrev_b32 v174, 2, v174
v_sub_u32 v172, v172, v174
buffer_load_dword v172, v172, s[40:43], s66 offen offset:0 sc1
s_waitcnt vmcnt(0)
v_cmp_le_u32 s[100:101], 1, v172
s_nop 0
s_cmp_eq_u64 s[100:101], -1
s_cbranch_scc1 k1_kernel_b_g1_pc_rdy
s_sub_u32 s91, s91, 1
s_cmp_lg_u32 s91, 0
s_cbranch_scc1 k1_kernel_b_g1_pc_spin
s_nop 0
k1_kernel_b_g1_pc_rdy:
s_barrier
buffer_load_dwordx4 v[64:67], v171, s[40:43], s68 offen sc1
buffer_load_dwordx4 v[68:71], v171, s[40:43], s69 offen sc1
s_add_u32 s68, s68, 6144
s_add_u32 s69, s69, 6144
s_setprio 3
v_mfma_f32_16x16x32_bf16 v[96:99], a[32:35], a[0:3], v[96:99]
v_subrev_u32 v161, 0x8000, v161
v_mfma_f32_16x16x32_bf16 v[112:115], a[32:35], a[4:7], v[112:115]
ds_read_b128 a[16:19], v161 offset:0
v_mfma_f32_16x16x32_bf16 v[128:131], a[32:35], a[8:11], v[128:131]
ds_read_b128 a[20:23], v161 offset:2048
s_add_u32 m0, s62, 81920
s_add_u32 s64, s64, 327680
buffer_load_dwordx4 v175, s[32:35], s64 offen lds
v_mfma_f32_16x16x32_bf16 v[144:147], a[32:35], a[12:15], v[144:147]
ds_read_b128 a[24:27], v161 offset:4096
s_setprio 2
v_mfma_f32_16x16x32_bf16 v[100:103], a[36:39], a[0:3], v[100:103]
ds_read_b128 a[28:31], v161 offset:6144
v_mfma_f32_16x16x32_bf16 v[116:119], a[36:39], a[4:7], v[116:119]
ds_read_b64_tr_b16 a[56:57], v162 offset:40960
v_mfma_f32_16x16x32_bf16 v[132:135], a[36:39], a[8:11], v[132:135]
ds_read_b64_tr_b16 a[58:59], v162 offset:41984
v_mfma_f32_16x16x32_bf16 v[148:151], a[36:39], a[12:15], v[148:151]
ds_read_b64_tr_b16 a[60:61], v163 offset:40960
s_setprio 1
v_mfma_f32_16x16x32_bf16 v[104:107], a[40:43], a[0:3], v[104:107]
ds_read_b64_tr_b16 a[62:63], v163 offset:41984
s_add_u32 m0, s62, 90112
s_add_u32 s64, s64, 65536
buffer_load_dwordx4 v175, s[32:35], s64 offen lds
v_mfma_f32_16x16x32_bf16 v[120:123], a[40:43], a[4:7], v[120:123]
ds_read_b64_tr_b16 a[64:65], v162 offset:45056
v_mfma_f32_16x16x32_bf16 v[136:139], a[40:43], a[8:11], v[136:139]
ds_read_b64_tr_b16 a[66:67], v162 offset:46080
v_mfma_f32_16x16x32_bf16 v[152:155], a[40:43], a[12:15], v[152:155]
ds_read_b64_tr_b16 a[68:69], v163 offset:45056
s_setprio 0
v_mfma_f32_16x16x32_bf16 v[108:111], a[44:47], a[0:3], v[108:111]
ds_read_b64_tr_b16 a[70:71], v163 offset:46080
v_mfma_f32_16x16x32_bf16 v[124:127], a[44:47], a[4:7], v[124:127]
v_mfma_f32_16x16x32_bf16 v[140:143], a[44:47], a[8:11], v[140:143]
v_mfma_f32_16x16x32_bf16 v[156:159], a[44:47], a[12:15], v[156:159]
buffer_load_dwordx4 v[72:75], v171, s[40:43], s68 offen sc1
buffer_load_dwordx4 v[76:79], v171, s[40:43], s69 offen sc1
s_sub_u32 s68, s68, 2048
s_sub_u32 s69, s69, 2048
s_waitcnt vmcnt(8) lgkmcnt(0)
s_barrier
s_setprio 3
v_mfma_f32_16x16x32_bf16 v[96:99], a[56:59], a[16:19], v[96:99]
ds_read_b128 a[0:3], v160 offset:32768
v_mfma_f32_16x16x32_bf16 v[112:115], a[56:59], a[20:23], v[112:115]
ds_read_b128 a[4:7], v160 offset:34816
v_mfma_f32_16x16x32_bf16 v[128:131], a[56:59], a[24:27], v[128:131]
ds_read_b128 a[8:11], v160 offset:36864
s_add_u32 m0, s62, 0
s_sub_u32 s64, s64, 196608
buffer_load_dwordx4 v175, s[32:35], s64 offen lds
v_mfma_f32_16x16x32_bf16 v[144:147], a[56:59], a[28:31], v[144:147]
ds_read_b128 a[12:15], v160 offset:38912
s_setprio 2
v_mfma_f32_16x16x32_bf16 v[100:103], a[60:63], a[16:19], v[100:103]
ds_read_b64_tr_b16 a[32:33], v162 offset:0
v_mfma_f32_16x16x32_bf16 v[116:119], a[60:63], a[20:23], v[116:119]
ds_read_b64_tr_b16 a[34:35], v162 offset:1024
v_mfma_f32_16x16x32_bf16 v[132:135], a[60:63], a[24:27], v[132:135]
ds_read_b64_tr_b16 a[36:37], v163 offset:0
v_mfma_f32_16x16x32_bf16 v[148:151], a[60:63], a[28:31], v[148:151]
ds_read_b64_tr_b16 a[38:39], v163 offset:1024
s_setprio 1
v_mfma_f32_16x16x32_bf16 v[104:107], a[64:67], a[16:19], v[104:107]
ds_read_b64_tr_b16 a[40:41], v162 offset:4096
s_add_u32 m0, s62, 8192
s_add_u32 s64, s64, 65536
buffer_load_dwordx4 v175, s[32:35], s64 offen lds
v_mfma_f32_16x16x32_bf16 v[120:123], a[64:67], a[20:23], v[120:123]
ds_read_b64_tr_b16 a[42:43], v162 offset:5120
v_mfma_f32_16x16x32_bf16 v[136:139], a[64:67], a[24:27], v[136:139]
ds_read_b64_tr_b16 a[44:45], v163 offset:4096
v_mfma_f32_16x16x32_bf16 v[152:155], a[64:67], a[28:31], v[152:155]
ds_read_b64_tr_b16 a[46:47], v163 offset:5120
s_setprio 0
v_mfma_f32_16x16x32_bf16 v[108:111], a[68:71], a[16:19], v[108:111]
v_mfma_f32_16x16x32_bf16 v[124:127], a[68:71], a[20:23], v[124:127]
v_mfma_f32_16x16x32_bf16 v[140:143], a[68:71], a[24:27], v[140:143]
v_mfma_f32_16x16x32_bf16 v[156:159], a[68:71], a[28:31], v[156:159]
buffer_load_dwordx4 v[80:83], v171, s[40:43], s68 offen sc1
buffer_load_dwordx4 v[84:87], v171, s[40:43], s69 offen sc1
s_add_u32 s68, s68, 10240
s_add_u32 s69, s69, 10240
s_waitcnt vmcnt(12) lgkmcnt(0)
s_barrier
s_setprio 3
v_mfma_f32_16x16x32_bf16 v[96:99], a[32:35], a[0:3], v[96:99]
ds_read_b128 a[16:19], v161 offset:32768
v_mfma_f32_16x16x32_bf16 v[112:115], a[32:35], a[4:7], v[112:115]
ds_read_b128 a[20:23], v161 offset:34816
v_mfma_f32_16x16x32_bf16 v[128:131], a[32:35], a[8:11], v[128:131]
ds_read_b128 a[24:27], v161 offset:36864
s_add_u32 m0, s62, 16384
s_add_u32 s64, s64, 589824
buffer_load_dwordx4 v175, s[32:35], s64 offen lds
v_mfma_f32_16x16x32_bf16 v[144:147], a[32:35], a[12:15], v[144:147]
ds_read_b128 a[28:31], v161 offset:38912
s_setprio 2
v_mfma_f32_16x16x32_bf16 v[100:103], a[36:39], a[0:3], v[100:103]
ds_read_b64_tr_b16 a[56:57], v162 offset:8192
v_mfma_f32_16x16x32_bf16 v[116:119], a[36:39], a[4:7], v[116:119]
ds_read_b64_tr_b16 a[58:59], v162 offset:9216
v_mfma_f32_16x16x32_bf16 v[132:135], a[36:39], a[8:11], v[132:135]
ds_read_b64_tr_b16 a[60:61], v163 offset:8192
v_mfma_f32_16x16x32_bf16 v[148:151], a[36:39], a[12:15], v[148:151]
ds_read_b64_tr_b16 a[62:63], v163 offset:9216
s_setprio 1
v_mfma_f32_16x16x32_bf16 v[104:107], a[40:43], a[0:3], v[104:107]
ds_read_b64_tr_b16 a[64:65], v162 offset:12288
s_add_u32 m0, s62, 24576
s_add_u32 s64, s64, 65536
buffer_load_dwordx4 v175, s[32:35], s64 offen lds
v_mfma_f32_16x16x32_bf16 v[120:123], a[40:43], a[4:7], v[120:123]
ds_read_b64_tr_b16 a[66:67], v162 offset:13312
v_mfma_f32_16x16x32_bf16 v[136:139], a[40:43], a[8:11], v[136:139]
ds_read_b64_tr_b16 a[68:69], v163 offset:12288
v_mfma_f32_16x16x32_bf16 v[152:155], a[40:43], a[12:15], v[152:155]
ds_read_b64_tr_b16 a[70:71], v163 offset:13312
s_setprio 0
v_mfma_f32_16x16x32_bf16 v[108:111], a[44:47], a[0:3], v[108:111]
v_mfma_f32_16x16x32_bf16 v[124:127], a[44:47], a[4:7], v[124:127]
v_mfma_f32_16x16x32_bf16 v[140:143], a[44:47], a[8:11], v[140:143]
v_mfma_f32_16x16x32_bf16 v[156:159], a[44:47], a[12:15], v[156:159]
buffer_load_dwordx4 v[88:91], v171, s[40:43], s68 offen sc1
buffer_load_dwordx4 v[92:95], v171, s[40:43], s69 offen sc1
s_add_u32 s68, s68, 6144
s_add_u32 s69, s69, 6144
s_waitcnt vmcnt(10) lgkmcnt(0)
s_barrier
s_setprio 3
v_mfma_f32_16x16x32_bf16 v[96:99], a[56:59], a[16:19], v[96:99]
v_lshrrev_b32 v164, 6, v171
v_lshrrev_b32 v165, 1, v164
v_and_b32 v165, 3, v165
v_lshrrev_b32 v166, 1, v171
v_and_b32 v166, 24, v166
v_lshl_add_u32 v166, v164, 7, v166
s_lshl_b32 s90, s89, 13
v_add_u32 v166, s90, v166
v_xor_b32 v164, 0, v165
v_lshl_add_u32 v160, v164, 5, v166
v_xor_b32 v164, 1, v165
v_lshl_add_u32 v161, v164, 5, v166
v_xor_b32 v164, 2, v165
v_lshl_add_u32 v162, v164, 5, v166
v_xor_b32 v164, 3, v165
v_lshl_add_u32 v163, v164, 5, v166
v_xor_b32 v160, 0x10000, v160
v_xor_b32 v161, 0x10000, v161
v_xor_b32 v162, 0x10000, v162
v_xor_b32 v163, 0x10000, v163
v_mfma_f32_16x16x32_bf16 v[112:115], a[56:59], a[20:23], v[112:115]
ds_read_b64_tr_b16 a[48:49], v160 offset:0
ds_read_b64_tr_b16 a[50:51], v160 offset:2048
v_mfma_f32_16x16x32_bf16 v[128:131], a[56:59], a[24:27], v[128:131]
ds_read_b64_tr_b16 a[52:53], v161 offset:0
ds_read_b64_tr_b16 a[54:55], v161 offset:2048
s_add_u32 m0, s62, 32768
s_add_u32 s64, s64, 327680
buffer_load_dwordx4 v175, s[32:35], s64 offen lds
v_mfma_f32_16x16x32_bf16 v[144:147], a[56:59], a[28:31], v[144:147]
ds_read_b64_tr_b16 a[72:73], v162 offset:4096
ds_read_b64_tr_b16 a[74:75], v162 offset:6144
ds_read_b64_tr_b16 a[56:57], v162 offset:0
ds_read_b64_tr_b16 a[58:59], v162 offset:2048
s_setprio 2
v_mfma_f32_16x16x32_bf16 v[100:103], a[60:63], a[16:19], v[100:103]
ds_read_b64_tr_b16 a[76:77], v163 offset:4096
ds_read_b64_tr_b16 a[78:79], v163 offset:6144
v_mfma_f32_16x16x32_bf16 v[116:119], a[60:63], a[20:23], v[116:119]
s_add_u32 m0, s62, 40960
s_add_u32 s64, s64, 65536
buffer_load_dwordx4 v175, s[32:35], s64 offen lds
v_mfma_f32_16x16x32_bf16 v[132:135], a[60:63], a[24:27], v[132:135]
v_mfma_f32_16x16x32_bf16 v[148:151], a[60:63], a[28:31], v[148:151]
ds_read_b64_tr_b16 a[60:61], v163 offset:0
ds_read_b64_tr_b16 a[62:63], v163 offset:2048
s_setprio 1
v_mfma_f32_16x16x32_bf16 v[104:107], a[64:67], a[16:19], v[104:107]
s_add_u32 m0, s62, 49152
s_sub_u32 s64, s64, 196608
buffer_load_dwordx4 v175, s[32:35], s64 offen lds
v_mfma_f32_16x16x32_bf16 v[120:123], a[64:67], a[20:23], v[120:123]
v_mfma_f32_16x16x32_bf16 v[136:139], a[64:67], a[24:27], v[136:139]
v_mfma_f32_16x16x32_bf16 v[152:155], a[64:67], a[28:31], v[152:155]
ds_read_b64_tr_b16 a[64:65], v160 offset:4096
ds_read_b64_tr_b16 a[66:67], v160 offset:6144
s_add_u32 m0, s62, 57344
s_add_u32 s64, s64, 65536
buffer_load_dwordx4 v175, s[32:35], s64 offen lds
s_setprio 0
v_mfma_f32_16x16x32_bf16 v[108:111], a[68:71], a[16:19], v[108:111]
v_mfma_f32_16x16x32_bf16 v[124:127], a[68:71], a[20:23], v[124:127]
v_mfma_f32_16x16x32_bf16 v[140:143], a[68:71], a[24:27], v[140:143]
v_mfma_f32_16x16x32_bf16 v[156:159], a[68:71], a[28:31], v[156:159]
ds_read_b64_tr_b16 a[68:69], v161 offset:4096
ds_read_b64_tr_b16 a[70:71], v161 offset:6144
buffer_load_dwordx4 a[0:3], v171, s[40:43], s68 offen sc1
buffer_load_dwordx4 a[4:7], v171, s[40:43], s69 offen sc1
s_sub_u32 s68, s68, 2048
s_sub_u32 s69, s69, 2048
s_waitcnt vmcnt(18)
s_waitcnt lgkmcnt(2)
s_setprio 1
v_mfma_f32_16x16x32_bf16 v[16:19], a[64:67], v[64:67], 0
v_mul_f32 v167, v96, v96
v_mul_f32 v168, v97, v97
v_mul_f32 v169, v98, v98
v_mul_f32 v170, v99, v99
v_fma_f32 v167, v167, s8, v173
v_fma_f32 v168, v168, s8, v173
v_mfma_f32_16x16x32_bf16 v[48:51], a[64:67], v[68:71], 0
v_fma_f32 v169, v169, s8, v173
v_fma_f32 v170, v170, s8, v173
v_mul_f32 v167, v167, v96
v_mul_f32 v168, v168, v97
v_mul_f32 v169, v169, v98
v_mul_f32 v170, v170, v99
ds_read_b64_tr_b16 a[64:65], v160 offset:20480
ds_read_b64_tr_b16 a[66:67], v160 offset:22528
s_waitcnt lgkmcnt(2)
v_mfma_f32_16x16x32_bf16 v[20:23], a[68:71], v[64:67], 0
v_exp_f32 v167, v167
v_mul_f32 v96, v96, v104
v_exp_f32 v168, v168
v_mul_f32 v97, v97, v105
v_mfma_f32_16x16x32_bf16 v[52:55], a[68:71], v[68:71], 0
v_exp_f32 v169, v169
v_mul_f32 v98, v98, v106
v_exp_f32 v170, v170
v_mul_f32 v99, v99, v107
ds_read_b64_tr_b16 a[68:69], v161 offset:20480
ds_read_b64_tr_b16 a[70:71], v161 offset:22528
s_add_u32 m0, s62, 98304
s_add_u32 s64, s64, 589824
buffer_load_dwordx4 v175, s[32:35], s64 offen lds
s_waitcnt lgkmcnt(14)
v_mfma_f32_16x16x32_bf16 v[24:27], a[72:75], v[64:67], 0
v_add_f32 v167, 1.0, v167
v_add_f32 v168, 1.0, v168
v_add_f32 v169, 1.0, v169
v_add_f32 v170, 1.0, v170
v_rcp_f32 v167, v167
v_mfma_f32_16x16x32_bf16 v[56:59], a[72:75], v[68:71], 0
v_rcp_f32 v168, v168
v_rcp_f32 v169, v169
v_rcp_f32 v170, v170
ds_read_b64_tr_b16 a[72:73], v162 offset:20480
ds_read_b64_tr_b16 a[74:75], v162 offset:22528
s_waitcnt lgkmcnt(12)
v_mfma_f32_16x16x32_bf16 v[28:31], a[76:79], v[64:67], 0
v_mul_f32 v96, v96, v167
v_mul_f32 v97, v97, v168
v_mul_f32 v98, v98, v169
v_mul_f32 v99, v99, v170
v_cvt_pk_bf16_f32 v104, v96, v97
v_cvt_pk_bf16_f32 v105, v98, v99
v_mfma_f32_16x16x32_bf16 v[60:63], a[76:79], v[68:71], 0
v_mul_f32 v167, v100, v100
v_mul_f32 v168, v101, v101
v_mul_f32 v169, v102, v102
v_mul_f32 v170, v103, v103
v_fma_f32 v167, v167, s8, v173
v_fma_f32 v168, v168, s8, v173
ds_read_b64_tr_b16 a[76:77], v163 offset:20480
ds_read_b64_tr_b16 a[78:79], v163 offset:22528
s_waitcnt lgkmcnt(15)
s_setprio 0
v_mfma_f32_16x16x32_bf16 v[0:3], a[48:51], v[64:67], 0
v_fma_f32 v169, v169, s8, v173
v_fma_f32 v170, v170, s8, v173
v_mul_f32 v167, v167, v100
v_mul_f32 v168, v168, v101
v_mul_f32 v169, v169, v102
v_mul_f32 v170, v170, v103
v_mfma_f32_16x16x32_bf16 v[32:35], a[48:51], v[68:71], 0
v_exp_f32 v167, v167
v_mul_f32 v100, v100, v108
v_exp_f32 v168, v168
v_mul_f32 v101, v101, v109
ds_read_b64_tr_b16 a[48:49], v160 offset:16384
ds_read_b64_tr_b16 a[50:51], v160 offset:18432
s_waitcnt lgkmcnt(15)
v_mfma_f32_16x16x32_bf16 v[4:7], a[52:55], v[64:67], 0
v_exp_f32 v169, v169
v_mul_f32 v102, v102, v110
v_exp_f32 v170, v170
v_mul_f32 v103, v103, v111
v_mfma_f32_16x16x32_bf16 v[36:39], a[52:55], v[68:71], 0
v_add_f32 v167, 1.0, v167
v_add_f32 v168, 1.0, v168
v_add_f32 v169, 1.0, v169
v_add_f32 v170, 1.0, v170
v_rcp_f32 v167, v167
ds_read_b64_tr_b16 a[52:53], v161 offset:16384
ds_read_b64_tr_b16 a[54:55], v161 offset:18432
s_add_u32 m0, s62, 106496
s_add_u32 s64, s64, 65536
buffer_load_dwordx4 v175, s[32:35], s64 offen lds
s_waitcnt lgkmcnt(15)
v_mfma_f32_16x16x32_bf16 v[8:11], a[56:59], v[64:67], 0
v_rcp_f32 v168, v168
v_rcp_f32 v169, v169
v_rcp_f32 v170, v170
v_mfma_f32_16x16x32_bf16 v[40:43], a[56:59], v[68:71], 0
v_mul_f32 v100, v100, v167
v_mul_f32 v101, v101, v168
v_mul_f32 v102, v102, v169
v_mul_f32 v103, v103, v170
v_cvt_pk_bf16_f32 v106, v100, v101
v_cvt_pk_bf16_f32 v107, v102, v103
ds_read_b64_tr_b16 a[56:57], v162 offset:16384
ds_read_b64_tr_b16 a[58:59], v162 offset:18432
s_waitcnt lgkmcnt(15)
v_mfma_f32_16x16x32_bf16 v[12:15], a[60:63], v[64:67], 0
buffer_store_dwordx4 v[104:107], v171, s[40:43], s94 offen sc1
s_add_u32 s94, s94, 147456
v_mul_f32 v167, v112, v112
v_mul_f32 v168, v113, v113
v_mul_f32 v169, v114, v114
v_mul_f32 v170, v115, v115
v_fma_f32 v167, v167, s8, v173
v_mfma_f32_16x16x32_bf16 v[44:47], a[60:63], v[68:71], 0
v_fma_f32 v168, v168, s8, v173
v_fma_f32 v169, v169, s8, v173
v_fma_f32 v170, v170, s8, v173
v_mul_f32 v167, v167, v112
v_mul_f32 v168, v168, v113
v_mul_f32 v169, v169, v114
ds_read_b64_tr_b16 a[60:61], v163 offset:16384
ds_read_b64_tr_b16 a[62:63], v163 offset:18432
buffer_load_dwordx4 a[8:11], v171, s[40:43], s68 offen sc1
buffer_load_dwordx4 a[12:15], v171, s[40:43], s69 offen sc1
s_add_u32 s68, s68, 10240
s_add_u32 s69, s69, 10240
s_waitcnt vmcnt(13) lgkmcnt(0)
s_barrier
v_xor_b32 v160, 0x10000, v160
v_xor_b32 v161, 0x10000, v161
v_xor_b32 v162, 0x10000, v162
v_xor_b32 v163, 0x10000, v163
s_setprio 3
v_mfma_f32_16x16x32_bf16 v[16:19], a[64:67], v[72:75], v[16:19]
v_mul_f32 v170, v170, v115
v_exp_f32 v167, v167
v_mul_f32 v112, v112, v120
v_exp_f32 v168, v168
v_mfma_f32_16x16x32_bf16 v[48:51], a[64:67], v[76:79], v[48:51]
v_mul_f32 v113, v113, v121
v_exp_f32 v169, v169
v_mul_f32 v114, v114, v122
v_exp_f32 v170, v170
ds_read_b64_tr_b16 a[64:65], v160 offset:4096
ds_read_b64_tr_b16 a[66:67], v160 offset:6144
v_mfma_f32_16x16x32_bf16 v[20:23], a[68:71], v[72:75], v[20:23]
v_mul_f32 v115, v115, v123
v_add_f32 v167, 1.0, v167
v_add_f32 v168, 1.0, v168
v_add_f32 v169, 1.0, v169
v_add_f32 v170, 1.0, v170
v_rcp_f32 v167, v167
v_mfma_f32_16x16x32_bf16 v[52:55], a[68:71], v[76:79], v[52:55]
v_rcp_f32 v168, v168
v_rcp_f32 v169, v169
v_rcp_f32 v170, v170
ds_read_b64_tr_b16 a[68:69], v161 offset:4096
ds_read_b64_tr_b16 a[70:71], v161 offset:6144
s_add_u32 m0, s62, 114688
s_add_u32 s64, s64, 327680
buffer_load_dwordx4 v175, s[32:35], s64 offen lds
v_mfma_f32_16x16x32_bf16 v[24:27], a[72:75], v[72:75], v[24:27]
v_mul_f32 v112, v112, v167
v_mul_f32 v113, v113, v168
v_mul_f32 v114, v114, v169
v_mul_f32 v115, v115, v170
v_cvt_pk_bf16_f32 v120, v112, v113
v_cvt_pk_bf16_f32 v121, v114, v115
v_mfma_f32_16x16x32_bf16 v[56:59], a[72:75], v[76:79], v[56:59]
v_mul_f32 v167, v116, v116
v_mul_f32 v168, v117, v117
v_mul_f32 v169, v118, v118
v_mul_f32 v170, v119, v119
v_fma_f32 v167, v167, s8, v173
v_fma_f32 v168, v168, s8, v173
ds_read_b64_tr_b16 a[72:73], v162 offset:4096
ds_read_b64_tr_b16 a[74:75], v162 offset:6144
v_mfma_f32_16x16x32_bf16 v[28:31], a[76:79], v[72:75], v[28:31]
v_fma_f32 v169, v169, s8, v173
v_fma_f32 v170, v170, s8, v173
v_mul_f32 v167, v167, v116
v_mul_f32 v168, v168, v117
v_mul_f32 v169, v169, v118
v_mul_f32 v170, v170, v119
v_mfma_f32_16x16x32_bf16 v[60:63], a[76:79], v[76:79], v[60:63]
v_exp_f32 v167, v167
v_mul_f32 v116, v116, v124
v_exp_f32 v168, v168
v_mul_f32 v117, v117, v125
ds_read_b64_tr_b16 a[76:77], v163 offset:4096
ds_read_b64_tr_b16 a[78:79], v163 offset:6144
s_setprio 2
v_mfma_f32_16x16x32_bf16 v[0:3], a[48:51], v[72:75], v[0:3]
v_exp_f32 v169, v169
v_mul_f32 v118, v118, v126
v_exp_f32 v170, v170
v_mul_f32 v119, v119, v127
v_mfma_f32_16x16x32_bf16 v[32:35], a[48:51], v[76:79], v[32:35]
v_add_f32 v167, 1.0, v167
v_add_f32 v168, 1.0, v168
v_add_f32 v169, 1.0, v169
v_add_f32 v170, 1.0, v170
v_rcp_f32 v167, v167
ds_read_b64_tr_b16 a[48:49], v160 offset:0
ds_read_b64_tr_b16 a[50:51], v160 offset:2048
v_mfma_f32_16x16x32_bf16 v[4:7], a[52:55], v[72:75], v[4:7]
v_rcp_f32 v168, v168
v_rcp_f32 v169, v169
v_rcp_f32 v170, v170
v_mfma_f32_16x16x32_bf16 v[36:39], a[52:55], v[76:79], v[36:39]
v_mul_f32 v116, v116, v167
v_mul_f32 v117, v117, v168
v_mul_f32 v118, v118, v169
v_mul_f32 v119, v119, v170
v_cvt_pk_bf16_f32 v122, v116, v117
v_cvt_pk_bf16_f32 v123, v118, v119
ds_read_b64_tr_b16 a[52:53], v161 offset:0
ds_read_b64_tr_b16 a[54:55], v161 offset:2048
s_add_u32 m0, s62, 122880
s_add_u32 s64, s64, 65536
buffer_load_dwordx4 v175, s[32:35], s64 offen lds
v_mfma_f32_16x16x32_bf16 v[8:11], a[56:59], v[72:75], v[8:11]
buffer_store_dwordx4 v[120:123], v171, s[40:43], s94 offen sc1
s_add_u32 s94, s94, 147456
v_mul_f32 v167, v128, v128
v_mul_f32 v168, v129, v129
v_mul_f32 v169, v130, v130
v_mul_f32 v170, v131, v131
v_fma_f32 v167, v167, s8, v173
v_mfma_f32_16x16x32_bf16 v[40:43], a[56:59], v[76:79], v[40:43]
v_fma_f32 v168, v168, s8, v173
v_fma_f32 v169, v169, s8, v173
v_fma_f32 v170, v170, s8, v173
v_mul_f32 v167, v167, v128
v_mul_f32 v168, v168, v129
v_mul_f32 v169, v169, v130
ds_read_b64_tr_b16 a[56:57], v162 offset:0
ds_read_b64_tr_b16 a[58:59], v162 offset:2048
v_mfma_f32_16x16x32_bf16 v[12:15], a[60:63], v[72:75], v[12:15]
v_mul_f32 v170, v170, v131
v_exp_f32 v167, v167
v_mul_f32 v128, v128, v136
v_exp_f32 v168, v168
v_mfma_f32_16x16x32_bf16 v[44:47], a[60:63], v[76:79], v[44:47]
v_mul_f32 v129, v129, v137
v_exp_f32 v169, v169
v_mul_f32 v130, v130, v138
v_exp_f32 v170, v170
ds_read_b64_tr_b16 a[60:61], v163 offset:0
ds_read_b64_tr_b16 a[62:63], v163 offset:2048
buffer_load_dwordx4 a[32:35], v171, s[40:43], s68 offen sc1
buffer_load_dwordx4 a[36:39], v171, s[40:43], s69 offen sc1
s_add_u32 s68, s68, 6144
s_add_u32 s69, s69, 6144
s_waitcnt vmcnt(20)
s_waitcnt lgkmcnt(14)
s_setprio 1
v_mfma_f32_16x16x32_bf16 v[16:19], a[64:67], v[80:83], v[16:19]
v_mul_f32 v131, v131, v139
v_add_f32 v167, 1.0, v167
v_add_f32 v168, 1.0, v168
v_add_f32 v169, 1.0, v169
v_add_f32 v170, 1.0, v170
v_rcp_f32 v167, v167
v_mfma_f32_16x16x32_bf16 v[48:51], a[64:67], v[84:87], v[48:51]
v_rcp_f32 v168, v168
v_rcp_f32 v169, v169
v_rcp_f32 v170, v170
ds_read_b64_tr_b16 a[64:65], v160 offset:20480
ds_read_b64_tr_b16 a[66:67], v160 offset:22528
s_waitcnt lgkmcnt(14)
v_mfma_f32_16x16x32_bf16 v[20:23], a[68:71], v[80:83], v[20:23]
v_mul_f32 v128, v128, v167
v_mul_f32 v129, v129, v168
v_mul_f32 v130, v130, v169
v_mul_f32 v131, v131, v170
v_cvt_pk_bf16_f32 v136, v128, v129
v_cvt_pk_bf16_f32 v137, v130, v131
v_mfma_f32_16x16x32_bf16 v[52:55], a[68:71], v[84:87], v[52:55]
v_mul_f32 v167, v132, v132
v_mul_f32 v168, v133, v133
v_mul_f32 v169, v134, v134
v_mul_f32 v170, v135, v135
v_fma_f32 v167, v167, s8, v173
v_fma_f32 v168, v168, s8, v173
ds_read_b64_tr_b16 a[68:69], v161 offset:20480
ds_read_b64_tr_b16 a[70:71], v161 offset:22528
s_add_u32 m0, s62, 65536
s_sub_u32 s64, s64, 196608
buffer_load_dwordx4 v175, s[32:35], s64 offen lds
s_waitcnt lgkmcnt(14)
v_mfma_f32_16x16x32_bf16 v[24:27], a[72:75], v[80:83], v[24:27]
v_fma_f32 v169, v169, s8, v173
v_fma_f32 v170, v170, s8, v173
v_mul_f32 v167, v167, v132
v_mul_f32 v168, v168, v133
v_mul_f32 v169, v169, v134
v_mul_f32 v170, v170, v135
v_mfma_f32_16x16x32_bf16 v[56:59], a[72:75], v[84:87], v[56:59]
v_exp_f32 v167, v167
v_mul_f32 v132, v132, v140
v_exp_f32 v168, v168
v_mul_f32 v133, v133, v141
ds_read_b64_tr_b16 a[72:73], v162 offset:20480
ds_read_b64_tr_b16 a[74:75], v162 offset:22528
s_waitcnt lgkmcnt(14)
v_mfma_f32_16x16x32_bf16 v[28:31], a[76:79], v[80:83], v[28:31]
v_exp_f32 v169, v169
v_mul_f32 v134, v134, v142
v_exp_f32 v170, v170
v_mul_f32 v135, v135, v143
v_mfma_f32_16x16x32_bf16 v[60:63], a[76:79], v[84:87], v[60:63]
v_add_f32 v167, 1.0, v167
v_add_f32 v168, 1.0, v168
v_add_f32 v169, 1.0, v169
v_add_f32 v170, 1.0, v170
v_rcp_f32 v167, v167
ds_read_b64_tr_b16 a[76:77], v163 offset:20480
ds_read_b64_tr_b16 a[78:79], v163 offset:22528
s_waitcnt lgkmcnt(14)
s_setprio 0
v_mfma_f32_16x16x32_bf16 v[0:3], a[48:51], v[80:83], v[0:3]
v_rcp_f32 v168, v168
v_rcp_f32 v169, v169
v_rcp_f32 v170, v170
v_mfma_f32_16x16x32_bf16 v[32:35], a[48:51], v[84:87], v[32:35]
v_mul_f32 v132, v132, v167
v_mul_f32 v133, v133, v168
v_mul_f32 v134, v134, v169
v_mul_f32 v135, v135, v170
v_cvt_pk_bf16_f32 v138, v132, v133
v_cvt_pk_bf16_f32 v139, v134, v135
ds_read_b64_tr_b16 a[48:49], v160 offset:16384
ds_read_b64_tr_b16 a[50:51], v160 offset:18432
s_waitcnt lgkmcnt(14)
v_mfma_f32_16x16x32_bf16 v[4:7], a[52:55], v[80:83], v[4:7]
buffer_store_dwordx4 v[136:139], v171, s[40:43], s94 offen sc1
s_add_u32 s94, s94, 147456
v_mul_f32 v167, v144, v144
v_mul_f32 v168, v145, v145
v_mul_f32 v169, v146, v146
v_mul_f32 v170, v147, v147
v_fma_f32 v167, v167, s8, v173
v_mfma_f32_16x16x32_bf16 v[36:39], a[52:55], v[84:87], v[36:39]
v_fma_f32 v168, v168, s8, v173
v_fma_f32 v169, v169, s8, v173
v_fma_f32 v170, v170, s8, v173
v_mul_f32 v167, v167, v144
v_mul_f32 v168, v168, v145
v_mul_f32 v169, v169, v146
ds_read_b64_tr_b16 a[52:53], v161 offset:16384
ds_read_b64_tr_b16 a[54:55], v161 offset:18432
s_add_u32 m0, s62, 73728
s_add_u32 s64, s64, 65536
buffer_load_dwordx4 v175, s[32:35], s64 offen lds
s_waitcnt lgkmcnt(14)
v_mfma_f32_16x16x32_bf16 v[8:11], a[56:59], v[80:83], v[8:11]
v_mul_f32 v170, v170, v147
v_exp_f32 v167, v167
v_mul_f32 v144, v144, v152
v_exp_f32 v168, v168
v_mfma_f32_16x16x32_bf16 v[40:43], a[56:59], v[84:87], v[40:43]
v_mul_f32 v145, v145, v153
v_exp_f32 v169, v169
v_mul_f32 v146, v146, v154
v_exp_f32 v170, v170
ds_read_b64_tr_b16 a[56:57], v162 offset:16384
ds_read_b64_tr_b16 a[58:59], v162 offset:18432
s_waitcnt lgkmcnt(14)
v_mfma_f32_16x16x32_bf16 v[12:15], a[60:63], v[80:83], v[12:15]
v_mul_f32 v147, v147, v155
v_add_f32 v167, 1.0, v167
v_add_f32 v168, 1.0, v168
v_add_f32 v169, 1.0, v169
v_add_f32 v170, 1.0, v170
v_rcp_f32 v167, v167
v_mfma_f32_16x16x32_bf16 v[44:47], a[60:63], v[84:87], v[44:47]
v_rcp_f32 v168, v168
v_rcp_f32 v169, v169
v_rcp_f32 v170, v170
ds_read_b64_tr_b16 a[60:61], v163 offset:16384
ds_read_b64_tr_b16 a[62:63], v163 offset:18432
buffer_load_dwordx4 a[40:43], v171, s[40:43], s68 offen sc1
buffer_load_dwordx4 a[44:47], v171, s[40:43], s69 offen sc1
s_sub_u32 s68, s68, 2048
s_sub_u32 s69, s69, 2048
s_waitcnt vmcnt(17) lgkmcnt(0)
s_barrier
s_setprio 3
v_mfma_f32_16x16x32_bf16 v[16:19], a[64:67], v[88:91], v[16:19]
v_mul_f32 v144, v144, v167
v_mul_f32 v145, v145, v168
v_mul_f32 v146, v146, v169
v_mul_f32 v147, v147, v170
v_cvt_pk_bf16_f32 v152, v144, v145
v_cvt_pk_bf16_f32 v153, v146, v147
v_mfma_f32_16x16x32_bf16 v[48:51], a[64:67], v[92:95], v[48:51]
v_mul_f32 v167, v148, v148
v_mul_f32 v168, v149, v149
v_mul_f32 v169, v150, v150
v_mul_f32 v170, v151, v151
v_fma_f32 v167, v167, s8, v173
v_fma_f32 v168, v168, s8, v173
ds_read_b64_tr_b16 a[64:65], v160 offset:36864
ds_read_b64_tr_b16 a[66:67], v160 offset:38912
v_mfma_f32_16x16x32_bf16 v[20:23], a[68:71], v[88:91], v[20:23]
v_fma_f32 v169, v169, s8, v173
v_fma_f32 v170, v170, s8, v173
v_mul_f32 v167, v167, v148
v_mul_f32 v168, v168, v149
v_mul_f32 v169, v169, v150
v_mul_f32 v170, v170, v151
v_mfma_f32_16x16x32_bf16 v[52:55], a[68:71], v[92:95], v[52:55]
v_exp_f32 v167, v167
v_mul_f32 v148, v148, v156
v_exp_f32 v168, v168
v_mul_f32 v149, v149, v157
ds_read_b64_tr_b16 a[68:69], v161 offset:36864
ds_read_b64_tr_b16 a[70:71], v161 offset:38912
s_add_u32 m0, s62, 81920
s_add_u32 s64, s64, 589824
buffer_load_dwordx4 v175, s[32:35], s64 offen lds
v_mfma_f32_16x16x32_bf16 v[24:27], a[72:75], v[88:91], v[24:27]
v_exp_f32 v169, v169
v_mul_f32 v150, v150, v158
v_exp_f32 v170, v170
v_mul_f32 v151, v151, v159
v_mfma_f32_16x16x32_bf16 v[56:59], a[72:75], v[92:95], v[56:59]
v_add_f32 v167, 1.0, v167
v_add_f32 v168, 1.0, v168
v_add_f32 v169, 1.0, v169
v_add_f32 v170, 1.0, v170
v_rcp_f32 v167, v167
ds_read_b64_tr_b16 a[72:73], v162 offset:36864
ds_read_b64_tr_b16 a[74:75], v162 offset:38912
v_mfma_f32_16x16x32_bf16 v[28:31], a[76:79], v[88:91], v[28:31]
v_rcp_f32 v168, v168
v_rcp_f32 v169, v169
v_rcp_f32 v170, v170
v_mfma_f32_16x16x32_bf16 v[60:63], a[76:79], v[92:95], v[60:63]
v_mul_f32 v148, v148, v167
v_mul_f32 v149, v149, v168
v_mul_f32 v150, v150, v169
v_mul_f32 v151, v151, v170
v_cvt_pk_bf16_f32 v154, v148, v149
v_cvt_pk_bf16_f32 v155, v150, v151
ds_read_b64_tr_b16 a[76:77], v163 offset:36864
ds_read_b64_tr_b16 a[78:79], v163 offset:38912
s_setprio 2
v_mfma_f32_16x16x32_bf16 v[0:3], a[48:51], v[88:91], v[0:3]
buffer_store_dwordx4 v[152:155], v171, s[40:43], s94 offen sc1
v_mfma_f32_16x16x32_bf16 v[32:35], a[48:51], v[92:95], v[32:35]
ds_read_b64_tr_b16 a[48:49], v160 offset:32768
ds_read_b64_tr_b16 a[50:51], v160 offset:34816
v_mfma_f32_16x16x32_bf16 v[4:7], a[52:55], v[88:91], v[4:7]
v_mfma_f32_16x16x32_bf16 v[36:39], a[52:55], v[92:95], v[36:39]
ds_read_b64_tr_b16 a[52:53], v161 offset:32768
ds_read_b64_tr_b16 a[54:55], v161 offset:34816
s_add_u32 m0, s62, 90112
s_add_u32 s64, s64, 65536
buffer_load_dwordx4 v175, s[32:35], s64 offen lds
v_mfma_f32_16x16x32_bf16 v[8:11], a[56:59], v[88:91], v[8:11]
v_mfma_f32_16x16x32_bf16 v[40:43], a[56:59], v[92:95], v[40:43]
ds_read_b64_tr_b16 a[56:57], v162 offset:32768
ds_read_b64_tr_b16 a[58:59], v162 offset:34816
v_mfma_f32_16x16x32_bf16 v[12:15], a[60:63], v[88:91], v[12:15]
v_mfma_f32_16x16x32_bf16 v[44:47], a[60:63], v[92:95], v[44:47]
ds_read_b64_tr_b16 a[60:61], v163 offset:32768
ds_read_b64_tr_b16 a[62:63], v163 offset:34816
buffer_load_dwordx4 a[16:19], v171, s[40:43], s68 offen sc1
buffer_load_dwordx4 a[20:23], v171, s[40:43], s69 offen sc1
s_add_u32 s68, s68, 10240
s_add_u32 s69, s69, 10240
s_waitcnt vmcnt(20)
s_waitcnt lgkmcnt(14)
s_setprio 1
v_mfma_f32_16x16x32_bf16 v[16:19], a[64:67], a[0:3], v[16:19]
v_mfma_f32_16x16x32_bf16 v[48:51], a[64:67], a[4:7], v[48:51]
ds_read_b64_tr_b16 a[64:65], v160 offset:53248
ds_read_b64_tr_b16 a[66:67], v160 offset:55296
s_waitcnt lgkmcnt(14)
v_mfma_f32_16x16x32_bf16 v[20:23], a[68:71], a[0:3], v[20:23]
v_mfma_f32_16x16x32_bf16 v[52:55], a[68:71], a[4:7], v[52:55]
ds_read_b64_tr_b16 a[68:69], v161 offset:53248
ds_read_b64_tr_b16 a[70:71], v161 offset:55296
s_add_u32 m0, s62, 0
s_add_u32 s64, s64, 327680
buffer_load_dwordx4 v175, s[32:35], s64 offen lds
s_waitcnt lgkmcnt(14)
v_mfma_f32_16x16x32_bf16 v[24:27], a[72:75], a[0:3], v[24:27]
v_mfma_f32_16x16x32_bf16 v[56:59], a[72:75], a[4:7], v[56:59]
ds_read_b64_tr_b16 a[72:73], v162 offset:53248
ds_read_b64_tr_b16 a[74:75], v162 offset:55296
s_waitcnt lgkmcnt(14)
v_mfma_f32_16x16x32_bf16 v[28:31], a[76:79], a[0:3], v[28:31]
v_mfma_f32_16x16x32_bf16 v[60:63], a[76:79], a[4:7], v[60:63]
ds_read_b64_tr_b16 a[76:77], v163 offset:53248
ds_read_b64_tr_b16 a[78:79], v163 offset:55296
s_waitcnt lgkmcnt(14)
s_setprio 0
v_mfma_f32_16x16x32_bf16 v[0:3], a[48:51], a[0:3], v[0:3]
v_mfma_f32_16x16x32_bf16 v[32:35], a[48:51], a[4:7], v[32:35]
ds_read_b64_tr_b16 a[48:49], v160 offset:49152
ds_read_b64_tr_b16 a[50:51], v160 offset:51200
s_waitcnt lgkmcnt(14)
v_mfma_f32_16x16x32_bf16 v[4:7], a[52:55], a[0:3], v[4:7]
v_mfma_f32_16x16x32_bf16 v[36:39], a[52:55], a[4:7], v[36:39]
ds_read_b64_tr_b16 a[52:53], v161 offset:49152
ds_read_b64_tr_b16 a[54:55], v161 offset:51200
s_add_u32 m0, s62, 8192
s_add_u32 s64, s64, 65536
buffer_load_dwordx4 v175, s[32:35], s64 offen lds
s_waitcnt lgkmcnt(14)
v_mfma_f32_16x16x32_bf16 v[8:11], a[56:59], a[0:3], v[8:11]
v_mfma_f32_16x16x32_bf16 v[40:43], a[56:59], a[4:7], v[40:43]
ds_read_b64_tr_b16 a[56:57], v162 offset:49152
ds_read_b64_tr_b16 a[58:59], v162 offset:51200
s_waitcnt lgkmcnt(14)
v_mfma_f32_16x16x32_bf16 v[12:15], a[60:63], a[0:3], v[12:15]
v_mfma_f32_16x16x32_bf16 v[44:47], a[60:63], a[4:7], v[44:47]
ds_read_b64_tr_b16 a[60:61], v163 offset:49152
ds_read_b64_tr_b16 a[62:63], v163 offset:51200
buffer_load_dwordx4 a[24:27], v171, s[40:43], s68 offen sc1
buffer_load_dwordx4 a[28:31], v171, s[40:43], s69 offen sc1
s_add_u32 s68, s68, 6144
s_add_u32 s69, s69, 6144
s_waitcnt vmcnt(7) lgkmcnt(0)
s_barrier
s_cmp_lg_u32 s87, 0
s_cbranch_scc1 k1_kernel_b_h2_sg
v_mov_b32 v174, 3
s_mov_b64 exec, 1
buffer_store_dword v174, off, s[40:43], s81 sc1
s_mov_b64 exec, -1
k1_kernel_b_h2_sg:
v_xor_b32 v160, 0x10000, v160
v_xor_b32 v161, 0x10000, v161
v_xor_b32 v162, 0x10000, v162
v_xor_b32 v163, 0x10000, v163
s_setprio 3
v_mfma_f32_16x16x32_bf16 v[16:19], a[64:67], a[8:11], v[16:19]
v_mfma_f32_16x16x32_bf16 v[48:51], a[64:67], a[12:15], v[48:51]
ds_read_b64_tr_b16 a[64:65], v160 offset:36864
ds_read_b64_tr_b16 a[66:67], v160 offset:38912
v_mfma_f32_16x16x32_bf16 v[20:23], a[68:71], a[8:11], v[20:23]
v_mfma_f32_16x16x32_bf16 v[52:55], a[68:71], a[12:15], v[52:55]
ds_read_b64_tr_b16 a[68:69], v161 offset:36864
ds_read_b64_tr_b16 a[70:71], v161 offset:38912
s_add_u32 m0, s62, 16384
s_sub_u32 s64, s64, 196608
buffer_load_dwordx4 v175, s[32:35], s64 offen lds
v_mfma_f32_16x16x32_bf16 v[24:27], a[72:75], a[8:11], v[24:27]
v_mfma_f32_16x16x32_bf16 v[56:59], a[72:75], a[12:15], v[56:59]
ds_read_b64_tr_b16 a[72:73], v162 offset:36864
ds_read_b64_tr_b16 a[74:75], v162 offset:38912
v_mfma_f32_16x16x32_bf16 v[28:31], a[76:79], a[8:11], v[28:31]
v_mfma_f32_16x16x32_bf16 v[60:63], a[76:79], a[12:15], v[60:63]
ds_read_b64_tr_b16 a[76:77], v163 offset:36864
ds_read_b64_tr_b16 a[78:79], v163 offset:38912
s_setprio 2
v_mfma_f32_16x16x32_bf16 v[0:3], a[48:51], a[8:11], v[0:3]
v_mfma_f32_16x16x32_bf16 v[32:35], a[48:51], a[12:15], v[32:35]
ds_read_b64_tr_b16 a[48:49], v160 offset:32768
ds_read_b64_tr_b16 a[50:51], v160 offset:34816
v_mfma_f32_16x16x32_bf16 v[4:7], a[52:55], a[8:11], v[4:7]
v_mfma_f32_16x16x32_bf16 v[36:39], a[52:55], a[12:15], v[36:39]
ds_read_b64_tr_b16 a[52:53], v161 offset:32768
ds_read_b64_tr_b16 a[54:55], v161 offset:34816
s_add_u32 m0, s62, 24576
s_add_u32 s64, s64, 65536
buffer_load_dwordx4 v175, s[32:35], s64 offen lds
v_mfma_f32_16x16x32_bf16 v[8:11], a[56:59], a[8:11], v[8:11]
v_mfma_f32_16x16x32_bf16 v[40:43], a[56:59], a[12:15], v[40:43]
ds_read_b64_tr_b16 a[56:57], v162 offset:32768
ds_read_b64_tr_b16 a[58:59], v162 offset:34816
v_mfma_f32_16x16x32_bf16 v[12:15], a[60:63], a[8:11], v[12:15]
v_mfma_f32_16x16x32_bf16 v[44:47], a[60:63], a[12:15], v[44:47]
ds_read_b64_tr_b16 a[60:61], v163 offset:32768
ds_read_b64_tr_b16 a[62:63], v163 offset:34816
buffer_load_dwordx4 a[0:3], v171, s[40:43], s68 offen sc1
buffer_load_dwordx4 a[4:7], v171, s[40:43], s69 offen sc1
s_sub_u32 s68, s68, 2048
s_sub_u32 s69, s69, 2048
s_waitcnt vmcnt(18)
s_waitcnt lgkmcnt(14)
s_setprio 1
v_mfma_f32_16x16x32_bf16 v[16:19], a[64:67], a[32:35], v[16:19]
v_mfma_f32_16x16x32_bf16 v[48:51], a[64:67], a[36:39], v[48:51]
ds_read_b64_tr_b16 a[64:65], v160 offset:53248
ds_read_b64_tr_b16 a[66:67], v160 offset:55296
s_waitcnt lgkmcnt(14)
v_mfma_f32_16x16x32_bf16 v[20:23], a[68:71], a[32:35], v[20:23]
v_mfma_f32_16x16x32_bf16 v[52:55], a[68:71], a[36:39], v[52:55]
ds_read_b64_tr_b16 a[68:69], v161 offset:53248
ds_read_b64_tr_b16 a[70:71], v161 offset:55296
s_add_u32 m0, s62, 32768
s_add_u32 s64, s64, 589824
buffer_load_dwordx4 v175, s[32:35], s64 offen lds
s_waitcnt lgkmcnt(14)
v_mfma_f32_16x16x32_bf16 v[24:27], a[72:75], a[32:35], v[24:27]
v_mfma_f32_16x16x32_bf16 v[56:59], a[72:75], a[36:39], v[56:59]
ds_read_b64_tr_b16 a[72:73], v162 offset:53248
ds_read_b64_tr_b16 a[74:75], v162 offset:55296
s_waitcnt lgkmcnt(14)
v_mfma_f32_16x16x32_bf16 v[28:31], a[76:79], a[32:35], v[28:31]
v_mfma_f32_16x16x32_bf16 v[60:63], a[76:79], a[36:39], v[60:63]
ds_read_b64_tr_b16 a[76:77], v163 offset:53248
ds_read_b64_tr_b16 a[78:79], v163 offset:55296
s_waitcnt lgkmcnt(14)
s_setprio 0
v_mfma_f32_16x16x32_bf16 v[0:3], a[48:51], a[32:35], v[0:3]
v_mfma_f32_16x16x32_bf16 v[32:35], a[48:51], a[36:39], v[32:35]
ds_read_b64_tr_b16 a[48:49], v160 offset:49152
ds_read_b64_tr_b16 a[50:51], v160 offset:51200
s_waitcnt lgkmcnt(14)
v_mfma_f32_16x16x32_bf16 v[4:7], a[52:55], a[32:35], v[4:7]
v_mfma_f32_16x16x32_bf16 v[36:39], a[52:55], a[36:39], v[36:39]
ds_read_b64_tr_b16 a[52:53], v161 offset:49152
ds_read_b64_tr_b16 a[54:55], v161 offset:51200
s_add_u32 m0, s62, 40960
s_add_u32 s64, s64, 65536
buffer_load_dwordx4 v175, s[32:35], s64 offen lds
s_waitcnt lgkmcnt(14)
v_mfma_f32_16x16x32_bf16 v[8:11], a[56:59], a[32:35], v[8:11]
v_mfma_f32_16x16x32_bf16 v[40:43], a[56:59], a[36:39], v[40:43]
ds_read_b64_tr_b16 a[56:57], v162 offset:49152
ds_read_b64_tr_b16 a[58:59], v162 offset:51200
s_waitcnt lgkmcnt(14)
v_mfma_f32_16x16x32_bf16 v[12:15], a[60:63], a[32:35], v[12:15]
v_mfma_f32_16x16x32_bf16 v[44:47], a[60:63], a[36:39], v[44:47]
ds_read_b64_tr_b16 a[60:61], v163 offset:49152
ds_read_b64_tr_b16 a[62:63], v163 offset:51200
buffer_load_dwordx4 a[8:11], v171, s[40:43], s68 offen sc1
buffer_load_dwordx4 a[12:15], v171, s[40:43], s69 offen sc1
s_add_u32 s68, s68, 10240
s_add_u32 s69, s69, 10240
s_waitcnt vmcnt(14) lgkmcnt(0)
s_barrier
s_setprio 3
v_mfma_f32_16x16x32_bf16 v[16:19], a[64:67], a[40:43], v[16:19]
v_mfma_f32_16x16x32_bf16 v[48:51], a[64:67], a[44:47], v[48:51]
ds_read_b64_tr_b16 a[64:65], v160 offset:4096
ds_read_b64_tr_b16 a[66:67], v160 offset:6144
v_mfma_f32_16x16x32_bf16 v[20:23], a[68:71], a[40:43], v[20:23]
v_mfma_f32_16x16x32_bf16 v[52:55], a[68:71], a[44:47], v[52:55]
ds_read_b64_tr_b16 a[68:69], v161 offset:4096
ds_read_b64_tr_b16 a[70:71], v161 offset:6144
s_add_u32 m0, s62, 49152
s_add_u32 s64, s64, 327680
buffer_load_dwordx4 v175, s[32:35], s64 offen lds
v_mfma_f32_16x16x32_bf16 v[24:27], a[72:75], a[40:43], v[24:27]
v_mfma_f32_16x16x32_bf16 v[56:59], a[72:75], a[44:47], v[56:59]
ds_read_b64_tr_b16 a[72:73], v162 offset:4096
ds_read_b64_tr_b16 a[74:75], v162 offset:6144
v_mfma_f32_16x16x32_bf16 v[28:31], a[76:79], a[40:43], v[28:31]
v_mfma_f32_16x16x32_bf16 v[60:63], a[76:79], a[44:47], v[60:63]
ds_read_b64_tr_b16 a[76:77], v163 offset:4096
ds_read_b64_tr_b16 a[78:79], v163 offset:6144
s_setprio 2
v_mfma_f32_16x16x32_bf16 v[0:3], a[48:51], a[40:43], v[0:3]
v_mfma_f32_16x16x32_bf16 v[32:35], a[48:51], a[44:47], v[32:35]
ds_read_b64_tr_b16 a[48:49], v160 offset:0
ds_read_b64_tr_b16 a[50:51], v160 offset:2048
v_mfma_f32_16x16x32_bf16 v[4:7], a[52:55], a[40:43], v[4:7]
v_mfma_f32_16x16x32_bf16 v[36:39], a[52:55], a[44:47], v[36:39]
ds_read_b64_tr_b16 a[52:53], v161 offset:0
ds_read_b64_tr_b16 a[54:55], v161 offset:2048
s_add_u32 m0, s62, 57344
s_add_u32 s64, s64, 65536
buffer_load_dwordx4 v175, s[32:35], s64 offen lds
v_mfma_f32_16x16x32_bf16 v[8:11], a[56:59], a[40:43], v[8:11]
v_mfma_f32_16x16x32_bf16 v[40:43], a[56:59], a[44:47], v[40:43]
ds_read_b64_tr_b16 a[56:57], v162 offset:0
ds_read_b64_tr_b16 a[58:59], v162 offset:2048
v_mfma_f32_16x16x32_bf16 v[12:15], a[60:63], a[40:43], v[12:15]
v_mfma_f32_16x16x32_bf16 v[44:47], a[60:63], a[44:47], v[44:47]
ds_read_b64_tr_b16 a[60:61], v163 offset:0
ds_read_b64_tr_b16 a[62:63], v163 offset:2048
buffer_load_dwordx4 a[32:35], v171, s[40:43], s68 offen sc1
buffer_load_dwordx4 a[36:39], v171, s[40:43], s69 offen sc1
s_add_u32 s68, s68, 6144
s_add_u32 s69, s69, 6144
s_waitcnt vmcnt(16)
s_waitcnt lgkmcnt(14)
s_setprio 1
v_mfma_f32_16x16x32_bf16 v[16:19], a[64:67], a[16:19], v[16:19]
v_mfma_f32_16x16x32_bf16 v[48:51], a[64:67], a[20:23], v[48:51]
ds_read_b64_tr_b16 a[64:65], v160 offset:20480
ds_read_b64_tr_b16 a[66:67], v160 offset:22528
s_waitcnt lgkmcnt(14)
v_mfma_f32_16x16x32_bf16 v[20:23], a[68:71], a[16:19], v[20:23]
v_mfma_f32_16x16x32_bf16 v[52:55], a[68:71], a[20:23], v[52:55]
ds_read_b64_tr_b16 a[68:69], v161 offset:20480
ds_read_b64_tr_b16 a[70:71], v161 offset:22528
s_add_u32 m0, s62, 98304
s_sub_u32 s64, s64, 196608
buffer_load_dwordx4 v175, s[32:35], s64 offen lds
s_waitcnt lgkmcnt(14)
v_mfma_f32_16x16x32_bf16 v[24:27], a[72:75], a[16:19], v[24:27]
v_mfma_f32_16x16x32_bf16 v[56:59], a[72:75], a[20:23], v[56:59]
ds_read_b64_tr_b16 a[72:73], v162 offset:20480
ds_read_b64_tr_b16 a[74:75], v162 offset:22528
s_waitcnt lgkmcnt(14)
v_mfma_f32_16x16x32_bf16 v[28:31], a[76:79], a[16:19], v[28:31]
v_mfma_f32_16x16x32_bf16 v[60:63], a[76:79], a[20:23], v[60:63]
ds_read_b64_tr_b16 a[76:77], v163 offset:20480
ds_read_b64_tr_b16 a[78:79], v163 offset:22528
s_waitcnt lgkmcnt(14)
s_setprio 0
v_mfma_f32_16x16x32_bf16 v[0:3], a[48:51], a[16:19], v[0:3]
v_mfma_f32_16x16x32_bf16 v[32:35], a[48:51], a[20:23], v[32:35]
ds_read_b64_tr_b16 a[48:49], v160 offset:16384
ds_read_b64_tr_b16 a[50:51], v160 offset:18432
s_waitcnt lgkmcnt(14)
v_mfma_f32_16x16x32_bf16 v[4:7], a[52:55], a[16:19], v[4:7]
v_mfma_f32_16x16x32_bf16 v[36:39], a[52:55], a[20:23], v[36:39]
ds_read_b64_tr_b16 a[52:53], v161 offset:16384
ds_read_b64_tr_b16 a[54:55], v161 offset:18432
s_add_u32 m0, s62, 106496
s_add_u32 s64, s64, 65536
buffer_load_dwordx4 v175, s[32:35], s64 offen lds
s_waitcnt lgkmcnt(14)
v_mfma_f32_16x16x32_bf16 v[8:11], a[56:59], a[16:19], v[8:11]
v_mfma_f32_16x16x32_bf16 v[40:43], a[56:59], a[20:23], v[40:43]
ds_read_b64_tr_b16 a[56:57], v162 offset:16384
ds_read_b64_tr_b16 a[58:59], v162 offset:18432
s_waitcnt lgkmcnt(14)
v_mfma_f32_16x16x32_bf16 v[12:15], a[60:63], a[16:19], v[12:15]
v_mfma_f32_16x16x32_bf16 v[44:47], a[60:63], a[20:23], v[44:47]
ds_read_b64_tr_b16 a[60:61], v163 offset:16384
ds_read_b64_tr_b16 a[62:63], v163 offset:18432
buffer_load_dwordx4 a[40:43], v171, s[40:43], s68 offen sc1
buffer_load_dwordx4 a[44:47], v171, s[40:43], s69 offen sc1
s_sub_u32 s68, s68, 2048
s_sub_u32 s69, s69, 2048
s_waitcnt vmcnt(14) lgkmcnt(0)
s_barrier
s_cmp_lg_u32 s87, 0
s_cbranch_scc1 k1_kernel_b_g2p_pi
v_lshrrev_b32 v172, 4, v171
v_min_u32 v172, 11, v172
v_and_b32 v174, 1, v172
v_lshlrev_b32 v172, 3, v172
v_lshlrev_b32 v174, 2, v174
v_sub_u32 v172, v172, v174
buffer_load_dword v172, v172, s[40:43], s66 offen offset:0 sc1
k1_kernel_b_g2p_pi:
v_xor_b32 v160, 0x10000, v160
v_xor_b32 v161, 0x10000, v161
v_xor_b32 v162, 0x10000, v162
v_xor_b32 v163, 0x10000, v163
s_setprio 3
v_mfma_f32_16x16x32_bf16 v[16:19], a[64:67], a[24:27], v[16:19]
v_mfma_f32_16x16x32_bf16 v[48:51], a[64:67], a[28:31], v[48:51]
ds_read_b64_tr_b16 a[64:65], v160 offset:4096
ds_read_b64_tr_b16 a[66:67], v160 offset:6144
v_mfma_f32_16x16x32_bf16 v[20:23], a[68:71], a[24:27], v[20:23]
v_mfma_f32_16x16x32_bf16 v[52:55], a[68:71], a[28:31], v[52:55]
ds_read_b64_tr_b16 a[68:69], v161 offset:4096
ds_read_b64_tr_b16 a[70:71], v161 offset:6144
s_add_u32 m0, s62, 114688
s_sub_u32 s64, s64, 3866624
buffer_load_dwordx4 v175, s[32:35], s64 offen lds
v_mfma_f32_16x16x32_bf16 v[24:27], a[72:75], a[24:27], v[24:27]
v_mfma_f32_16x16x32_bf16 v[56:59], a[72:75], a[28:31], v[56:59]
ds_read_b64_tr_b16 a[72:73], v162 offset:4096
ds_read_b64_tr_b16 a[74:75], v162 offset:6144
v_mfma_f32_16x16x32_bf16 v[28:31], a[76:79], a[24:27], v[28:31]
v_mfma_f32_16x16x32_bf16 v[60:63], a[76:79], a[28:31], v[60:63]
ds_read_b64_tr_b16 a[76:77], v163 offset:4096
ds_read_b64_tr_b16 a[78:79], v163 offset:6144
s_setprio 2
v_mfma_f32_16x16x32_bf16 v[0:3], a[48:51], a[24:27], v[0:3]
v_mfma_f32_16x16x32_bf16 v[32:35], a[48:51], a[28:31], v[32:35]
ds_read_b64_tr_b16 a[48:49], v160 offset:0
ds_read_b64_tr_b16 a[50:51], v160 offset:2048
v_mfma_f32_16x16x32_bf16 v[4:7], a[52:55], a[24:27], v[4:7]
v_mfma_f32_16x16x32_bf16 v[36:39], a[52:55], a[28:31], v[36:39]
ds_read_b64_tr_b16 a[52:53], v161 offset:0
ds_read_b64_tr_b16 a[54:55], v161 offset:2048
s_add_u32 m0, s62, 122880
s_add_u32 s64, s64, 65536
buffer_load_dwordx4 v175, s[32:35], s64 offen lds
v_mfma_f32_16x16x32_bf16 v[8:11], a[56:59], a[24:27], v[8:11]
v_mfma_f32_16x16x32_bf16 v[40:43], a[56:59], a[28:31], v[40:43]
ds_read_b64_tr_b16 a[56:57], v162 offset:0
ds_read_b64_tr_b16 a[58:59], v162 offset:2048
v_mfma_f32_16x16x32_bf16 v[12:15], a[60:63], a[24:27], v[12:15]
v_mfma_f32_16x16x32_bf16 v[44:47], a[60:63], a[28:31], v[44:47]
ds_read_b64_tr_b16 a[60:61], v163 offset:0
ds_read_b64_tr_b16 a[62:63], v163 offset:2048
buffer_load_dwordx4 a[16:19], v171, s[40:43], s68 offen sc1
buffer_load_dwordx4 a[20:23], v171, s[40:43], s69 offen sc1
s_sub_u32 s68, s68, 59392
s_sub_u32 s69, s69, 59392
s_waitcnt vmcnt(16)
s_waitcnt lgkmcnt(14)
s_setprio 1
v_mfma_f32_16x16x32_bf16 v[16:19], a[64:67], a[0:3], v[16:19]
v_mfma_f32_16x16x32_bf16 v[48:51], a[64:67], a[4:7], v[48:51]
ds_read_b64_tr_b16 a[64:65], v160 offset:20480
ds_read_b64_tr_b16 a[66:67], v160 offset:22528
s_waitcnt lgkmcnt(14)
v_mfma_f32_16x16x32_bf16 v[20:23], a[68:71], a[0:3], v[20:23]
v_mfma_f32_16x16x32_bf16 v[52:55], a[68:71], a[4:7], v[52:55]
ds_read_b64_tr_b16 a[68:69], v161 offset:20480
ds_read_b64_tr_b16 a[70:71], v161 offset:22528
s_add_u32 m0, s62, 65536
s_add_u32 s64, s64, 327680
buffer_load_dwordx4 v175, s[32:35], s64 offen lds
s_waitcnt lgkmcnt(14)
v_mfma_f32_16x16x32_bf16 v[24:27], a[72:75], a[0:3], v[24:27]
v_mfma_f32_16x16x32_bf16 v[56:59], a[72:75], a[4:7], v[56:59]
ds_read_b64_tr_b16 a[72:73], v162 offset:20480
ds_read_b64_tr_b16 a[74:75], v162 offset:22528
s_waitcnt lgkmcnt(14)
v_mfma_f32_16x16x32_bf16 v[28:31], a[76:79], a[0:3], v[28:31]
v_mfma_f32_16x16x32_bf16 v[60:63], a[76:79], a[4:7], v[60:63]
ds_read_b64_tr_b16 a[76:77], v163 offset:20480
ds_read_b64_tr_b16 a[78:79], v163 offset:22528
s_waitcnt lgkmcnt(14)
s_setprio 0
v_mfma_f32_16x16x32_bf16 v[0:3], a[48:51], a[0:3], v[0:3]
v_mfma_f32_16x16x32_bf16 v[32:35], a[48:51], a[4:7], v[32:35]
ds_read_b64_tr_b16 a[48:49], v160 offset:16384
ds_read_b64_tr_b16 a[50:51], v160 offset:18432
s_waitcnt lgkmcnt(14)
v_mfma_f32_16x16x32_bf16 v[4:7], a[52:55], a[0:3], v[4:7]
v_mfma_f32_16x16x32_bf16 v[36:39], a[52:55], a[4:7], v[36:39]
ds_read_b64_tr_b16 a[52:53], v161 offset:16384
ds_read_b64_tr_b16 a[54:55], v161 offset:18432
s_add_u32 m0, s62, 73728
s_add_u32 s64, s64, 65536
buffer_load_dwordx4 v175, s[32:35], s64 offen lds
s_waitcnt lgkmcnt(14)
v_mfma_f32_16x16x32_bf16 v[8:11], a[56:59], a[0:3], v[8:11]
v_mfma_f32_16x16x32_bf16 v[40:43], a[56:59], a[4:7], v[40:43]
ds_read_b64_tr_b16 a[56:57], v162 offset:16384
ds_read_b64_tr_b16 a[58:59], v162 offset:18432
s_waitcnt lgkmcnt(14)
v_mfma_f32_16x16x32_bf16 v[12:15], a[60:63], a[0:3], v[12:15]
v_mfma_f32_16x16x32_bf16 v[44:47], a[60:63], a[4:7], v[44:47]
ds_read_b64_tr_b16 a[60:61], v163 offset:16384
ds_read_b64_tr_b16 a[62:63], v163 offset:18432
s_waitcnt vmcnt(12) lgkmcnt(0)
s_cmp_lg_u32 s87, 0
s_cbranch_scc1 k1_kernel_b_g2p_pc_rdy
s_waitcnt vmcnt(6)
v_cmp_le_u32 s[100:101], 3, v172
s_nop 0
s_cmp_eq_u64 s[100:101], -1
s_cbranch_scc1 k1_kernel_b_g2p_pc_rdy
s_mov_b32 s91, 40000
k1_kernel_b_g2p_pc_spin:
s_sleep 2
v_lshrrev_b32 v172, 4, v171
v_min_u32 v172, 11, v172
v_and_b32 v174, 1, v172
v_lshlrev_b32 v172, 3, v172
v_lshlrev_b32 v174, 2, v174
v_sub_u32 v172, v172, v174
buffer_load_dword v172, v172, s[40:43], s66 offen offset:0 sc1
s_waitcnt vmcnt(0)
v_cmp_le_u32 s[100:101], 3, v172
s_nop 0
s_cmp_eq_u64 s[100:101], -1
s_cbranch_scc1 k1_kernel_b_g2p_pc_rdy
s_sub_u32 s91, s91, 1
s_cmp_lg_u32 s91, 0
s_cbranch_scc1 k1_kernel_b_g2p_pc_spin
s_nop 0
k1_kernel_b_g2p_pc_rdy:
s_barrier
buffer_load_dwordx4 a[24:27], v171, s[40:43], s68 offen sc1
buffer_load_dwordx4 a[28:31], v171, s[40:43], s69 offen sc1
s_add_u32 s68, s68, 6144
s_add_u32 s69, s69, 6144
s_setprio 3
v_mfma_f32_16x16x32_bf16 v[16:19], a[64:67], a[8:11], v[16:19]
v_mfma_f32_16x16x32_bf16 v[48:51], a[64:67], a[12:15], v[48:51]
ds_read_b64_tr_b16 a[64:65], v160 offset:36864
ds_read_b64_tr_b16 a[66:67], v160 offset:38912
v_mfma_f32_16x16x32_bf16 v[20:23], a[68:71], a[8:11], v[20:23]
v_mfma_f32_16x16x32_bf16 v[52:55], a[68:71], a[12:15], v[52:55]
ds_read_b64_tr_b16 a[68:69], v161 offset:36864
ds_read_b64_tr_b16 a[70:71], v161 offset:38912
s_add_u32 m0, s62, 81920
s_add_u32 s64, s64, 458752
buffer_load_dwordx4 v175, s[32:35], s64 offen lds
v_mfma_f32_16x16x32_bf16 v[24:27], a[72:75], a[8:11], v[24:27]
v_mfma_f32_16x16x32_bf16 v[56:59], a[72:75], a[12:15], v[56:59]
ds_read_b64_tr_b16 a[72:73], v162 offset:36864
ds_read_b64_tr_b16 a[74:75], v162 offset:38912
v_mfma_f32_16x16x32_bf16 v[28:31], a[76:79], a[8:11], v[28:31]
v_mfma_f32_16x16x32_bf16 v[60:63], a[76:79], a[12:15], v[60:63]
ds_read_b64_tr_b16 a[76:77], v163 offset:36864
ds_read_b64_tr_b16 a[78:79], v163 offset:38912
s_setprio 2
v_mfma_f32_16x16x32_bf16 v[0:3], a[48:51], a[8:11], v[0:3]
v_mfma_f32_16x16x32_bf16 v[32:35], a[48:51], a[12:15], v[32:35]
ds_read_b64_tr_b16 a[48:49], v160 offset:32768
ds_read_b64_tr_b16 a[50:51], v160 offset:34816
v_mfma_f32_16x16x32_bf16 v[4:7], a[52:55], a[8:11], v[4:7]
v_mfma_f32_16x16x32_bf16 v[36:39], a[52:55], a[12:15], v[36:39]
ds_read_b64_tr_b16 a[52:53], v161 offset:32768
ds_read_b64_tr_b16 a[54:55], v161 offset:34816
s_add_u32 m0, s62, 90112
s_add_u32 s64, s64, 65536
buffer_load_dwordx4 v175, s[32:35], s64 offen lds
v_mfma_f32_16x16x32_bf16 v[8:11], a[56:59], a[8:11], v[8:11]
v_mfma_f32_16x16x32_bf16 v[40:43], a[56:59], a[12:15], v[40:43]
ds_read_b64_tr_b16 a[56:57], v162 offset:32768
ds_read_b64_tr_b16 a[58:59], v162 offset:34816
v_mfma_f32_16x16x32_bf16 v[12:15], a[60:63], a[8:11], v[12:15]
v_mfma_f32_16x16x32_bf16 v[44:47], a[60:63], a[12:15], v[44:47]
ds_read_b64_tr_b16 a[60:61], v163 offset:32768
ds_read_b64_tr_b16 a[62:63], v163 offset:34816
buffer_load_dwordx4 a[0:3], v171, s[40:43], s68 offen sc1
buffer_load_dwordx4 a[4:7], v171, s[40:43], s69 offen sc1
s_add_u32 s68, s68, 8192
s_add_u32 s69, s69, 8192
s_waitcnt vmcnt(16)
s_waitcnt lgkmcnt(14)
s_setprio 1
v_mfma_f32_16x16x32_bf16 v[16:19], a[64:67], a[32:35], v[16:19]
v_mfma_f32_16x16x32_bf16 v[48:51], a[64:67], a[36:39], v[48:51]
ds_read_b64_tr_b16 a[64:65], v160 offset:53248
ds_read_b64_tr_b16 a[66:67], v160 offset:55296
s_waitcnt lgkmcnt(14)
v_mfma_f32_16x16x32_bf16 v[20:23], a[68:71], a[32:35], v[20:23]
v_mfma_f32_16x16x32_bf16 v[52:55], a[68:71], a[36:39], v[52:55]
ds_read_b64_tr_b16 a[68:69], v161 offset:53248
ds_read_b64_tr_b16 a[70:71], v161 offset:55296
s_add_u32 m0, s62, 0
s_add_u32 s64, s64, 327680
buffer_load_dwordx4 v175, s[32:35], s64 offen lds
s_waitcnt lgkmcnt(14)
v_mfma_f32_16x16x32_bf16 v[24:27], a[72:75], a[32:35], v[24:27]
v_mfma_f32_16x16x32_bf16 v[56:59], a[72:75], a[36:39], v[56:59]
ds_read_b64_tr_b16 a[72:73], v162 offset:53248
ds_read_b64_tr_b16 a[74:75], v162 offset:55296
s_waitcnt lgkmcnt(14)
v_mfma_f32_16x16x32_bf16 v[28:31], a[76:79], a[32:35], v[28:31]
v_mfma_f32_16x16x32_bf16 v[60:63], a[76:79], a[36:39], v[60:63]
ds_read_b64_tr_b16 a[76:77], v163 offset:53248
ds_read_b64_tr_b16 a[78:79], v163 offset:55296
s_waitcnt lgkmcnt(14)
s_setprio 0
v_mfma_f32_16x16x32_bf16 v[0:3], a[48:51], a[32:35], v[0:3]
v_mfma_f32_16x16x32_bf16 v[32:35], a[48:51], a[36:39], v[32:35]
ds_read_b64_tr_b16 a[48:49], v160 offset:49152
ds_read_b64_tr_b16 a[50:51], v160 offset:51200
s_waitcnt lgkmcnt(14)
v_mfma_f32_16x16x32_bf16 v[4:7], a[52:55], a[32:35], v[4:7]
v_mfma_f32_16x16x32_bf16 v[36:39], a[52:55], a[36:39], v[36:39]
ds_read_b64_tr_b16 a[52:53], v161 offset:49152
ds_read_b64_tr_b16 a[54:55], v161 offset:51200
s_add_u32 m0, s62, 8192
s_add_u32 s64, s64, 65536
buffer_load_dwordx4 v175, s[32:35], s64 offen lds
s_waitcnt lgkmcnt(14)
v_mfma_f32_16x16x32_bf16 v[8:11], a[56:59], a[32:35], v[8:11]
v_mfma_f32_16x16x32_bf16 v[40:43], a[56:59], a[36:39], v[40:43]
ds_read_b64_tr_b16 a[56:57], v162 offset:49152
ds_read_b64_tr_b16 a[58:59], v162 offset:51200
s_waitcnt lgkmcnt(14)
v_mfma_f32_16x16x32_bf16 v[12:15], a[60:63], a[32:35], v[12:15]
v_mfma_f32_16x16x32_bf16 v[44:47], a[60:63], a[36:39], v[44:47]
ds_read_b64_tr_b16 a[60:61], v163 offset:49152
ds_read_b64_tr_b16 a[62:63], v163 offset:51200
buffer_load_dwordx4 a[8:11], v171, s[40:43], s68 offen sc1
buffer_load_dwordx4 a[12:15], v171, s[40:43], s69 offen sc1
s_add_u32 s68, s68, 6144
s_add_u32 s69, s69, 6144
s_waitcnt vmcnt(14) lgkmcnt(0)
s_barrier
v_xor_b32 v160, 0x10000, v160
v_xor_b32 v161, 0x10000, v161
v_xor_b32 v162, 0x10000, v162
v_xor_b32 v163, 0x10000, v163
s_setprio 3
v_mfma_f32_16x16x32_bf16 v[16:19], a[64:67], a[40:43], v[16:19]
v_mfma_f32_16x16x32_bf16 v[48:51], a[64:67], a[44:47], v[48:51]
ds_read_b64_tr_b16 a[64:65], v160 offset:36864
ds_read_b64_tr_b16 a[66:67], v160 offset:38912
v_mfma_f32_16x16x32_bf16 v[20:23], a[68:71], a[40:43], v[20:23]
v_mfma_f32_16x16x32_bf16 v[52:55], a[68:71], a[44:47], v[52:55]
ds_read_b64_tr_b16 a[68:69], v161 offset:36864
ds_read_b64_tr_b16 a[70:71], v161 offset:38912
s_add_u32 m0, s62, 16384
s_add_u32 s64, s64, 458752
buffer_load_dwordx4 v175, s[32:35], s64 offen lds
v_mfma_f32_16x16x32_bf16 v[24:27], a[72:75], a[40:43], v[24:27]
v_mfma_f32_16x16x32_bf16 v[56:59], a[72:75], a[44:47], v[56:59]
ds_read_b64_tr_b16 a[72:73], v162 offset:36864
ds_read_b64_tr_b16 a[74:75], v162 offset:38912
v_mfma_f32_16x16x32_bf16 v[28:31], a[76:79], a[40:43], v[28:31]
v_mfma_f32_16x16x32_bf16 v[60:63], a[76:79], a[44:47], v[60:63]
ds_read_b64_tr_b16 a[76:77], v163 offset:36864
ds_read_b64_tr_b16 a[78:79], v163 offset:38912
s_setprio 2
v_mfma_f32_16x16x32_bf16 v[0:3], a[48:51], a[40:43], v[0:3]
v_mfma_f32_16x16x32_bf16 v[32:35], a[48:51], a[44:47], v[32:35]
ds_read_b64_tr_b16 a[48:49], v160 offset:32768
ds_read_b64_tr_b16 a[50:51], v160 offset:34816
v_mfma_f32_16x16x32_bf16 v[4:7], a[52:55], a[40:43], v[4:7]
v_mfma_f32_16x16x32_bf16 v[36:39], a[52:55], a[44:47], v[36:39]
ds_read_b64_tr_b16 a[52:53], v161 offset:32768
ds_read_b64_tr_b16 a[54:55], v161 offset:34816
s_add_u32 m0, s62, 24576
s_add_u32 s64, s64, 65536
buffer_load_dwordx4 v175, s[32:35], s64 offen lds
v_mfma_f32_16x16x32_bf16 v[8:11], a[56:59], a[40:43], v[8:11]
v_mfma_f32_16x16x32_bf16 v[40:43], a[56:59], a[44:47], v[40:43]
ds_read_b64_tr_b16 a[56:57], v162 offset:32768
ds_read_b64_tr_b16 a[58:59], v162 offset:34816
v_mfma_f32_16x16x32_bf16 v[12:15], a[60:63], a[40:43], v[12:15]
v_mfma_f32_16x16x32_bf16 v[44:47], a[60:63], a[44:47], v[44:47]
ds_read_b64_tr_b16 a[60:61], v163 offset:32768
ds_read_b64_tr_b16 a[62:63], v163 offset:34816
buffer_load_dwordx4 a[32:35], v171, s[40:43], s68 offen sc1
buffer_load_dwordx4 a[36:39], v171, s[40:43], s69 offen sc1
s_add_u32 s68, s68, 8192
s_add_u32 s69, s69, 8192
s_waitcnt vmcnt(16)
s_waitcnt lgkmcnt(14)
s_setprio 1
v_mfma_f32_16x16x32_bf16 v[16:19], a[64:67], a[16:19], v[16:19]
v_mfma_f32_16x16x32_bf16 v[48:51], a[64:67], a[20:23], v[48:51]
ds_read_b64_tr_b16 a[64:65], v160 offset:53248
ds_read_b64_tr_b16 a[66:67], v160 offset:55296
s_waitcnt lgkmcnt(14)
v_mfma_f32_16x16x32_bf16 v[20:23], a[68:71], a[16:19], v[20:23]
v_mfma_f32_16x16x32_bf16 v[52:55], a[68:71], a[20:23], v[52:55]
ds_read_b64_tr_b16 a[68:69], v161 offset:53248
ds_read_b64_tr_b16 a[70:71], v161 offset:55296
s_add_u32 m0, s62, 32768
s_add_u32 s64, s64, 327680
buffer_load_dwordx4 v175, s[32:35], s64 offen lds
s_waitcnt lgkmcnt(14)
v_mfma_f32_16x16x32_bf16 v[24:27], a[72:75], a[16:19], v[24:27]
v_mfma_f32_16x16x32_bf16 v[56:59], a[72:75], a[20:23], v[56:59]
ds_read_b64_tr_b16 a[72:73], v162 offset:53248
ds_read_b64_tr_b16 a[74:75], v162 offset:55296
s_waitcnt lgkmcnt(14)
v_mfma_f32_16x16x32_bf16 v[28:31], a[76:79], a[16:19], v[28:31]
v_mfma_f32_16x16x32_bf16 v[60:63], a[76:79], a[20:23], v[60:63]
ds_read_b64_tr_b16 a[76:77], v163 offset:53248
ds_read_b64_tr_b16 a[78:79], v163 offset:55296
s_waitcnt lgkmcnt(14)
s_setprio 0
v_mfma_f32_16x16x32_bf16 v[0:3], a[48:51], a[16:19], v[0:3]
v_mfma_f32_16x16x32_bf16 v[32:35], a[48:51], a[20:23], v[32:35]
ds_read_b64_tr_b16 a[48:49], v160 offset:49152
ds_read_b64_tr_b16 a[50:51], v160 offset:51200
s_waitcnt lgkmcnt(14)
v_mfma_f32_16x16x32_bf16 v[4:7], a[52:55], a[16:19], v[4:7]
v_mfma_f32_16x16x32_bf16 v[36:39], a[52:55], a[20:23], v[36:39]
ds_read_b64_tr_b16 a[52:53], v161 offset:49152
ds_read_b64_tr_b16 a[54:55], v161 offset:51200
s_add_u32 m0, s62, 40960
s_add_u32 s64, s64, 65536
buffer_load_dwordx4 v175, s[32:35], s64 offen lds
s_waitcnt lgkmcnt(14)
v_mfma_f32_16x16x32_bf16 v[8:11], a[56:59], a[16:19], v[8:11]
v_mfma_f32_16x16x32_bf16 v[40:43], a[56:59], a[20:23], v[40:43]
ds_read_b64_tr_b16 a[56:57], v162 offset:49152
ds_read_b64_tr_b16 a[58:59], v162 offset:51200
s_waitcnt lgkmcnt(14)
v_mfma_f32_16x16x32_bf16 v[12:15], a[60:63], a[16:19], v[12:15]
v_mfma_f32_16x16x32_bf16 v[44:47], a[60:63], a[20:23], v[44:47]
ds_read_b64_tr_b16 a[60:61], v163 offset:49152
ds_read_b64_tr_b16 a[62:63], v163 offset:51200
buffer_load_dwordx4 a[40:43], v171, s[40:43], s68 offen sc1
buffer_load_dwordx4 a[44:47], v171, s[40:43], s69 offen sc1
s_add_u32 s68, s68, 6144
s_add_u32 s69, s69, 6144
s_waitcnt vmcnt(14) lgkmcnt(0)
s_barrier
s_setprio 3
v_mfma_f32_16x16x32_bf16 v[16:19], a[64:67], a[24:27], v[16:19]
v_mfma_f32_16x16x32_bf16 v[48:51], a[64:67], a[28:31], v[48:51]
ds_read_b64_tr_b16 a[64:65], v160 offset:4096
ds_read_b64_tr_b16 a[66:67], v160 offset:6144
v_mfma_f32_16x16x32_bf16 v[20:23], a[68:71], a[24:27], v[20:23]
v_mfma_f32_16x16x32_bf16 v[52:55], a[68:71], a[28:31], v[52:55]
ds_read_b64_tr_b16 a[68:69], v161 offset:4096
ds_read_b64_tr_b16 a[70:71], v161 offset:6144
s_add_u32 m0, s62, 49152
s_add_u32 s64, s64, 458752
buffer_load_dwordx4 v175, s[32:35], s64 offen lds
v_mfma_f32_16x16x32_bf16 v[24:27], a[72:75], a[24:27], v[24:27]
v_mfma_f32_16x16x32_bf16 v[56:59], a[72:75], a[28:31], v[56:59]
ds_read_b64_tr_b16 a[72:73], v162 offset:4096
ds_read_b64_tr_b16 a[74:75], v162 offset:6144
v_mfma_f32_16x16x32_bf16 v[28:31], a[76:79], a[24:27], v[28:31]
v_mfma_f32_16x16x32_bf16 v[60:63], a[76:79], a[28:31], v[60:63]
ds_read_b64_tr_b16 a[76:77], v163 offset:4096
ds_read_b64_tr_b16 a[78:79], v163 offset:6144
s_setprio 2
v_mfma_f32_16x16x32_bf16 v[0:3], a[48:51], a[24:27], v[0:3]
v_mfma_f32_16x16x32_bf16 v[32:35], a[48:51], a[28:31], v[32:35]
ds_read_b64_tr_b16 a[48:49], v160 offset:0
ds_read_b64_tr_b16 a[50:51], v160 offset:2048
v_mfma_f32_16x16x32_bf16 v[4:7], a[52:55], a[24:27], v[4:7]
v_mfma_f32_16x16x32_bf16 v[36:39], a[52:55], a[28:31], v[36:39]
ds_read_b64_tr_b16 a[52:53], v161 offset:0
ds_read_b64_tr_b16 a[54:55], v161 offset:2048
s_add_u32 m0, s62, 57344
s_add_u32 s64, s64, 65536
buffer_load_dwordx4 v175, s[32:35], s64 offen lds
v_mfma_f32_16x16x32_bf16 v[8:11], a[56:59], a[24:27], v[8:11]
v_mfma_f32_16x16x32_bf16 v[40:43], a[56:59], a[28:31], v[40:43]
ds_read_b64_tr_b16 a[56:57], v162 offset:0
ds_read_b64_tr_b16 a[58:59], v162 offset:2048
v_mfma_f32_16x16x32_bf16 v[12:15], a[60:63], a[24:27], v[12:15]
v_mfma_f32_16x16x32_bf16 v[44:47], a[60:63], a[28:31], v[44:47]
ds_read_b64_tr_b16 a[60:61], v163 offset:0
ds_read_b64_tr_b16 a[62:63], v163 offset:2048
buffer_load_dwordx4 a[16:19], v171, s[40:43], s68 offen sc1
buffer_load_dwordx4 a[20:23], v171, s[40:43], s69 offen sc1
s_add_u32 s68, s68, 8192
s_add_u32 s69, s69, 8192
s_waitcnt vmcnt(16)
s_waitcnt lgkmcnt(14)
s_setprio 1
v_mfma_f32_16x16x32_bf16 v[16:19], a[64:67], a[0:3], v[16:19]
v_mfma_f32_16x16x32_bf16 v[48:51], a[64:67], a[4:7], v[48:51]
ds_read_b64_tr_b16 a[64:65], v160 offset:20480
ds_read_b64_tr_b16 a[66:67], v160 offset:22528
s_waitcnt lgkmcnt(14)
v_mfma_f32_16x16x32_bf16 v[20:23], a[68:71], a[0:3], v[20:23]
v_mfma_f32_16x16x32_bf16 v[52:55], a[68:71], a[4:7], v[52:55]
ds_read_b64_tr_b16 a[68:69], v161 offset:20480
ds_read_b64_tr_b16 a[70:71], v161 offset:22528
s_add_u32 m0, s62, 98304
s_add_u32 s64, s64, 327680
buffer_load_dwordx4 v175, s[32:35], s64 offen lds
s_waitcnt lgkmcnt(14)
v_mfma_f32_16x16x32_bf16 v[24:27], a[72:75], a[0:3], v[24:27]
v_mfma_f32_16x16x32_bf16 v[56:59], a[72:75], a[4:7], v[56:59]
ds_read_b64_tr_b16 a[72:73], v162 offset:20480
ds_read_b64_tr_b16 a[74:75], v162 offset:22528
s_waitcnt lgkmcnt(14)
v_mfma_f32_16x16x32_bf16 v[28:31], a[76:79], a[0:3], v[28:31]
v_mfma_f32_16x16x32_bf16 v[60:63], a[76:79], a[4:7], v[60:63]
ds_read_b64_tr_b16 a[76:77], v163 offset:20480
ds_read_b64_tr_b16 a[78:79], v163 offset:22528
s_waitcnt lgkmcnt(14)
s_setprio 0
v_mfma_f32_16x16x32_bf16 v[0:3], a[48:51], a[0:3], v[0:3]
v_mfma_f32_16x16x32_bf16 v[32:35], a[48:51], a[4:7], v[32:35]
ds_read_b64_tr_b16 a[48:49], v160 offset:16384
ds_read_b64_tr_b16 a[50:51], v160 offset:18432
s_waitcnt lgkmcnt(14)
v_mfma_f32_16x16x32_bf16 v[4:7], a[52:55], a[0:3], v[4:7]
v_mfma_f32_16x16x32_bf16 v[36:39], a[52:55], a[4:7], v[36:39]
ds_read_b64_tr_b16 a[52:53], v161 offset:16384
ds_read_b64_tr_b16 a[54:55], v161 offset:18432
s_add_u32 m0, s62, 106496
s_add_u32 s64, s64, 65536
buffer_load_dwordx4 v175, s[32:35], s64 offen lds
s_waitcnt lgkmcnt(14)
v_mfma_f32_16x16x32_bf16 v[8:11], a[56:59], a[0:3], v[8:11]
v_mfma_f32_16x16x32_bf16 v[40:43], a[56:59], a[4:7], v[40:43]
ds_read_b64_tr_b16 a[56:57], v162 offset:16384
ds_read_b64_tr_b16 a[58:59], v162 offset:18432
s_waitcnt lgkmcnt(14)
v_mfma_f32_16x16x32_bf16 v[12:15], a[60:63], a[0:3], v[12:15]
v_mfma_f32_16x16x32_bf16 v[44:47], a[60:63], a[4:7], v[44:47]
ds_read_b64_tr_b16 a[60:61], v163 offset:16384
ds_read_b64_tr_b16 a[62:63], v163 offset:18432
buffer_load_dwordx4 a[24:27], v171, s[40:43], s68 offen sc1
buffer_load_dwordx4 a[28:31], v171, s[40:43], s69 offen sc1
s_add_u32 s68, s68, 6144
s_add_u32 s69, s69, 6144
s_waitcnt vmcnt(14) lgkmcnt(0)
s_barrier
v_xor_b32 v160, 0x10000, v160
v_xor_b32 v161, 0x10000, v161
v_xor_b32 v162, 0x10000, v162
v_xor_b32 v163, 0x10000, v163
s_setprio 3
v_mfma_f32_16x16x32_bf16 v[16:19], a[64:67], a[8:11], v[16:19]
v_mfma_f32_16x16x32_bf16 v[48:51], a[64:67], a[12:15], v[48:51]
ds_read_b64_tr_b16 a[64:65], v160 offset:4096
ds_read_b64_tr_b16 a[66:67], v160 offset:6144
v_mfma_f32_16x16x32_bf16 v[20:23], a[68:71], a[8:11], v[20:23]
v_mfma_f32_16x16x32_bf16 v[52:55], a[68:71], a[12:15], v[52:55]
ds_read_b64_tr_b16 a[68:69], v161 offset:4096
ds_read_b64_tr_b16 a[70:71], v161 offset:6144
s_add_u32 m0, s62, 114688
s_add_u32 s64, s64, 458752
buffer_load_dwordx4 v175, s[32:35], s64 offen lds
v_mfma_f32_16x16x32_bf16 v[24:27], a[72:75], a[8:11], v[24:27]
v_mfma_f32_16x16x32_bf16 v[56:59], a[72:75], a[12:15], v[56:59]
ds_read_b64_tr_b16 a[72:73], v162 offset:4096
ds_read_b64_tr_b16 a[74:75], v162 offset:6144
v_mfma_f32_16x16x32_bf16 v[28:31], a[76:79], a[8:11], v[28:31]
v_mfma_f32_16x16x32_bf16 v[60:63], a[76:79], a[12:15], v[60:63]
ds_read_b64_tr_b16 a[76:77], v163 offset:4096
ds_read_b64_tr_b16 a[78:79], v163 offset:6144
s_setprio 2
v_mfma_f32_16x16x32_bf16 v[0:3], a[48:51], a[8:11], v[0:3]
v_mfma_f32_16x16x32_bf16 v[32:35], a[48:51], a[12:15], v[32:35]
ds_read_b64_tr_b16 a[48:49], v160 offset:0
ds_read_b64_tr_b16 a[50:51], v160 offset:2048
v_mfma_f32_16x16x32_bf16 v[4:7], a[52:55], a[8:11], v[4:7]
v_mfma_f32_16x16x32_bf16 v[36:39], a[52:55], a[12:15], v[36:39]
ds_read_b64_tr_b16 a[52:53], v161 offset:0
ds_read_b64_tr_b16 a[54:55], v161 offset:2048
s_add_u32 m0, s62, 122880
s_add_u32 s64, s64, 65536
buffer_load_dwordx4 v175, s[32:35], s64 offen lds
v_mfma_f32_16x16x32_bf16 v[8:11], a[56:59], a[8:11], v[8:11]
v_mfma_f32_16x16x32_bf16 v[40:43], a[56:59], a[12:15], v[40:43]
ds_read_b64_tr_b16 a[56:57], v162 offset:0
ds_read_b64_tr_b16 a[58:59], v162 offset:2048
v_mfma_f32_16x16x32_bf16 v[12:15], a[60:63], a[8:11], v[12:15]
v_mfma_f32_16x16x32_bf16 v[44:47], a[60:63], a[12:15], v[44:47]
ds_read_b64_tr_b16 a[60:61], v163 offset:0
ds_read_b64_tr_b16 a[62:63], v163 offset:2048
buffer_load_dwordx4 a[0:3], v171, s[40:43], s68 offen sc1
buffer_load_dwordx4 a[4:7], v171, s[40:43], s69 offen sc1
s_add_u32 s68, s68, 8192
s_add_u32 s69, s69, 8192
s_waitcnt vmcnt(16)
s_waitcnt lgkmcnt(14)
s_setprio 1
v_mfma_f32_16x16x32_bf16 v[16:19], a[64:67], a[32:35], v[16:19]
v_mfma_f32_16x16x32_bf16 v[48:51], a[64:67], a[36:39], v[48:51]
ds_read_b64_tr_b16 a[64:65], v160 offset:20480
ds_read_b64_tr_b16 a[66:67], v160 offset:22528
s_waitcnt lgkmcnt(14)
v_mfma_f32_16x16x32_bf16 v[20:23], a[68:71], a[32:35], v[20:23]
v_mfma_f32_16x16x32_bf16 v[52:55], a[68:71], a[36:39], v[52:55]
ds_read_b64_tr_b16 a[68:69], v161 offset:20480
ds_read_b64_tr_b16 a[70:71], v161 offset:22528
s_add_u32 m0, s62, 65536
s_add_u32 s64, s64, 327680
buffer_load_dwordx4 v175, s[32:35], s64 offen lds
s_waitcnt lgkmcnt(14)
v_mfma_f32_16x16x32_bf16 v[24:27], a[72:75], a[32:35], v[24:27]
v_mfma_f32_16x16x32_bf16 v[56:59], a[72:75], a[36:39], v[56:59]
ds_read_b64_tr_b16 a[72:73], v162 offset:20480
ds_read_b64_tr_b16 a[74:75], v162 offset:22528
s_waitcnt lgkmcnt(14)
v_mfma_f32_16x16x32_bf16 v[28:31], a[76:79], a[32:35], v[28:31]
v_mfma_f32_16x16x32_bf16 v[60:63], a[76:79], a[36:39], v[60:63]
ds_read_b64_tr_b16 a[76:77], v163 offset:20480
ds_read_b64_tr_b16 a[78:79], v163 offset:22528
s_waitcnt lgkmcnt(14)
s_setprio 0
v_mfma_f32_16x16x32_bf16 v[0:3], a[48:51], a[32:35], v[0:3]
v_mfma_f32_16x16x32_bf16 v[32:35], a[48:51], a[36:39], v[32:35]
ds_read_b64_tr_b16 a[48:49], v160 offset:16384
ds_read_b64_tr_b16 a[50:51], v160 offset:18432
s_waitcnt lgkmcnt(14)
v_mfma_f32_16x16x32_bf16 v[4:7], a[52:55], a[32:35], v[4:7]
v_mfma_f32_16x16x32_bf16 v[36:39], a[52:55], a[36:39], v[36:39]
ds_read_b64_tr_b16 a[52:53], v161 offset:16384
ds_read_b64_tr_b16 a[54:55], v161 offset:18432
s_add_u32 m0, s62, 73728
s_add_u32 s64, s64, 65536
buffer_load_dwordx4 v175, s[32:35], s64 offen lds
s_waitcnt lgkmcnt(14)
v_mfma_f32_16x16x32_bf16 v[8:11], a[56:59], a[32:35], v[8:11]
v_mfma_f32_16x16x32_bf16 v[40:43], a[56:59], a[36:39], v[40:43]
ds_read_b64_tr_b16 a[56:57], v162 offset:16384
ds_read_b64_tr_b16 a[58:59], v162 offset:18432
s_waitcnt lgkmcnt(14)
v_mfma_f32_16x16x32_bf16 v[12:15], a[60:63], a[32:35], v[12:15]
v_mfma_f32_16x16x32_bf16 v[44:47], a[60:63], a[36:39], v[44:47]
ds_read_b64_tr_b16 a[60:61], v163 offset:16384
ds_read_b64_tr_b16 a[62:63], v163 offset:18432
buffer_load_dwordx4 a[8:11], v171, s[40:43], s68 offen sc1
buffer_load_dwordx4 a[12:15], v171, s[40:43], s69 offen sc1
s_add_u32 s68, s68, 6144
s_add_u32 s69, s69, 6144
s_waitcnt vmcnt(14) lgkmcnt(0)
s_barrier
s_setprio 3
v_mfma_f32_16x16x32_bf16 v[16:19], a[64:67], a[40:43], v[16:19]
v_mfma_f32_16x16x32_bf16 v[48:51], a[64:67], a[44:47], v[48:51]
ds_read_b64_tr_b16 a[64:65], v160 offset:36864
ds_read_b64_tr_b16 a[66:67], v160 offset:38912
v_mfma_f32_16x16x32_bf16 v[20:23], a[68:71], a[40:43], v[20:23]
v_mfma_f32_16x16x32_bf16 v[52:55], a[68:71], a[44:47], v[52:55]
ds_read_b64_tr_b16 a[68:69], v161 offset:36864
ds_read_b64_tr_b16 a[70:71], v161 offset:38912
s_add_u32 m0, s62, 81920
s_add_u32 s64, s64, 458752
buffer_load_dwordx4 v175, s[32:35], s64 offen lds
v_mfma_f32_16x16x32_bf16 v[24:27], a[72:75], a[40:43], v[24:27]
v_mfma_f32_16x16x32_bf16 v[56:59], a[72:75], a[44:47], v[56:59]
ds_read_b64_tr_b16 a[72:73], v162 offset:36864
ds_read_b64_tr_b16 a[74:75], v162 offset:38912
v_mfma_f32_16x16x32_bf16 v[28:31], a[76:79], a[40:43], v[28:31]
v_mfma_f32_16x16x32_bf16 v[60:63], a[76:79], a[44:47], v[60:63]
ds_read_b64_tr_b16 a[76:77], v163 offset:36864
ds_read_b64_tr_b16 a[78:79], v163 offset:38912
s_setprio 2
v_mfma_f32_16x16x32_bf16 v[0:3], a[48:51], a[40:43], v[0:3]
v_mfma_f32_16x16x32_bf16 v[32:35], a[48:51], a[44:47], v[32:35]
ds_read_b64_tr_b16 a[48:49], v160 offset:32768
ds_read_b64_tr_b16 a[50:51], v160 offset:34816
v_mfma_f32_16x16x32_bf16 v[4:7], a[52:55], a[40:43], v[4:7]
v_mfma_f32_16x16x32_bf16 v[36:39], a[52:55], a[44:47], v[36:39]
ds_read_b64_tr_b16 a[52:53], v161 offset:32768
ds_read_b64_tr_b16 a[54:55], v161 offset:34816
s_add_u32 m0, s62, 90112
s_add_u32 s64, s64, 65536
buffer_load_dwordx4 v175, s[32:35], s64 offen lds
v_mfma_f32_16x16x32_bf16 v[8:11], a[56:59], a[40:43], v[8:11]
v_mfma_f32_16x16x32_bf16 v[40:43], a[56:59], a[44:47], v[40:43]
ds_read_b64_tr_b16 a[56:57], v162 offset:32768
ds_read_b64_tr_b16 a[58:59], v162 offset:34816
v_mfma_f32_16x16x32_bf16 v[12:15], a[60:63], a[40:43], v[12:15]
v_mfma_f32_16x16x32_bf16 v[44:47], a[60:63], a[44:47], v[44:47]
ds_read_b64_tr_b16 a[60:61], v163 offset:32768
ds_read_b64_tr_b16 a[62:63], v163 offset:34816
buffer_load_dwordx4 a[32:35], v171, s[40:43], s68 offen sc1
buffer_load_dwordx4 a[36:39], v171, s[40:43], s69 offen sc1
s_add_u32 s68, s68, 8192
s_add_u32 s69, s69, 8192
s_waitcnt vmcnt(16)
s_waitcnt lgkmcnt(14)
s_setprio 1
v_mfma_f32_16x16x32_bf16 v[16:19], a[64:67], a[16:19], v[16:19]
v_mfma_f32_16x16x32_bf16 v[48:51], a[64:67], a[20:23], v[48:51]
ds_read_b64_tr_b16 a[64:65], v160 offset:53248
ds_read_b64_tr_b16 a[66:67], v160 offset:55296
s_waitcnt lgkmcnt(14)
v_mfma_f32_16x16x32_bf16 v[20:23], a[68:71], a[16:19], v[20:23]
v_mfma_f32_16x16x32_bf16 v[52:55], a[68:71], a[20:23], v[52:55]
ds_read_b64_tr_b16 a[68:69], v161 offset:53248
ds_read_b64_tr_b16 a[70:71], v161 offset:55296
s_add_u32 m0, s62, 0
s_add_u32 s64, s64, 327680
buffer_load_dwordx4 v175, s[32:35], s64 offen lds
s_waitcnt lgkmcnt(14)
v_mfma_f32_16x16x32_bf16 v[24:27], a[72:75], a[16:19], v[24:27]
v_mfma_f32_16x16x32_bf16 v[56:59], a[72:75], a[20:23], v[56:59]
ds_read_b64_tr_b16 a[72:73], v162 offset:53248
ds_read_b64_tr_b16 a[74:75], v162 offset:55296
s_waitcnt lgkmcnt(14)
v_mfma_f32_16x16x32_bf16 v[28:31], a[76:79], a[16:19], v[28:31]
v_mfma_f32_16x16x32_bf16 v[60:63], a[76:79], a[20:23], v[60:63]
ds_read_b64_tr_b16 a[76:77], v163 offset:53248
ds_read_b64_tr_b16 a[78:79], v163 offset:55296
s_waitcnt lgkmcnt(14)
s_setprio 0
v_mfma_f32_16x16x32_bf16 v[0:3], a[48:51], a[16:19], v[0:3]
v_mfma_f32_16x16x32_bf16 v[32:35], a[48:51], a[20:23], v[32:35]
ds_read_b64_tr_b16 a[48:49], v160 offset:49152
ds_read_b64_tr_b16 a[50:51], v160 offset:51200
s_waitcnt lgkmcnt(14)
v_mfma_f32_16x16x32_bf16 v[4:7], a[52:55], a[16:19], v[4:7]
v_mfma_f32_16x16x32_bf16 v[36:39], a[52:55], a[20:23], v[36:39]
ds_read_b64_tr_b16 a[52:53], v161 offset:49152
ds_read_b64_tr_b16 a[54:55], v161 offset:51200
s_add_u32 m0, s62, 8192
s_add_u32 s64, s64, 65536
buffer_load_dwordx4 v175, s[32:35], s64 offen lds
s_waitcnt lgkmcnt(14)
v_mfma_f32_16x16x32_bf16 v[8:11], a[56:59], a[16:19], v[8:11]
v_mfma_f32_16x16x32_bf16 v[40:43], a[56:59], a[20:23], v[40:43]
ds_read_b64_tr_b16 a[56:57], v162 offset:49152
ds_read_b64_tr_b16 a[58:59], v162 offset:51200
s_waitcnt lgkmcnt(14)
v_mfma_f32_16x16x32_bf16 v[12:15], a[60:63], a[16:19], v[12:15]
v_mfma_f32_16x16x32_bf16 v[44:47], a[60:63], a[20:23], v[44:47]
ds_read_b64_tr_b16 a[60:61], v163 offset:49152
ds_read_b64_tr_b16 a[62:63], v163 offset:51200
buffer_load_dwordx4 a[40:43], v171, s[40:43], s68 offen sc1
buffer_load_dwordx4 a[44:47], v171, s[40:43], s69 offen sc1
s_add_u32 s68, s68, 6144
s_add_u32 s69, s69, 6144
s_waitcnt vmcnt(14) lgkmcnt(0)
s_barrier
s_cmp_lg_u32 s87, 0
s_cbranch_scc1 k1_kernel_b_g3p_pi
v_lshrrev_b32 v172, 4, v171
v_min_u32 v172, 7, v172
v_and_b32 v174, 1, v172
v_lshlrev_b32 v172, 3, v172
v_lshlrev_b32 v174, 2, v174
v_sub_u32 v172, v172, v174
buffer_load_dword v172, v172, s[40:43], s66 offen offset:8 sc1
k1_kernel_b_g3p_pi:
v_xor_b32 v160, 0x10000, v160
v_xor_b32 v161, 0x10000, v161
v_xor_b32 v162, 0x10000, v162
v_xor_b32 v163, 0x10000, v163
s_setprio 3
v_mfma_f32_16x16x32_bf16 v[16:19], a[64:67], a[24:27], v[16:19]
v_mfma_f32_16x16x32_bf16 v[48:51], a[64:67], a[28:31], v[48:51]
ds_read_b64_tr_b16 a[64:65], v160 offset:36864
ds_read_b64_tr_b16 a[66:67], v160 offset:38912
v_mfma_f32_16x16x32_bf16 v[20:23], a[68:71], a[24:27], v[20:23]
v_mfma_f32_16x16x32_bf16 v[52:55], a[68:71], a[28:31], v[52:55]
ds_read_b64_tr_b16 a[68:69], v161 offset:36864
ds_read_b64_tr_b16 a[70:71], v161 offset:38912
s_add_u32 m0, s62, 16384
s_sub_u32 s64, s64, 4521984
buffer_load_dwordx4 v175, s[32:35], s64 offen lds
v_mfma_f32_16x16x32_bf16 v[24:27], a[72:75], a[24:27], v[24:27]
v_mfma_f32_16x16x32_bf16 v[56:59], a[72:75], a[28:31], v[56:59]
ds_read_b64_tr_b16 a[72:73], v162 offset:36864
ds_read_b64_tr_b16 a[74:75], v162 offset:38912
v_mfma_f32_16x16x32_bf16 v[28:31], a[76:79], a[24:27], v[28:31]
v_mfma_f32_16x16x32_bf16 v[60:63], a[76:79], a[28:31], v[60:63]
ds_read_b64_tr_b16 a[76:77], v163 offset:36864
ds_read_b64_tr_b16 a[78:79], v163 offset:38912
s_setprio 2
v_mfma_f32_16x16x32_bf16 v[0:3], a[48:51], a[24:27], v[0:3]
v_mfma_f32_16x16x32_bf16 v[32:35], a[48:51], a[28:31], v[32:35]
ds_read_b64_tr_b16 a[48:49], v160 offset:32768
ds_read_b64_tr_b16 a[50:51], v160 offset:34816
v_mfma_f32_16x16x32_bf16 v[4:7], a[52:55], a[24:27], v[4:7]
v_mfma_f32_16x16x32_bf16 v[36:39], a[52:55], a[28:31], v[36:39]
ds_read_b64_tr_b16 a[52:53], v161 offset:32768
ds_read_b64_tr_b16 a[54:55], v161 offset:34816
s_add_u32 m0, s62, 24576
s_add_u32 s64, s64, 65536
buffer_load_dwordx4 v175, s[32:35], s64 offen lds
v_mfma_f32_16x16x32_bf16 v[8:11], a[56:59], a[24:27], v[8:11]
v_mfma_f32_16x16x32_bf16 v[40:43], a[56:59], a[28:31], v[40:43]
ds_read_b64_tr_b16 a[56:57], v162 offset:32768
ds_read_b64_tr_b16 a[58:59], v162 offset:34816
v_mfma_f32_16x16x32_bf16 v[12:15], a[60:63], a[24:27], v[12:15]
v_mfma_f32_16x16x32_bf16 v[44:47], a[60:63], a[28:31], v[44:47]
ds_read_b64_tr_b16 a[60:61], v163 offset:32768
ds_read_b64_tr_b16 a[62:63], v163 offset:34816
buffer_load_dwordx4 a[16:19], v171, s[40:43], s68 offen sc1
buffer_load_dwordx4 a[20:23], v171, s[40:43], s69 offen sc1
s_sub_u32 s68, s68, 69632
s_sub_u32 s69, s69, 69632
s_waitcnt vmcnt(16)
s_waitcnt lgkmcnt(14)
s_setprio 1
v_mfma_f32_16x16x32_bf16 v[16:19], a[64:67], a[0:3], v[16:19]
v_mfma_f32_16x16x32_bf16 v[48:51], a[64:67], a[4:7], v[48:51]
ds_read_b64_tr_b16 a[64:65], v160 offset:53248
ds_read_b64_tr_b16 a[66:67], v160 offset:55296
s_waitcnt lgkmcnt(14)
v_mfma_f32_16x16x32_bf16 v[20:23], a[68:71], a[0:3], v[20:23]
v_mfma_f32_16x16x32_bf16 v[52:55], a[68:71], a[4:7], v[52:55]
ds_read_b64_tr_b16 a[68:69], v161 offset:53248
ds_read_b64_tr_b16 a[70:71], v161 offset:55296
s_add_u32 m0, s62, 32768
s_add_u32 s64, s64, 65536
buffer_load_dwordx4 v175, s[32:35], s64 offen lds
s_waitcnt lgkmcnt(14)
v_mfma_f32_16x16x32_bf16 v[24:27], a[72:75], a[0:3], v[24:27]
v_mfma_f32_16x16x32_bf16 v[56:59], a[72:75], a[4:7], v[56:59]
ds_read_b64_tr_b16 a[72:73], v162 offset:53248
ds_read_b64_tr_b16 a[74:75], v162 offset:55296
s_waitcnt lgkmcnt(14)
v_mfma_f32_16x16x32_bf16 v[28:31], a[76:79], a[0:3], v[28:31]
v_mfma_f32_16x16x32_bf16 v[60:63], a[76:79], a[4:7], v[60:63]
ds_read_b64_tr_b16 a[76:77], v163 offset:53248
ds_read_b64_tr_b16 a[78:79], v163 offset:55296
s_waitcnt lgkmcnt(14)
s_setprio 0
v_mfma_f32_16x16x32_bf16 v[0:3], a[48:51], a[0:3], v[0:3]
v_mfma_f32_16x16x32_bf16 v[32:35], a[48:51], a[4:7], v[32:35]
ds_read_b64_tr_b16 a[48:49], v160 offset:49152
ds_read_b64_tr_b16 a[50:51], v160 offset:51200
s_waitcnt lgkmcnt(14)
v_mfma_f32_16x16x32_bf16 v[4:7], a[52:55], a[0:3], v[4:7]
v_mfma_f32_16x16x32_bf16 v[36:39], a[52:55], a[4:7], v[36:39]
ds_read_b64_tr_b16 a[52:53], v161 offset:49152
ds_read_b64_tr_b16 a[54:55], v161 offset:51200
s_add_u32 m0, s62, 40960
s_add_u32 s64, s64, 65536
buffer_load_dwordx4 v175, s[32:35], s64 offen lds
s_waitcnt lgkmcnt(14)
v_mfma_f32_16x16x32_bf16 v[8:11], a[56:59], a[0:3], v[8:11]
v_mfma_f32_16x16x32_bf16 v[40:43], a[56:59], a[4:7], v[40:43]
ds_read_b64_tr_b16 a[56:57], v162 offset:49152
ds_read_b64_tr_b16 a[58:59], v162 offset:51200
s_waitcnt lgkmcnt(14)
v_mfma_f32_16x16x32_bf16 v[12:15], a[60:63], a[0:3], v[12:15]
v_mfma_f32_16x16x32_bf16 v[44:47], a[60:63], a[4:7], v[44:47]
ds_read_b64_tr_b16 a[60:61], v163 offset:49152
ds_read_b64_tr_b16 a[62:63], v163 offset:51200
s_waitcnt vmcnt(12) lgkmcnt(0)
s_cmp_lg_u32 s87, 0
s_cbranch_scc1 k1_kernel_b_g3p_pc_rdy
s_waitcnt vmcnt(6)
v_cmp_le_u32 s[100:101], 3, v172
s_nop 0
s_cmp_eq_u64 s[100:101], -1
s_cbranch_scc1 k1_kernel_b_g3p_pc_rdy
s_mov_b32 s91, 40000
k1_kernel_b_g3p_pc_spin:
s_sleep 2
v_lshrrev_b32 v172, 4, v171
v_min_u32 v172, 7, v172
v_and_b32 v174, 1, v172
v_lshlrev_b32 v172, 3, v172
v_lshlrev_b32 v174, 2, v174
v_sub_u32 v172, v172, v174
buffer_load_dword v172, v172, s[40:43], s66 offen offset:8 sc1
s_waitcnt vmcnt(0)
v_cmp_le_u32 s[100:101], 3, v172
s_nop 0
s_cmp_eq_u64 s[100:101], -1
s_cbranch_scc1 k1_kernel_b_g3p_pc_rdy
s_sub_u32 s91, s91, 1
s_cmp_lg_u32 s91, 0
s_cbranch_scc1 k1_kernel_b_g3p_pc_spin
s_nop 0
k1_kernel_b_g3p_pc_rdy:
s_barrier
buffer_load_dwordx4 a[24:27], v171, s[40:43], s68 offen sc1
buffer_load_dwordx4 a[28:31], v171, s[40:43], s69 offen sc1
s_add_u32 s68, s68, 2048
s_add_u32 s69, s69, 2048
s_setprio 3
v_mfma_f32_16x16x32_bf16 v[16:19], a[64:67], a[8:11], v[16:19]
v_mfma_f32_16x16x32_bf16 v[48:51], a[64:67], a[12:15], v[48:51]
ds_read_b64_tr_b16 a[64:65], v160 offset:4096
ds_read_b64_tr_b16 a[66:67], v160 offset:6144
v_mfma_f32_16x16x32_bf16 v[20:23], a[68:71], a[8:11], v[20:23]
v_mfma_f32_16x16x32_bf16 v[52:55], a[68:71], a[12:15], v[52:55]
ds_read_b64_tr_b16 a[68:69], v161 offset:4096
ds_read_b64_tr_b16 a[70:71], v161 offset:6144
s_add_u32 m0, s62, 49152
s_add_u32 s64, s64, 720896
buffer_load_dwordx4 v175, s[32:35], s64 offen lds
v_mfma_f32_16x16x32_bf16 v[24:27], a[72:75], a[8:11], v[24:27]
v_mfma_f32_16x16x32_bf16 v[56:59], a[72:75], a[12:15], v[56:59]
ds_read_b64_tr_b16 a[72:73], v162 offset:4096
ds_read_b64_tr_b16 a[74:75], v162 offset:6144
v_mfma_f32_16x16x32_bf16 v[28:31], a[76:79], a[8:11], v[28:31]
v_mfma_f32_16x16x32_bf16 v[60:63], a[76:79], a[12:15], v[60:63]
ds_read_b64_tr_b16 a[76:77], v163 offset:4096
ds_read_b64_tr_b16 a[78:79], v163 offset:6144
s_setprio 2
v_mfma_f32_16x16x32_bf16 v[0:3], a[48:51], a[8:11], v[0:3]
v_mfma_f32_16x16x32_bf16 v[32:35], a[48:51], a[12:15], v[32:35]
ds_read_b64_tr_b16 a[48:49], v160 offset:0
ds_read_b64_tr_b16 a[50:51], v160 offset:2048
v_mfma_f32_16x16x32_bf16 v[4:7], a[52:55], a[8:11], v[4:7]
v_mfma_f32_16x16x32_bf16 v[36:39], a[52:55], a[12:15], v[36:39]
ds_read_b64_tr_b16 a[52:53], v161 offset:0
ds_read_b64_tr_b16 a[54:55], v161 offset:2048
s_add_u32 m0, s62, 57344
s_add_u32 s64, s64, 65536
buffer_load_dwordx4 v175, s[32:35], s64 offen lds
v_mfma_f32_16x16x32_bf16 v[8:11], a[56:59], a[8:11], v[8:11]
v_mfma_f32_16x16x32_bf16 v[40:43], a[56:59], a[12:15], v[40:43]
ds_read_b64_tr_b16 a[56:57], v162 offset:0
ds_read_b64_tr_b16 a[58:59], v162 offset:2048
v_mfma_f32_16x16x32_bf16 v[12:15], a[60:63], a[8:11], v[12:15]
v_mfma_f32_16x16x32_bf16 v[44:47], a[60:63], a[12:15], v[44:47]
ds_read_b64_tr_b16 a[60:61], v163 offset:0
ds_read_b64_tr_b16 a[62:63], v163 offset:2048
buffer_load_dwordx4 a[0:3], v171, s[40:43], s68 offen sc1
buffer_load_dwordx4 a[4:7], v171, s[40:43], s69 offen sc1
s_add_u32 s68, s68, 12288
s_add_u32 s69, s69, 12288
s_waitcnt vmcnt(16)
s_waitcnt lgkmcnt(14)
s_setprio 1
v_mfma_f32_16x16x32_bf16 v[16:19], a[64:67], a[32:35], v[16:19]
v_mfma_f32_16x16x32_bf16 v[48:51], a[64:67], a[36:39], v[48:51]
ds_read_b64_tr_b16 a[64:65], v160 offset:20480
ds_read_b64_tr_b16 a[66:67], v160 offset:22528
s_waitcnt lgkmcnt(14)
v_mfma_f32_16x16x32_bf16 v[20:23], a[68:71], a[32:35], v[20:23]
v_mfma_f32_16x16x32_bf16 v[52:55], a[68:71], a[36:39], v[52:55]
ds_read_b64_tr_b16 a[68:69], v161 offset:20480
ds_read_b64_tr_b16 a[70:71], v161 offset:22528
s_add_u32 m0, s62, 98304
s_add_u32 s64, s64, 65536
buffer_load_dwordx4 v175, s[32:35], s64 offen lds
s_waitcnt lgkmcnt(14)
v_mfma_f32_16x16x32_bf16 v[24:27], a[72:75], a[32:35], v[24:27]
v_mfma_f32_16x16x32_bf16 v[56:59], a[72:75], a[36:39], v[56:59]
ds_read_b64_tr_b16 a[72:73], v162 offset:20480
ds_read_b64_tr_b16 a[74:75], v162 offset:22528
s_waitcnt lgkmcnt(14)
v_mfma_f32_16x16x32_bf16 v[28:31], a[76:79], a[32:35], v[28:31]
v_mfma_f32_16x16x32_bf16 v[60:63], a[76:79], a[36:39], v[60:63]
ds_read_b64_tr_b16 a[76:77], v163 offset:20480
ds_read_b64_tr_b16 a[78:79], v163 offset:22528
s_waitcnt lgkmcnt(14)
s_setprio 0
v_mfma_f32_16x16x32_bf16 v[0:3], a[48:51], a[32:35], v[0:3]
v_mfma_f32_16x16x32_bf16 v[32:35], a[48:51], a[36:39], v[32:35]
ds_read_b64_tr_b16 a[48:49], v160 offset:16384
ds_read_b64_tr_b16 a[50:51], v160 offset:18432
s_waitcnt lgkmcnt(14)
v_mfma_f32_16x16x32_bf16 v[4:7], a[52:55], a[32:35], v[4:7]
v_mfma_f32_16x16x32_bf16 v[36:39], a[52:55], a[36:39], v[36:39]
ds_read_b64_tr_b16 a[52:53], v161 offset:16384
ds_read_b64_tr_b16 a[54:55], v161 offset:18432
s_add_u32 m0, s62, 106496
s_add_u32 s64, s64, 65536
buffer_load_dwordx4 v175, s[32:35], s64 offen lds
s_waitcnt lgkmcnt(14)
v_mfma_f32_16x16x32_bf16 v[8:11], a[56:59], a[32:35], v[8:11]
v_mfma_f32_16x16x32_bf16 v[40:43], a[56:59], a[36:39], v[40:43]
ds_read_b64_tr_b16 a[56:57], v162 offset:16384
ds_read_b64_tr_b16 a[58:59], v162 offset:18432
s_waitcnt lgkmcnt(14)
v_mfma_f32_16x16x32_bf16 v[12:15], a[60:63], a[32:35], v[12:15]
v_mfma_f32_16x16x32_bf16 v[44:47], a[60:63], a[36:39], v[44:47]
ds_read_b64_tr_b16 a[60:61], v163 offset:16384
ds_read_b64_tr_b16 a[62:63], v163 offset:18432
buffer_load_dwordx4 a[8:11], v171, s[40:43], s68 offen sc1
buffer_load_dwordx4 a[12:15], v171, s[40:43], s69 offen sc1
s_add_u32 s68, s68, 2048
s_add_u32 s69, s69, 2048
s_waitcnt vmcnt(14) lgkmcnt(0)
s_barrier
v_xor_b32 v160, 0x10000, v160
v_xor_b32 v161, 0x10000, v161
v_xor_b32 v162, 0x10000, v162
v_xor_b32 v163, 0x10000, v163
s_setprio 3
v_mfma_f32_16x16x32_bf16 v[16:19], a[64:67], a[40:43], v[16:19]
v_mfma_f32_16x16x32_bf16 v[48:51], a[64:67], a[44:47], v[48:51]
ds_read_b64_tr_b16 a[64:65], v160 offset:4096
ds_read_b64_tr_b16 a[66:67], v160 offset:6144
v_mfma_f32_16x16x32_bf16 v[20:23], a[68:71], a[40:43], v[20:23]
v_mfma_f32_16x16x32_bf16 v[52:55], a[68:71], a[44:47], v[52:55]
ds_read_b64_tr_b16 a[68:69], v161 offset:4096
ds_read_b64_tr_b16 a[70:71], v161 offset:6144
s_add_u32 m0, s62, 114688
s_add_u32 s64, s64, 720896
buffer_load_dwordx4 v175, s[32:35], s64 offen lds
v_mfma_f32_16x16x32_bf16 v[24:27], a[72:75], a[40:43], v[24:27]
v_mfma_f32_16x16x32_bf16 v[56:59], a[72:75], a[44:47], v[56:59]
ds_read_b64_tr_b16 a[72:73], v162 offset:4096
ds_read_b64_tr_b16 a[74:75], v162 offset:6144
v_mfma_f32_16x16x32_bf16 v[28:31], a[76:79], a[40:43], v[28:31]
v_mfma_f32_16x16x32_bf16 v[60:63], a[76:79], a[44:47], v[60:63]
ds_read_b64_tr_b16 a[76:77], v163 offset:4096
ds_read_b64_tr_b16 a[78:79], v163 offset:6144
s_setprio 2
v_mfma_f32_16x16x32_bf16 v[0:3], a[48:51], a[40:43], v[0:3]
v_mfma_f32_16x16x32_bf16 v[32:35], a[48:51], a[44:47], v[32:35]
ds_read_b64_tr_b16 a[48:49], v160 offset:0
ds_read_b64_tr_b16 a[50:51], v160 offset:2048
v_mfma_f32_16x16x32_bf16 v[4:7], a[52:55], a[40:43], v[4:7]
v_mfma_f32_16x16x32_bf16 v[36:39], a[52:55], a[44:47], v[36:39]
ds_read_b64_tr_b16 a[52:53], v161 offset:0
ds_read_b64_tr_b16 a[54:55], v161 offset:2048
s_add_u32 m0, s62, 122880
s_add_u32 s64, s64, 65536
buffer_load_dwordx4 v175, s[32:35], s64 offen lds
v_mfma_f32_16x16x32_bf16 v[8:11], a[56:59], a[40:43], v[8:11]
v_mfma_f32_16x16x32_bf16 v[40:43], a[56:59], a[44:47], v[40:43]
ds_read_b64_tr_b16 a[56:57], v162 offset:0
ds_read_b64_tr_b16 a[58:59], v162 offset:2048
v_mfma_f32_16x16x32_bf16 v[12:15], a[60:63], a[40:43], v[12:15]
v_mfma_f32_16x16x32_bf16 v[44:47], a[60:63], a[44:47], v[44:47]
ds_read_b64_tr_b16 a[60:61], v163 offset:0
ds_read_b64_tr_b16 a[62:63], v163 offset:2048
buffer_load_dwordx4 a[32:35], v171, s[40:43], s68 offen sc1
buffer_load_dwordx4 a[36:39], v171, s[40:43], s69 offen sc1
s_add_u32 s68, s68, 12288
s_add_u32 s69, s69, 12288
s_waitcnt vmcnt(16)
s_waitcnt lgkmcnt(14)
s_setprio 1
v_mfma_f32_16x16x32_bf16 v[16:19], a[64:67], a[16:19], v[16:19]
v_mfma_f32_16x16x32_bf16 v[48:51], a[64:67], a[20:23], v[48:51]
ds_read_b64_tr_b16 a[64:65], v160 offset:20480
ds_read_b64_tr_b16 a[66:67], v160 offset:22528
s_waitcnt lgkmcnt(14)
v_mfma_f32_16x16x32_bf16 v[20:23], a[68:71], a[16:19], v[20:23]
v_mfma_f32_16x16x32_bf16 v[52:55], a[68:71], a[20:23], v[52:55]
ds_read_b64_tr_b16 a[68:69], v161 offset:20480
ds_read_b64_tr_b16 a[70:71], v161 offset:22528
s_add_u32 m0, s62, 65536
s_add_u32 s64, s64, 65536
buffer_load_dwordx4 v175, s[32:35], s64 offen lds
s_waitcnt lgkmcnt(14)
v_mfma_f32_16x16x32_bf16 v[24:27], a[72:75], a[16:19], v[24:27]
v_mfma_f32_16x16x32_bf16 v[56:59], a[72:75], a[20:23], v[56:59]
ds_read_b64_tr_b16 a[72:73], v162 offset:20480
ds_read_b64_tr_b16 a[74:75], v162 offset:22528
s_waitcnt lgkmcnt(14)
v_mfma_f32_16x16x32_bf16 v[28:31], a[76:79], a[16:19], v[28:31]
v_mfma_f32_16x16x32_bf16 v[60:63], a[76:79], a[20:23], v[60:63]
ds_read_b64_tr_b16 a[76:77], v163 offset:20480
ds_read_b64_tr_b16 a[78:79], v163 offset:22528
s_waitcnt lgkmcnt(14)
s_setprio 0
v_mfma_f32_16x16x32_bf16 v[0:3], a[48:51], a[16:19], v[0:3]
v_mfma_f32_16x16x32_bf16 v[32:35], a[48:51], a[20:23], v[32:35]
ds_read_b64_tr_b16 a[48:49], v160 offset:16384
ds_read_b64_tr_b16 a[50:51], v160 offset:18432
s_waitcnt lgkmcnt(14)
v_mfma_f32_16x16x32_bf16 v[4:7], a[52:55], a[16:19], v[4:7]
v_mfma_f32_16x16x32_bf16 v[36:39], a[52:55], a[20:23], v[36:39]
ds_read_b64_tr_b16 a[52:53], v161 offset:16384
ds_read_b64_tr_b16 a[54:55], v161 offset:18432
s_add_u32 m0, s62, 73728
s_add_u32 s64, s64, 65536
buffer_load_dwordx4 v175, s[32:35], s64 offen lds
s_waitcnt lgkmcnt(14)
v_mfma_f32_16x16x32_bf16 v[8:11], a[56:59], a[16:19], v[8:11]
v_mfma_f32_16x16x32_bf16 v[40:43], a[56:59], a[20:23], v[40:43]
ds_read_b64_tr_b16 a[56:57], v162 offset:16384
ds_read_b64_tr_b16 a[58:59], v162 offset:18432
s_waitcnt lgkmcnt(14)
v_mfma_f32_16x16x32_bf16 v[12:15], a[60:63], a[16:19], v[12:15]
v_mfma_f32_16x16x32_bf16 v[44:47], a[60:63], a[20:23], v[44:47]
ds_read_b64_tr_b16 a[60:61], v163 offset:16384
ds_read_b64_tr_b16 a[62:63], v163 offset:18432
buffer_load_dwordx4 a[40:43], v171, s[40:43], s68 offen sc1
buffer_load_dwordx4 a[44:47], v171, s[40:43], s69 offen sc1
s_add_u32 s68, s68, 2048
s_add_u32 s69, s69, 2048
s_waitcnt vmcnt(14) lgkmcnt(0)
s_barrier
s_setprio 3
v_mfma_f32_16x16x32_bf16 v[16:19], a[64:67], a[24:27], v[16:19]
v_mfma_f32_16x16x32_bf16 v[48:51], a[64:67], a[28:31], v[48:51]
ds_read_b64_tr_b16 a[64:65], v160 offset:36864
ds_read_b64_tr_b16 a[66:67], v160 offset:38912
v_mfma_f32_16x16x32_bf16 v[20:23], a[68:71], a[24:27], v[20:23]
v_mfma_f32_16x16x32_bf16 v[52:55], a[68:71], a[28:31], v[52:55]
ds_read_b64_tr_b16 a[68:69], v161 offset:36864
ds_read_b64_tr_b16 a[70:71], v161 offset:38912
s_add_u32 m0, s62, 81920
s_add_u32 s64, s64, 720896
buffer_load_dwordx4 v175, s[32:35], s64 offen lds
v_mfma_f32_16x16x32_bf16 v[24:27], a[72:75], a[24:27], v[24:27]
v_mfma_f32_16x16x32_bf16 v[56:59], a[72:75], a[28:31], v[56:59]
ds_read_b64_tr_b16 a[72:73], v162 offset:36864
ds_read_b64_tr_b16 a[74:75], v162 offset:38912
v_mfma_f32_16x16x32_bf16 v[28:31], a[76:79], a[24:27], v[28:31]
v_mfma_f32_16x16x32_bf16 v[60:63], a[76:79], a[28:31], v[60:63]
ds_read_b64_tr_b16 a[76:77], v163 offset:36864
ds_read_b64_tr_b16 a[78:79], v163 offset:38912
s_setprio 2
v_mfma_f32_16x16x32_bf16 v[0:3], a[48:51], a[24:27], v[0:3]
v_mfma_f32_16x16x32_bf16 v[32:35], a[48:51], a[28:31], v[32:35]
ds_read_b64_tr_b16 a[48:49], v160 offset:32768
ds_read_b64_tr_b16 a[50:51], v160 offset:34816
v_mfma_f32_16x16x32_bf16 v[4:7], a[52:55], a[24:27], v[4:7]
v_mfma_f32_16x16x32_bf16 v[36:39], a[52:55], a[28:31], v[36:39]
ds_read_b64_tr_b16 a[52:53], v161 offset:32768
ds_read_b64_tr_b16 a[54:55], v161 offset:34816
s_add_u32 m0, s62, 90112
s_add_u32 s64, s64, 65536
buffer_load_dwordx4 v175, s[32:35], s64 offen lds
v_mfma_f32_16x16x32_bf16 v[8:11], a[56:59], a[24:27], v[8:11]
v_mfma_f32_16x16x32_bf16 v[40:43], a[56:59], a[28:31], v[40:43]
ds_read_b64_tr_b16 a[56:57], v162 offset:32768
ds_read_b64_tr_b16 a[58:59], v162 offset:34816
v_mfma_f32_16x16x32_bf16 v[12:15], a[60:63], a[24:27], v[12:15]
v_mfma_f32_16x16x32_bf16 v[44:47], a[60:63], a[28:31], v[44:47]
ds_read_b64_tr_b16 a[60:61], v163 offset:32768
ds_read_b64_tr_b16 a[62:63], v163 offset:34816
buffer_load_dwordx4 a[16:19], v171, s[40:43], s68 offen sc1
buffer_load_dwordx4 a[20:23], v171, s[40:43], s69 offen sc1
s_add_u32 s68, s68, 12288
s_add_u32 s69, s69, 12288
s_waitcnt vmcnt(16)
s_waitcnt lgkmcnt(14)
s_setprio 1
v_mfma_f32_16x16x32_bf16 v[16:19], a[64:67], a[0:3], v[16:19]
v_mfma_f32_16x16x32_bf16 v[48:51], a[64:67], a[4:7], v[48:51]
ds_read_b64_tr_b16 a[64:65], v160 offset:53248
ds_read_b64_tr_b16 a[66:67], v160 offset:55296
s_waitcnt lgkmcnt(14)
v_mfma_f32_16x16x32_bf16 v[20:23], a[68:71], a[0:3], v[20:23]
v_mfma_f32_16x16x32_bf16 v[52:55], a[68:71], a[4:7], v[52:55]
ds_read_b64_tr_b16 a[68:69], v161 offset:53248
ds_read_b64_tr_b16 a[70:71], v161 offset:55296
s_add_u32 m0, s62, 0
s_add_u32 s64, s64, 65536
buffer_load_dwordx4 v175, s[32:35], s64 offen lds
s_waitcnt lgkmcnt(14)
v_mfma_f32_16x16x32_bf16 v[24:27], a[72:75], a[0:3], v[24:27]
v_mfma_f32_16x16x32_bf16 v[56:59], a[72:75], a[4:7], v[56:59]
ds_read_b64_tr_b16 a[72:73], v162 offset:53248
ds_read_b64_tr_b16 a[74:75], v162 offset:55296
s_waitcnt lgkmcnt(14)
v_mfma_f32_16x16x32_bf16 v[28:31], a[76:79], a[0:3], v[28:31]
v_mfma_f32_16x16x32_bf16 v[60:63], a[76:79], a[4:7], v[60:63]
ds_read_b64_tr_b16 a[76:77], v163 offset:53248
ds_read_b64_tr_b16 a[78:79], v163 offset:55296
s_waitcnt lgkmcnt(14)
s_setprio 0
v_mfma_f32_16x16x32_bf16 v[0:3], a[48:51], a[0:3], v[0:3]
v_mfma_f32_16x16x32_bf16 v[32:35], a[48:51], a[4:7], v[32:35]
ds_read_b64_tr_b16 a[48:49], v160 offset:49152
ds_read_b64_tr_b16 a[50:51], v160 offset:51200
s_waitcnt lgkmcnt(14)
v_mfma_f32_16x16x32_bf16 v[4:7], a[52:55], a[0:3], v[4:7]
v_mfma_f32_16x16x32_bf16 v[36:39], a[52:55], a[4:7], v[36:39]
ds_read_b64_tr_b16 a[52:53], v161 offset:49152
ds_read_b64_tr_b16 a[54:55], v161 offset:51200
s_add_u32 m0, s62, 8192
s_add_u32 s64, s64, 65536
buffer_load_dwordx4 v175, s[32:35], s64 offen lds
s_waitcnt lgkmcnt(14)
v_mfma_f32_16x16x32_bf16 v[8:11], a[56:59], a[0:3], v[8:11]
v_mfma_f32_16x16x32_bf16 v[40:43], a[56:59], a[4:7], v[40:43]
ds_read_b64_tr_b16 a[56:57], v162 offset:49152
ds_read_b64_tr_b16 a[58:59], v162 offset:51200
s_waitcnt lgkmcnt(14)
v_mfma_f32_16x16x32_bf16 v[12:15], a[60:63], a[0:3], v[12:15]
v_mfma_f32_16x16x32_bf16 v[44:47], a[60:63], a[4:7], v[44:47]
ds_read_b64_tr_b16 a[60:61], v163 offset:49152
ds_read_b64_tr_b16 a[62:63], v163 offset:51200
buffer_load_dwordx4 a[24:27], v171, s[40:43], s68 offen sc1
buffer_load_dwordx4 a[28:31], v171, s[40:43], s69 offen sc1
s_add_u32 s68, s68, 2048
s_add_u32 s69, s69, 2048
s_waitcnt vmcnt(14) lgkmcnt(0)
s_barrier
s_cmp_lg_u32 s87, 0
s_cbranch_scc1 k1_kernel_b_op_pi
v_lshrrev_b32 v172, 2, v171
v_min_u32 v172, 60, v172
buffer_load_dword v172, v172, s[40:43], s71 offen offset:0 sc1
k1_kernel_b_op_pi:
v_xor_b32 v160, 0x10000, v160
v_xor_b32 v161, 0x10000, v161
v_xor_b32 v162, 0x10000, v162
v_xor_b32 v163, 0x10000, v163
s_setprio 3
v_mfma_f32_16x16x32_bf16 v[16:19], a[64:67], a[8:11], v[16:19]
v_mfma_f32_16x16x32_bf16 v[48:51], a[64:67], a[12:15], v[48:51]
ds_read_b64_tr_b16 a[64:65], v160 offset:36864
ds_read_b64_tr_b16 a[66:67], v160 offset:38912
v_mfma_f32_16x16x32_bf16 v[20:23], a[68:71], a[8:11], v[20:23]
v_mfma_f32_16x16x32_bf16 v[52:55], a[68:71], a[12:15], v[52:55]
ds_read_b64_tr_b16 a[68:69], v161 offset:36864
ds_read_b64_tr_b16 a[70:71], v161 offset:38912
s_add_u32 m0, s62, 16384
s_sub_u32 s64, s64, 3604480
buffer_load_dwordx4 v175, s[20:23], s64 offen lds
v_mfma_f32_16x16x32_bf16 v[24:27], a[72:75], a[8:11], v[24:27]
v_mfma_f32_16x16x32_bf16 v[56:59], a[72:75], a[12:15], v[56:59]
ds_read_b64_tr_b16 a[72:73], v162 offset:36864
ds_read_b64_tr_b16 a[74:75], v162 offset:38912
v_mfma_f32_16x16x32_bf16 v[28:31], a[76:79], a[8:11], v[28:31]
v_mfma_f32_16x16x32_bf16 v[60:63], a[76:79], a[12:15], v[60:63]
ds_read_b64_tr_b16 a[76:77], v163 offset:36864
ds_read_b64_tr_b16 a[78:79], v163 offset:38912
s_setprio 2
v_mfma_f32_16x16x32_bf16 v[0:3], a[48:51], a[8:11], v[0:3]
v_mfma_f32_16x16x32_bf16 v[32:35], a[48:51], a[12:15], v[32:35]
ds_read_b64_tr_b16 a[48:49], v160 offset:32768
ds_read_b64_tr_b16 a[50:51], v160 offset:34816
v_mfma_f32_16x16x32_bf16 v[4:7], a[52:55], a[8:11], v[4:7]
v_mfma_f32_16x16x32_bf16 v[36:39], a[52:55], a[12:15], v[36:39]
ds_read_b64_tr_b16 a[52:53], v161 offset:32768
ds_read_b64_tr_b16 a[54:55], v161 offset:34816
s_add_u32 m0, s62, 24576
s_add_u32 s64, s64, 65536
buffer_load_dwordx4 v175, s[20:23], s64 offen lds
v_mfma_f32_16x16x32_bf16 v[8:11], a[56:59], a[8:11], v[8:11]
v_mfma_f32_16x16x32_bf16 v[40:43], a[56:59], a[12:15], v[40:43]
ds_read_b64_tr_b16 a[56:57], v162 offset:32768
ds_read_b64_tr_b16 a[58:59], v162 offset:34816
v_mfma_f32_16x16x32_bf16 v[12:15], a[60:63], a[8:11], v[12:15]
v_mfma_f32_16x16x32_bf16 v[44:47], a[60:63], a[12:15], v[44:47]
ds_read_b64_tr_b16 a[60:61], v163 offset:32768
ds_read_b64_tr_b16 a[62:63], v163 offset:34816
buffer_load_dwordx4 a[0:3], v171, s[40:43], s68 offen sc1
buffer_load_dwordx4 a[4:7], v171, s[40:43], s69 offen sc1
s_add_u32 s68, s68, 59392
s_add_u32 s69, s69, 59392
s_waitcnt vmcnt(16)
s_waitcnt lgkmcnt(14)
s_setprio 1
v_mfma_f32_16x16x32_bf16 v[16:19], a[64:67], a[32:35], v[16:19]
v_mfma_f32_16x16x32_bf16 v[48:51], a[64:67], a[36:39], v[48:51]
ds_read_b64_tr_b16 a[64:65], v160 offset:53248
ds_read_b64_tr_b16 a[66:67], v160 offset:55296
s_waitcnt lgkmcnt(14)
v_mfma_f32_16x16x32_bf16 v[20:23], a[68:71], a[32:35], v[20:23]
v_mfma_f32_16x16x32_bf16 v[52:55], a[68:71], a[36:39], v[52:55]
ds_read_b64_tr_b16 a[68:69], v161 offset:53248
ds_read_b64_tr_b16 a[70:71], v161 offset:55296
s_add_u32 m0, s62, 32768
s_add_u32 s64, s64, 65536
buffer_load_dwordx4 v175, s[20:23], s64 offen lds
s_waitcnt lgkmcnt(14)
v_mfma_f32_16x16x32_bf16 v[24:27], a[72:75], a[32:35], v[24:27]
v_mfma_f32_16x16x32_bf16 v[56:59], a[72:75], a[36:39], v[56:59]
ds_read_b64_tr_b16 a[72:73], v162 offset:53248
ds_read_b64_tr_b16 a[74:75], v162 offset:55296
s_waitcnt lgkmcnt(14)
v_mfma_f32_16x16x32_bf16 v[28:31], a[76:79], a[32:35], v[28:31]
v_mfma_f32_16x16x32_bf16 v[60:63], a[76:79], a[36:39], v[60:63]
ds_read_b64_tr_b16 a[76:77], v163 offset:53248
ds_read_b64_tr_b16 a[78:79], v163 offset:55296
s_waitcnt lgkmcnt(14)
s_setprio 0
v_mfma_f32_16x16x32_bf16 v[0:3], a[48:51], a[32:35], v[0:3]
v_mfma_f32_16x16x32_bf16 v[32:35], a[48:51], a[36:39], v[32:35]
ds_read_b64_tr_b16 a[48:49], v160 offset:49152
ds_read_b64_tr_b16 a[50:51], v160 offset:51200
s_waitcnt lgkmcnt(14)
v_mfma_f32_16x16x32_bf16 v[4:7], a[52:55], a[32:35], v[4:7]
v_mfma_f32_16x16x32_bf16 v[36:39], a[52:55], a[36:39], v[36:39]
ds_read_b64_tr_b16 a[52:53], v161 offset:49152
ds_read_b64_tr_b16 a[54:55], v161 offset:51200
s_add_u32 m0, s62, 40960
s_add_u32 s64, s64, 65536
buffer_load_dwordx4 v175, s[20:23], s64 offen lds
s_waitcnt lgkmcnt(14)
v_mfma_f32_16x16x32_bf16 v[8:11], a[56:59], a[32:35], v[8:11]
v_mfma_f32_16x16x32_bf16 v[40:43], a[56:59], a[36:39], v[40:43]
ds_read_b64_tr_b16 a[56:57], v162 offset:49152
ds_read_b64_tr_b16 a[58:59], v162 offset:51200
s_waitcnt lgkmcnt(14)
v_mfma_f32_16x16x32_bf16 v[12:15], a[60:63], a[32:35], v[12:15]
v_mfma_f32_16x16x32_bf16 v[44:47], a[60:63], a[36:39], v[44:47]
ds_read_b64_tr_b16 a[60:61], v163 offset:49152
ds_read_b64_tr_b16 a[62:63], v163 offset:51200
s_waitcnt vmcnt(12) lgkmcnt(0)
s_cmp_lg_u32 s87, 0
s_cbranch_scc1 k1_kernel_b_op_pc_rdy
s_waitcnt vmcnt(6)
v_cmp_le_u32 s[100:101], 1, v172
s_nop 0
s_cmp_eq_u64 s[100:101], -1
s_cbranch_scc1 k1_kernel_b_op_pc_rdy
s_mov_b32 s91, 40000
k1_kernel_b_op_pc_spin:
s_sleep 2
v_lshrrev_b32 v172, 2, v171
v_min_u32 v172, 60, v172
buffer_load_dword v172, v172, s[40:43], s71 offen offset:0 sc1
s_waitcnt vmcnt(0)
v_cmp_le_u32 s[100:101], 1, v172
s_nop 0
s_cmp_eq_u64 s[100:101], -1
s_cbranch_scc1 k1_kernel_b_op_pc_rdy
s_sub_u32 s91, s91, 1
s_cmp_lg_u32 s91, 0
s_cbranch_scc1 k1_kernel_b_op_pc_spin
s_nop 0
k1_kernel_b_op_pc_rdy:
s_barrier
buffer_load_dwordx4 a[8:11], v171, s[40:43], s68 offen sc1
buffer_load_dwordx4 a[12:15], v171, s[40:43], s69 offen sc1
s_add_u32 s68, s68, 2048
s_add_u32 s69, s69, 2048
s_setprio 3
v_mfma_f32_16x16x32_bf16 v[16:19], a[64:67], a[40:43], v[16:19]
v_mfma_f32_16x16x32_bf16 v[48:51], a[64:67], a[44:47], v[48:51]
ds_read_b64_tr_b16 a[64:65], v160 offset:4096
ds_read_b64_tr_b16 a[66:67], v160 offset:6144
v_mfma_f32_16x16x32_bf16 v[20:23], a[68:71], a[40:43], v[20:23]
v_mfma_f32_16x16x32_bf16 v[52:55], a[68:71], a[44:47], v[52:55]
ds_read_b64_tr_b16 a[68:69], v161 offset:4096
ds_read_b64_tr_b16 a[70:71], v161 offset:6144
s_add_u32 m0, s62, 98304
s_nop 0
buffer_load_dwordx4 v175, s[20:23], s67 offen lds
v_mfma_f32_16x16x32_bf16 v[24:27], a[72:75], a[40:43], v[24:27]
v_mfma_f32_16x16x32_bf16 v[56:59], a[72:75], a[44:47], v[56:59]
ds_read_b64_tr_b16 a[72:73], v162 offset:4096
ds_read_b64_tr_b16 a[74:75], v162 offset:6144
v_mfma_f32_16x16x32_bf16 v[28:31], a[76:79], a[40:43], v[28:31]
v_mfma_f32_16x16x32_bf16 v[60:63], a[76:79], a[44:47], v[60:63]
ds_read_b64_tr_b16 a[76:77], v163 offset:4096
ds_read_b64_tr_b16 a[78:79], v163 offset:6144
s_setprio 2
v_mfma_f32_16x16x32_bf16 v[0:3], a[48:51], a[40:43], v[0:3]
v_mfma_f32_16x16x32_bf16 v[32:35], a[48:51], a[44:47], v[32:35]
ds_read_b64_tr_b16 a[48:49], v160 offset:0
ds_read_b64_tr_b16 a[50:51], v160 offset:2048
v_mfma_f32_16x16x32_bf16 v[4:7], a[52:55], a[40:43], v[4:7]
v_mfma_f32_16x16x32_bf16 v[36:39], a[52:55], a[44:47], v[36:39]
ds_read_b64_tr_b16 a[52:53], v161 offset:0
ds_read_b64_tr_b16 a[54:55], v161 offset:2048
s_add_u32 m0, s62, 106496
s_add_u32 s67, s67, 131072
buffer_load_dwordx4 v175, s[20:23], s67 offen lds
v_mfma_f32_16x16x32_bf16 v[8:11], a[56:59], a[40:43], v[8:11]
v_mfma_f32_16x16x32_bf16 v[40:43], a[56:59], a[44:47], v[40:43]
ds_read_b64_tr_b16 a[56:57], v162 offset:0
ds_read_b64_tr_b16 a[58:59], v162 offset:2048
v_mfma_f32_16x16x32_bf16 v[12:15], a[60:63], a[40:43], v[12:15]
v_mfma_f32_16x16x32_bf16 v[44:47], a[60:63], a[44:47], v[44:47]
ds_read_b64_tr_b16 a[60:61], v163 offset:0
ds_read_b64_tr_b16 a[62:63], v163 offset:2048
buffer_load_dwordx4 a[32:35], v171, s[40:43], s68 offen sc1
buffer_load_dwordx4 a[36:39], v171, s[40:43], s69 offen sc1
s_add_u32 s68, s68, 0
s_add_u32 s69, s69, 0
s_waitcnt vmcnt(16)
s_waitcnt lgkmcnt(14)
s_setprio 1
v_mfma_f32_16x16x32_bf16 v[16:19], a[64:67], a[16:19], v[16:19]
v_mfma_f32_16x16x32_bf16 v[48:51], a[64:67], a[20:23], v[48:51]
ds_read_b64_tr_b16 a[64:65], v160 offset:20480
ds_read_b64_tr_b16 a[66:67], v160 offset:22528
s_waitcnt lgkmcnt(14)
v_mfma_f32_16x16x32_bf16 v[20:23], a[68:71], a[16:19], v[20:23]
v_mfma_f32_16x16x32_bf16 v[52:55], a[68:71], a[20:23], v[52:55]
ds_read_b64_tr_b16 a[68:69], v161 offset:20480
ds_read_b64_tr_b16 a[70:71], v161 offset:22528
s_add_u32 m0, s62, 114688
s_add_u32 s67, s67, 131072
buffer_load_dwordx4 v175, s[20:23], s67 offen lds
s_waitcnt lgkmcnt(14)
v_mfma_f32_16x16x32_bf16 v[24:27], a[72:75], a[16:19], v[24:27]
v_mfma_f32_16x16x32_bf16 v[56:59], a[72:75], a[20:23], v[56:59]
ds_read_b64_tr_b16 a[72:73], v162 offset:20480
ds_read_b64_tr_b16 a[74:75], v162 offset:22528
s_waitcnt lgkmcnt(14)
v_mfma_f32_16x16x32_bf16 v[28:31], a[76:79], a[16:19], v[28:31]
v_mfma_f32_16x16x32_bf16 v[60:63], a[76:79], a[20:23], v[60:63]
ds_read_b64_tr_b16 a[76:77], v163 offset:20480
ds_read_b64_tr_b16 a[78:79], v163 offset:22528
s_waitcnt lgkmcnt(14)
s_setprio 0
v_mfma_f32_16x16x32_bf16 v[0:3], a[48:51], a[16:19], v[0:3]
v_mfma_f32_16x16x32_bf16 v[32:35], a[48:51], a[20:23], v[32:35]
ds_read_b64_tr_b16 a[48:49], v160 offset:16384
ds_read_b64_tr_b16 a[50:51], v160 offset:18432
s_waitcnt lgkmcnt(14)
v_mfma_f32_16x16x32_bf16 v[4:7], a[52:55], a[16:19], v[4:7]
v_mfma_f32_16x16x32_bf16 v[36:39], a[52:55], a[20:23], v[36:39]
ds_read_b64_tr_b16 a[52:53], v161 offset:16384
ds_read_b64_tr_b16 a[54:55], v161 offset:18432
s_add_u32 m0, s62, 122880
s_add_u32 s67, s67, 131072
buffer_load_dwordx4 v175, s[20:23], s67 offen lds
s_waitcnt lgkmcnt(14)
v_mfma_f32_16x16x32_bf16 v[8:11], a[56:59], a[16:19], v[8:11]
v_mfma_f32_16x16x32_bf16 v[40:43], a[56:59], a[20:23], v[40:43]
ds_read_b64_tr_b16 a[56:57], v162 offset:16384
ds_read_b64_tr_b16 a[58:59], v162 offset:18432
s_waitcnt lgkmcnt(14)
v_mfma_f32_16x16x32_bf16 v[12:15], a[60:63], a[16:19], v[12:15]
v_mfma_f32_16x16x32_bf16 v[44:47], a[60:63], a[20:23], v[44:47]
ds_read_b64_tr_b16 a[60:61], v163 offset:16384
ds_read_b64_tr_b16 a[62:63], v163 offset:18432
buffer_load_dwordx4 a[40:43], v171, s[40:43], s54 offen sc1
buffer_load_dwordx4 a[44:47], v171, s[40:43], s55 offen sc1
s_add_u32 s54, s54, 2048
s_add_u32 s55, s55, 2048
s_waitcnt vmcnt(14) lgkmcnt(0)
s_barrier
v_xor_b32 v160, 0x10000, v160
v_xor_b32 v161, 0x10000, v161
v_xor_b32 v162, 0x10000, v162
v_xor_b32 v163, 0x10000, v163
s_setprio 3
v_mfma_f32_16x16x32_bf16 v[16:19], a[64:67], a[24:27], v[16:19]
v_mfma_f32_16x16x32_bf16 v[48:51], a[64:67], a[28:31], v[48:51]
ds_read_b64_tr_b16 a[64:65], v160 offset:4096
ds_read_b64_tr_b16 a[66:67], v160 offset:6144
v_mfma_f32_16x16x32_bf16 v[20:23], a[68:71], a[24:27], v[20:23]
v_mfma_f32_16x16x32_bf16 v[52:55], a[68:71], a[28:31], v[52:55]
ds_read_b64_tr_b16 a[68:69], v161 offset:4096
ds_read_b64_tr_b16 a[70:71], v161 offset:6144
s_add_u32 m0, s62, 65536
s_add_u32 s67, s67, 131072
buffer_load_dwordx4 v175, s[20:23], s67 offen lds
v_mfma_f32_16x16x32_bf16 v[24:27], a[72:75], a[24:27], v[24:27]
v_mfma_f32_16x16x32_bf16 v[56:59], a[72:75], a[28:31], v[56:59]
ds_read_b64_tr_b16 a[72:73], v162 offset:4096
ds_read_b64_tr_b16 a[74:75], v162 offset:6144
v_mfma_f32_16x16x32_bf16 v[28:31], a[76:79], a[24:27], v[28:31]
v_mfma_f32_16x16x32_bf16 v[60:63], a[76:79], a[28:31], v[60:63]
ds_read_b64_tr_b16 a[76:77], v163 offset:4096
ds_read_b64_tr_b16 a[78:79], v163 offset:6144
s_setprio 2
v_mfma_f32_16x16x32_bf16 v[0:3], a[48:51], a[24:27], v[0:3]
v_mfma_f32_16x16x32_bf16 v[32:35], a[48:51], a[28:31], v[32:35]
ds_read_b64_tr_b16 a[48:49], v160 offset:0
ds_read_b64_tr_b16 a[50:51], v160 offset:2048
v_mfma_f32_16x16x32_bf16 v[4:7], a[52:55], a[24:27], v[4:7]
v_mfma_f32_16x16x32_bf16 v[36:39], a[52:55], a[28:31], v[36:39]
ds_read_b64_tr_b16 a[52:53], v161 offset:0
ds_read_b64_tr_b16 a[54:55], v161 offset:2048
s_add_u32 m0, s62, 73728
s_add_u32 s67, s67, 131072
buffer_load_dwordx4 v175, s[20:23], s67 offen lds
v_mfma_f32_16x16x32_bf16 v[8:11], a[56:59], a[24:27], v[8:11]
v_mfma_f32_16x16x32_bf16 v[40:43], a[56:59], a[28:31], v[40:43]
ds_read_b64_tr_b16 a[56:57], v162 offset:0
ds_read_b64_tr_b16 a[58:59], v162 offset:2048
v_mfma_f32_16x16x32_bf16 v[12:15], a[60:63], a[24:27], v[12:15]
v_mfma_f32_16x16x32_bf16 v[44:47], a[60:63], a[28:31], v[44:47]
ds_read_b64_tr_b16 a[60:61], v163 offset:0
ds_read_b64_tr_b16 a[62:63], v163 offset:2048
buffer_load_dwordx4 a[16:19], v171, s[40:43], s54 offen sc1
buffer_load_dwordx4 a[20:23], v171, s[40:43], s55 offen sc1
s_add_u32 s54, s54, 2048
s_add_u32 s55, s55, 2048
s_waitcnt vmcnt(16)
s_waitcnt lgkmcnt(14)
s_setprio 1
v_mfma_f32_16x16x32_bf16 v[16:19], a[64:67], a[0:3], v[16:19]
v_mfma_f32_16x16x32_bf16 v[48:51], a[64:67], a[4:7], v[48:51]
ds_read_b64_tr_b16 a[64:65], v160 offset:20480
ds_read_b64_tr_b16 a[66:67], v160 offset:22528
s_waitcnt lgkmcnt(14)
v_mfma_f32_16x16x32_bf16 v[20:23], a[68:71], a[0:3], v[20:23]
v_mfma_f32_16x16x32_bf16 v[52:55], a[68:71], a[4:7], v[52:55]
ds_read_b64_tr_b16 a[68:69], v161 offset:20480
ds_read_b64_tr_b16 a[70:71], v161 offset:22528
s_add_u32 m0, s62, 81920
s_add_u32 s67, s67, 131072
buffer_load_dwordx4 v175, s[20:23], s67 offen lds
s_waitcnt lgkmcnt(14)
v_mfma_f32_16x16x32_bf16 v[24:27], a[72:75], a[0:3], v[24:27]
v_mfma_f32_16x16x32_bf16 v[56:59], a[72:75], a[4:7], v[56:59]
ds_read_b64_tr_b16 a[72:73], v162 offset:20480
ds_read_b64_tr_b16 a[74:75], v162 offset:22528
s_waitcnt lgkmcnt(14)
v_mfma_f32_16x16x32_bf16 v[28:31], a[76:79], a[0:3], v[28:31]
v_mfma_f32_16x16x32_bf16 v[60:63], a[76:79], a[4:7], v[60:63]
ds_read_b64_tr_b16 a[76:77], v163 offset:20480
ds_read_b64_tr_b16 a[78:79], v163 offset:22528
s_waitcnt lgkmcnt(14)
s_setprio 0
v_mfma_f32_16x16x32_bf16 v[0:3], a[48:51], a[0:3], v[0:3]
v_mfma_f32_16x16x32_bf16 v[32:35], a[48:51], a[4:7], v[32:35]
ds_read_b64_tr_b16 a[48:49], v160 offset:16384
ds_read_b64_tr_b16 a[50:51], v160 offset:18432
s_waitcnt lgkmcnt(14)
v_mfma_f32_16x16x32_bf16 v[4:7], a[52:55], a[0:3], v[4:7]
v_mfma_f32_16x16x32_bf16 v[36:39], a[52:55], a[4:7], v[36:39]
ds_read_b64_tr_b16 a[52:53], v161 offset:16384
ds_read_b64_tr_b16 a[54:55], v161 offset:18432
s_add_u32 m0, s62, 90112
s_add_u32 s67, s67, 131072
buffer_load_dwordx4 v175, s[20:23], s67 offen lds
s_waitcnt lgkmcnt(14)
v_mfma_f32_16x16x32_bf16 v[8:11], a[56:59], a[0:3], v[8:11]
v_mfma_f32_16x16x32_bf16 v[40:43], a[56:59], a[4:7], v[40:43]
ds_read_b64_tr_b16 a[56:57], v162 offset:16384
ds_read_b64_tr_b16 a[58:59], v162 offset:18432
s_waitcnt lgkmcnt(14)
v_mfma_f32_16x16x32_bf16 v[12:15], a[60:63], a[0:3], v[12:15]
v_mfma_f32_16x16x32_bf16 v[44:47], a[60:63], a[4:7], v[44:47]
ds_read_b64_tr_b16 a[60:61], v163 offset:16384
ds_read_b64_tr_b16 a[62:63], v163 offset:18432
buffer_load_dwordx4 a[24:27], v171, s[40:43], s54 offen sc1
buffer_load_dwordx4 a[28:31], v171, s[40:43], s55 offen sc1
s_add_u32 s54, s54, 2048
s_add_u32 s55, s55, 2048
s_waitcnt vmcnt(16) lgkmcnt(0)
s_barrier
s_setprio 3
v_mfma_f32_16x16x32_bf16 v[16:19], a[64:67], a[8:11], v[16:19]
v_mfma_f32_16x16x32_bf16 v[48:51], a[64:67], a[12:15], v[48:51]
ds_read_b64_tr_b16 a[64:65], v160 offset:36864
ds_read_b64_tr_b16 a[66:67], v160 offset:38912
v_mfma_f32_16x16x32_bf16 v[20:23], a[68:71], a[8:11], v[20:23]
v_mfma_f32_16x16x32_bf16 v[52:55], a[68:71], a[12:15], v[52:55]
ds_read_b64_tr_b16 a[68:69], v161 offset:36864
ds_read_b64_tr_b16 a[70:71], v161 offset:38912
s_add_u32 m0, s62, 0
s_add_u32 s67, s67, 131072
buffer_load_dwordx4 v175, s[20:23], s67 offen lds
v_mfma_f32_16x16x32_bf16 v[24:27], a[72:75], a[8:11], v[24:27]
v_mfma_f32_16x16x32_bf16 v[56:59], a[72:75], a[12:15], v[56:59]
ds_read_b64_tr_b16 a[72:73], v162 offset:36864
ds_read_b64_tr_b16 a[74:75], v162 offset:38912
v_mfma_f32_16x16x32_bf16 v[28:31], a[76:79], a[8:11], v[28:31]
v_mfma_f32_16x16x32_bf16 v[60:63], a[76:79], a[12:15], v[60:63]
ds_read_b64_tr_b16 a[76:77], v163 offset:36864
ds_read_b64_tr_b16 a[78:79], v163 offset:38912
s_setprio 2
v_mfma_f32_16x16x32_bf16 v[0:3], a[48:51], a[8:11], v[0:3]
v_mfma_f32_16x16x32_bf16 v[32:35], a[48:51], a[12:15], v[32:35]
ds_read_b64_tr_b16 a[48:49], v160 offset:32768
ds_read_b64_tr_b16 a[50:51], v160 offset:34816
v_mfma_f32_16x16x32_bf16 v[4:7], a[52:55], a[8:11], v[4:7]
v_mfma_f32_16x16x32_bf16 v[36:39], a[52:55], a[12:15], v[36:39]
ds_read_b64_tr_b16 a[52:53], v161 offset:32768
ds_read_b64_tr_b16 a[54:55], v161 offset:34816
s_add_u32 m0, s62, 8192
s_add_u32 s67, s67, 131072
buffer_load_dwordx4 v175, s[20:23], s67 offen lds
v_mfma_f32_16x16x32_bf16 v[8:11], a[56:59], a[8:11], v[8:11]
v_mfma_f32_16x16x32_bf16 v[40:43], a[56:59], a[12:15], v[40:43]
ds_read_b64_tr_b16 a[56:57], v162 offset:32768
ds_read_b64_tr_b16 a[58:59], v162 offset:34816
v_mfma_f32_16x16x32_bf16 v[12:15], a[60:63], a[8:11], v[12:15]
v_mfma_f32_16x16x32_bf16 v[44:47], a[60:63], a[12:15], v[44:47]
ds_read_b64_tr_b16 a[60:61], v163 offset:32768
ds_read_b64_tr_b16 a[62:63], v163 offset:34816
buffer_load_dwordx4 a[0:3], v171, s[40:43], s54 offen sc1
buffer_load_dwordx4 a[4:7], v171, s[40:43], s55 offen sc1
s_add_u32 s54, s54, 2048
s_add_u32 s55, s55, 2048
s_waitcnt vmcnt(14) lgkmcnt(0)
s_barrier
s_lshl_b32 s90, s87, 12
s_add_u32 s90, s90, 131072
v_add_u32 v167, s90, v171
s_xor_b32 s90, s90, 16384
v_add_u32 v168, s90, v171
v_lshrrev_b32 v164, 4, v171
v_and_b32 v164, 15, v164
v_lshrrev_b32 v166, 8, v171
v_lshlrev_b32 v166, 3, v166
v_lshl_add_u32 v166, v164, 11, v166
v_add_u32 v166, s95, v166
v_lshlrev_b32 v164, 2, v164
v_subrev_u32 v160, s63, v160
v_subrev_u32 v161, s63, v161
v_subrev_u32 v162, s63, v162
v_subrev_u32 v163, s63, v163
v_xor_b32 v160, 0x10000, v160
v_xor_b32 v161, 0x10000, v161
v_xor_b32 v162, 0x10000, v162
v_xor_b32 v163, 0x10000, v163
s_setprio 1
v_mfma_f32_16x16x32_bf16 v[16:19], a[64:67], a[32:35], v[16:19]
v_mfma_f32_16x16x32_bf16 v[48:51], a[64:67], a[36:39], v[48:51]
ds_read_b64_tr_b16 a[64:65], v160 offset:32768
ds_read_b64_tr_b16 a[66:67], v160 offset:34816
v_mfma_f32_16x16x32_bf16 v[20:23], a[68:71], a[32:35], v[20:23]
v_mfma_f32_16x16x32_bf16 v[52:55], a[68:71], a[36:39], v[52:55]
ds_read_b64_tr_b16 a[68:69], v161 offset:32768
ds_read_b64_tr_b16 a[70:71], v161 offset:34816
s_add_u32 m0, s62, 16384
s_add_u32 s67, s67, 131072
buffer_load_dwordx4 v175, s[20:23], s67 offen lds
v_mfma_f32_16x16x32_bf16 v[24:27], a[72:75], a[32:35], v[24:27]
v_mfma_f32_16x16x32_bf16 v[56:59], a[72:75], a[36:39], v[56:59]
ds_read_b64_tr_b16 a[72:73], v162 offset:32768
ds_read_b64_tr_b16 a[74:75], v162 offset:34816
v_mfma_f32_16x16x32_bf16 v[28:31], a[76:79], a[32:35], v[28:31]
v_mfma_f32_16x16x32_bf16 v[60:63], a[76:79], a[36:39], v[60:63]
ds_read_b64_tr_b16 a[76:77], v163 offset:32768
ds_read_b64_tr_b16 a[78:79], v163 offset:34816
s_setprio 0
v_mfma_f32_16x16x32_bf16 v[0:3], a[48:51], a[32:35], v[0:3]
v_mfma_f32_16x16x32_bf16 v[32:35], a[48:51], a[36:39], v[32:35]
v_mfma_f32_16x16x32_bf16 v[4:7], a[52:55], a[32:35], v[4:7]
ds_write_b128 v167, v[48:51] offset:0
v_mfma_f32_16x16x32_bf16 v[36:39], a[52:55], a[36:39], v[36:39]
ds_write_b128 v167, v[52:55] offset:1024
s_add_u32 m0, s62, 24576
s_add_u32 s67, s67, 131072
buffer_load_dwordx4 v175, s[20:23], s67 offen lds
v_mfma_f32_16x16x32_bf16 v[8:11], a[56:59], a[32:35], v[8:11]
ds_write_b128 v167, v[56:59] offset:2048
v_mfma_f32_16x16x32_bf16 v[40:43], a[56:59], a[36:39], v[40:43]
ds_write_b128 v167, v[60:63] offset:3072
v_mfma_f32_16x16x32_bf16 v[12:15], a[60:63], a[32:35], v[12:15]
v_mfma_f32_16x16x32_bf16 v[44:47], a[60:63], a[36:39], v[44:47]
buffer_load_dwordx4 a[8:11], v171, s[40:43], s54 offen sc1
buffer_load_dwordx4 a[12:15], v171, s[40:43], s55 offen sc1
s_add_u32 s54, s54, 2048
s_add_u32 s55, s55, 2048
s_waitcnt vmcnt(16) lgkmcnt(0)
s_barrier
s_setprio 2
v_mfma_f32_16x16x32_bf16 v[0:3], a[64:67], a[40:43], v[0:3]
ds_read_b64_tr_b16 a[48:49], v160 offset:40960
ds_read_b64_tr_b16 a[50:51], v160 offset:43008
ds_read_b128 v[128:131], v168 offset:0
v_mfma_f32_16x16x32_bf16 v[32:35], a[64:67], a[44:47], v[32:35]
ds_read_b128 v[132:135], v168 offset:1024
v_mfma_f32_16x16x32_bf16 v[4:7], a[68:71], a[40:43], v[4:7]
ds_read_b64_tr_b16 a[52:53], v161 offset:40960
ds_read_b64_tr_b16 a[54:55], v161 offset:43008
ds_read_b128 v[136:139], v168 offset:2048
v_mfma_f32_16x16x32_bf16 v[36:39], a[68:71], a[44:47], v[36:39]
ds_read_b128 v[140:143], v168 offset:3072
s_add_u32 m0, s62, 32768
s_add_u32 s67, s67, 131072
buffer_load_dwordx4 v175, s[20:23], s67 offen lds
v_mfma_f32_16x16x32_bf16 v[8:11], a[72:75], a[40:43], v[8:11]
ds_read_b64_tr_b16 a[56:57], v162 offset:40960
ds_read_b64_tr_b16 a[58:59], v162 offset:43008
v_mfma_f32_16x16x32_bf16 v[40:43], a[72:75], a[44:47], v[40:43]
v_mfma_f32_16x16x32_bf16 v[12:15], a[76:79], a[40:43], v[12:15]
ds_read_b64_tr_b16 a[60:61], v163 offset:40960
ds_read_b64_tr_b16 a[62:63], v163 offset:43008
v_mfma_f32_16x16x32_bf16 v[44:47], a[76:79], a[44:47], v[44:47]
buffer_load_dwordx4 a[32:35], v171, s[40:43], s54 offen sc1
buffer_load_dwordx4 a[36:39], v171, s[40:43], s55 offen sc1
s_add_u32 s54, s54, 2048
s_add_u32 s55, s55, 2048
s_waitcnt vmcnt(15)
buffer_load_dword v165, v164, s[40:43], s70 offen sc1
s_waitcnt lgkmcnt(4)
s_waitcnt lgkmcnt(10)
s_setprio 1
v_mfma_f32_16x16x32_bf16 v[0:3], a[48:51], a[16:19], v[0:3]
ds_read_b64_tr_b16 a[64:65], v160 offset:49152
ds_read_b64_tr_b16 a[66:67], v160 offset:51200
v_add_f32 v16, v16, v128
v_add_f32 v17, v17, v129
v_add_f32 v18, v18, v130
v_add_f32 v19, v19, v131
buffer_store_dwordx4 v[16:19], v171, s[40:43], s44 offen offset:0 sc1
v_mfma_f32_16x16x32_bf16 v[32:35], a[48:51], a[20:23], v[32:35]
v_add_f32 v20, v20, v132
v_add_f32 v21, v21, v133
v_add_f32 v22, v22, v134
v_add_f32 v23, v23, v135
buffer_store_dwordx4 v[20:23], v171, s[40:43], s44 offen offset:1024 sc1
s_waitcnt lgkmcnt(8)
v_mfma_f32_16x16x32_bf16 v[4:7], a[52:55], a[16:19], v[4:7]
ds_read_b64_tr_b16 a[68:69], v161 offset:49152
ds_read_b64_tr_b16 a[70:71], v161 offset:51200
v_add_f32 v24, v24, v136
v_add_f32 v25, v25, v137
v_add_f32 v26, v26, v138
v_add_f32 v27, v27, v139
buffer_store_dwordx4 v[24:27], v171, s[40:43], s44 offen offset:2048 sc1
v_mfma_f32_16x16x32_bf16 v[36:39], a[52:55], a[20:23], v[36:39]
v_add_f32 v28, v28, v140
v_add_f32 v29, v29, v141
v_add_f32 v30, v30, v142
v_add_f32 v31, v31, v143
buffer_store_dwordx4 v[28:31], v171, s[40:43], s44 offen offset:3072 sc1
s_waitcnt lgkmcnt(6)
v_mfma_f32_16x16x32_bf16 v[8:11], a[56:59], a[16:19], v[8:11]
ds_read_b64_tr_b16 a[72:73], v162 offset:49152
ds_read_b64_tr_b16 a[74:75], v162 offset:51200
v_mfma_f32_16x16x32_bf16 v[40:43], a[56:59], a[20:23], v[40:43]
s_waitcnt lgkmcnt(6)
v_mfma_f32_16x16x32_bf16 v[12:15], a[60:63], a[16:19], v[12:15]
ds_read_b64_tr_b16 a[76:77], v163 offset:49152
ds_read_b64_tr_b16 a[78:79], v163 offset:51200
v_mfma_f32_16x16x32_bf16 v[44:47], a[60:63], a[20:23], v[44:47]
buffer_load_dwordx4 a[40:43], v171, s[40:43], s54 offen sc1
buffer_load_dwordx4 a[44:47], v171, s[40:43], s55 offen sc1
s_add_u32 s54, s54, 2048
s_add_u32 s55, s55, 2048
s_waitcnt vmcnt(18)
s_waitcnt lgkmcnt(6)
s_setprio 0
v_mfma_f32_16x16x32_bf16 v[0:3], a[64:67], a[24:27], v[0:3]
ds_read_b64_tr_b16 a[48:49], v160 offset:57344
ds_read_b64_tr_b16 a[50:51], v160 offset:59392
v_mfma_f32_16x16x32_bf16 v[32:35], a[64:67], a[28:31], v[32:35]
s_waitcnt lgkmcnt(6)
v_mfma_f32_16x16x32_bf16 v[4:7], a[68:71], a[24:27], v[4:7]
ds_read_b64_tr_b16 a[52:53], v161 offset:57344
ds_read_b64_tr_b16 a[54:55], v161 offset:59392
v_mfma_f32_16x16x32_bf16 v[36:39], a[68:71], a[28:31], v[36:39]
s_waitcnt lgkmcnt(6)
v_mfma_f32_16x16x32_bf16 v[8:11], a[72:75], a[24:27], v[8:11]
ds_read_b64_tr_b16 a[56:57], v162 offset:57344
ds_read_b64_tr_b16 a[58:59], v162 offset:59392
v_mfma_f32_16x16x32_bf16 v[40:43], a[72:75], a[28:31], v[40:43]
s_waitcnt lgkmcnt(6)
v_mfma_f32_16x16x32_bf16 v[12:15], a[76:79], a[24:27], v[12:15]
ds_read_b64_tr_b16 a[60:61], v163 offset:57344
ds_read_b64_tr_b16 a[62:63], v163 offset:59392
v_mfma_f32_16x16x32_bf16 v[44:47], a[76:79], a[28:31], v[44:47]
buffer_load_dwordx4 a[16:19], v171, s[40:43], s54 offen sc1
buffer_load_dwordx4 a[20:23], v171, s[40:43], s55 offen sc1
s_add_u32 s54, s54, 2048
s_add_u32 s55, s55, 2048
s_waitcnt vmcnt(16) lgkmcnt(0)
s_barrier
s_setprio 3
v_mfma_f32_16x16x32_bf16 v[0:3], a[48:51], a[0:3], v[0:3]
ds_read_b64_tr_b16 a[64:65], v160 offset:0
ds_read_b64_tr_b16 a[66:67], v160 offset:2048
v_mfma_f32_16x16x32_bf16 v[32:35], a[48:51], a[4:7], v[32:35]
v_mfma_f32_16x16x32_bf16 v[4:7], a[52:55], a[0:3], v[4:7]
ds_read_b64_tr_b16 a[68:69], v161 offset:0
ds_read_b64_tr_b16 a[70:71], v161 offset:2048
v_mfma_f32_16x16x32_bf16 v[36:39], a[52:55], a[4:7], v[36:39]
v_mfma_f32_16x16x32_bf16 v[8:11], a[56:59], a[0:3], v[8:11]
ds_read_b64_tr_b16 a[72:73], v162 offset:0
ds_read_b64_tr_b16 a[74:75], v162 offset:2048
v_mfma_f32_16x16x32_bf16 v[40:43], a[56:59], a[4:7], v[40:43]
v_mfma_f32_16x16x32_bf16 v[12:15], a[60:63], a[0:3], v[12:15]
ds_read_b64_tr_b16 a[76:77], v163 offset:0
ds_read_b64_tr_b16 a[78:79], v163 offset:2048
v_mfma_f32_16x16x32_bf16 v[44:47], a[60:63], a[4:7], v[44:47]
buffer_load_dwordx4 a[24:27], v171, s[40:43], s54 offen sc1
buffer_load_dwordx4 a[28:31], v171, s[40:43], s55 offen sc1
s_add_u32 s54, s54, 2048
s_add_u32 s55, s55, 2048
s_waitcnt vmcnt(6)
s_barrier
s_cmp_lg_u32 s87, 0
s_cbranch_scc1 k1_kernel_b_p_sg
v_mov_b32 v174, 1
s_mov_b64 exec, 1
buffer_store_dword v174, off, s[40:43], s80 sc1
s_mov_b64 exec, -1
k1_kernel_b_p_sg:
s_waitcnt lgkmcnt(6)
s_setprio 2
v_mfma_f32_16x16x32_bf16 v[0:3], a[64:67], a[8:11], v[0:3]
ds_read_b64_tr_b16 a[48:49], v160 offset:8192
ds_read_b64_tr_b16 a[50:51], v160 offset:10240
v_mfma_f32_16x16x32_bf16 v[32:35], a[64:67], a[12:15], v[32:35]
s_waitcnt lgkmcnt(6)
v_mfma_f32_16x16x32_bf16 v[4:7], a[68:71], a[8:11], v[4:7]
ds_read_b64_tr_b16 a[52:53], v161 offset:8192
ds_read_b64_tr_b16 a[54:55], v161 offset:10240
v_mfma_f32_16x16x32_bf16 v[36:39], a[68:71], a[12:15], v[36:39]
s_waitcnt lgkmcnt(6)
v_mfma_f32_16x16x32_bf16 v[8:11], a[72:75], a[8:11], v[8:11]
ds_read_b64_tr_b16 a[56:57], v162 offset:8192
ds_read_b64_tr_b16 a[58:59], v162 offset:10240
v_mfma_f32_16x16x32_bf16 v[40:43], a[72:75], a[12:15], v[40:43]
s_waitcnt lgkmcnt(6)
v_mfma_f32_16x16x32_bf16 v[12:15], a[76:79], a[8:11], v[12:15]
ds_read_b64_tr_b16 a[60:61], v163 offset:8192
ds_read_b64_tr_b16 a[62:63], v163 offset:10240
v_mfma_f32_16x16x32_bf16 v[44:47], a[76:79], a[12:15], v[44:47]
buffer_load_dwordx4 a[0:3], v171, s[40:43], s54 offen sc1
buffer_load_dwordx4 a[4:7], v171, s[40:43], s55 offen sc1
s_add_u32 s54, s54, 2048
s_add_u32 s55, s55, 2048
s_waitcnt vmcnt(13)
s_waitcnt lgkmcnt(6)
s_setprio 1
v_mfma_f32_16x16x32_bf16 v[0:3], a[48:51], a[32:35], v[0:3]
ds_read_b64_tr_b16 a[64:65], v160 offset:16384
ds_read_b64_tr_b16 a[66:67], v160 offset:18432
v_mfma_f32_16x16x32_bf16 v[32:35], a[48:51], a[36:39], v[32:35]
s_waitcnt lgkmcnt(6)
v_mfma_f32_16x16x32_bf16 v[4:7], a[52:55], a[32:35], v[4:7]
ds_read_b64_tr_b16 a[68:69], v161 offset:16384
ds_read_b64_tr_b16 a[70:71], v161 offset:18432
v_mfma_f32_16x16x32_bf16 v[36:39], a[52:55], a[36:39], v[36:39]
s_waitcnt lgkmcnt(6)
v_mfma_f32_16x16x32_bf16 v[8:11], a[56:59], a[32:35], v[8:11]
ds_read_b64_tr_b16 a[72:73], v162 offset:16384
ds_read_b64_tr_b16 a[74:75], v162 offset:18432
v_mfma_f32_16x16x32_bf16 v[40:43], a[56:59], a[36:39], v[40:43]
s_waitcnt lgkmcnt(6)
v_mfma_f32_16x16x32_bf16 v[12:15], a[60:63], a[32:35], v[12:15]
ds_read_b64_tr_b16 a[76:77], v163 offset:16384
ds_read_b64_tr_b16 a[78:79], v163 offset:18432
v_mfma_f32_16x16x32_bf16 v[44:47], a[60:63], a[36:39], v[44:47]
s_lshr_b32 s55, s63, 2
s_sub_u32 s54, s54, s55
s_add_u32 s55, s54, 1024
buffer_load_dwordx4 a[8:11], v171, s[40:43], s54 offen sc1
buffer_load_dwordx4 a[12:15], v171, s[40:43], s55 offen sc1
s_add_u32 s54, s54, 2048
s_add_u32 s55, s55, 2048
s_waitcnt vmcnt(8)
s_waitcnt lgkmcnt(6)
s_setprio 0
v_mfma_f32_16x16x32_bf16 v[0:3], a[64:67], a[40:43], v[0:3]
ds_read_b64_tr_b16 a[48:49], v160 offset:24576
ds_read_b64_tr_b16 a[50:51], v160 offset:26624
v_mfma_f32_16x16x32_bf16 v[32:35], a[64:67], a[44:47], v[32:35]
s_waitcnt lgkmcnt(6)
v_mfma_f32_16x16x32_bf16 v[4:7], a[68:71], a[40:43], v[4:7]
ds_read_b64_tr_b16 a[52:53], v161 offset:24576
ds_read_b64_tr_b16 a[54:55], v161 offset:26624
v_mfma_f32_16x16x32_bf16 v[36:39], a[68:71], a[44:47], v[36:39]
s_waitcnt lgkmcnt(6)
v_mfma_f32_16x16x32_bf16 v[8:11], a[72:75], a[40:43], v[8:11]
ds_read_b64_tr_b16 a[56:57], v162 offset:24576
ds_read_b64_tr_b16 a[58:59], v162 offset:26624
v_mfma_f32_16x16x32_bf16 v[40:43], a[72:75], a[44:47], v[40:43]
s_waitcnt lgkmcnt(6)
v_mfma_f32_16x16x32_bf16 v[12:15], a[76:79], a[40:43], v[12:15]
ds_read_b64_tr_b16 a[60:61], v163 offset:24576
ds_read_b64_tr_b16 a[62:63], v163 offset:26624
v_mfma_f32_16x16x32_bf16 v[44:47], a[76:79], a[44:47], v[44:47]
buffer_load_dwordx4 a[32:35], v171, s[40:43], s54 offen sc1
buffer_load_dwordx4 a[36:39], v171, s[40:43], s55 offen sc1
s_add_u32 s54, s54, 2048
s_add_u32 s55, s55, 2048
s_waitcnt vmcnt(8) lgkmcnt(0)
s_barrier
v_xor_b32 v160, 0x10000, v160
v_xor_b32 v161, 0x10000, v161
v_xor_b32 v162, 0x10000, v162
v_xor_b32 v163, 0x10000, v163
s_setprio 3
v_mfma_f32_16x16x32_bf16 v[0:3], a[48:51], a[16:19], v[0:3]
ds_read_b64_tr_b16 a[64:65], v160 offset:0
ds_read_b64_tr_b16 a[66:67], v160 offset:2048
v_mfma_f32_16x16x32_bf16 v[32:35], a[48:51], a[20:23], v[32:35]
v_mfma_f32_16x16x32_bf16 v[4:7], a[52:55], a[16:19], v[4:7]
ds_read_b64_tr_b16 a[68:69], v161 offset:0
ds_read_b64_tr_b16 a[70:71], v161 offset:2048
v_mfma_f32_16x16x32_bf16 v[36:39], a[52:55], a[20:23], v[36:39]
v_mfma_f32_16x16x32_bf16 v[8:11], a[56:59], a[16:19], v[8:11]
ds_read_b64_tr_b16 a[72:73], v162 offset:0
ds_read_b64_tr_b16 a[74:75], v162 offset:2048
v_mfma_f32_16x16x32_bf16 v[40:43], a[56:59], a[20:23], v[40:43]
v_mfma_f32_16x16x32_bf16 v[12:15], a[60:63], a[16:19], v[12:15]
ds_read_b64_tr_b16 a[76:77], v163 offset:0
ds_read_b64_tr_b16 a[78:79], v163 offset:2048
v_mfma_f32_16x16x32_bf16 v[44:47], a[60:63], a[20:23], v[44:47]
buffer_load_dwordx4 a[40:43], v171, s[40:43], s54 offen sc1
buffer_load_dwordx4 a[44:47], v171, s[40:43], s55 offen sc1
s_add_u32 s54, s54, 2048
s_add_u32 s55, s55, 2048
s_waitcnt vmcnt(8)
s_cmp_lg_u32 s87, 0
s_cbranch_scc1 k1_kernel_b_pp_pi
v_lshrrev_b32 v172, 2, v171
v_min_u32 v172, 4, v172
buffer_load_dword v172, v172, s[40:43], s56 offen offset:0 sc1
k1_kernel_b_pp_pi:
s_waitcnt lgkmcnt(6)
s_setprio 2
v_mfma_f32_16x16x32_bf16 v[0:3], a[64:67], a[24:27], v[0:3]
ds_read_b64_tr_b16 a[48:49], v160 offset:8192
ds_read_b64_tr_b16 a[50:51], v160 offset:10240
v_mfma_f32_16x16x32_bf16 v[32:35], a[64:67], a[28:31], v[32:35]
s_waitcnt lgkmcnt(6)
v_mfma_f32_16x16x32_bf16 v[4:7], a[68:71], a[24:27], v[4:7]
ds_read_b64_tr_b16 a[52:53], v161 offset:8192
ds_read_b64_tr_b16 a[54:55], v161 offset:10240
v_mfma_f32_16x16x32_bf16 v[36:39], a[68:71], a[28:31], v[36:39]
s_waitcnt lgkmcnt(6)
v_mfma_f32_16x16x32_bf16 v[8:11], a[72:75], a[24:27], v[8:11]
ds_read_b64_tr_b16 a[56:57], v162 offset:8192
ds_read_b64_tr_b16 a[58:59], v162 offset:10240
v_mfma_f32_16x16x32_bf16 v[40:43], a[72:75], a[28:31], v[40:43]
s_waitcnt lgkmcnt(6)
v_mfma_f32_16x16x32_bf16 v[12:15], a[76:79], a[24:27], v[12:15]
ds_read_b64_tr_b16 a[60:61], v163 offset:8192
ds_read_b64_tr_b16 a[62:63], v163 offset:10240
v_mfma_f32_16x16x32_bf16 v[44:47], a[76:79], a[28:31], v[44:47]
s_waitcnt vmcnt(6)
v_subrev_u32 v160, s63, v160
v_subrev_u32 v161, s63, v161
v_subrev_u32 v162, s63, v162
v_subrev_u32 v163, s63, v163
s_waitcnt lgkmcnt(6)
s_setprio 1
v_mfma_f32_16x16x32_bf16 v[0:3], a[48:51], a[0:3], v[0:3]
ds_read_b64_tr_b16 a[64:65], v160 offset:20480
ds_read_b64_tr_b16 a[66:67], v160 offset:22528
v_mfma_f32_16x16x32_bf16 v[32:35], a[48:51], a[4:7], v[32:35]
ds_read_b64_tr_b16 a[48:49], v160 offset:16384
ds_read_b64_tr_b16 a[50:51], v160 offset:18432
s_waitcnt lgkmcnt(8)
v_mfma_f32_16x16x32_bf16 v[4:7], a[52:55], a[0:3], v[4:7]
ds_read_b64_tr_b16 a[68:69], v161 offset:20480
ds_read_b64_tr_b16 a[70:71], v161 offset:22528
v_mfma_f32_16x16x32_bf16 v[36:39], a[52:55], a[4:7], v[36:39]
ds_read_b64_tr_b16 a[52:53], v161 offset:16384
ds_read_b64_tr_b16 a[54:55], v161 offset:18432
s_waitcnt lgkmcnt(10)
v_mfma_f32_16x16x32_bf16 v[8:11], a[56:59], a[0:3], v[8:11]
ds_read_b64_tr_b16 a[72:73], v162 offset:20480
ds_read_b64_tr_b16 a[74:75], v162 offset:22528
v_mfma_f32_16x16x32_bf16 v[40:43], a[56:59], a[4:7], v[40:43]
ds_read_b64_tr_b16 a[56:57], v162 offset:16384
ds_read_b64_tr_b16 a[58:59], v162 offset:18432
s_waitcnt lgkmcnt(12)
v_mfma_f32_16x16x32_bf16 v[12:15], a[60:63], a[0:3], v[12:15]
ds_read_b64_tr_b16 a[76:77], v163 offset:20480
ds_read_b64_tr_b16 a[78:79], v163 offset:22528
v_mfma_f32_16x16x32_bf16 v[44:47], a[60:63], a[4:7], v[44:47]
ds_read_b64_tr_b16 a[60:61], v163 offset:16384
ds_read_b64_tr_b16 a[62:63], v163 offset:18432
s_waitcnt vmcnt(4)
s_cmp_lg_u32 s87, 0
s_cbranch_scc1 k1_kernel_b_pp_pc_rdy
s_waitcnt vmcnt(0)
v_cmp_le_u32 s[100:101], 1, v172
s_nop 0
s_cmp_eq_u64 s[100:101], -1
s_cbranch_scc1 k1_kernel_b_pp_pc_rdy
s_mov_b32 s91, 40000
k1_kernel_b_pp_pc_spin:
s_sleep 2
v_lshrrev_b32 v172, 2, v171
v_min_u32 v172, 4, v172
buffer_load_dword v172, v172, s[40:43], s56 offen offset:0 sc1
s_waitcnt vmcnt(0)
v_cmp_le_u32 s[100:101], 1, v172
s_nop 0
s_cmp_eq_u64 s[100:101], -1
s_cbranch_scc1 k1_kernel_b_pp_pc_rdy
s_sub_u32 s91, s91, 1
s_cmp_lg_u32 s91, 0
s_cbranch_scc1 k1_kernel_b_pp_pc_spin
s_nop 0
k1_kernel_b_pp_pc_rdy:
s_barrier
s_waitcnt lgkmcnt(12)
s_setprio 0
v_mfma_f32_16x16x32_bf16 v[0:3], a[48:51], a[8:11], v[0:3]
ds_read_b64_tr_b16 a[48:49], v160 offset:24576
ds_read_b64_tr_b16 a[50:51], v160 offset:26624
buffer_load_dwordx4 v[144:147], v171, s[40:43], s45 offen offset:0 sc1
s_waitcnt lgkmcnt(10)
v_mfma_f32_16x16x32_bf16 v[4:7], a[52:55], a[8:11], v[4:7]
ds_read_b64_tr_b16 a[52:53], v161 offset:24576
ds_read_b64_tr_b16 a[54:55], v161 offset:26624
buffer_load_dwordx4 v[148:151], v171, s[40:43], s45 offen offset:1024 sc1
s_waitcnt lgkmcnt(8)
v_mfma_f32_16x16x32_bf16 v[8:11], a[56:59], a[8:11], v[8:11]
ds_read_b64_tr_b16 a[56:57], v162 offset:24576
ds_read_b64_tr_b16 a[58:59], v162 offset:26624
buffer_load_dwordx4 v[152:155], v171, s[40:43], s45 offen offset:2048 sc1
s_waitcnt lgkmcnt(6)
v_mfma_f32_16x16x32_bf16 v[12:15], a[60:63], a[8:11], v[12:15]
ds_read_b64_tr_b16 a[60:61], v163 offset:24576
ds_read_b64_tr_b16 a[62:63], v163 offset:26624
buffer_load_dwordx4 v[156:159], v171, s[40:43], s45 offen offset:3072 sc1
s_waitcnt lgkmcnt(15)
v_mfma_f32_16x16x32_bf16 v[0:3], a[64:67], a[12:15], v[0:3]
ds_read_b64_tr_b16 a[64:65], v160 offset:28672
ds_read_b64_tr_b16 a[66:67], v160 offset:30720
ds_write_b128 v167, v[32:35] offset:0
s_waitcnt lgkmcnt(15)
v_mfma_f32_16x16x32_bf16 v[4:7], a[68:71], a[12:15], v[4:7]
ds_read_b64_tr_b16 a[68:69], v161 offset:28672
ds_read_b64_tr_b16 a[70:71], v161 offset:30720
ds_write_b128 v167, v[36:39] offset:1024
s_waitcnt lgkmcnt(15)
v_mfma_f32_16x16x32_bf16 v[8:11], a[72:75], a[12:15], v[8:11]
ds_read_b64_tr_b16 a[72:73], v162 offset:28672
ds_read_b64_tr_b16 a[74:75], v162 offset:30720
ds_write_b128 v167, v[40:43] offset:2048
s_waitcnt lgkmcnt(15)
v_mfma_f32_16x16x32_bf16 v[12:15], a[76:79], a[12:15], v[12:15]
ds_read_b64_tr_b16 a[76:77], v163 offset:28672
ds_read_b64_tr_b16 a[78:79], v163 offset:30720
ds_write_b128 v167, v[44:47] offset:3072
s_waitcnt vmcnt(6) lgkmcnt(0)
s_barrier
s_setprio 3
v_mfma_f32_16x16x32_bf16 v[0:3], a[48:51], a[32:35], v[0:3]
ds_read_b64_tr_b16 a[48:49], v160 offset:32768
ds_read_b64_tr_b16 a[50:51], v160 offset:34816
ds_read_b128 v[128:131], v168 offset:0
v_mfma_f32_16x16x32_bf16 v[4:7], a[52:55], a[32:35], v[4:7]
ds_read_b64_tr_b16 a[52:53], v161 offset:32768
ds_read_b64_tr_b16 a[54:55], v161 offset:34816
ds_read_b128 v[132:135], v168 offset:1024
v_mfma_f32_16x16x32_bf16 v[8:11], a[56:59], a[32:35], v[8:11]
ds_read_b64_tr_b16 a[56:57], v162 offset:32768
ds_read_b64_tr_b16 a[58:59], v162 offset:34816
ds_read_b128 v[136:139], v168 offset:2048
v_mfma_f32_16x16x32_bf16 v[12:15], a[60:63], a[32:35], v[12:15]
ds_read_b64_tr_b16 a[60:61], v163 offset:32768
ds_read_b64_tr_b16 a[62:63], v163 offset:34816
ds_read_b128 v[140:143], v168 offset:3072
v_mfma_f32_16x16x32_bf16 v[0:3], a[64:67], a[36:39], v[0:3]
ds_read_b64_tr_b16 a[64:65], v160 offset:36864
ds_read_b64_tr_b16 a[66:67], v160 offset:38912
v_mfma_f32_16x16x32_bf16 v[4:7], a[68:71], a[36:39], v[4:7]
ds_read_b64_tr_b16 a[68:69], v161 offset:36864
ds_read_b64_tr_b16 a[70:71], v161 offset:38912
v_mfma_f32_16x16x32_bf16 v[8:11], a[72:75], a[36:39], v[8:11]
ds_read_b64_tr_b16 a[72:73], v162 offset:36864
ds_read_b64_tr_b16 a[74:75], v162 offset:38912
v_mfma_f32_16x16x32_bf16 v[12:15], a[76:79], a[36:39], v[12:15]
ds_read_b64_tr_b16 a[76:77], v163 offset:36864
ds_read_b64_tr_b16 a[78:79], v163 offset:38912
s_waitcnt vmcnt(4)
s_waitcnt vmcnt(0) lgkmcnt(8)
s_waitcnt lgkmcnt(15)
s_setprio 2
v_mfma_f32_16x16x32_bf16 v[0:3], a[48:51], a[40:43], v[0:3]
v_add_f32 v128, v128, v144
v_add_f32 v129, v129, v145
v_add_f32 v130, v130, v146
v_add_f32 v131, v131, v147
v_mul_f32 v128, v128, v165
v_mul_f32 v129, v129, v165
v_mul_f32 v130, v130, v165
v_mul_f32 v131, v131, v165
s_waitcnt lgkmcnt(15)
v_mfma_f32_16x16x32_bf16 v[4:7], a[52:55], a[40:43], v[4:7]
v_add_f32 v132, v132, v148
v_add_f32 v133, v133, v149
v_add_f32 v134, v134, v150
v_add_f32 v135, v135, v151
v_mul_f32 v132, v132, v165
v_mul_f32 v133, v133, v165
v_mul_f32 v134, v134, v165
v_mul_f32 v135, v135, v165
s_waitcnt lgkmcnt(12)
v_mfma_f32_16x16x32_bf16 v[8:11], a[56:59], a[40:43], v[8:11]
v_add_f32 v136, v136, v152
v_add_f32 v137, v137, v153
v_add_f32 v138, v138, v154
v_add_f32 v139, v139, v155
v_mul_f32 v136, v136, v165
v_mul_f32 v137, v137, v165
v_mul_f32 v138, v138, v165
v_mul_f32 v139, v139, v165
s_waitcnt lgkmcnt(9)
v_mfma_f32_16x16x32_bf16 v[12:15], a[60:63], a[40:43], v[12:15]
v_add_f32 v140, v140, v156
v_add_f32 v141, v141, v157
v_add_f32 v142, v142, v158
v_add_f32 v143, v143, v159
v_mul_f32 v140, v140, v165
v_mul_f32 v141, v141, v165
v_mul_f32 v142, v142, v165
v_mul_f32 v143, v143, v165
s_waitcnt lgkmcnt(6)
v_mfma_f32_16x16x32_bf16 v[0:3], a[64:67], a[44:47], v[0:3]
s_waitcnt lgkmcnt(4)
v_mfma_f32_16x16x32_bf16 v[4:7], a[68:71], a[44:47], v[4:7]
s_waitcnt lgkmcnt(2)
v_mfma_f32_16x16x32_bf16 v[8:11], a[72:75], a[44:47], v[8:11]
s_waitcnt lgkmcnt(0)
v_mfma_f32_16x16x32_bf16 v[12:15], a[76:79], a[44:47], v[12:15]
s_nop 1
v_fmac_f32 v128, v0, v165
v_fmac_f32 v129, v1, v165
v_fmac_f32 v130, v2, v165
v_fmac_f32 v131, v3, v165
v_cvt_pk_bf16_f32 v128, v128, v129
v_cvt_pk_bf16_f32 v129, v130, v131
buffer_store_dwordx2 v[128:129], v166, s[24:27], 0 offen offset:0 nt
v_fmac_f32 v132, v4, v165
v_fmac_f32 v133, v5, v165
v_fmac_f32 v134, v6, v165
v_fmac_f32 v135, v7, v165
v_cvt_pk_bf16_f32 v132, v132, v133
v_cvt_pk_bf16_f32 v133, v134, v135
buffer_store_dwordx2 v[132:133], v166, s[24:27], 0 offen offset:32 nt
v_fmac_f32 v136, v8, v165
v_fmac_f32 v137, v9, v165
v_fmac_f32 v138, v10, v165
v_fmac_f32 v139, v11, v165
v_cvt_pk_bf16_f32 v136, v136, v137
v_cvt_pk_bf16_f32 v137, v138, v139
buffer_store_dwordx2 v[136:137], v166, s[24:27], 0 offen offset:64 nt
v_fmac_f32 v140, v12, v165
v_fmac_f32 v141, v13, v165
v_fmac_f32 v142, v14, v165
v_fmac_f32 v143, v15, v165
v_cvt_pk_bf16_f32 v140, v140, v141
v_cvt_pk_bf16_f32 v141, v142, v143
buffer_store_dwordx2 v[140:141], v166, s[24:27], 0 offen offset:96 nt
s_endpgm
k1_kernel_a_far:
s_mov_b32 s8, 0xbdd2d3e8
s_mov_b32 vcc_lo, s89
s_mov_b32 vcc_hi, 0
s_mov_b32 s9, 0x3fb8aa3b
s_and_b32 s6, s2, 6
s_lshl_b32 s6, s6, 1
s_lshr_b32 s7, s2, 3
s_and_b32 s7, s7, 3
s_add_u32 s4, s6, s7
s_lshr_b32 s5, s2, 5
s_lshl_b32 s63, s89, 12
s_lshl_b32 s64, s88, 14
s_lshl_b32 s6, s5, 8
s_add_u32 s64, s64, s6
s_xor_b32 s7, s89, 1
s_lshl_b32 s7, s7, 7
s_add_u32 s64, s64, s7
s_add_u32 s64, s64, 4587520
s_add_u32 s95, s6, 128
s_lshl_b32 s67, s87, 14
s_add_u32 s67, s67, s95
s_add_u32 s67, s67, 393216
s_lshl_b32 s6, s4, 3
s_lshl_b32 s7, s88, 1
s_add_u32 s6, s6, s7
s_add_u32 s90, s6, s89
s_xor_b32 s91, s90, 1
s_lshl_b32 s7, s89, 10
s_mul_i32 s54, s90, 147456
s_add_u32 s54, s54, s7
s_add_u32 s68, s54, 71680
s_add_u32 s54, s54, 120832
s_mul_i32 s55, s91, 147456
s_add_u32 s55, s55, s7
s_add_u32 s69, s55, 71680
s_add_u32 s55, s55, 120832
s_lshl_b32 s70, s90, 6
s_add_u32 s70, s70, 29360128
s_lshl_b32 s7, s90, 15
s_add_u32 s95, s95, s7
s_lshr_b32 s71, s4, 1
s_lshl_b32 s71, s71, 7
s_add_u32 s66, s71, 30426112
s_add_u32 s71, s71, 30408704
s_lshl_b32 s6, s4, 3
s_add_u32 s6, s6, s5
s_lshl_b32 s56, s6, 7
s_add_u32 s56, s56, 30409728
s_add_u32 s80, s56, 4
s_lshl_b32 s6, s6, 16
s_add_u32 s6, s6, 33554432
s_and_b32 s7, s90, 7
s_lshl_b32 s7, s7, 12
s_add_u32 s6, s6, s7
s_add_u32 s45, s6, 32768
s_add_u32 s44, s6, 0
s_lshl_b32 s81, s85, 2
s_add_u32 s81, s81, s83
s_lshl_b32 s81, s81, 2
s_lshl_b32 s7, s86, 7
s_add_u32 s81, s81, s7
s_add_u32 s81, s81, 30426112
s_lshl_b32 s6, s86, 4
s_lshl_b32 s7, s88, 2
s_add_u32 s6, s6, s7
s_mul_i32 s6, s6, 147456
s_mul_i32 s7, s85, 14336
s_add_u32 s7, s7, s6
s_lshl_b32 s90, s89, 10
s_lshl_b32 s91, s82, 11
s_add_u32 s94, s7, s91
s_add_u32 s94, s94, s90
s_add_u32 s94, s94, 10240
s_add_u32 s7, s77, 112
s_lshl_b32 s7, s7, 10
s_add_u32 s65, s6, s7
s_mul_i32 s73, s77, 9216
s_add_u32 s73, s73, 25165824
s_lshl_b32 s7, s88, 11
s_add_u32 s72, s73, s7
s_add_u32 s73, s73, 8192
s_lshr_b32 s7, s88, 1
s_lshl_b32 s7, s7, 12
s_lshl_b32 s74, s89, 11
s_add_u32 s74, s74, s7
s_add_u32 s74, s74, 147456
s_lshl_b32 s79, s86, 7
s_lshl_b32 s7, s78, 2
s_add_u32 s79, s79, s7
s_add_u32 s79, s79, 30408704
s_lshl_b32 s84, s78, 7
s_add_u32 s84, s84, 30427136
s_lshl_b32 s7, s86, 2
s_add_u32 s93, s84, s7
v_mov_b32 v4, 0
v_mov_b32 v5, 0
v_mov_b32 v6, 0
v_mov_b32 v7, 0
s_mov_b32 s6, s81
s_cmp_eq_u32 s88, 1
s_cselect_b32 s6, s80, s6
s_cmp_eq_u32 s88, 2
s_cselect_b32 s6, s79, s6
s_cmp_eq_u32 s88, 3
s_cselect_b32 s6, s93, s6
s_mov_b64 exec, 1
buffer_store_dword v4, off, s[40:43], s6 sc1
s_lshl_b32 s6, s86, 3
s_add_u32 s6, s6, s87
s_mul_i32 s6, s6, 288
s_mul_i32 s7, s78, 18432
s_add_u32 s6, s6, s7
s_add_u32 s6, s6, 25165824
s_mov_b64 exec, 0x3ffff
buffer_store_dwordx4 v[4:7], v171, s[40:43], s6 offen sc1
s_mov_b64 exec, -1
v_lshrrev_b32 v9, 3, v0
v_and_b32 v175, 6, v9
v_and_b32 v8, 7, v0
v_xor_b32 v8, v8, v175
v_lshlrev_b32 v8, 4, v8
v_lshl_add_u32 v175, v9, 11, v8
s_waitcnt vmcnt(17)
s_lshr_b32 s90, s88, 1
s_mul_i32 s90, s90, 0x80008000
v_lshl_or_b32 v100, v109, 16, v108
v_xor_b32 v100, s90, v100
v_lshl_or_b32 v101, v111, 16, v110
v_xor_b32 v101, s90, v101
v_lshl_or_b32 v102, v113, 16, v112
v_xor_b32 v102, s90, v102
v_lshl_or_b32 v103, v115, 16, v114
v_xor_b32 v103, s90, v103
v_lshl_or_b32 v104, v117, 16, v116
v_xor_b32 v104, s90, v104
v_lshl_or_b32 v105, v119, 16, v118
v_xor_b32 v105, s90, v105
v_lshl_or_b32 v106, v121, 16, v120
v_xor_b32 v106, s90, v106
v_lshl_or_b32 v107, v123, 16, v122
v_xor_b32 v107, s90, v107
v_add_u32 v5, s74, v171
ds_write_b128 v5, v[100:103]
ds_write_b128 v5, v[104:107] offset:1024
v_lshlrev_b32 v146, 16, v128
v_lshlrev_b32 v147, 16, v136
v_and_b32 v148, 0xffff0000, v128
v_and_b32 v149, 0xffff0000, v136
v_mul_f32 v172, v146, v147
v_mul_f32 v145, v148, v149
v_lshlrev_b32 v146, 16, v129
v_lshlrev_b32 v147, 16, v137
v_and_b32 v148, 0xffff0000, v129
v_and_b32 v149, 0xffff0000, v137
v_fmac_f32 v172, v146, v147
v_fmac_f32 v145, v148, v149
v_lshlrev_b32 v146, 16, v130
v_lshlrev_b32 v147, 16, v138
v_and_b32 v148, 0xffff0000, v130
v_and_b32 v149, 0xffff0000, v138
v_fmac_f32 v172, v146, v147
v_fmac_f32 v145, v148, v149
v_lshlrev_b32 v146, 16, v131
v_lshlrev_b32 v147, 16, v139
v_and_b32 v148, 0xffff0000, v131
v_and_b32 v149, 0xffff0000, v139
v_fmac_f32 v172, v146, v147
v_fmac_f32 v145, v148, v149
v_lshlrev_b32 v146, 16, v132
v_lshlrev_b32 v147, 16, v140
v_and_b32 v148, 0xffff0000, v132
v_and_b32 v149, 0xffff0000, v140
v_fmac_f32 v172, v146, v147
v_fmac_f32 v145, v148, v149
v_lshlrev_b32 v146, 16, v133
v_lshlrev_b32 v147, 16, v141
v_and_b32 v148, 0xffff0000, v133
v_and_b32 v149, 0xffff0000, v141
v_fmac_f32 v172, v146, v147
v_fmac_f32 v145, v148, v149
v_lshlrev_b32 v146, 16, v134
v_lshlrev_b32 v147, 16, v142
v_and_b32 v148, 0xffff0000, v134
v_and_b32 v149, 0xffff0000, v142
v_fmac_f32 v172, v146, v147
v_fmac_f32 v145, v148, v149
v_lshlrev_b32 v146, 16, v135
v_lshlrev_b32 v147, 16, v143
v_and_b32 v148, 0xffff0000, v135
v_and_b32 v149, 0xffff0000, v143
v_fmac_f32 v172, v146, v147
v_fmac_f32 v145, v148, v149
v_add_f32 v172, v172, v145
s_nop 1
v_add_f32_dpp v172, v172, v172 row_ror:8 row_mask:0xf bank_mask:0xf
s_nop 1
v_add_f32_dpp v172, v172, v172 row_ror:4 row_mask:0xf bank_mask:0xf
s_nop 1
v_add_f32_dpp v172, v172, v172 row_ror:2 row_mask:0xf bank_mask:0xf
s_nop 1
v_add_f32_dpp v172, v172, v172 row_ror:1 row_mask:0xf bank_mask:0xf
v_mov_b32 v146, v172
s_nop 1
v_permlane16_swap_b32 v172, v146
v_add_f32 v172, v172, v146
v_mov_b32 v146, v172
s_nop 1
v_permlane32_swap_b32 v172, v146
v_add_f32 v172, v172, v146
v_cvt_pk_bf16_f32 v172, v172, v172
v_lshlrev_b32 v172, 16, v172
v_mul_f32 v172, 0xbfb8aa3b, v172
v_exp_f32 v172, v172
s_nop 0
v_add_f32 v172, 1.0, v172
v_rcp_f32 v172, v172
s_nop 0
v_cvt_pk_bf16_f32 v172, v172, v172
v_lshlrev_b32 v172, 16, v172
s_lshl_b32 s90, s39, 2
s_add_u32 s90, s90, 29360128
v_sub_f32 v146, 1.0, v172
s_lshr_b32 s91, s39, 6
v_cvt_pk_bf16_f32 v146, v146, v146
s_lshl_b32 s91, s91, 8
v_lshlrev_b32 v146, 16, v146
s_and_b32 s100, s39, 15
v_max_f32 v146, 0x21800000, v146
s_lshl_b32 s100, s100, 4
v_rcp_f32 v147, v146
s_add_u32 s91, s91, s100
s_bfe_u32 s100, s39, 0x20004
s_lshl_b32 s100, s100, 2
v_mul_f32 v172, v172, v147
s_add_u32 s91, s91, s100
s_add_u32 s91, s91, 29368320
v_mov_b32 v174, v146
s_mov_b64 exec, 1
buffer_store_dword v174, off, s[40:43], s90 sc1
buffer_store_dword v172, off, s[40:43], s91 sc1
s_mov_b64 exec, -1
s_waitcnt vmcnt(7) lgkmcnt(0)
s_barrier
ds_read_b128 a[0:3], v160 offset:0
ds_read_b128 a[4:7], v160 offset:2048
ds_read_b128 a[8:11], v160 offset:4096
ds_read_b128 a[12:15], v160 offset:6144
ds_read_b64_tr_b16 a[32:33], v162 offset:0
ds_read_b64_tr_b16 a[34:35], v162 offset:1024
ds_read_b64_tr_b16 a[36:37], v163 offset:0
ds_read_b64_tr_b16 a[38:39], v163 offset:1024
ds_read_b64_tr_b16 a[40:41], v162 offset:4096
ds_read_b64_tr_b16 a[42:43], v162 offset:5120
ds_read_b64_tr_b16 a[44:45], v163 offset:4096
ds_read_b64_tr_b16 a[46:47], v163 offset:5120
ds_read_b64_tr_b16 a[48:49], v162 offset:8192
ds_read_b64_tr_b16 a[50:51], v162 offset:9216
ds_read_b64_tr_b16 a[52:53], v163 offset:8192
ds_read_b64_tr_b16 a[54:55], v163 offset:9216
ds_read_b64_tr_b16 a[56:57], v167 offset:0
ds_read_b64_tr_b16 a[58:59], v167 offset:1024
ds_read_b64_tr_b16 a[60:61], v168 offset:0
ds_read_b64_tr_b16 a[62:63], v168 offset:1024
ds_read_b64_tr_b16 a[64:65], v167 offset:4096
ds_read_b64_tr_b16 a[66:67], v167 offset:5120
ds_read_b64_tr_b16 a[68:69], v168 offset:4096
ds_read_b64_tr_b16 a[70:71], v168 offset:5120
s_waitcnt vmcnt(4) lgkmcnt(0)
s_barrier
s_setprio 3
v_mfma_f32_16x16x32_bf16 v[64:67], a[32:35], a[0:3], 0
ds_read_b128 a[16:19], v161 offset:0
v_mfma_f32_16x16x32_bf16 v[72:75], a[32:35], a[4:7], 0
ds_read_b128 a[20:23], v161 offset:2048
s_add_u32 m0, s58, 32768
s_add_u32 s53, s53, 229376
buffer_load_dwordx4 v164, s[16:19], s48 offen lds
v_mfma_f32_16x16x32_bf16 v[80:83], a[32:35], a[8:11], 0
ds_read_b128 a[24:27], v161 offset:4096
v_mfma_f32_16x16x32_bf16 v[88:91], a[32:35], a[12:15], 0
ds_read_b128 a[28:31], v161 offset:6144
ds_read_b64_tr_b16 a[32:33], v162 offset:12288
v_mfma_f32_16x16x32_bf16 v[68:71], a[36:39], a[0:3], 0
ds_read_b64_tr_b16 a[72:73], v167 offset:12288
ds_read_b64_tr_b16 a[34:35], v162 offset:13312
s_add_u32 m0, s58, 33792
s_add_u32 s48, s48, 128
buffer_load_dwordx4 v165, s[16:19], s49 offen lds
v_mfma_f32_16x16x32_bf16 v[76:79], a[36:39], a[4:7], 0
ds_read_b64_tr_b16 a[74:75], v167 offset:13312
v_mfma_f32_16x16x32_bf16 v[84:87], a[36:39], a[8:11], 0
ds_read_b64_tr_b16 a[76:77], v168 offset:12288
v_mfma_f32_16x16x32_bf16 v[92:95], a[36:39], a[12:15], 0
ds_read_b64_tr_b16 a[78:79], v168 offset:13312
ds_read_b64_tr_b16 a[36:37], v163 offset:12288
v_mfma_f32_16x16x32_bf16 v[32:35], a[40:43], a[0:3], 0
ds_read_b64_tr_b16 a[38:39], v163 offset:13312
s_add_u32 m0, s58, 34816
s_add_u32 s49, s49, 128
buffer_load_dwordx4 v164, s[16:19], s50 offen lds
v_mfma_f32_16x16x32_bf16 v[40:43], a[40:43], a[4:7], 0
s_setprio 2
v_mfma_f32_16x16x32_bf16 v[48:51], a[40:43], a[8:11], 0
v_mfma_f32_16x16x32_bf16 v[56:59], a[40:43], a[12:15], 0
ds_read_b64_tr_b16 a[40:41], v162 offset:16384
v_mfma_f32_16x16x32_bf16 v[36:39], a[44:47], a[0:3], 0
ds_read_b64_tr_b16 a[42:43], v162 offset:17408
s_add_u32 m0, s58, 35840
s_add_u32 s50, s50, 128
buffer_load_dwordx4 v165, s[16:19], s51 offen lds
v_mfma_f32_16x16x32_bf16 v[44:47], a[44:47], a[4:7], 0
v_mfma_f32_16x16x32_bf16 v[52:55], a[44:47], a[8:11], 0
v_mfma_f32_16x16x32_bf16 v[60:63], a[44:47], a[12:15], 0
ds_read_b64_tr_b16 a[44:45], v163 offset:16384
v_mfma_f32_16x16x32_bf16 v[0:3], a[0:3], a[48:51], 0
ds_read_b64_tr_b16 a[46:47], v163 offset:17408
s_add_u32 m0, s57, 122880
s_add_u32 s51, s51, 128
s_mov_b32 exec_hi, 0xffff
buffer_load_dwordx4 v170, s[20:23], s52 offen lds
s_mov_b32 exec_hi, -1
v_mfma_f32_16x16x32_bf16 v[4:7], a[4:7], a[48:51], 0
v_mfma_f32_16x16x32_bf16 v[8:11], a[8:11], a[48:51], 0
v_mfma_f32_16x16x32_bf16 v[12:15], a[12:15], a[48:51], 0
ds_read_b64_tr_b16 a[48:49], v162 offset:20480
s_setprio 1
v_mfma_f32_16x16x32_bf16 v[16:19], a[0:3], a[52:55], 0
ds_read_b64_tr_b16 a[50:51], v162 offset:21504
s_add_u32 m0, s57, 129024
s_mov_b32 exec_hi, 0xffff
buffer_load_dwordx4 v169, s[20:23], s52 offen lds
s_mov_b32 exec_hi, -1
v_mfma_f32_16x16x32_bf16 v[20:23], a[4:7], a[52:55], 0
v_mfma_f32_16x16x32_bf16 v[24:27], a[8:11], a[52:55], 0
v_mfma_f32_16x16x32_bf16 v[28:31], a[12:15], a[52:55], 0
ds_read_b64_tr_b16 a[52:53], v163 offset:20480
s_add_u32 m0, s62, 81920
s_add_u32 s52, s52, 196608
buffer_load_dwordx4 v166, s[28:31], s53 offen lds
v_mfma_f32_16x16x32_bf16 v[96:99], a[56:59], a[0:3], 0
ds_read_b64_tr_b16 a[54:55], v163 offset:21504
v_mfma_f32_16x16x32_bf16 v[112:115], a[56:59], a[4:7], 0
v_mfma_f32_16x16x32_bf16 v[128:131], a[56:59], a[8:11], 0
v_mfma_f32_16x16x32_bf16 v[144:147], a[56:59], a[12:15], 0
ds_read_b64_tr_b16 a[56:57], v167 offset:8192
s_add_u32 m0, s57, 135168
s_add_u32 s53, s53, 229376
s_mov_b32 exec_hi, 0xffff
buffer_load_dwordx4 v170, s[20:23], s52 offen lds
s_mov_b32 exec_hi, -1
v_mfma_f32_16x16x32_bf16 v[100:103], a[60:63], a[0:3], 0
ds_read_b64_tr_b16 a[58:59], v167 offset:9216
v_mfma_f32_16x16x32_bf16 v[116:119], a[60:63], a[4:7], 0
s_setprio 0
v_mfma_f32_16x16x32_bf16 v[132:135], a[60:63], a[8:11], 0
v_mfma_f32_16x16x32_bf16 v[148:151], a[60:63], a[12:15], 0
ds_read_b64_tr_b16 a[60:61], v168 offset:8192
s_add_u32 m0, s57, 141312
s_mov_b32 exec_hi, 0xffff
buffer_load_dwordx4 v169, s[20:23], s52 offen lds
s_mov_b32 exec_hi, -1
v_mfma_f32_16x16x32_bf16 v[104:107], a[64:67], a[0:3], 0
ds_read_b64_tr_b16 a[62:63], v168 offset:9216
v_mfma_f32_16x16x32_bf16 v[120:123], a[64:67], a[4:7], 0
v_mfma_f32_16x16x32_bf16 v[136:139], a[64:67], a[8:11], 0
v_mfma_f32_16x16x32_bf16 v[152:155], a[64:67], a[12:15], 0
s_add_u32 m0, s62, 90112
s_add_u32 s52, s52, 196608
buffer_load_dwordx4 v166, s[28:31], s53 offen lds
v_mfma_f32_16x16x32_bf16 v[108:111], a[68:71], a[0:3], 0
v_mfma_f32_16x16x32_bf16 v[124:127], a[68:71], a[4:7], 0
v_mfma_f32_16x16x32_bf16 v[140:143], a[68:71], a[8:11], 0
v_mfma_f32_16x16x32_bf16 v[156:159], a[68:71], a[12:15], 0
s_waitcnt vmcnt(3) lgkmcnt(0)
s_barrier
s_setprio 3
v_mfma_f32_16x16x32_bf16 v[64:67], a[32:35], a[16:19], v[64:67]
ds_read_b128 a[0:3], v160 offset:32768
v_mfma_f32_16x16x32_bf16 v[72:75], a[32:35], a[20:23], v[72:75]
ds_read_b128 a[4:7], v160 offset:34816
s_add_u32 m0, s57, 98304
s_add_u32 s53, s53, 229376
s_mov_b32 exec_hi, 0xffff
buffer_load_dwordx4 v170, s[20:23], s52 offen lds
s_mov_b32 exec_hi, -1
v_mfma_f32_16x16x32_bf16 v[80:83], a[32:35], a[24:27], v[80:83]
ds_read_b128 a[8:11], v160 offset:36864
v_mfma_f32_16x16x32_bf16 v[88:91], a[32:35], a[28:31], v[88:91]
ds_read_b128 a[12:15], v160 offset:38912
ds_read_b64_tr_b16 a[32:33], v162 offset:24576
v_mfma_f32_16x16x32_bf16 v[68:71], a[36:39], a[16:19], v[68:71]
ds_read_b64_tr_b16 a[64:65], v167 offset:20480
ds_read_b64_tr_b16 a[34:35], v162 offset:25600
s_add_u32 m0, s57, 104448
s_mov_b32 exec_hi, 0xffff
buffer_load_dwordx4 v169, s[20:23], s52 offen lds
s_mov_b32 exec_hi, -1
v_mfma_f32_16x16x32_bf16 v[76:79], a[36:39], a[20:23], v[76:79]
ds_read_b64_tr_b16 a[66:67], v167 offset:21504
v_mfma_f32_16x16x32_bf16 v[84:87], a[36:39], a[24:27], v[84:87]
ds_read_b64_tr_b16 a[68:69], v168 offset:20480
v_mfma_f32_16x16x32_bf16 v[92:95], a[36:39], a[28:31], v[92:95]
ds_read_b64_tr_b16 a[70:71], v168 offset:21504
ds_read_b64_tr_b16 a[36:37], v163 offset:24576
s_add_u32 m0, s62, 65536
s_add_u32 s52, s52, 196608
buffer_load_dwordx4 v166, s[28:31], s53 offen lds
v_mfma_f32_16x16x32_bf16 v[32:35], a[40:43], a[16:19], v[32:35]
ds_read_b64_tr_b16 a[38:39], v163 offset:25600
v_mfma_f32_16x16x32_bf16 v[40:43], a[40:43], a[20:23], v[40:43]
s_setprio 2
v_mfma_f32_16x16x32_bf16 v[48:51], a[40:43], a[24:27], v[48:51]
v_mfma_f32_16x16x32_bf16 v[56:59], a[40:43], a[28:31], v[56:59]
ds_read_b64_tr_b16 a[40:41], v162 offset:28672
s_add_u32 m0, s58, 0
s_add_u32 s53, s53, 229376
buffer_load_dwordx4 v164, s[16:19], s48 offen lds
v_mfma_f32_16x16x32_bf16 v[36:39], a[44:47], a[16:19], v[36:39]
ds_read_b64_tr_b16 a[42:43], v162 offset:29696
v_mfma_f32_16x16x32_bf16 v[44:47], a[44:47], a[20:23], v[44:47]
v_mfma_f32_16x16x32_bf16 v[52:55], a[44:47], a[24:27], v[52:55]
s_add_u32 m0, s58, 1024
s_add_u32 s48, s48, 128
buffer_load_dwordx4 v165, s[16:19], s49 offen lds
v_mfma_f32_16x16x32_bf16 v[60:63], a[44:47], a[28:31], v[60:63]
ds_read_b64_tr_b16 a[44:45], v163 offset:28672
v_mfma_f32_16x16x32_bf16 v[0:3], a[16:19], a[48:51], v[0:3]
ds_read_b64_tr_b16 a[46:47], v163 offset:29696
v_mfma_f32_16x16x32_bf16 v[4:7], a[20:23], a[48:51], v[4:7]
v_mfma_f32_16x16x32_bf16 v[8:11], a[24:27], a[48:51], v[8:11]
s_add_u32 m0, s58, 2048
s_add_u32 s49, s49, 128
buffer_load_dwordx4 v164, s[16:19], s50 offen lds
v_mfma_f32_16x16x32_bf16 v[12:15], a[28:31], a[48:51], v[12:15]
ds_read_b64_tr_b16 a[48:49], v162 offset:32768
s_setprio 1
v_mfma_f32_16x16x32_bf16 v[16:19], a[16:19], a[52:55], v[16:19]
ds_read_b64_tr_b16 a[50:51], v162 offset:33792
v_mfma_f32_16x16x32_bf16 v[20:23], a[20:23], a[52:55], v[20:23]
s_add_u32 m0, s58, 3072
s_add_u32 s50, s50, 128
buffer_load_dwordx4 v165, s[16:19], s51 offen lds
v_mfma_f32_16x16x32_bf16 v[24:27], a[24:27], a[52:55], v[24:27]
v_mfma_f32_16x16x32_bf16 v[28:31], a[28:31], a[52:55], v[28:31]
ds_read_b64_tr_b16 a[52:53], v163 offset:32768
v_mfma_f32_16x16x32_bf16 v[96:99], a[56:59], a[16:19], v[96:99]
ds_read_b64_tr_b16 a[54:55], v163 offset:33792
v_mfma_f32_16x16x32_bf16 v[112:115], a[56:59], a[20:23], v[112:115]
s_add_u32 m0, s57, 110592
s_add_u32 s51, s51, 128
s_mov_b32 exec_hi, 0xffff
buffer_load_dwordx4 v170, s[20:23], s52 offen lds
s_mov_b32 exec_hi, -1
v_mfma_f32_16x16x32_bf16 v[128:131], a[56:59], a[24:27], v[128:131]
v_mfma_f32_16x16x32_bf16 v[144:147], a[56:59], a[28:31], v[144:147]
ds_read_b64_tr_b16 a[56:57], v167 offset:16384
v_mfma_f32_16x16x32_bf16 v[100:103], a[60:63], a[16:19], v[100:103]
ds_read_b64_tr_b16 a[58:59], v167 offset:17408
s_add_u32 m0, s57, 116736
s_mov_b32 exec_hi, 0xffff
buffer_load_dwordx4 v169, s[20:23], s52 offen lds
s_mov_b32 exec_hi, -1
v_mfma_f32_16x16x32_bf16 v[116:119], a[60:63], a[20:23], v[116:119]
s_setprio 0
v_mfma_f32_16x16x32_bf16 v[132:135], a[60:63], a[24:27], v[132:135]
v_mfma_f32_16x16x32_bf16 v[148:151], a[60:63], a[28:31], v[148:151]
ds_read_b64_tr_b16 a[60:61], v168 offset:16384
v_mfma_f32_16x16x32_bf16 v[104:107], a[72:75], a[16:19], v[104:107]
ds_read_b64_tr_b16 a[62:63], v168 offset:17408
s_add_u32 m0, s62, 73728
s_add_u32 s52, s52, 196608
buffer_load_dwordx4 v166, s[28:31], s53 offen lds
v_mfma_f32_16x16x32_bf16 v[120:123], a[72:75], a[20:23], v[120:123]
v_mfma_f32_16x16x32_bf16 v[136:139], a[72:75], a[24:27], v[136:139]
v_mfma_f32_16x16x32_bf16 v[152:155], a[72:75], a[28:31], v[152:155]
v_lshlrev_b32 v173, 3, v171
s_cmp_lg_u32 s87, 0
s_cbranch_scc1 k1_kernel_a_1
s_mov_b32 m0, 155648
s_nop 0
buffer_load_dword v173, s[32:35], s76 offen lds
k1_kernel_a_1:
s_add_u32 s76, s76, s59
v_mfma_f32_16x16x32_bf16 v[108:111], a[76:79], a[16:19], v[108:111]
v_mfma_f32_16x16x32_bf16 v[124:127], a[76:79], a[20:23], v[124:127]
v_mfma_f32_16x16x32_bf16 v[140:143], a[76:79], a[24:27], v[140:143]
v_mfma_f32_16x16x32_bf16 v[156:159], a[76:79], a[28:31], v[156:159]
s_waitcnt vmcnt(10) lgkmcnt(0)
s_barrier
s_setprio 3
v_mfma_f32_16x16x32_bf16 v[64:67], a[32:35], a[0:3], v[64:67]
ds_read_b128 a[16:19], v161 offset:32768
v_mfma_f32_16x16x32_bf16 v[72:75], a[32:35], a[4:7], v[72:75]
ds_read_b128 a[20:23], v161 offset:34816
s_add_u32 m0, s57, 122880
s_add_u32 s53, s53, 229376
s_mov_b32 exec_hi, 0xffff
buffer_load_dwordx4 v170, s[20:23], s52 offen lds
s_mov_b32 exec_hi, -1
v_mfma_f32_16x16x32_bf16 v[80:83], a[32:35], a[8:11], v[80:83]
ds_read_b128 a[24:27], v161 offset:36864
v_mfma_f32_16x16x32_bf16 v[88:91], a[32:35], a[12:15], v[88:91]
ds_read_b128 a[28:31], v161 offset:38912
ds_read_b64_tr_b16 a[32:33], v162 offset:36864
v_mfma_f32_16x16x32_bf16 v[68:71], a[36:39], a[0:3], v[68:71]
ds_read_b64_tr_b16 a[72:73], v167 offset:28672
ds_read_b64_tr_b16 a[34:35], v162 offset:37888
v_mfma_f32_16x16x32_bf16 v[76:79], a[36:39], a[4:7], v[76:79]
ds_read_b64_tr_b16 a[74:75], v167 offset:29696
v_mfma_f32_16x16x32_bf16 v[84:87], a[36:39], a[8:11], v[84:87]
ds_read_b64_tr_b16 a[76:77], v168 offset:28672
v_mfma_f32_16x16x32_bf16 v[92:95], a[36:39], a[12:15], v[92:95]
ds_read_b64_tr_b16 a[78:79], v168 offset:29696
ds_read_b64_tr_b16 a[36:37], v163 offset:36864
v_mfma_f32_16x16x32_bf16 v[32:35], a[40:43], a[0:3], v[32:35]
ds_read_b64_tr_b16 a[38:39], v163 offset:37888
v_mfma_f32_16x16x32_bf16 v[40:43], a[40:43], a[4:7], v[40:43]
s_setprio 2
v_mfma_f32_16x16x32_bf16 v[48:51], a[40:43], a[8:11], v[48:51]
v_mfma_f32_16x16x32_bf16 v[56:59], a[40:43], a[12:15], v[56:59]
ds_read_b64_tr_b16 a[40:41], v162 offset:40960
v_mfma_f32_16x16x32_bf16 v[36:39], a[44:47], a[0:3], v[36:39]
ds_read_b64_tr_b16 a[42:43], v162 offset:41984
v_mfma_f32_16x16x32_bf16 v[44:47], a[44:47], a[4:7], v[44:47]
s_add_u32 m0, s57, 129024
s_mov_b32 exec_hi, 0xffff
buffer_load_dwordx4 v169, s[20:23], s52 offen lds
s_mov_b32 exec_hi, -1
v_mfma_f32_16x16x32_bf16 v[52:55], a[44:47], a[8:11], v[52:55]
v_mfma_f32_16x16x32_bf16 v[60:63], a[44:47], a[12:15], v[60:63]
ds_read_b64_tr_b16 a[44:45], v163 offset:40960
v_mfma_f32_16x16x32_bf16 v[0:3], a[0:3], a[48:51], v[0:3]
ds_read_b64_tr_b16 a[46:47], v163 offset:41984
v_mfma_f32_16x16x32_bf16 v[4:7], a[4:7], a[48:51], v[4:7]
v_mfma_f32_16x16x32_bf16 v[8:11], a[8:11], a[48:51], v[8:11]
v_mfma_f32_16x16x32_bf16 v[12:15], a[12:15], a[48:51], v[12:15]
ds_read_b64_tr_b16 a[48:49], v162 offset:45056
s_setprio 1
v_mfma_f32_16x16x32_bf16 v[16:19], a[0:3], a[52:55], v[16:19]
ds_read_b64_tr_b16 a[50:51], v162 offset:46080
v_mfma_f32_16x16x32_bf16 v[20:23], a[4:7], a[52:55], v[20:23]
v_mfma_f32_16x16x32_bf16 v[24:27], a[8:11], a[52:55], v[24:27]
v_mfma_f32_16x16x32_bf16 v[28:31], a[12:15], a[52:55], v[28:31]
ds_read_b64_tr_b16 a[52:53], v163 offset:45056
v_mfma_f32_16x16x32_bf16 v[96:99], a[56:59], a[0:3], v[96:99]
ds_read_b64_tr_b16 a[54:55], v163 offset:46080
v_mfma_f32_16x16x32_bf16 v[112:115], a[56:59], a[4:7], v[112:115]
v_mfma_f32_16x16x32_bf16 v[128:131], a[56:59], a[8:11], v[128:131]
s_add_u32 m0, s62, 81920
s_add_u32 s52, s52, 196608
buffer_load_dwordx4 v166, s[28:31], s53 offen lds
v_mfma_f32_16x16x32_bf16 v[144:147], a[56:59], a[12:15], v[144:147]
ds_read_b64_tr_b16 a[56:57], v167 offset:24576
v_mfma_f32_16x16x32_bf16 v[100:103], a[60:63], a[0:3], v[100:103]
ds_read_b64_tr_b16 a[58:59], v167 offset:25600
v_mfma_f32_16x16x32_bf16 v[116:119], a[60:63], a[4:7], v[116:119]
s_setprio 0
v_mfma_f32_16x16x32_bf16 v[132:135], a[60:63], a[8:11], v[132:135]
v_mfma_f32_16x16x32_bf16 v[148:151], a[60:63], a[12:15], v[148:151]
ds_read_b64_tr_b16 a[60:61], v168 offset:24576
v_mfma_f32_16x16x32_bf16 v[104:107], a[64:67], a[0:3], v[104:107]
ds_read_b64_tr_b16 a[62:63], v168 offset:25600
v_mfma_f32_16x16x32_bf16 v[120:123], a[64:67], a[4:7], v[120:123]
v_mfma_f32_16x16x32_bf16 v[136:139], a[64:67], a[8:11], v[136:139]
v_mfma_f32_16x16x32_bf16 v[152:155], a[64:67], a[12:15], v[152:155]
v_mfma_f32_16x16x32_bf16 v[108:111], a[68:71], a[0:3], v[108:111]
v_mfma_f32_16x16x32_bf16 v[124:127], a[68:71], a[4:7], v[124:127]
v_mfma_f32_16x16x32_bf16 v[140:143], a[68:71], a[8:11], v[140:143]
v_mfma_f32_16x16x32_bf16 v[156:159], a[68:71], a[12:15], v[156:159]
s_waitcnt vmcnt(6) lgkmcnt(0)
s_barrier
s_setprio 3
v_mfma_f32_16x16x32_bf16 v[64:67], a[32:35], a[16:19], v[64:67]
ds_read_b128 a[0:3], v160 offset:0
v_mfma_f32_16x16x32_bf16 v[72:75], a[32:35], a[20:23], v[72:75]
ds_read_b128 a[4:7], v160 offset:2048
s_add_u32 m0, s58, 32768
s_add_u32 s53, s53, 229376
buffer_load_dwordx4 v164, s[16:19], s48 offen lds
v_mfma_f32_16x16x32_bf16 v[80:83], a[32:35], a[24:27], v[80:83]
ds_read_b128 a[8:11], v160 offset:4096
v_mfma_f32_16x16x32_bf16 v[88:91], a[32:35], a[28:31], v[88:91]
ds_read_b128 a[12:15], v160 offset:6144
ds_read_b64_tr_b16 a[32:33], v162 offset:0
v_mfma_f32_16x16x32_bf16 v[68:71], a[36:39], a[16:19], v[68:71]
ds_read_b64_tr_b16 a[64:65], v167 offset:4096
ds_read_b64_tr_b16 a[34:35], v162 offset:1024
v_mfma_f32_16x16x32_bf16 v[76:79], a[36:39], a[20:23], v[76:79]
ds_read_b64_tr_b16 a[66:67], v167 offset:5120
v_mfma_f32_16x16x32_bf16 v[84:87], a[36:39], a[24:27], v[84:87]
ds_read_b64_tr_b16 a[68:69], v168 offset:4096
s_add_u32 m0, s58, 33792
s_add_u32 s48, s48, 128
buffer_load_dwordx4 v165, s[16:19], s49 offen lds
v_mfma_f32_16x16x32_bf16 v[92:95], a[36:39], a[28:31], v[92:95]
ds_read_b64_tr_b16 a[70:71], v168 offset:5120
ds_read_b64_tr_b16 a[36:37], v163 offset:0
v_mfma_f32_16x16x32_bf16 v[32:35], a[40:43], a[16:19], v[32:35]
ds_read_b64_tr_b16 a[38:39], v163 offset:1024
v_mfma_f32_16x16x32_bf16 v[40:43], a[40:43], a[20:23], v[40:43]
s_setprio 2
v_mfma_f32_16x16x32_bf16 v[48:51], a[40:43], a[24:27], v[48:51]
v_mfma_f32_16x16x32_bf16 v[56:59], a[40:43], a[28:31], v[56:59]
ds_read_b64_tr_b16 a[40:41], v162 offset:4096
s_add_u32 m0, s58, 34816
s_add_u32 s49, s49, 128
buffer_load_dwordx4 v164, s[16:19], s50 offen lds
v_mfma_f32_16x16x32_bf16 v[36:39], a[44:47], a[16:19], v[36:39]
ds_read_b64_tr_b16 a[42:43], v162 offset:5120
v_mfma_f32_16x16x32_bf16 v[44:47], a[44:47], a[20:23], v[44:47]
v_mfma_f32_16x16x32_bf16 v[52:55], a[44:47], a[24:27], v[52:55]
v_mfma_f32_16x16x32_bf16 v[60:63], a[44:47], a[28:31], v[60:63]
ds_read_b64_tr_b16 a[44:45], v163 offset:4096
v_mfma_f32_16x16x32_bf16 v[0:3], a[16:19], a[48:51], v[0:3]
ds_read_b64_tr_b16 a[46:47], v163 offset:5120
v_mfma_f32_16x16x32_bf16 v[4:7], a[20:23], a[48:51], v[4:7]
s_add_u32 m0, s58, 35840
s_add_u32 s50, s50, 128
buffer_load_dwordx4 v165, s[16:19], s51 offen lds
v_mfma_f32_16x16x32_bf16 v[8:11], a[24:27], a[48:51], v[8:11]
v_mfma_f32_16x16x32_bf16 v[12:15], a[28:31], a[48:51], v[12:15]
ds_read_b64_tr_b16 a[48:49], v162 offset:8192
s_setprio 1
v_mfma_f32_16x16x32_bf16 v[16:19], a[16:19], a[52:55], v[16:19]
ds_read_b64_tr_b16 a[50:51], v162 offset:9216
v_mfma_f32_16x16x32_bf16 v[20:23], a[20:23], a[52:55], v[20:23]
v_mfma_f32_16x16x32_bf16 v[24:27], a[24:27], a[52:55], v[24:27]
s_add_u32 m0, s57, 135168
s_add_u32 s51, s51, 128
s_mov_b32 exec_hi, 0xffff
buffer_load_dwordx4 v170, s[20:23], s52 offen lds
s_mov_b32 exec_hi, -1
v_mfma_f32_16x16x32_bf16 v[28:31], a[28:31], a[52:55], v[28:31]
ds_read_b64_tr_b16 a[52:53], v163 offset:8192
v_mfma_f32_16x16x32_bf16 v[96:99], a[56:59], a[16:19], v[96:99]
ds_read_b64_tr_b16 a[54:55], v163 offset:9216
v_mfma_f32_16x16x32_bf16 v[112:115], a[56:59], a[20:23], v[112:115]
v_mfma_f32_16x16x32_bf16 v[128:131], a[56:59], a[24:27], v[128:131]
v_mfma_f32_16x16x32_bf16 v[144:147], a[56:59], a[28:31], v[144:147]
ds_read_b64_tr_b16 a[56:57], v167 offset:0
v_mfma_f32_16x16x32_bf16 v[100:103], a[60:63], a[16:19], v[100:103]
ds_read_b64_tr_b16 a[58:59], v167 offset:1024
s_add_u32 m0, s57, 141312
s_mov_b32 exec_hi, 0xffff
buffer_load_dwordx4 v169, s[20:23], s52 offen lds
s_mov_b32 exec_hi, -1
v_mfma_f32_16x16x32_bf16 v[116:119], a[60:63], a[20:23], v[116:119]
s_setprio 0
v_mfma_f32_16x16x32_bf16 v[132:135], a[60:63], a[24:27], v[132:135]
v_mfma_f32_16x16x32_bf16 v[148:151], a[60:63], a[28:31], v[148:151]
ds_read_b64_tr_b16 a[60:61], v168 offset:0
v_mfma_f32_16x16x32_bf16 v[104:107], a[72:75], a[16:19], v[104:107]
ds_read_b64_tr_b16 a[62:63], v168 offset:1024
v_mfma_f32_16x16x32_bf16 v[120:123], a[72:75], a[20:23], v[120:123]
s_add_u32 m0, s62, 90112
s_add_u32 s52, s52, 196608
buffer_load_dwordx4 v166, s[28:31], s53 offen lds
v_mfma_f32_16x16x32_bf16 v[136:139], a[72:75], a[24:27], v[136:139]
v_mfma_f32_16x16x32_bf16 v[152:155], a[72:75], a[28:31], v[152:155]
v_mfma_f32_16x16x32_bf16 v[108:111], a[76:79], a[16:19], v[108:111]
v_mfma_f32_16x16x32_bf16 v[124:127], a[76:79], a[20:23], v[124:127]
v_mfma_f32_16x16x32_bf16 v[140:143], a[76:79], a[24:27], v[140:143]
v_mfma_f32_16x16x32_bf16 v[156:159], a[76:79], a[28:31], v[156:159]
s_waitcnt vmcnt(10) lgkmcnt(0)
s_barrier
s_setprio 3
v_mfma_f32_16x16x32_bf16 v[64:67], a[32:35], a[0:3], v[64:67]
ds_read_b128 a[16:19], v161 offset:0
v_mfma_f32_16x16x32_bf16 v[72:75], a[32:35], a[4:7], v[72:75]
ds_read_b128 a[20:23], v161 offset:2048
s_add_u32 m0, s57, 98304
s_add_u32 s53, s53, 229376
s_mov_b32 exec_hi, 0xffff
buffer_load_dwordx4 v170, s[20:23], s52 offen lds
s_mov_b32 exec_hi, -1
v_mfma_f32_16x16x32_bf16 v[80:83], a[32:35], a[8:11], v[80:83]
ds_read_b128 a[24:27], v161 offset:4096
v_mfma_f32_16x16x32_bf16 v[88:91], a[32:35], a[12:15], v[88:91]
ds_read_b128 a[28:31], v161 offset:6144
ds_read_b64_tr_b16 a[32:33], v162 offset:12288
v_mfma_f32_16x16x32_bf16 v[68:71], a[36:39], a[0:3], v[68:71]
ds_read_b64_tr_b16 a[72:73], v167 offset:12288
ds_read_b64_tr_b16 a[34:35], v162 offset:13312
v_mfma_f32_16x16x32_bf16 v[76:79], a[36:39], a[4:7], v[76:79]
ds_read_b64_tr_b16 a[74:75], v167 offset:13312
v_mfma_f32_16x16x32_bf16 v[84:87], a[36:39], a[8:11], v[84:87]
ds_read_b64_tr_b16 a[76:77], v168 offset:12288
v_mfma_f32_16x16x32_bf16 v[92:95], a[36:39], a[12:15], v[92:95]
ds_read_b64_tr_b16 a[78:79], v168 offset:13312
ds_read_b64_tr_b16 a[36:37], v163 offset:12288
v_mfma_f32_16x16x32_bf16 v[32:35], a[40:43], a[0:3], v[32:35]
ds_read_b64_tr_b16 a[38:39], v163 offset:13312
v_mfma_f32_16x16x32_bf16 v[40:43], a[40:43], a[4:7], v[40:43]
s_setprio 2
v_mfma_f32_16x16x32_bf16 v[48:51], a[40:43], a[8:11], v[48:51]
s_add_u32 m0, s57, 104448
s_mov_b32 exec_hi, 0xffff
buffer_load_dwordx4 v169, s[20:23], s52 offen lds
s_mov_b32 exec_hi, -1
v_mfma_f32_16x16x32_bf16 v[56:59], a[40:43], a[12:15], v[56:59]
ds_read_b64_tr_b16 a[40:41], v162 offset:16384
v_mfma_f32_16x16x32_bf16 v[36:39], a[44:47], a[0:3], v[36:39]
ds_read_b64_tr_b16 a[42:43], v162 offset:17408
v_mfma_f32_16x16x32_bf16 v[44:47], a[44:47], a[4:7], v[44:47]
v_mfma_f32_16x16x32_bf16 v[52:55], a[44:47], a[8:11], v[52:55]
v_mfma_f32_16x16x32_bf16 v[60:63], a[44:47], a[12:15], v[60:63]
ds_read_b64_tr_b16 a[44:45], v163 offset:16384
v_mfma_f32_16x16x32_bf16 v[0:3], a[0:3], a[48:51], v[0:3]
ds_read_b64_tr_b16 a[46:47], v163 offset:17408
v_mfma_f32_16x16x32_bf16 v[4:7], a[4:7], a[48:51], v[4:7]
v_mfma_f32_16x16x32_bf16 v[8:11], a[8:11], a[48:51], v[8:11]
v_mfma_f32_16x16x32_bf16 v[12:15], a[12:15], a[48:51], v[12:15]
ds_read_b64_tr_b16 a[48:49], v162 offset:20480
s_setprio 1
v_mfma_f32_16x16x32_bf16 v[16:19], a[0:3], a[52:55], v[16:19]
ds_read_b64_tr_b16 a[50:51], v162 offset:21504
s_add_u32 m0, s62, 65536
s_add_u32 s52, s52, 196608
buffer_load_dwordx4 v166, s[28:31], s53 offen lds
v_mfma_f32_16x16x32_bf16 v[20:23], a[4:7], a[52:55], v[20:23]
v_mfma_f32_16x16x32_bf16 v[24:27], a[8:11], a[52:55], v[24:27]
v_mfma_f32_16x16x32_bf16 v[28:31], a[12:15], a[52:55], v[28:31]
ds_read_b64_tr_b16 a[52:53], v163 offset:20480
v_mfma_f32_16x16x32_bf16 v[96:99], a[56:59], a[0:3], v[96:99]
ds_read_b64_tr_b16 a[54:55], v163 offset:21504
v_mfma_f32_16x16x32_bf16 v[112:115], a[56:59], a[4:7], v[112:115]
v_mfma_f32_16x16x32_bf16 v[128:131], a[56:59], a[8:11], v[128:131]
v_mfma_f32_16x16x32_bf16 v[144:147], a[56:59], a[12:15], v[144:147]
ds_read_b64_tr_b16 a[56:57], v167 offset:8192
v_mfma_f32_16x16x32_bf16 v[100:103], a[60:63], a[0:3], v[100:103]
ds_read_b64_tr_b16 a[58:59], v167 offset:9216
v_mfma_f32_16x16x32_bf16 v[116:119], a[60:63], a[4:7], v[116:119]
s_cmp_lg_u32 s87, 1
s_cbranch_scc1 k1_kernel_a_2
s_mov_b32 m0, 155648
s_nop 0
buffer_load_dword v173, s[32:35], s76 offen lds
k1_kernel_a_2:
s_add_u32 s76, s76, s59
s_setprio 0
v_mfma_f32_16x16x32_bf16 v[132:135], a[60:63], a[8:11], v[132:135]
v_mfma_f32_16x16x32_bf16 v[148:151], a[60:63], a[12:15], v[148:151]
ds_read_b64_tr_b16 a[60:61], v168 offset:8192
v_mfma_f32_16x16x32_bf16 v[104:107], a[64:67], a[0:3], v[104:107]
ds_read_b64_tr_b16 a[62:63], v168 offset:9216
v_mfma_f32_16x16x32_bf16 v[120:123], a[64:67], a[4:7], v[120:123]
v_mfma_f32_16x16x32_bf16 v[136:139], a[64:67], a[8:11], v[136:139]
v_mfma_f32_16x16x32_bf16 v[152:155], a[64:67], a[12:15], v[152:155]
v_mfma_f32_16x16x32_bf16 v[108:111], a[68:71], a[0:3], v[108:111]
v_mfma_f32_16x16x32_bf16 v[124:127], a[68:71], a[4:7], v[124:127]
v_mfma_f32_16x16x32_bf16 v[140:143], a[68:71], a[8:11], v[140:143]
v_mfma_f32_16x16x32_bf16 v[156:159], a[68:71], a[12:15], v[156:159]
s_waitcnt vmcnt(6) lgkmcnt(0)
s_barrier
s_setprio 3
v_mfma_f32_16x16x32_bf16 v[64:67], a[32:35], a[16:19], v[64:67]
ds_read_b128 a[0:3], v160 offset:32768
v_mfma_f32_16x16x32_bf16 v[72:75], a[32:35], a[20:23], v[72:75]
ds_read_b128 a[4:7], v160 offset:34816
s_add_u32 m0, s58, 0
s_add_u32 s53, s53, 229376
buffer_load_dwordx4 v164, s[16:19], s48 offen lds
v_mfma_f32_16x16x32_bf16 v[80:83], a[32:35], a[24:27], v[80:83]
ds_read_b128 a[8:11], v160 offset:36864
v_mfma_f32_16x16x32_bf16 v[88:91], a[32:35], a[28:31], v[88:91]
ds_read_b128 a[12:15], v160 offset:38912
ds_read_b64_tr_b16 a[32:33], v162 offset:24576
v_mfma_f32_16x16x32_bf16 v[68:71], a[36:39], a[16:19], v[68:71]
ds_read_b64_tr_b16 a[64:65], v167 offset:20480
ds_read_b64_tr_b16 a[34:35], v162 offset:25600
v_mfma_f32_16x16x32_bf16 v[76:79], a[36:39], a[20:23], v[76:79]
ds_read_b64_tr_b16 a[66:67], v167 offset:21504
v_mfma_f32_16x16x32_bf16 v[84:87], a[36:39], a[24:27], v[84:87]
ds_read_b64_tr_b16 a[68:69], v168 offset:20480
s_add_u32 m0, s58, 1024
s_add_u32 s48, s48, 128
buffer_load_dwordx4 v165, s[16:19], s49 offen lds
v_mfma_f32_16x16x32_bf16 v[92:95], a[36:39], a[28:31], v[92:95]
ds_read_b64_tr_b16 a[70:71], v168 offset:21504
ds_read_b64_tr_b16 a[36:37], v163 offset:24576
v_mfma_f32_16x16x32_bf16 v[32:35], a[40:43], a[16:19], v[32:35]
ds_read_b64_tr_b16 a[38:39], v163 offset:25600
v_mfma_f32_16x16x32_bf16 v[40:43], a[40:43], a[20:23], v[40:43]
s_setprio 2
v_mfma_f32_16x16x32_bf16 v[48:51], a[40:43], a[24:27], v[48:51]
v_mfma_f32_16x16x32_bf16 v[56:59], a[40:43], a[28:31], v[56:59]
ds_read_b64_tr_b16 a[40:41], v162 offset:28672
s_add_u32 m0, s58, 2048
s_add_u32 s49, s49, 128
buffer_load_dwordx4 v164, s[16:19], s50 offen lds
v_mfma_f32_16x16x32_bf16 v[36:39], a[44:47], a[16:19], v[36:39]
ds_read_b64_tr_b16 a[42:43], v162 offset:29696
v_mfma_f32_16x16x32_bf16 v[44:47], a[44:47], a[20:23], v[44:47]
v_mfma_f32_16x16x32_bf16 v[52:55], a[44:47], a[24:27], v[52:55]
v_mfma_f32_16x16x32_bf16 v[60:63], a[44:47], a[28:31], v[60:63]
ds_read_b64_tr_b16 a[44:45], v163 offset:28672
v_mfma_f32_16x16x32_bf16 v[0:3], a[16:19], a[48:51], v[0:3]
ds_read_b64_tr_b16 a[46:47], v163 offset:29696
v_mfma_f32_16x16x32_bf16 v[4:7], a[20:23], a[48:51], v[4:7]
s_add_u32 m0, s58, 3072
s_add_u32 s50, s50, 128
buffer_load_dwordx4 v165, s[16:19], s51 offen lds
v_mfma_f32_16x16x32_bf16 v[8:11], a[24:27], a[48:51], v[8:11]
v_mfma_f32_16x16x32_bf16 v[12:15], a[28:31], a[48:51], v[12:15]
ds_read_b64_tr_b16 a[48:49], v162 offset:32768
s_setprio 1
v_mfma_f32_16x16x32_bf16 v[16:19], a[16:19], a[52:55], v[16:19]
ds_read_b64_tr_b16 a[50:51], v162 offset:33792
v_mfma_f32_16x16x32_bf16 v[20:23], a[20:23], a[52:55], v[20:23]
v_mfma_f32_16x16x32_bf16 v[24:27], a[24:27], a[52:55], v[24:27]
s_add_u32 m0, s57, 110592
s_add_u32 s51, s51, 128
s_mov_b32 exec_hi, 0xffff
buffer_load_dwordx4 v170, s[20:23], s52 offen lds
s_mov_b32 exec_hi, -1
v_mfma_f32_16x16x32_bf16 v[28:31], a[28:31], a[52:55], v[28:31]
ds_read_b64_tr_b16 a[52:53], v163 offset:32768
v_mfma_f32_16x16x32_bf16 v[96:99], a[56:59], a[16:19], v[96:99]
ds_read_b64_tr_b16 a[54:55], v163 offset:33792
v_mfma_f32_16x16x32_bf16 v[112:115], a[56:59], a[20:23], v[112:115]
v_mfma_f32_16x16x32_bf16 v[128:131], a[56:59], a[24:27], v[128:131]
v_mfma_f32_16x16x32_bf16 v[144:147], a[56:59], a[28:31], v[144:147]
ds_read_b64_tr_b16 a[56:57], v167 offset:16384
v_mfma_f32_16x16x32_bf16 v[100:103], a[60:63], a[16:19], v[100:103]
ds_read_b64_tr_b16 a[58:59], v167 offset:17408
s_add_u32 m0, s57, 116736
s_mov_b32 exec_hi, 0xffff
buffer_load_dwordx4 v169, s[20:23], s52 offen lds
s_mov_b32 exec_hi, -1
v_mfma_f32_16x16x32_bf16 v[116:119], a[60:63], a[20:23], v[116:119]
s_setprio 0
v_mfma_f32_16x16x32_bf16 v[132:135], a[60:63], a[24:27], v[132:135]
v_mfma_f32_16x16x32_bf16 v[148:151], a[60:63], a[28:31], v[148:151]
ds_read_b64_tr_b16 a[60:61], v168 offset:16384
v_mfma_f32_16x16x32_bf16 v[104:107], a[72:75], a[16:19], v[104:107]
ds_read_b64_tr_b16 a[62:63], v168 offset:17408
v_mfma_f32_16x16x32_bf16 v[120:123], a[72:75], a[20:23], v[120:123]
s_add_u32 m0, s62, 73728
s_add_u32 s52, s52, 196608
buffer_load_dwordx4 v166, s[28:31], s53 offen lds
v_mfma_f32_16x16x32_bf16 v[136:139], a[72:75], a[24:27], v[136:139]
v_mfma_f32_16x16x32_bf16 v[152:155], a[72:75], a[28:31], v[152:155]
v_mfma_f32_16x16x32_bf16 v[108:111], a[76:79], a[16:19], v[108:111]
v_mfma_f32_16x16x32_bf16 v[124:127], a[76:79], a[20:23], v[124:127]
v_mfma_f32_16x16x32_bf16 v[140:143], a[76:79], a[24:27], v[140:143]
v_mfma_f32_16x16x32_bf16 v[156:159], a[76:79], a[28:31], v[156:159]
s_waitcnt vmcnt(10) lgkmcnt(0)
s_barrier
s_setprio 3
v_mfma_f32_16x16x32_bf16 v[64:67], a[32:35], a[0:3], v[64:67]
ds_read_b128 a[16:19], v161 offset:32768
v_mfma_f32_16x16x32_bf16 v[72:75], a[32:35], a[4:7], v[72:75]
ds_read_b128 a[20:23], v161 offset:34816
s_add_u32 m0, s57, 122880
s_add_u32 s53, s53, 229376
s_mov_b32 exec_hi, 0xffff
buffer_load_dwordx4 v170, s[20:23], s52 offen lds
s_mov_b32 exec_hi, -1
v_mfma_f32_16x16x32_bf16 v[80:83], a[32:35], a[8:11], v[80:83]
ds_read_b128 a[24:27], v161 offset:36864
v_mfma_f32_16x16x32_bf16 v[88:91], a[32:35], a[12:15], v[88:91]
ds_read_b128 a[28:31], v161 offset:38912
ds_read_b64_tr_b16 a[32:33], v162 offset:36864
v_mfma_f32_16x16x32_bf16 v[68:71], a[36:39], a[0:3], v[68:71]
ds_read_b64_tr_b16 a[72:73], v167 offset:28672
ds_read_b64_tr_b16 a[34:35], v162 offset:37888
v_mfma_f32_16x16x32_bf16 v[76:79], a[36:39], a[4:7], v[76:79]
ds_read_b64_tr_b16 a[74:75], v167 offset:29696
v_mfma_f32_16x16x32_bf16 v[84:87], a[36:39], a[8:11], v[84:87]
ds_read_b64_tr_b16 a[76:77], v168 offset:28672
v_mfma_f32_16x16x32_bf16 v[92:95], a[36:39], a[12:15], v[92:95]
ds_read_b64_tr_b16 a[78:79], v168 offset:29696
ds_read_b64_tr_b16 a[36:37], v163 offset:36864
v_mfma_f32_16x16x32_bf16 v[32:35], a[40:43], a[0:3], v[32:35]
ds_read_b64_tr_b16 a[38:39], v163 offset:37888
v_mfma_f32_16x16x32_bf16 v[40:43], a[40:43], a[4:7], v[40:43]
s_setprio 2
v_mfma_f32_16x16x32_bf16 v[48:51], a[40:43], a[8:11], v[48:51]
v_mfma_f32_16x16x32_bf16 v[56:59], a[40:43], a[12:15], v[56:59]
ds_read_b64_tr_b16 a[40:41], v162 offset:40960
v_mfma_f32_16x16x32_bf16 v[36:39], a[44:47], a[0:3], v[36:39]
ds_read_b64_tr_b16 a[42:43], v162 offset:41984
v_mfma_f32_16x16x32_bf16 v[44:47], a[44:47], a[4:7], v[44:47]
s_add_u32 m0, s57, 129024
s_mov_b32 exec_hi, 0xffff
buffer_load_dwordx4 v169, s[20:23], s52 offen lds
s_mov_b32 exec_hi, -1
v_mfma_f32_16x16x32_bf16 v[52:55], a[44:47], a[8:11], v[52:55]
v_mfma_f32_16x16x32_bf16 v[60:63], a[44:47], a[12:15], v[60:63]
ds_read_b64_tr_b16 a[44:45], v163 offset:40960
v_mfma_f32_16x16x32_bf16 v[0:3], a[0:3], a[48:51], v[0:3]
ds_read_b64_tr_b16 a[46:47], v163 offset:41984
v_mfma_f32_16x16x32_bf16 v[4:7], a[4:7], a[48:51], v[4:7]
v_mfma_f32_16x16x32_bf16 v[8:11], a[8:11], a[48:51], v[8:11]
v_mfma_f32_16x16x32_bf16 v[12:15], a[12:15], a[48:51], v[12:15]
ds_read_b64_tr_b16 a[48:49], v162 offset:45056
s_setprio 1
v_mfma_f32_16x16x32_bf16 v[16:19], a[0:3], a[52:55], v[16:19]
ds_read_b64_tr_b16 a[50:51], v162 offset:46080
v_mfma_f32_16x16x32_bf16 v[20:23], a[4:7], a[52:55], v[20:23]
v_mfma_f32_16x16x32_bf16 v[24:27], a[8:11], a[52:55], v[24:27]
v_mfma_f32_16x16x32_bf16 v[28:31], a[12:15], a[52:55], v[28:31]
ds_read_b64_tr_b16 a[52:53], v163 offset:45056
v_mfma_f32_16x16x32_bf16 v[96:99], a[56:59], a[0:3], v[96:99]
ds_read_b64_tr_b16 a[54:55], v163 offset:46080
v_mfma_f32_16x16x32_bf16 v[112:115], a[56:59], a[4:7], v[112:115]
v_mfma_f32_16x16x32_bf16 v[128:131], a[56:59], a[8:11], v[128:131]
s_add_u32 m0, s62, 81920
s_add_u32 s52, s52, 196608
buffer_load_dwordx4 v166, s[28:31], s53 offen lds
v_mfma_f32_16x16x32_bf16 v[144:147], a[56:59], a[12:15], v[144:147]
ds_read_b64_tr_b16 a[56:57], v167 offset:24576
v_mfma_f32_16x16x32_bf16 v[100:103], a[60:63], a[0:3], v[100:103]
ds_read_b64_tr_b16 a[58:59], v167 offset:25600
v_mfma_f32_16x16x32_bf16 v[116:119], a[60:63], a[4:7], v[116:119]
s_setprio 0
v_mfma_f32_16x16x32_bf16 v[132:135], a[60:63], a[8:11], v[132:135]
v_mfma_f32_16x16x32_bf16 v[148:151], a[60:63], a[12:15], v[148:151]
ds_read_b64_tr_b16 a[60:61], v168 offset:24576
v_mfma_f32_16x16x32_bf16 v[104:107], a[64:67], a[0:3], v[104:107]
ds_read_b64_tr_b16 a[62:63], v168 offset:25600
v_mfma_f32_16x16x32_bf16 v[120:123], a[64:67], a[4:7], v[120:123]
v_mfma_f32_16x16x32_bf16 v[136:139], a[64:67], a[8:11], v[136:139]
v_mfma_f32_16x16x32_bf16 v[152:155], a[64:67], a[12:15], v[152:155]
v_mfma_f32_16x16x32_bf16 v[108:111], a[68:71], a[0:3], v[108:111]
v_mfma_f32_16x16x32_bf16 v[124:127], a[68:71], a[4:7], v[124:127]
v_mfma_f32_16x16x32_bf16 v[140:143], a[68:71], a[8:11], v[140:143]
v_mfma_f32_16x16x32_bf16 v[156:159], a[68:71], a[12:15], v[156:159]
s_waitcnt vmcnt(6) lgkmcnt(0)
s_barrier
s_setprio 3
v_mfma_f32_16x16x32_bf16 v[64:67], a[32:35], a[16:19], v[64:67]
ds_read_b128 a[0:3], v160 offset:0
v_mfma_f32_16x16x32_bf16 v[72:75], a[32:35], a[20:23], v[72:75]
ds_read_b128 a[4:7], v160 offset:2048
s_add_u32 m0, s58, 32768
s_add_u32 s53, s53, 229376
buffer_load_dwordx4 v164, s[16:19], s48 offen lds
v_mfma_f32_16x16x32_bf16 v[80:83], a[32:35], a[24:27], v[80:83]
ds_read_b128 a[8:11], v160 offset:4096
v_mfma_f32_16x16x32_bf16 v[88:91], a[32:35], a[28:31], v[88:91]
ds_read_b128 a[12:15], v160 offset:6144
ds_read_b64_tr_b16 a[32:33], v162 offset:0
v_mfma_f32_16x16x32_bf16 v[68:71], a[36:39], a[16:19], v[68:71]
ds_read_b64_tr_b16 a[64:65], v167 offset:4096
ds_read_b64_tr_b16 a[34:35], v162 offset:1024
v_mfma_f32_16x16x32_bf16 v[76:79], a[36:39], a[20:23], v[76:79]
ds_read_b64_tr_b16 a[66:67], v167 offset:5120
s_add_u32 m0, s58, 33792
s_add_u32 s48, s48, 128
buffer_load_dwordx4 v165, s[16:19], s49 offen lds
v_mfma_f32_16x16x32_bf16 v[84:87], a[36:39], a[24:27], v[84:87]
ds_read_b64_tr_b16 a[68:69], v168 offset:4096
v_mfma_f32_16x16x32_bf16 v[92:95], a[36:39], a[28:31], v[92:95]
ds_read_b64_tr_b16 a[70:71], v168 offset:5120
ds_read_b64_tr_b16 a[36:37], v163 offset:0
v_mfma_f32_16x16x32_bf16 v[32:35], a[40:43], a[16:19], v[32:35]
ds_read_b64_tr_b16 a[38:39], v163 offset:1024
v_mfma_f32_16x16x32_bf16 v[40:43], a[40:43], a[20:23], v[40:43]
s_setprio 2
v_mfma_f32_16x16x32_bf16 v[48:51], a[40:43], a[24:27], v[48:51]
s_add_u32 m0, s58, 34816
s_add_u32 s49, s49, 128
buffer_load_dwordx4 v164, s[16:19], s50 offen lds
v_mfma_f32_16x16x32_bf16 v[56:59], a[40:43], a[28:31], v[56:59]
ds_read_b64_tr_b16 a[40:41], v162 offset:4096
v_mfma_f32_16x16x32_bf16 v[36:39], a[44:47], a[16:19], v[36:39]
ds_read_b64_tr_b16 a[42:43], v162 offset:5120
v_mfma_f32_16x16x32_bf16 v[44:47], a[44:47], a[20:23], v[44:47]
v_mfma_f32_16x16x32_bf16 v[52:55], a[44:47], a[24:27], v[52:55]
v_mfma_f32_16x16x32_bf16 v[60:63], a[44:47], a[28:31], v[60:63]
ds_read_b64_tr_b16 a[44:45], v163 offset:4096
s_add_u32 m0, s58, 35840
s_add_u32 s50, s50, 128
buffer_load_dwordx4 v165, s[16:19], s51 offen lds
v_mfma_f32_16x16x32_bf16 v[0:3], a[16:19], a[48:51], v[0:3]
ds_read_b64_tr_b16 a[46:47], v163 offset:5120
v_mfma_f32_16x16x32_bf16 v[4:7], a[20:23], a[48:51], v[4:7]
v_mfma_f32_16x16x32_bf16 v[8:11], a[24:27], a[48:51], v[8:11]
v_mfma_f32_16x16x32_bf16 v[12:15], a[28:31], a[48:51], v[12:15]
ds_read_b64_tr_b16 a[48:49], v162 offset:8192
s_setprio 1
v_mfma_f32_16x16x32_bf16 v[16:19], a[16:19], a[52:55], v[16:19]
ds_read_b64_tr_b16 a[50:51], v162 offset:9216
s_add_u32 m0, s57, 135168
s_add_u32 s51, s51, 128
s_mov_b32 exec_hi, 0xffff
buffer_load_dwordx4 v170, s[20:23], s52 offen lds
s_mov_b32 exec_hi, -1
v_mfma_f32_16x16x32_bf16 v[20:23], a[20:23], a[52:55], v[20:23]
v_mfma_f32_16x16x32_bf16 v[24:27], a[24:27], a[52:55], v[24:27]
v_mfma_f32_16x16x32_bf16 v[28:31], a[28:31], a[52:55], v[28:31]
ds_read_b64_tr_b16 a[52:53], v163 offset:8192
v_mfma_f32_16x16x32_bf16 v[96:99], a[56:59], a[16:19], v[96:99]
ds_read_b64_tr_b16 a[54:55], v163 offset:9216
s_add_u32 m0, s57, 141312
s_mov_b32 exec_hi, 0xffff
buffer_load_dwordx4 v169, s[20:23], s52 offen lds
s_mov_b32 exec_hi, -1
v_mfma_f32_16x16x32_bf16 v[112:115], a[56:59], a[20:23], v[112:115]
v_mfma_f32_16x16x32_bf16 v[128:131], a[56:59], a[24:27], v[128:131]
v_mfma_f32_16x16x32_bf16 v[144:147], a[56:59], a[28:31], v[144:147]
ds_read_b64_tr_b16 a[56:57], v167 offset:0
v_mfma_f32_16x16x32_bf16 v[100:103], a[60:63], a[16:19], v[100:103]
ds_read_b64_tr_b16 a[58:59], v167 offset:1024
v_mfma_f32_16x16x32_bf16 v[116:119], a[60:63], a[20:23], v[116:119]
s_add_u32 m0, s62, 90112
s_add_u32 s52, s52, 196608
buffer_load_dwordx4 v166, s[28:31], s53 offen lds
s_setprio 0
v_mfma_f32_16x16x32_bf16 v[132:135], a[60:63], a[24:27], v[132:135]
v_mfma_f32_16x16x32_bf16 v[148:151], a[60:63], a[28:31], v[148:151]
ds_read_b64_tr_b16 a[60:61], v168 offset:0
v_mfma_f32_16x16x32_bf16 v[104:107], a[72:75], a[16:19], v[104:107]
ds_read_b64_tr_b16 a[62:63], v168 offset:1024
v_mfma_f32_16x16x32_bf16 v[120:123], a[72:75], a[20:23], v[120:123]
v_mfma_f32_16x16x32_bf16 v[136:139], a[72:75], a[24:27], v[136:139]
s_cmp_lg_u32 s87, 2
s_cbranch_scc1 k1_kernel_a_3
s_mov_b32 m0, 155648
s_nop 0
buffer_load_dword v173, s[32:35], s76 offen lds
k1_kernel_a_3:
s_add_u32 s76, s76, s59
v_mfma_f32_16x16x32_bf16 v[152:155], a[72:75], a[28:31], v[152:155]
v_mfma_f32_16x16x32_bf16 v[108:111], a[76:79], a[16:19], v[108:111]
v_mfma_f32_16x16x32_bf16 v[124:127], a[76:79], a[20:23], v[124:127]
v_mfma_f32_16x16x32_bf16 v[140:143], a[76:79], a[24:27], v[140:143]
v_mfma_f32_16x16x32_bf16 v[156:159], a[76:79], a[28:31], v[156:159]
s_waitcnt vmcnt(10) lgkmcnt(0)
s_barrier
s_setprio 3
v_mfma_f32_16x16x32_bf16 v[64:67], a[32:35], a[0:3], v[64:67]
ds_read_b128 a[16:19], v161 offset:0
v_mfma_f32_16x16x32_bf16 v[72:75], a[32:35], a[4:7], v[72:75]
ds_read_b128 a[20:23], v161 offset:2048
s_add_u32 m0, s57, 98304
s_add_u32 s53, s53, 229376
s_mov_b32 exec_hi, 0xffff
buffer_load_dwordx4 v170, s[20:23], s52 offen lds
s_mov_b32 exec_hi, -1
v_mfma_f32_16x16x32_bf16 v[80:83], a[32:35], a[8:11], v[80:83]
ds_read_b128 a[24:27], v161 offset:4096
v_mfma_f32_16x16x32_bf16 v[88:91], a[32:35], a[12:15], v[88:91]
ds_read_b128 a[28:31], v161 offset:6144
ds_read_b64_tr_b16 a[32:33], v162 offset:12288
v_mfma_f32_16x16x32_bf16 v[68:71], a[36:39], a[0:3], v[68:71]
ds_read_b64_tr_b16 a[72:73], v167 offset:12288
ds_read_b64_tr_b16 a[34:35], v162 offset:13312
v_mfma_f32_16x16x32_bf16 v[76:79], a[36:39], a[4:7], v[76:79]
ds_read_b64_tr_b16 a[74:75], v167 offset:13312
v_mfma_f32_16x16x32_bf16 v[84:87], a[36:39], a[8:11], v[84:87]
ds_read_b64_tr_b16 a[76:77], v168 offset:12288
v_mfma_f32_16x16x32_bf16 v[92:95], a[36:39], a[12:15], v[92:95]
ds_read_b64_tr_b16 a[78:79], v168 offset:13312
ds_read_b64_tr_b16 a[36:37], v163 offset:12288
v_mfma_f32_16x16x32_bf16 v[32:35], a[40:43], a[0:3], v[32:35]
ds_read_b64_tr_b16 a[38:39], v163 offset:13312
v_mfma_f32_16x16x32_bf16 v[40:43], a[40:43], a[4:7], v[40:43]
s_setprio 2
v_mfma_f32_16x16x32_bf16 v[48:51], a[40:43], a[8:11], v[48:51]
v_mfma_f32_16x16x32_bf16 v[56:59], a[40:43], a[12:15], v[56:59]
ds_read_b64_tr_b16 a[40:41], v162 offset:16384
v_mfma_f32_16x16x32_bf16 v[36:39], a[44:47], a[0:3], v[36:39]
ds_read_b64_tr_b16 a[42:43], v162 offset:17408
v_mfma_f32_16x16x32_bf16 v[44:47], a[44:47], a[4:7], v[44:47]
s_add_u32 m0, s57, 104448
s_mov_b32 exec_hi, 0xffff
buffer_load_dwordx4 v169, s[20:23], s52 offen lds
s_mov_b32 exec_hi, -1
v_mfma_f32_16x16x32_bf16 v[52:55], a[44:47], a[8:11], v[52:55]
v_mfma_f32_16x16x32_bf16 v[60:63], a[44:47], a[12:15], v[60:63]
ds_read_b64_tr_b16 a[44:45], v163 offset:16384
v_mfma_f32_16x16x32_bf16 v[0:3], a[0:3], a[48:51], v[0:3]
ds_read_b64_tr_b16 a[46:47], v163 offset:17408
v_mfma_f32_16x16x32_bf16 v[4:7], a[4:7], a[48:51], v[4:7]
v_mfma_f32_16x16x32_bf16 v[8:11], a[8:11], a[48:51], v[8:11]
v_mfma_f32_16x16x32_bf16 v[12:15], a[12:15], a[48:51], v[12:15]
ds_read_b64_tr_b16 a[48:49], v162 offset:20480
s_setprio 1
v_mfma_f32_16x16x32_bf16 v[16:19], a[0:3], a[52:55], v[16:19]
ds_read_b64_tr_b16 a[50:51], v162 offset:21504
v_mfma_f32_16x16x32_bf16 v[20:23], a[4:7], a[52:55], v[20:23]
v_mfma_f32_16x16x32_bf16 v[24:27], a[8:11], a[52:55], v[24:27]
v_mfma_f32_16x16x32_bf16 v[28:31], a[12:15], a[52:55], v[28:31]
ds_read_b64_tr_b16 a[52:53], v163 offset:20480
v_mfma_f32_16x16x32_bf16 v[96:99], a[56:59], a[0:3], v[96:99]
ds_read_b64_tr_b16 a[54:55], v163 offset:21504
v_mfma_f32_16x16x32_bf16 v[112:115], a[56:59], a[4:7], v[112:115]
v_mfma_f32_16x16x32_bf16 v[128:131], a[56:59], a[8:11], v[128:131]
s_add_u32 m0, s62, 65536
s_add_u32 s52, s52, 196608
buffer_load_dwordx4 v166, s[28:31], s53 offen lds
v_mfma_f32_16x16x32_bf16 v[144:147], a[56:59], a[12:15], v[144:147]
ds_read_b64_tr_b16 a[56:57], v167 offset:8192
v_mfma_f32_16x16x32_bf16 v[100:103], a[60:63], a[0:3], v[100:103]
ds_read_b64_tr_b16 a[58:59], v167 offset:9216
v_mfma_f32_16x16x32_bf16 v[116:119], a[60:63], a[4:7], v[116:119]
s_setprio 0
v_mfma_f32_16x16x32_bf16 v[132:135], a[60:63], a[8:11], v[132:135]
v_mfma_f32_16x16x32_bf16 v[148:151], a[60:63], a[12:15], v[148:151]
ds_read_b64_tr_b16 a[60:61], v168 offset:8192
v_mfma_f32_16x16x32_bf16 v[104:107], a[64:67], a[0:3], v[104:107]
ds_read_b64_tr_b16 a[62:63], v168 offset:9216
v_mfma_f32_16x16x32_bf16 v[120:123], a[64:67], a[4:7], v[120:123]
v_mfma_f32_16x16x32_bf16 v[136:139], a[64:67], a[8:11], v[136:139]
v_mfma_f32_16x16x32_bf16 v[152:155], a[64:67], a[12:15], v[152:155]
v_mfma_f32_16x16x32_bf16 v[108:111], a[68:71], a[0:3], v[108:111]
v_mfma_f32_16x16x32_bf16 v[124:127], a[68:71], a[4:7], v[124:127]
v_mfma_f32_16x16x32_bf16 v[140:143], a[68:71], a[8:11], v[140:143]
v_mfma_f32_16x16x32_bf16 v[156:159], a[68:71], a[12:15], v[156:159]
s_waitcnt vmcnt(6) lgkmcnt(0)
s_barrier
s_cmp_lg_u32 s87, 0
s_cbranch_scc1 k1_kernel_a_cnt_sg
v_mov_b32 v174, 1
s_mov_b64 exec, 1
s_and_b32 s90, s2, 63
s_lshl_b32 s90, s90, 2
buffer_atomic_add v174, off, s[96:99], s90 sc1
s_mov_b64 exec, -1
k1_kernel_a_cnt_sg:
s_setprio 3
v_mfma_f32_16x16x32_bf16 v[64:67], a[32:35], a[16:19], v[64:67]
ds_read_b128 a[0:3], v160 offset:32768
v_mfma_f32_16x16x32_bf16 v[72:75], a[32:35], a[20:23], v[72:75]
ds_read_b128 a[4:7], v160 offset:34816
s_add_u32 m0, s58, 0
s_add_u32 s53, s53, 229376
buffer_load_dwordx4 v164, s[16:19], s48 offen lds
v_mfma_f32_16x16x32_bf16 v[80:83], a[32:35], a[24:27], v[80:83]
ds_read_b128 a[8:11], v160 offset:36864
v_mfma_f32_16x16x32_bf16 v[88:91], a[32:35], a[28:31], v[88:91]
ds_read_b128 a[12:15], v160 offset:38912
ds_read_b64_tr_b16 a[32:33], v162 offset:24576
v_mfma_f32_16x16x32_bf16 v[68:71], a[36:39], a[16:19], v[68:71]
ds_read_b64_tr_b16 a[64:65], v167 offset:20480
ds_read_b64_tr_b16 a[34:35], v162 offset:25600
v_mfma_f32_16x16x32_bf16 v[76:79], a[36:39], a[20:23], v[76:79]
ds_read_b64_tr_b16 a[66:67], v167 offset:21504
v_mfma_f32_16x16x32_bf16 v[84:87], a[36:39], a[24:27], v[84:87]
ds_read_b64_tr_b16 a[68:69], v168 offset:20480
s_add_u32 m0, s58, 1024
s_add_u32 s48, s48, 128
buffer_load_dwordx4 v165, s[16:19], s49 offen lds
v_mfma_f32_16x16x32_bf16 v[92:95], a[36:39], a[28:31], v[92:95]
ds_read_b64_tr_b16 a[70:71], v168 offset:21504
ds_read_b64_tr_b16 a[36:37], v163 offset:24576
v_mfma_f32_16x16x32_bf16 v[32:35], a[40:43], a[16:19], v[32:35]
ds_read_b64_tr_b16 a[38:39], v163 offset:25600
v_mfma_f32_16x16x32_bf16 v[40:43], a[40:43], a[20:23], v[40:43]
s_setprio 2
v_mfma_f32_16x16x32_bf16 v[48:51], a[40:43], a[24:27], v[48:51]
v_mfma_f32_16x16x32_bf16 v[56:59], a[40:43], a[28:31], v[56:59]
ds_read_b64_tr_b16 a[40:41], v162 offset:28672
s_add_u32 m0, s58, 2048
s_add_u32 s49, s49, 128
buffer_load_dwordx4 v164, s[16:19], s50 offen lds
v_mfma_f32_16x16x32_bf16 v[36:39], a[44:47], a[16:19], v[36:39]
ds_read_b64_tr_b16 a[42:43], v162 offset:29696
v_mfma_f32_16x16x32_bf16 v[44:47], a[44:47], a[20:23], v[44:47]
v_mfma_f32_16x16x32_bf16 v[52:55], a[44:47], a[24:27], v[52:55]
v_mfma_f32_16x16x32_bf16 v[60:63], a[44:47], a[28:31], v[60:63]
ds_read_b64_tr_b16 a[44:45], v163 offset:28672
v_mfma_f32_16x16x32_bf16 v[0:3], a[16:19], a[48:51], v[0:3]
ds_read_b64_tr_b16 a[46:47], v163 offset:29696
v_mfma_f32_16x16x32_bf16 v[4:7], a[20:23], a[48:51], v[4:7]
s_add_u32 m0, s58, 3072
s_add_u32 s50, s50, 128
buffer_load_dwordx4 v165, s[16:19], s51 offen lds
v_mfma_f32_16x16x32_bf16 v[8:11], a[24:27], a[48:51], v[8:11]
v_mfma_f32_16x16x32_bf16 v[12:15], a[28:31], a[48:51], v[12:15]
ds_read_b64_tr_b16 a[48:49], v162 offset:32768
s_setprio 1
v_mfma_f32_16x16x32_bf16 v[16:19], a[16:19], a[52:55], v[16:19]
ds_read_b64_tr_b16 a[50:51], v162 offset:33792
v_mfma_f32_16x16x32_bf16 v[20:23], a[20:23], a[52:55], v[20:23]
v_mfma_f32_16x16x32_bf16 v[24:27], a[24:27], a[52:55], v[24:27]
s_add_u32 m0, s57, 110592
s_add_u32 s51, s51, 128
s_mov_b32 exec_hi, 0xffff
buffer_load_dwordx4 v170, s[20:23], s52 offen lds
s_mov_b32 exec_hi, -1
v_mfma_f32_16x16x32_bf16 v[28:31], a[28:31], a[52:55], v[28:31]
ds_read_b64_tr_b16 a[52:53], v163 offset:32768
v_mfma_f32_16x16x32_bf16 v[96:99], a[56:59], a[16:19], v[96:99]
ds_read_b64_tr_b16 a[54:55], v163 offset:33792
v_mfma_f32_16x16x32_bf16 v[112:115], a[56:59], a[20:23], v[112:115]
v_mfma_f32_16x16x32_bf16 v[128:131], a[56:59], a[24:27], v[128:131]
v_mfma_f32_16x16x32_bf16 v[144:147], a[56:59], a[28:31], v[144:147]
ds_read_b64_tr_b16 a[56:57], v167 offset:16384
v_mfma_f32_16x16x32_bf16 v[100:103], a[60:63], a[16:19], v[100:103]
ds_read_b64_tr_b16 a[58:59], v167 offset:17408
s_add_u32 m0, s57, 116736
s_mov_b32 exec_hi, 0xffff
buffer_load_dwordx4 v169, s[20:23], s52 offen lds
s_mov_b32 exec_hi, -1
v_mfma_f32_16x16x32_bf16 v[116:119], a[60:63], a[20:23], v[116:119]
s_setprio 0
v_mfma_f32_16x16x32_bf16 v[132:135], a[60:63], a[24:27], v[132:135]
v_mfma_f32_16x16x32_bf16 v[148:151], a[60:63], a[28:31], v[148:151]
ds_read_b64_tr_b16 a[60:61], v168 offset:16384
v_mfma_f32_16x16x32_bf16 v[104:107], a[72:75], a[16:19], v[104:107]
ds_read_b64_tr_b16 a[62:63], v168 offset:17408
v_mfma_f32_16x16x32_bf16 v[120:123], a[72:75], a[20:23], v[120:123]
s_add_u32 m0, s62, 73728
s_add_u32 s52, s52, 196608
buffer_load_dwordx4 v166, s[28:31], s53 offen lds
v_mfma_f32_16x16x32_bf16 v[136:139], a[72:75], a[24:27], v[136:139]
v_mfma_f32_16x16x32_bf16 v[152:155], a[72:75], a[28:31], v[152:155]
v_mfma_f32_16x16x32_bf16 v[108:111], a[76:79], a[16:19], v[108:111]
v_mfma_f32_16x16x32_bf16 v[124:127], a[76:79], a[20:23], v[124:127]
v_mfma_f32_16x16x32_bf16 v[140:143], a[76:79], a[24:27], v[140:143]
v_mfma_f32_16x16x32_bf16 v[156:159], a[76:79], a[28:31], v[156:159]
s_waitcnt vmcnt(10) lgkmcnt(0)
s_barrier
s_setprio 3
v_mfma_f32_16x16x32_bf16 v[64:67], a[32:35], a[0:3], v[64:67]
ds_read_b128 a[16:19], v161 offset:32768
v_mfma_f32_16x16x32_bf16 v[72:75], a[32:35], a[4:7], v[72:75]
ds_read_b128 a[20:23], v161 offset:34816
s_add_u32 m0, s57, 122880
s_add_u32 s53, s53, 229376
s_mov_b32 exec_hi, 0xffff
buffer_load_dwordx4 v170, s[20:23], s52 offen lds
s_mov_b32 exec_hi, -1
v_mfma_f32_16x16x32_bf16 v[80:83], a[32:35], a[8:11], v[80:83]
ds_read_b128 a[24:27], v161 offset:36864
v_mfma_f32_16x16x32_bf16 v[88:91], a[32:35], a[12:15], v[88:91]
ds_read_b128 a[28:31], v161 offset:38912
ds_read_b64_tr_b16 a[32:33], v162 offset:36864
v_mfma_f32_16x16x32_bf16 v[68:71], a[36:39], a[0:3], v[68:71]
ds_read_b64_tr_b16 a[72:73], v167 offset:28672
ds_read_b64_tr_b16 a[34:35], v162 offset:37888
v_mfma_f32_16x16x32_bf16 v[76:79], a[36:39], a[4:7], v[76:79]
ds_read_b64_tr_b16 a[74:75], v167 offset:29696
v_mfma_f32_16x16x32_bf16 v[84:87], a[36:39], a[8:11], v[84:87]
ds_read_b64_tr_b16 a[76:77], v168 offset:28672
v_mfma_f32_16x16x32_bf16 v[92:95], a[36:39], a[12:15], v[92:95]
ds_read_b64_tr_b16 a[78:79], v168 offset:29696
ds_read_b64_tr_b16 a[36:37], v163 offset:36864
v_mfma_f32_16x16x32_bf16 v[32:35], a[40:43], a[0:3], v[32:35]
ds_read_b64_tr_b16 a[38:39], v163 offset:37888
v_mfma_f32_16x16x32_bf16 v[40:43], a[40:43], a[4:7], v[40:43]
s_setprio 2
v_mfma_f32_16x16x32_bf16 v[48:51], a[40:43], a[8:11], v[48:51]
s_add_u32 m0, s57, 129024
s_mov_b32 exec_hi, 0xffff
buffer_load_dwordx4 v169, s[20:23], s52 offen lds
s_mov_b32 exec_hi, -1
v_mfma_f32_16x16x32_bf16 v[56:59], a[40:43], a[12:15], v[56:59]
ds_read_b64_tr_b16 a[40:41], v162 offset:40960
v_mfma_f32_16x16x32_bf16 v[36:39], a[44:47], a[0:3], v[36:39]
ds_read_b64_tr_b16 a[42:43], v162 offset:41984
v_mfma_f32_16x16x32_bf16 v[44:47], a[44:47], a[4:7], v[44:47]
v_mfma_f32_16x16x32_bf16 v[52:55], a[44:47], a[8:11], v[52:55]
v_mfma_f32_16x16x32_bf16 v[60:63], a[44:47], a[12:15], v[60:63]
ds_read_b64_tr_b16 a[44:45], v163 offset:40960
v_mfma_f32_16x16x32_bf16 v[0:3], a[0:3], a[48:51], v[0:3]
ds_read_b64_tr_b16 a[46:47], v163 offset:41984
v_mfma_f32_16x16x32_bf16 v[4:7], a[4:7], a[48:51], v[4:7]
v_mfma_f32_16x16x32_bf16 v[8:11], a[8:11], a[48:51], v[8:11]
v_mfma_f32_16x16x32_bf16 v[12:15], a[12:15], a[48:51], v[12:15]
ds_read_b64_tr_b16 a[48:49], v162 offset:45056
s_setprio 1
v_mfma_f32_16x16x32_bf16 v[16:19], a[0:3], a[52:55], v[16:19]
ds_read_b64_tr_b16 a[50:51], v162 offset:46080
s_add_u32 m0, s62, 81920
s_add_u32 s52, s52, 196608
buffer_load_dwordx4 v166, s[28:31], s53 offen lds
v_mfma_f32_16x16x32_bf16 v[20:23], a[4:7], a[52:55], v[20:23]
v_mfma_f32_16x16x32_bf16 v[24:27], a[8:11], a[52:55], v[24:27]
v_mfma_f32_16x16x32_bf16 v[28:31], a[12:15], a[52:55], v[28:31]
ds_read_b64_tr_b16 a[52:53], v163 offset:45056
v_mfma_f32_16x16x32_bf16 v[96:99], a[56:59], a[0:3], v[96:99]
ds_read_b64_tr_b16 a[54:55], v163 offset:46080
v_mfma_f32_16x16x32_bf16 v[112:115], a[56:59], a[4:7], v[112:115]
v_mfma_f32_16x16x32_bf16 v[128:131], a[56:59], a[8:11], v[128:131]
v_mfma_f32_16x16x32_bf16 v[144:147], a[56:59], a[12:15], v[144:147]
ds_read_b64_tr_b16 a[56:57], v167 offset:24576
v_mfma_f32_16x16x32_bf16 v[100:103], a[60:63], a[0:3], v[100:103]
ds_read_b64_tr_b16 a[58:59], v167 offset:25600
v_mfma_f32_16x16x32_bf16 v[116:119], a[60:63], a[4:7], v[116:119]
s_cmp_lg_u32 s87, 3
s_cbranch_scc1 k1_kernel_a_4
s_mov_b32 m0, 155648
s_nop 0
buffer_load_dword v173, s[32:35], s76 offen lds
k1_kernel_a_4:
s_add_u32 s76, s76, s59
s_setprio 0
v_mfma_f32_16x16x32_bf16 v[132:135], a[60:63], a[8:11], v[132:135]
v_mfma_f32_16x16x32_bf16 v[148:151], a[60:63], a[12:15], v[148:151]
ds_read_b64_tr_b16 a[60:61], v168 offset:24576
v_mfma_f32_16x16x32_bf16 v[104:107], a[64:67], a[0:3], v[104:107]
ds_read_b64_tr_b16 a[62:63], v168 offset:25600
v_mfma_f32_16x16x32_bf16 v[120:123], a[64:67], a[4:7], v[120:123]
v_mfma_f32_16x16x32_bf16 v[136:139], a[64:67], a[8:11], v[136:139]
v_mfma_f32_16x16x32_bf16 v[152:155], a[64:67], a[12:15], v[152:155]
v_mfma_f32_16x16x32_bf16 v[108:111], a[68:71], a[0:3], v[108:111]
v_mfma_f32_16x16x32_bf16 v[124:127], a[68:71], a[4:7], v[124:127]
v_mfma_f32_16x16x32_bf16 v[140:143], a[68:71], a[8:11], v[140:143]
v_mfma_f32_16x16x32_bf16 v[156:159], a[68:71], a[12:15], v[156:159]
s_waitcnt vmcnt(6) lgkmcnt(0)
s_barrier
s_setprio 3
v_mfma_f32_16x16x32_bf16 v[64:67], a[32:35], a[16:19], v[64:67]
ds_read_b128 a[0:3], v160 offset:0
v_mfma_f32_16x16x32_bf16 v[72:75], a[32:35], a[20:23], v[72:75]
ds_read_b128 a[4:7], v160 offset:2048
s_add_u32 m0, s58, 32768
s_add_u32 s53, s53, 229376
buffer_load_dwordx4 v164, s[16:19], s48 offen lds
v_mfma_f32_16x16x32_bf16 v[80:83], a[32:35], a[24:27], v[80:83]
ds_read_b128 a[8:11], v160 offset:4096
v_mfma_f32_16x16x32_bf16 v[88:91], a[32:35], a[28:31], v[88:91]
ds_read_b128 a[12:15], v160 offset:6144
ds_read_b64_tr_b16 a[32:33], v162 offset:0
v_mfma_f32_16x16x32_bf16 v[68:71], a[36:39], a[16:19], v[68:71]
ds_read_b64_tr_b16 a[64:65], v167 offset:4096
ds_read_b64_tr_b16 a[34:35], v162 offset:1024
v_mfma_f32_16x16x32_bf16 v[76:79], a[36:39], a[20:23], v[76:79]
ds_read_b64_tr_b16 a[66:67], v167 offset:5120
v_mfma_f32_16x16x32_bf16 v[84:87], a[36:39], a[24:27], v[84:87]
ds_read_b64_tr_b16 a[68:69], v168 offset:4096
s_add_u32 m0, s58, 33792
s_add_u32 s48, s48, 128
buffer_load_dwordx4 v165, s[16:19], s49 offen lds
v_mfma_f32_16x16x32_bf16 v[92:95], a[36:39], a[28:31], v[92:95]
ds_read_b64_tr_b16 a[70:71], v168 offset:5120
ds_read_b64_tr_b16 a[36:37], v163 offset:0
v_mfma_f32_16x16x32_bf16 v[32:35], a[40:43], a[16:19], v[32:35]
ds_read_b64_tr_b16 a[38:39], v163 offset:1024
v_mfma_f32_16x16x32_bf16 v[40:43], a[40:43], a[20:23], v[40:43]
s_setprio 2
v_mfma_f32_16x16x32_bf16 v[48:51], a[40:43], a[24:27], v[48:51]
v_mfma_f32_16x16x32_bf16 v[56:59], a[40:43], a[28:31], v[56:59]
ds_read_b64_tr_b16 a[40:41], v162 offset:4096
s_add_u32 m0, s58, 34816
s_add_u32 s49, s49, 128
buffer_load_dwordx4 v164, s[16:19], s50 offen lds
v_mfma_f32_16x16x32_bf16 v[36:39], a[44:47], a[16:19], v[36:39]
ds_read_b64_tr_b16 a[42:43], v162 offset:5120
v_mfma_f32_16x16x32_bf16 v[44:47], a[44:47], a[20:23], v[44:47]
v_mfma_f32_16x16x32_bf16 v[52:55], a[44:47], a[24:27], v[52:55]
v_mfma_f32_16x16x32_bf16 v[60:63], a[44:47], a[28:31], v[60:63]
ds_read_b64_tr_b16 a[44:45], v163 offset:4096
v_mfma_f32_16x16x32_bf16 v[0:3], a[16:19], a[48:51], v[0:3]
ds_read_b64_tr_b16 a[46:47], v163 offset:5120
v_mfma_f32_16x16x32_bf16 v[4:7], a[20:23], a[48:51], v[4:7]
s_add_u32 m0, s58, 35840
s_add_u32 s50, s50, 128
buffer_load_dwordx4 v165, s[16:19], s51 offen lds
v_mfma_f32_16x16x32_bf16 v[8:11], a[24:27], a[48:51], v[8:11]
v_mfma_f32_16x16x32_bf16 v[12:15], a[28:31], a[48:51], v[12:15]
ds_read_b64_tr_b16 a[48:49], v162 offset:8192
s_setprio 1
v_mfma_f32_16x16x32_bf16 v[16:19], a[16:19], a[52:55], v[16:19]
ds_read_b64_tr_b16 a[50:51], v162 offset:9216
v_mfma_f32_16x16x32_bf16 v[20:23], a[20:23], a[52:55], v[20:23]
v_mfma_f32_16x16x32_bf16 v[24:27], a[24:27], a[52:55], v[24:27]
s_add_u32 m0, s57, 135168
s_add_u32 s51, s51, 128
s_mov_b32 exec_hi, 0xffff
buffer_load_dwordx4 v170, s[20:23], s52 offen lds
s_mov_b32 exec_hi, -1
v_mfma_f32_16x16x32_bf16 v[28:31], a[28:31], a[52:55], v[28:31]
ds_read_b64_tr_b16 a[52:53], v163 offset:8192
v_mfma_f32_16x16x32_bf16 v[96:99], a[56:59], a[16:19], v[96:99]
ds_read_b64_tr_b16 a[54:55], v163 offset:9216
v_mfma_f32_16x16x32_bf16 v[112:115], a[56:59], a[20:23], v[112:115]
v_mfma_f32_16x16x32_bf16 v[128:131], a[56:59], a[24:27], v[128:131]
v_mfma_f32_16x16x32_bf16 v[144:147], a[56:59], a[28:31], v[144:147]
ds_read_b64_tr_b16 a[56:57], v167 offset:0
v_mfma_f32_16x16x32_bf16 v[100:103], a[60:63], a[16:19], v[100:103]
ds_read_b64_tr_b16 a[58:59], v167 offset:1024
s_add_u32 m0, s57, 141312
s_mov_b32 exec_hi, 0xffff
buffer_load_dwordx4 v169, s[20:23], s52 offen lds
s_mov_b32 exec_hi, -1
v_mfma_f32_16x16x32_bf16 v[116:119], a[60:63], a[20:23], v[116:119]
s_setprio 0
v_mfma_f32_16x16x32_bf16 v[132:135], a[60:63], a[24:27], v[132:135]
v_mfma_f32_16x16x32_bf16 v[148:151], a[60:63], a[28:31], v[148:151]
ds_read_b64_tr_b16 a[60:61], v168 offset:0
v_mfma_f32_16x16x32_bf16 v[104:107], a[72:75], a[16:19], v[104:107]
ds_read_b64_tr_b16 a[62:63], v168 offset:1024
v_mfma_f32_16x16x32_bf16 v[120:123], a[72:75], a[20:23], v[120:123]
s_add_u32 m0, s62, 90112
s_add_u32 s52, s52, 196608
buffer_load_dwordx4 v166, s[28:31], s53 offen lds
v_mfma_f32_16x16x32_bf16 v[136:139], a[72:75], a[24:27], v[136:139]
v_mfma_f32_16x16x32_bf16 v[152:155], a[72:75], a[28:31], v[152:155]
v_mfma_f32_16x16x32_bf16 v[108:111], a[76:79], a[16:19], v[108:111]
v_mfma_f32_16x16x32_bf16 v[124:127], a[76:79], a[20:23], v[124:127]
v_mfma_f32_16x16x32_bf16 v[140:143], a[76:79], a[24:27], v[140:143]
v_mfma_f32_16x16x32_bf16 v[156:159], a[76:79], a[28:31], v[156:159]
s_waitcnt vmcnt(10) lgkmcnt(0)
s_barrier
s_setprio 3
v_mfma_f32_16x16x32_bf16 v[64:67], a[32:35], a[0:3], v[64:67]
ds_read_b128 a[16:19], v161 offset:0
v_mfma_f32_16x16x32_bf16 v[72:75], a[32:35], a[4:7], v[72:75]
ds_read_b128 a[20:23], v161 offset:2048
s_add_u32 m0, s57, 98304
s_add_u32 s53, s53, 2523136
s_mov_b32 exec_hi, 0xffff
buffer_load_dwordx4 v170, s[20:23], s52 offen lds
s_mov_b32 exec_hi, -1
v_mfma_f32_16x16x32_bf16 v[80:83], a[32:35], a[8:11], v[80:83]
ds_read_b128 a[24:27], v161 offset:4096
v_mfma_f32_16x16x32_bf16 v[88:91], a[32:35], a[12:15], v[88:91]
ds_read_b128 a[28:31], v161 offset:6144
ds_read_b64_tr_b16 a[32:33], v162 offset:12288
v_mfma_f32_16x16x32_bf16 v[68:71], a[36:39], a[0:3], v[68:71]
ds_read_b64_tr_b16 a[72:73], v167 offset:12288
ds_read_b64_tr_b16 a[34:35], v162 offset:13312
v_mfma_f32_16x16x32_bf16 v[76:79], a[36:39], a[4:7], v[76:79]
ds_read_b64_tr_b16 a[74:75], v167 offset:13312
v_mfma_f32_16x16x32_bf16 v[84:87], a[36:39], a[8:11], v[84:87]
ds_read_b64_tr_b16 a[76:77], v168 offset:12288
v_mfma_f32_16x16x32_bf16 v[92:95], a[36:39], a[12:15], v[92:95]
ds_read_b64_tr_b16 a[78:79], v168 offset:13312
ds_read_b64_tr_b16 a[36:37], v163 offset:12288
v_mfma_f32_16x16x32_bf16 v[32:35], a[40:43], a[0:3], v[32:35]
ds_read_b64_tr_b16 a[38:39], v163 offset:13312
v_mfma_f32_16x16x32_bf16 v[40:43], a[40:43], a[4:7], v[40:43]
s_setprio 2
v_mfma_f32_16x16x32_bf16 v[48:51], a[40:43], a[8:11], v[48:51]
v_mfma_f32_16x16x32_bf16 v[56:59], a[40:43], a[12:15], v[56:59]
ds_read_b64_tr_b16 a[40:41], v162 offset:16384
v_mfma_f32_16x16x32_bf16 v[36:39], a[44:47], a[0:3], v[36:39]
ds_read_b64_tr_b16 a[42:43], v162 offset:17408
v_mfma_f32_16x16x32_bf16 v[44:47], a[44:47], a[4:7], v[44:47]
v_mfma_f32_16x16x32_bf16 v[52:55], a[44:47], a[8:11], v[52:55]
v_mfma_f32_16x16x32_bf16 v[60:63], a[44:47], a[12:15], v[60:63]
ds_read_b64_tr_b16 a[44:45], v163 offset:16384
v_mfma_f32_16x16x32_bf16 v[0:3], a[0:3], a[48:51], v[0:3]
ds_read_b64_tr_b16 a[46:47], v163 offset:17408
v_mfma_f32_16x16x32_bf16 v[4:7], a[4:7], a[48:51], v[4:7]
v_mfma_f32_16x16x32_bf16 v[8:11], a[8:11], a[48:51], v[8:11]
v_mfma_f32_16x16x32_bf16 v[12:15], a[12:15], a[48:51], v[12:15]
ds_read_b64_tr_b16 a[48:49], v162 offset:20480
s_setprio 1
v_mfma_f32_16x16x32_bf16 v[16:19], a[0:3], a[52:55], v[16:19]
ds_read_b64_tr_b16 a[50:51], v162 offset:21504
s_add_u32 m0, s57, 104448
s_mov_b32 exec_hi, 0xffff
buffer_load_dwordx4 v169, s[20:23], s52 offen lds
s_mov_b32 exec_hi, -1
v_mfma_f32_16x16x32_bf16 v[20:23], a[4:7], a[52:55], v[20:23]
v_mfma_f32_16x16x32_bf16 v[24:27], a[8:11], a[52:55], v[24:27]
v_mfma_f32_16x16x32_bf16 v[28:31], a[12:15], a[52:55], v[28:31]
ds_read_b64_tr_b16 a[52:53], v163 offset:20480
v_mfma_f32_16x16x32_bf16 v[96:99], a[56:59], a[0:3], v[96:99]
ds_read_b64_tr_b16 a[54:55], v163 offset:21504
v_mfma_f32_16x16x32_bf16 v[112:115], a[56:59], a[4:7], v[112:115]
v_mfma_f32_16x16x32_bf16 v[128:131], a[56:59], a[8:11], v[128:131]
v_mfma_f32_16x16x32_bf16 v[144:147], a[56:59], a[12:15], v[144:147]
ds_read_b64_tr_b16 a[56:57], v167 offset:8192
v_mfma_f32_16x16x32_bf16 v[100:103], a[60:63], a[0:3], v[100:103]
ds_read_b64_tr_b16 a[58:59], v167 offset:9216
v_mfma_f32_16x16x32_bf16 v[116:119], a[60:63], a[4:7], v[116:119]
s_setprio 0
v_mfma_f32_16x16x32_bf16 v[132:135], a[60:63], a[8:11], v[132:135]
v_mfma_f32_16x16x32_bf16 v[148:151], a[60:63], a[12:15], v[148:151]
ds_read_b64_tr_b16 a[60:61], v168 offset:8192
v_mfma_f32_16x16x32_bf16 v[104:107], a[64:67], a[0:3], v[104:107]
ds_read_b64_tr_b16 a[62:63], v168 offset:9216
v_mfma_f32_16x16x32_bf16 v[120:123], a[64:67], a[4:7], v[120:123]
v_mfma_f32_16x16x32_bf16 v[136:139], a[64:67], a[8:11], v[136:139]
v_mfma_f32_16x16x32_bf16 v[152:155], a[64:67], a[12:15], v[152:155]
v_mfma_f32_16x16x32_bf16 v[108:111], a[68:71], a[0:3], v[108:111]
v_mfma_f32_16x16x32_bf16 v[124:127], a[68:71], a[4:7], v[124:127]
v_mfma_f32_16x16x32_bf16 v[140:143], a[68:71], a[8:11], v[140:143]
v_mfma_f32_16x16x32_bf16 v[156:159], a[68:71], a[12:15], v[156:159]
s_waitcnt vmcnt(5) lgkmcnt(0)
s_barrier
s_setprio 3
v_mfma_f32_16x16x32_bf16 v[64:67], a[32:35], a[16:19], v[64:67]
ds_read_b128 a[0:3], v160 offset:32768
v_mfma_f32_16x16x32_bf16 v[72:75], a[32:35], a[20:23], v[72:75]
ds_read_b128 a[4:7], v160 offset:34816
s_add_u32 m0, s58, 0
s_add_u32 s52, s52, 196608
buffer_load_dwordx4 v164, s[16:19], s48 offen lds
v_mfma_f32_16x16x32_bf16 v[80:83], a[32:35], a[24:27], v[80:83]
ds_read_b128 a[8:11], v160 offset:36864
v_mfma_f32_16x16x32_bf16 v[88:91], a[32:35], a[28:31], v[88:91]
ds_read_b128 a[12:15], v160 offset:38912
ds_read_b64_tr_b16 a[32:33], v162 offset:24576
v_mfma_f32_16x16x32_bf16 v[68:71], a[36:39], a[16:19], v[68:71]
ds_read_b64_tr_b16 a[64:65], v167 offset:20480
ds_read_b64_tr_b16 a[34:35], v162 offset:25600
v_mfma_f32_16x16x32_bf16 v[76:79], a[36:39], a[20:23], v[76:79]
ds_read_b64_tr_b16 a[66:67], v167 offset:21504
v_mfma_f32_16x16x32_bf16 v[84:87], a[36:39], a[24:27], v[84:87]
ds_read_b64_tr_b16 a[68:69], v168 offset:20480
s_add_u32 m0, s58, 1024
s_add_u32 s48, s48, 128
buffer_load_dwordx4 v165, s[16:19], s49 offen lds
v_mfma_f32_16x16x32_bf16 v[92:95], a[36:39], a[28:31], v[92:95]
ds_read_b64_tr_b16 a[70:71], v168 offset:21504
ds_read_b64_tr_b16 a[36:37], v163 offset:24576
v_mfma_f32_16x16x32_bf16 v[32:35], a[40:43], a[16:19], v[32:35]
ds_read_b64_tr_b16 a[38:39], v163 offset:25600
v_mfma_f32_16x16x32_bf16 v[40:43], a[40:43], a[20:23], v[40:43]
s_setprio 2
v_mfma_f32_16x16x32_bf16 v[48:51], a[40:43], a[24:27], v[48:51]
v_mfma_f32_16x16x32_bf16 v[56:59], a[40:43], a[28:31], v[56:59]
ds_read_b64_tr_b16 a[40:41], v162 offset:28672
s_add_u32 m0, s58, 2048
s_add_u32 s49, s49, 128
buffer_load_dwordx4 v164, s[16:19], s50 offen lds
v_mfma_f32_16x16x32_bf16 v[36:39], a[44:47], a[16:19], v[36:39]
ds_read_b64_tr_b16 a[42:43], v162 offset:29696
v_mfma_f32_16x16x32_bf16 v[44:47], a[44:47], a[20:23], v[44:47]
v_mfma_f32_16x16x32_bf16 v[52:55], a[44:47], a[24:27], v[52:55]
v_mfma_f32_16x16x32_bf16 v[60:63], a[44:47], a[28:31], v[60:63]
ds_read_b64_tr_b16 a[44:45], v163 offset:28672
v_mfma_f32_16x16x32_bf16 v[0:3], a[16:19], a[48:51], v[0:3]
ds_read_b64_tr_b16 a[46:47], v163 offset:29696
v_mfma_f32_16x16x32_bf16 v[4:7], a[20:23], a[48:51], v[4:7]
s_add_u32 m0, s58, 3072
s_add_u32 s50, s50, 128
buffer_load_dwordx4 v165, s[16:19], s51 offen lds
v_mfma_f32_16x16x32_bf16 v[8:11], a[24:27], a[48:51], v[8:11]
v_mfma_f32_16x16x32_bf16 v[12:15], a[28:31], a[48:51], v[12:15]
ds_read_b64_tr_b16 a[48:49], v162 offset:32768
s_setprio 1
v_mfma_f32_16x16x32_bf16 v[16:19], a[16:19], a[52:55], v[16:19]
ds_read_b64_tr_b16 a[50:51], v162 offset:33792
v_mfma_f32_16x16x32_bf16 v[20:23], a[20:23], a[52:55], v[20:23]
v_mfma_f32_16x16x32_bf16 v[24:27], a[24:27], a[52:55], v[24:27]
s_add_u32 m0, s57, 110592
s_add_u32 s51, s51, 128
s_mov_b32 exec_hi, 0xffff
buffer_load_dwordx4 v170, s[20:23], s52 offen lds
s_mov_b32 exec_hi, -1
v_mfma_f32_16x16x32_bf16 v[28:31], a[28:31], a[52:55], v[28:31]
ds_read_b64_tr_b16 a[52:53], v163 offset:32768
v_mfma_f32_16x16x32_bf16 v[96:99], a[56:59], a[16:19], v[96:99]
ds_read_b64_tr_b16 a[54:55], v163 offset:33792
v_mfma_f32_16x16x32_bf16 v[112:115], a[56:59], a[20:23], v[112:115]
v_mfma_f32_16x16x32_bf16 v[128:131], a[56:59], a[24:27], v[128:131]
v_mfma_f32_16x16x32_bf16 v[144:147], a[56:59], a[28:31], v[144:147]
ds_read_b64_tr_b16 a[56:57], v167 offset:16384
v_mfma_f32_16x16x32_bf16 v[100:103], a[60:63], a[16:19], v[100:103]
ds_read_b64_tr_b16 a[58:59], v167 offset:17408
s_add_u32 m0, s57, 116736
s_mov_b32 exec_hi, 0xffff
buffer_load_dwordx4 v169, s[20:23], s52 offen lds
s_mov_b32 exec_hi, -1
v_mfma_f32_16x16x32_bf16 v[116:119], a[60:63], a[20:23], v[116:119]
s_setprio 0
v_mfma_f32_16x16x32_bf16 v[132:135], a[60:63], a[24:27], v[132:135]
v_mfma_f32_16x16x32_bf16 v[148:151], a[60:63], a[28:31], v[148:151]
ds_read_b64_tr_b16 a[60:61], v168 offset:16384
v_mfma_f32_16x16x32_bf16 v[104:107], a[72:75], a[16:19], v[104:107]
ds_read_b64_tr_b16 a[62:63], v168 offset:17408
v_mfma_f32_16x16x32_bf16 v[120:123], a[72:75], a[20:23], v[120:123]
s_cmp_lg_u32 s87, 4
s_cbranch_scc1 k1_kernel_a_5
s_mov_b32 m0, 155648
s_nop 0
buffer_load_dword v173, s[32:35], s76 offen lds
k1_kernel_a_5:
s_add_u32 s76, s76, s59
v_mfma_f32_16x16x32_bf16 v[136:139], a[72:75], a[24:27], v[136:139]
v_mfma_f32_16x16x32_bf16 v[152:155], a[72:75], a[28:31], v[152:155]
v_mfma_f32_16x16x32_bf16 v[108:111], a[76:79], a[16:19], v[108:111]
v_mfma_f32_16x16x32_bf16 v[124:127], a[76:79], a[20:23], v[124:127]
v_mfma_f32_16x16x32_bf16 v[140:143], a[76:79], a[24:27], v[140:143]
v_mfma_f32_16x16x32_bf16 v[156:159], a[76:79], a[28:31], v[156:159]
s_waitcnt vmcnt(8) lgkmcnt(0)
s_barrier
s_setprio 3
v_mfma_f32_16x16x32_bf16 v[64:67], a[32:35], a[0:3], v[64:67]
ds_read_b128 a[16:19], v161 offset:32768
v_mfma_f32_16x16x32_bf16 v[72:75], a[32:35], a[4:7], v[72:75]
ds_read_b128 a[20:23], v161 offset:34816
s_add_u32 m0, s57, 122880
s_add_u32 s52, s52, 196608
s_mov_b32 exec_hi, 0xffff
buffer_load_dwordx4 v170, s[20:23], s52 offen lds
s_mov_b32 exec_hi, -1
v_mfma_f32_16x16x32_bf16 v[80:83], a[32:35], a[8:11], v[80:83]
ds_read_b128 a[24:27], v161 offset:36864
v_mfma_f32_16x16x32_bf16 v[88:91], a[32:35], a[12:15], v[88:91]
ds_read_b128 a[28:31], v161 offset:38912
ds_read_b64_tr_b16 a[32:33], v162 offset:36864
v_mfma_f32_16x16x32_bf16 v[68:71], a[36:39], a[0:3], v[68:71]
ds_read_b64_tr_b16 a[72:73], v167 offset:28672
ds_read_b64_tr_b16 a[34:35], v162 offset:37888
v_mfma_f32_16x16x32_bf16 v[76:79], a[36:39], a[4:7], v[76:79]
ds_read_b64_tr_b16 a[74:75], v167 offset:29696
v_mfma_f32_16x16x32_bf16 v[84:87], a[36:39], a[8:11], v[84:87]
ds_read_b64_tr_b16 a[76:77], v168 offset:28672
v_mfma_f32_16x16x32_bf16 v[92:95], a[36:39], a[12:15], v[92:95]
ds_read_b64_tr_b16 a[78:79], v168 offset:29696
ds_read_b64_tr_b16 a[36:37], v163 offset:36864
v_mfma_f32_16x16x32_bf16 v[32:35], a[40:43], a[0:3], v[32:35]
ds_read_b64_tr_b16 a[38:39], v163 offset:37888
v_mfma_f32_16x16x32_bf16 v[40:43], a[40:43], a[4:7], v[40:43]
s_setprio 2
v_mfma_f32_16x16x32_bf16 v[48:51], a[40:43], a[8:11], v[48:51]
v_mfma_f32_16x16x32_bf16 v[56:59], a[40:43], a[12:15], v[56:59]
ds_read_b64_tr_b16 a[40:41], v162 offset:40960
v_mfma_f32_16x16x32_bf16 v[36:39], a[44:47], a[0:3], v[36:39]
ds_read_b64_tr_b16 a[42:43], v162 offset:41984
v_mfma_f32_16x16x32_bf16 v[44:47], a[44:47], a[4:7], v[44:47]
v_mfma_f32_16x16x32_bf16 v[52:55], a[44:47], a[8:11], v[52:55]
v_mfma_f32_16x16x32_bf16 v[60:63], a[44:47], a[12:15], v[60:63]
ds_read_b64_tr_b16 a[44:45], v163 offset:40960
v_mfma_f32_16x16x32_bf16 v[0:3], a[0:3], a[48:51], v[0:3]
ds_read_b64_tr_b16 a[46:47], v163 offset:41984
v_mfma_f32_16x16x32_bf16 v[4:7], a[4:7], a[48:51], v[4:7]
v_mfma_f32_16x16x32_bf16 v[8:11], a[8:11], a[48:51], v[8:11]
v_mfma_f32_16x16x32_bf16 v[12:15], a[12:15], a[48:51], v[12:15]
ds_read_b64_tr_b16 a[48:49], v162 offset:45056
s_setprio 1
v_mfma_f32_16x16x32_bf16 v[16:19], a[0:3], a[52:55], v[16:19]
ds_read_b64_tr_b16 a[50:51], v162 offset:46080
s_add_u32 m0, s57, 129024
s_mov_b32 exec_hi, 0xffff
buffer_load_dwordx4 v169, s[20:23], s52 offen lds
s_mov_b32 exec_hi, -1
v_mfma_f32_16x16x32_bf16 v[20:23], a[4:7], a[52:55], v[20:23]
v_mfma_f32_16x16x32_bf16 v[24:27], a[8:11], a[52:55], v[24:27]
v_mfma_f32_16x16x32_bf16 v[28:31], a[12:15], a[52:55], v[28:31]
ds_read_b64_tr_b16 a[52:53], v163 offset:45056
v_mfma_f32_16x16x32_bf16 v[96:99], a[56:59], a[0:3], v[96:99]
ds_read_b64_tr_b16 a[54:55], v163 offset:46080
v_mfma_f32_16x16x32_bf16 v[112:115], a[56:59], a[4:7], v[112:115]
v_mfma_f32_16x16x32_bf16 v[128:131], a[56:59], a[8:11], v[128:131]
v_mfma_f32_16x16x32_bf16 v[144:147], a[56:59], a[12:15], v[144:147]
ds_read_b64_tr_b16 a[56:57], v167 offset:24576
v_mfma_f32_16x16x32_bf16 v[100:103], a[60:63], a[0:3], v[100:103]
ds_read_b64_tr_b16 a[58:59], v167 offset:25600
v_mfma_f32_16x16x32_bf16 v[116:119], a[60:63], a[4:7], v[116:119]
s_setprio 0
v_mfma_f32_16x16x32_bf16 v[132:135], a[60:63], a[8:11], v[132:135]
v_mfma_f32_16x16x32_bf16 v[148:151], a[60:63], a[12:15], v[148:151]
ds_read_b64_tr_b16 a[60:61], v168 offset:24576
v_mfma_f32_16x16x32_bf16 v[104:107], a[64:67], a[0:3], v[104:107]
ds_read_b64_tr_b16 a[62:63], v168 offset:25600
v_mfma_f32_16x16x32_bf16 v[120:123], a[64:67], a[4:7], v[120:123]
v_mfma_f32_16x16x32_bf16 v[136:139], a[64:67], a[8:11], v[136:139]
v_mfma_f32_16x16x32_bf16 v[152:155], a[64:67], a[12:15], v[152:155]
v_mfma_f32_16x16x32_bf16 v[108:111], a[68:71], a[0:3], v[108:111]
v_mfma_f32_16x16x32_bf16 v[124:127], a[68:71], a[4:7], v[124:127]
v_mfma_f32_16x16x32_bf16 v[140:143], a[68:71], a[8:11], v[140:143]
v_mfma_f32_16x16x32_bf16 v[156:159], a[68:71], a[12:15], v[156:159]
s_waitcnt vmcnt(4) lgkmcnt(0)
s_barrier
s_setprio 3
v_mfma_f32_16x16x32_bf16 v[64:67], a[32:35], a[16:19], v[64:67]
ds_read_b128 a[0:3], v160 offset:0
v_mfma_f32_16x16x32_bf16 v[72:75], a[32:35], a[20:23], v[72:75]
ds_read_b128 a[4:7], v160 offset:2048
s_add_u32 m0, s58, 32768
s_add_u32 s52, s52, 196608
buffer_load_dwordx4 v164, s[16:19], s48 offen lds
v_mfma_f32_16x16x32_bf16 v[80:83], a[32:35], a[24:27], v[80:83]
ds_read_b128 a[8:11], v160 offset:4096
v_mfma_f32_16x16x32_bf16 v[88:91], a[32:35], a[28:31], v[88:91]
ds_read_b128 a[12:15], v160 offset:6144
ds_read_b64_tr_b16 a[32:33], v162 offset:0
v_mfma_f32_16x16x32_bf16 v[68:71], a[36:39], a[16:19], v[68:71]
ds_read_b64_tr_b16 a[34:35], v162 offset:1024
v_mfma_f32_16x16x32_bf16 v[76:79], a[36:39], a[20:23], v[76:79]
v_mfma_f32_16x16x32_bf16 v[84:87], a[36:39], a[24:27], v[84:87]
v_mfma_f32_16x16x32_bf16 v[92:95], a[36:39], a[28:31], v[92:95]
ds_read_b64_tr_b16 a[36:37], v163 offset:0
s_add_u32 m0, s58, 33792
s_add_u32 s48, s48, 128
buffer_load_dwordx4 v165, s[16:19], s49 offen lds
v_mfma_f32_16x16x32_bf16 v[32:35], a[40:43], a[16:19], v[32:35]
ds_read_b64_tr_b16 a[38:39], v163 offset:1024
v_mfma_f32_16x16x32_bf16 v[40:43], a[40:43], a[20:23], v[40:43]
s_setprio 2
v_mfma_f32_16x16x32_bf16 v[48:51], a[40:43], a[24:27], v[48:51]
v_mfma_f32_16x16x32_bf16 v[56:59], a[40:43], a[28:31], v[56:59]
ds_read_b64_tr_b16 a[40:41], v162 offset:4096
v_mfma_f32_16x16x32_bf16 v[36:39], a[44:47], a[16:19], v[36:39]
ds_read_b64_tr_b16 a[42:43], v162 offset:5120
v_mfma_f32_16x16x32_bf16 v[44:47], a[44:47], a[20:23], v[44:47]
s_add_u32 m0, s58, 34816
s_add_u32 s49, s49, 128
buffer_load_dwordx4 v164, s[16:19], s50 offen lds
v_mfma_f32_16x16x32_bf16 v[52:55], a[44:47], a[24:27], v[52:55]
v_mfma_f32_16x16x32_bf16 v[60:63], a[44:47], a[28:31], v[60:63]
ds_read_b64_tr_b16 a[44:45], v163 offset:4096
v_mfma_f32_16x16x32_bf16 v[0:3], a[16:19], a[48:51], v[0:3]
ds_read_b64_tr_b16 a[46:47], v163 offset:5120
v_mfma_f32_16x16x32_bf16 v[4:7], a[20:23], a[48:51], v[4:7]
v_mfma_f32_16x16x32_bf16 v[8:11], a[24:27], a[48:51], v[8:11]
v_mfma_f32_16x16x32_bf16 v[12:15], a[28:31], a[48:51], v[12:15]
ds_read_b64_tr_b16 a[48:49], v162 offset:8192
s_setprio 1
v_mfma_f32_16x16x32_bf16 v[16:19], a[16:19], a[52:55], v[16:19]
ds_read_b64_tr_b16 a[50:51], v162 offset:9216
s_add_u32 m0, s58, 35840
s_add_u32 s50, s50, 128
buffer_load_dwordx4 v165, s[16:19], s51 offen lds
v_mfma_f32_16x16x32_bf16 v[20:23], a[20:23], a[52:55], v[20:23]
v_mfma_f32_16x16x32_bf16 v[24:27], a[24:27], a[52:55], v[24:27]
v_mfma_f32_16x16x32_bf16 v[28:31], a[28:31], a[52:55], v[28:31]
ds_read_b64_tr_b16 a[52:53], v163 offset:8192
v_mfma_f32_16x16x32_bf16 v[96:99], a[56:59], a[16:19], v[96:99]
ds_read_b64_tr_b16 a[54:55], v163 offset:9216
v_mfma_f32_16x16x32_bf16 v[112:115], a[56:59], a[20:23], v[112:115]
v_mfma_f32_16x16x32_bf16 v[128:131], a[56:59], a[24:27], v[128:131]
s_add_u32 m0, s57, 135168
s_add_u32 s51, s51, 128
s_mov_b32 exec_hi, 0xffff
buffer_load_dwordx4 v170, s[20:23], s52 offen lds
s_mov_b32 exec_hi, -1
v_mfma_f32_16x16x32_bf16 v[144:147], a[56:59], a[28:31], v[144:147]
v_mfma_f32_16x16x32_bf16 v[100:103], a[60:63], a[16:19], v[100:103]
v_mfma_f32_16x16x32_bf16 v[116:119], a[60:63], a[20:23], v[116:119]
s_setprio 0
v_mfma_f32_16x16x32_bf16 v[132:135], a[60:63], a[24:27], v[132:135]
v_mfma_f32_16x16x32_bf16 v[148:151], a[60:63], a[28:31], v[148:151]
v_mfma_f32_16x16x32_bf16 v[104:107], a[72:75], a[16:19], v[104:107]
s_add_u32 m0, s57, 141312
s_mov_b32 exec_hi, 0xffff
buffer_load_dwordx4 v169, s[20:23], s52 offen lds
s_mov_b32 exec_hi, -1
v_mfma_f32_16x16x32_bf16 v[120:123], a[72:75], a[20:23], v[120:123]
v_mfma_f32_16x16x32_bf16 v[136:139], a[72:75], a[24:27], v[136:139]
v_mfma_f32_16x16x32_bf16 v[152:155], a[72:75], a[28:31], v[152:155]
v_mfma_f32_16x16x32_bf16 v[108:111], a[76:79], a[16:19], v[108:111]
v_mfma_f32_16x16x32_bf16 v[124:127], a[76:79], a[20:23], v[124:127]
v_mfma_f32_16x16x32_bf16 v[140:143], a[76:79], a[24:27], v[140:143]
v_mfma_f32_16x16x32_bf16 v[156:159], a[76:79], a[28:31], v[156:159]
s_waitcnt vmcnt(8) lgkmcnt(0)
s_barrier
s_setprio 3
v_mfma_f32_16x16x32_bf16 v[64:67], a[32:35], a[0:3], v[64:67]
ds_read_b128 a[16:19], v161 offset:0
v_mfma_f32_16x16x32_bf16 v[72:75], a[32:35], a[4:7], v[72:75]
ds_read_b128 a[20:23], v161 offset:2048
v_mfma_f32_16x16x32_bf16 v[80:83], a[32:35], a[8:11], v[80:83]
ds_read_b128 a[24:27], v161 offset:4096
s_add_u32 m0, s58, 65536
s_add_u32 s52, s52, 196608
buffer_load_dwordx4 v164, s[16:19], s48 offen lds
v_mfma_f32_16x16x32_bf16 v[88:91], a[32:35], a[12:15], v[88:91]
ds_read_b128 a[28:31], v161 offset:6144
v_mfma_f32_16x16x32_bf16 v[68:71], a[36:39], a[0:3], v[68:71]
v_mfma_f32_16x16x32_bf16 v[76:79], a[36:39], a[4:7], v[76:79]
ds_read_b64_tr_b16 a[56:57], v162 offset:12288
s_add_u32 m0, s58, 66560
s_add_u32 s48, s48, 128
buffer_load_dwordx4 v165, s[16:19], s49 offen lds
s_setprio 2
v_mfma_f32_16x16x32_bf16 v[84:87], a[36:39], a[8:11], v[84:87]
ds_read_b64_tr_b16 a[58:59], v162 offset:13312
v_mfma_f32_16x16x32_bf16 v[92:95], a[36:39], a[12:15], v[92:95]
ds_read_b64_tr_b16 a[60:61], v163 offset:12288
v_mfma_f32_16x16x32_bf16 v[32:35], a[40:43], a[0:3], v[32:35]
s_add_u32 m0, s58, 67584
s_add_u32 s49, s49, 128
buffer_load_dwordx4 v164, s[16:19], s50 offen lds
v_mfma_f32_16x16x32_bf16 v[40:43], a[40:43], a[4:7], v[40:43]
ds_read_b64_tr_b16 a[62:63], v163 offset:13312
v_mfma_f32_16x16x32_bf16 v[48:51], a[40:43], a[8:11], v[48:51]
ds_read_b64_tr_b16 a[64:65], v162 offset:16384
v_mfma_f32_16x16x32_bf16 v[56:59], a[40:43], a[12:15], v[56:59]
ds_read_b64_tr_b16 a[66:67], v162 offset:17408
s_add_u32 m0, s58, 68608
s_add_u32 s50, s50, 128
buffer_load_dwordx4 v165, s[16:19], s51 offen lds
s_setprio 1
v_mfma_f32_16x16x32_bf16 v[36:39], a[44:47], a[0:3], v[36:39]
v_mfma_f32_16x16x32_bf16 v[44:47], a[44:47], a[4:7], v[44:47]
ds_read_b64_tr_b16 a[68:69], v163 offset:16384
v_mfma_f32_16x16x32_bf16 v[52:55], a[44:47], a[8:11], v[52:55]
ds_read_b64_tr_b16 a[70:71], v163 offset:17408
s_add_u32 m0, s57, 98304
s_add_u32 s51, s51, 128
s_mov_b32 exec_hi, 0xffff
buffer_load_dwordx4 v170, s[20:23], s52 offen lds
s_mov_b32 exec_hi, -1
v_mfma_f32_16x16x32_bf16 v[60:63], a[44:47], a[12:15], v[60:63]
ds_read_b64_tr_b16 a[72:73], v162 offset:20480
v_mfma_f32_16x16x32_bf16 v[0:3], a[0:3], a[48:51], v[0:3]
v_mfma_f32_16x16x32_bf16 v[4:7], a[4:7], a[48:51], v[4:7]
ds_read_b64_tr_b16 a[74:75], v162 offset:21504
s_add_u32 m0, s57, 104448
s_mov_b32 exec_hi, 0xffff
buffer_load_dwordx4 v169, s[20:23], s52 offen lds
s_mov_b32 exec_hi, -1
s_setprio 0
v_mfma_f32_16x16x32_bf16 v[8:11], a[8:11], a[48:51], v[8:11]
ds_read_b64_tr_b16 a[76:77], v163 offset:20480
v_mfma_f32_16x16x32_bf16 v[12:15], a[12:15], a[48:51], v[12:15]
ds_read_b64_tr_b16 a[78:79], v163 offset:21504
v_mfma_f32_16x16x32_bf16 v[16:19], a[0:3], a[52:55], v[16:19]
s_cmp_lg_u32 s87, 5
s_cbranch_scc1 k1_kernel_a_6
s_mov_b32 m0, 155648
s_nop 0
buffer_load_dword v173, s[32:35], s76 offen lds
k1_kernel_a_6:
s_add_u32 s76, s76, s59
v_mfma_f32_16x16x32_bf16 v[20:23], a[4:7], a[52:55], v[20:23]
v_mfma_f32_16x16x32_bf16 v[24:27], a[8:11], a[52:55], v[24:27]
v_mfma_f32_16x16x32_bf16 v[28:31], a[12:15], a[52:55], v[28:31]
s_waitcnt vmcnt(8) lgkmcnt(0)
s_barrier
s_setprio 3
v_mfma_f32_16x16x32_bf16 v[64:67], a[56:59], a[16:19], v[64:67]
ds_read_b128 a[0:3], v160 offset:32768
v_mfma_f32_16x16x32_bf16 v[72:75], a[56:59], a[20:23], v[72:75]
ds_read_b128 a[4:7], v160 offset:34816
v_mfma_f32_16x16x32_bf16 v[80:83], a[56:59], a[24:27], v[80:83]
ds_read_b128 a[8:11], v160 offset:36864
s_add_u32 m0, s58, 0
s_add_u32 s52, s52, 196608
buffer_load_dwordx4 v164, s[16:19], s48 offen lds
v_mfma_f32_16x16x32_bf16 v[88:91], a[56:59], a[28:31], v[88:91]
ds_read_b128 a[12:15], v160 offset:38912
v_mfma_f32_16x16x32_bf16 v[68:71], a[60:63], a[16:19], v[68:71]
v_mfma_f32_16x16x32_bf16 v[76:79], a[60:63], a[20:23], v[76:79]
ds_read_b64_tr_b16 a[32:33], v162 offset:24576
s_setprio 2
v_mfma_f32_16x16x32_bf16 v[84:87], a[60:63], a[24:27], v[84:87]
ds_read_b64_tr_b16 a[34:35], v162 offset:25600
v_mfma_f32_16x16x32_bf16 v[92:95], a[60:63], a[28:31], v[92:95]
ds_read_b64_tr_b16 a[36:37], v163 offset:24576
s_add_u32 m0, s58, 1024
s_add_u32 s48, s48, 128
buffer_load_dwordx4 v165, s[16:19], s49 offen lds
v_mfma_f32_16x16x32_bf16 v[32:35], a[64:67], a[16:19], v[32:35]
v_mfma_f32_16x16x32_bf16 v[40:43], a[64:67], a[20:23], v[40:43]
ds_read_b64_tr_b16 a[38:39], v163 offset:25600
v_mfma_f32_16x16x32_bf16 v[48:51], a[64:67], a[24:27], v[48:51]
ds_read_b64_tr_b16 a[40:41], v162 offset:28672
v_mfma_f32_16x16x32_bf16 v[56:59], a[64:67], a[28:31], v[56:59]
ds_read_b64_tr_b16 a[42:43], v162 offset:29696
s_setprio 1
v_mfma_f32_16x16x32_bf16 v[36:39], a[68:71], a[16:19], v[36:39]
s_add_u32 m0, s57, 110592
s_add_u32 s49, s49, 128
s_mov_b32 exec_hi, 0xffff
buffer_load_dwordx4 v170, s[20:23], s52 offen lds
s_mov_b32 exec_hi, -1
v_mfma_f32_16x16x32_bf16 v[44:47], a[68:71], a[20:23], v[44:47]
ds_read_b64_tr_b16 a[44:45], v163 offset:28672
v_mfma_f32_16x16x32_bf16 v[52:55], a[68:71], a[24:27], v[52:55]
ds_read_b64_tr_b16 a[46:47], v163 offset:29696
v_mfma_f32_16x16x32_bf16 v[60:63], a[68:71], a[28:31], v[60:63]
ds_read_b64_tr_b16 a[48:49], v162 offset:32768
v_mfma_f32_16x16x32_bf16 v[0:3], a[16:19], a[72:75], v[0:3]
v_mfma_f32_16x16x32_bf16 v[4:7], a[20:23], a[72:75], v[4:7]
ds_read_b64_tr_b16 a[50:51], v162 offset:33792
s_add_u32 m0, s57, 116736
s_mov_b32 exec_hi, 0xffff
buffer_load_dwordx4 v169, s[20:23], s52 offen lds
s_mov_b32 exec_hi, -1
s_setprio 0
v_mfma_f32_16x16x32_bf16 v[8:11], a[24:27], a[72:75], v[8:11]
ds_read_b64_tr_b16 a[52:53], v163 offset:32768
v_mfma_f32_16x16x32_bf16 v[12:15], a[28:31], a[72:75], v[12:15]
ds_read_b64_tr_b16 a[54:55], v163 offset:33792
v_mfma_f32_16x16x32_bf16 v[16:19], a[16:19], a[76:79], v[16:19]
v_mfma_f32_16x16x32_bf16 v[20:23], a[20:23], a[76:79], v[20:23]
v_mfma_f32_16x16x32_bf16 v[24:27], a[24:27], a[76:79], v[24:27]
v_mfma_f32_16x16x32_bf16 v[28:31], a[28:31], a[76:79], v[28:31]
s_waitcnt vmcnt(10) lgkmcnt(0)
s_barrier
s_setprio 3
v_mfma_f32_16x16x32_bf16 v[64:67], a[32:35], a[0:3], v[64:67]
ds_read_b128 a[16:19], v161 offset:32768
v_mfma_f32_16x16x32_bf16 v[72:75], a[32:35], a[4:7], v[72:75]
ds_read_b128 a[20:23], v161 offset:34816
v_mfma_f32_16x16x32_bf16 v[80:83], a[32:35], a[8:11], v[80:83]
ds_read_b128 a[24:27], v161 offset:36864
s_add_u32 m0, s58, 2048
s_add_u32 s52, s52, 196608
buffer_load_dwordx4 v164, s[16:19], s50 offen lds
v_mfma_f32_16x16x32_bf16 v[88:91], a[32:35], a[12:15], v[88:91]
ds_read_b128 a[28:31], v161 offset:38912
v_mfma_f32_16x16x32_bf16 v[68:71], a[36:39], a[0:3], v[68:71]
v_mfma_f32_16x16x32_bf16 v[76:79], a[36:39], a[4:7], v[76:79]
ds_read_b64_tr_b16 a[56:57], v162 offset:36864
s_setprio 2
v_mfma_f32_16x16x32_bf16 v[84:87], a[36:39], a[8:11], v[84:87]
ds_read_b64_tr_b16 a[58:59], v162 offset:37888
s_add_u32 m0, s58, 3072
s_add_u32 s50, s50, 128
buffer_load_dwordx4 v165, s[16:19], s51 offen lds
v_mfma_f32_16x16x32_bf16 v[92:95], a[36:39], a[12:15], v[92:95]
ds_read_b64_tr_b16 a[60:61], v163 offset:36864
v_mfma_f32_16x16x32_bf16 v[32:35], a[40:43], a[0:3], v[32:35]
v_mfma_f32_16x16x32_bf16 v[40:43], a[40:43], a[4:7], v[40:43]
ds_read_b64_tr_b16 a[62:63], v163 offset:37888
v_mfma_f32_16x16x32_bf16 v[48:51], a[40:43], a[8:11], v[48:51]
ds_read_b64_tr_b16 a[64:65], v162 offset:40960
s_add_u32 m0, s57, 122880
s_add_u32 s51, s51, 128
s_mov_b32 exec_hi, 0xffff
buffer_load_dwordx4 v170, s[20:23], s52 offen lds
s_mov_b32 exec_hi, -1
v_mfma_f32_16x16x32_bf16 v[56:59], a[40:43], a[12:15], v[56:59]
ds_read_b64_tr_b16 a[66:67], v162 offset:41984
s_setprio 1
v_mfma_f32_16x16x32_bf16 v[36:39], a[44:47], a[0:3], v[36:39]
v_mfma_f32_16x16x32_bf16 v[44:47], a[44:47], a[4:7], v[44:47]
ds_read_b64_tr_b16 a[68:69], v163 offset:40960
v_mfma_f32_16x16x32_bf16 v[52:55], a[44:47], a[8:11], v[52:55]
ds_read_b64_tr_b16 a[70:71], v163 offset:41984
s_add_u32 m0, s57, 129024
s_mov_b32 exec_hi, 0xffff
buffer_load_dwordx4 v169, s[20:23], s52 offen lds
s_mov_b32 exec_hi, -1
v_mfma_f32_16x16x32_bf16 v[60:63], a[44:47], a[12:15], v[60:63]
ds_read_b64_tr_b16 a[72:73], v162 offset:45056
v_mfma_f32_16x16x32_bf16 v[0:3], a[0:3], a[48:51], v[0:3]
v_mfma_f32_16x16x32_bf16 v[4:7], a[4:7], a[48:51], v[4:7]
ds_read_b64_tr_b16 a[74:75], v162 offset:46080
s_setprio 0
v_mfma_f32_16x16x32_bf16 v[8:11], a[8:11], a[48:51], v[8:11]
ds_read_b64_tr_b16 a[76:77], v163 offset:45056
s_lshl_b32 s76, s2, 13
s_mov_b32 s32, s60
s_mov_b32 s33, s61
s_mov_b32 s34, 7340032
s_mov_b32 s59, 2097152
s_cmp_lg_u32 s87, 6
s_cbranch_scc1 k1_kernel_a_7
s_mov_b32 m0, 155648
s_nop 0
buffer_load_dword v173, s[32:35], s76 offen lds
k1_kernel_a_7:
s_add_u32 s76, s76, s59
v_mfma_f32_16x16x32_bf16 v[12:15], a[12:15], a[48:51], v[12:15]
ds_read_b64_tr_b16 a[78:79], v163 offset:46080
v_mfma_f32_16x16x32_bf16 v[16:19], a[0:3], a[52:55], v[16:19]
v_mfma_f32_16x16x32_bf16 v[20:23], a[4:7], a[52:55], v[20:23]
v_mfma_f32_16x16x32_bf16 v[24:27], a[8:11], a[52:55], v[24:27]
v_mfma_f32_16x16x32_bf16 v[28:31], a[12:15], a[52:55], v[28:31]
s_waitcnt vmcnt(8) lgkmcnt(0)
s_barrier
s_setprio 3
v_mfma_f32_16x16x32_bf16 v[64:67], a[56:59], a[16:19], v[64:67]
v_add_u32 v160, 0x8000, v160
v_mfma_f32_16x16x32_bf16 v[72:75], a[56:59], a[20:23], v[72:75]
ds_read_b128 a[0:3], v160 offset:32768
v_mfma_f32_16x16x32_bf16 v[80:83], a[56:59], a[24:27], v[80:83]
ds_read_b128 a[4:7], v160 offset:34816
s_add_u32 m0, s58, 32768
s_add_u32 s52, s52, 196608
buffer_load_dwordx4 v164, s[16:19], s48 offen lds
v_mfma_f32_16x16x32_bf16 v[88:91], a[56:59], a[28:31], v[88:91]
ds_read_b128 a[8:11], v160 offset:36864
v_mfma_f32_16x16x32_bf16 v[68:71], a[60:63], a[16:19], v[68:71]
ds_read_b128 a[12:15], v160 offset:38912
v_mfma_f32_16x16x32_bf16 v[76:79], a[60:63], a[20:23], v[76:79]
s_setprio 2
v_mfma_f32_16x16x32_bf16 v[84:87], a[60:63], a[24:27], v[84:87]
ds_read_b64_tr_b16 a[32:33], v162 offset:0
v_mfma_f32_16x16x32_bf16 v[92:95], a[60:63], a[28:31], v[92:95]
ds_read_b64_tr_b16 a[34:35], v162 offset:1024
s_add_u32 m0, s58, 33792
s_add_u32 s48, s48, 128
buffer_load_dwordx4 v165, s[16:19], s49 offen lds
v_mfma_f32_16x16x32_bf16 v[32:35], a[64:67], a[16:19], v[32:35]
ds_read_b64_tr_b16 a[36:37], v163 offset:0
v_mfma_f32_16x16x32_bf16 v[40:43], a[64:67], a[20:23], v[40:43]
ds_read_b64_tr_b16 a[38:39], v163 offset:1024
v_mfma_f32_16x16x32_bf16 v[48:51], a[64:67], a[24:27], v[48:51]
v_mfma_f32_16x16x32_bf16 v[56:59], a[64:67], a[28:31], v[56:59]
ds_read_b64_tr_b16 a[40:41], v162 offset:4096
s_setprio 1
v_mfma_f32_16x16x32_bf16 v[36:39], a[68:71], a[16:19], v[36:39]
ds_read_b64_tr_b16 a[42:43], v162 offset:5120
s_add_u32 m0, s57, 135168
s_add_u32 s49, s49, 128
s_mov_b32 exec_hi, 0xffff
buffer_load_dwordx4 v170, s[20:23], s52 offen lds
s_mov_b32 exec_hi, -1
v_mfma_f32_16x16x32_bf16 v[44:47], a[68:71], a[20:23], v[44:47]
ds_read_b64_tr_b16 a[44:45], v163 offset:4096
v_mfma_f32_16x16x32_bf16 v[52:55], a[68:71], a[24:27], v[52:55]
ds_read_b64_tr_b16 a[46:47], v163 offset:5120
v_mfma_f32_16x16x32_bf16 v[60:63], a[68:71], a[28:31], v[60:63]
v_mfma_f32_16x16x32_bf16 v[0:3], a[16:19], a[72:75], v[0:3]
ds_read_b64_tr_b16 a[48:49], v162 offset:8192
v_mfma_f32_16x16x32_bf16 v[4:7], a[20:23], a[72:75], v[4:7]
ds_read_b64_tr_b16 a[50:51], v162 offset:9216
s_add_u32 m0, s57, 141312
s_mov_b32 exec_hi, 0xffff
buffer_load_dwordx4 v169, s[20:23], s52 offen lds
s_mov_b32 exec_hi, -1
s_setprio 0
v_mfma_f32_16x16x32_bf16 v[8:11], a[24:27], a[72:75], v[8:11]
ds_read_b64_tr_b16 a[52:53], v163 offset:8192
v_mfma_f32_16x16x32_bf16 v[12:15], a[28:31], a[72:75], v[12:15]
ds_read_b64_tr_b16 a[54:55], v163 offset:9216
v_mfma_f32_16x16x32_bf16 v[16:19], a[16:19], a[76:79], v[16:19]
v_mfma_f32_16x16x32_bf16 v[20:23], a[20:23], a[76:79], v[20:23]
v_mfma_f32_16x16x32_bf16 v[24:27], a[24:27], a[76:79], v[24:27]
v_mfma_f32_16x16x32_bf16 v[28:31], a[28:31], a[76:79], v[28:31]
s_waitcnt vmcnt(8) lgkmcnt(0)
s_barrier
s_setprio 3
v_mfma_f32_16x16x32_bf16 v[64:67], a[32:35], a[0:3], v[64:67]
v_add_u32 v161, 0x8000, v161
v_mfma_f32_16x16x32_bf16 v[72:75], a[32:35], a[4:7], v[72:75]
ds_read_b128 a[16:19], v161 offset:32768
v_mfma_f32_16x16x32_bf16 v[80:83], a[32:35], a[8:11], v[80:83]
ds_read_b128 a[20:23], v161 offset:34816
s_add_u32 m0, s58, 34816
s_add_u32 s52, s52, 196608
buffer_load_dwordx4 v164, s[16:19], s50 offen lds
v_mfma_f32_16x16x32_bf16 v[88:91], a[32:35], a[12:15], v[88:91]
ds_read_b128 a[24:27], v161 offset:36864
v_mfma_f32_16x16x32_bf16 v[68:71], a[36:39], a[0:3], v[68:71]
ds_read_b128 a[28:31], v161 offset:38912
v_mfma_f32_16x16x32_bf16 v[76:79], a[36:39], a[4:7], v[76:79]
s_setprio 2
v_mfma_f32_16x16x32_bf16 v[84:87], a[36:39], a[8:11], v[84:87]
ds_read_b64_tr_b16 a[56:57], v162 offset:12288
s_add_u32 m0, s58, 35840
s_add_u32 s50, s50, 128
buffer_load_dwordx4 v165, s[16:19], s51 offen lds
v_mfma_f32_16x16x32_bf16 v[92:95], a[36:39], a[12:15], v[92:95]
ds_read_b64_tr_b16 a[58:59], v162 offset:13312
v_mfma_f32_16x16x32_bf16 v[32:35], a[40:43], a[0:3], v[32:35]
ds_read_b64_tr_b16 a[60:61], v163 offset:12288
v_mfma_f32_16x16x32_bf16 v[40:43], a[40:43], a[4:7], v[40:43]
ds_read_b64_tr_b16 a[62:63], v163 offset:13312
v_mfma_f32_16x16x32_bf16 v[48:51], a[40:43], a[8:11], v[48:51]
s_add_u32 m0, s57, 98304
s_add_u32 s51, s51, 128
s_mov_b32 exec_hi, 0xffff
buffer_load_dwordx4 v170, s[20:23], s52 offen lds
s_mov_b32 exec_hi, -1
v_mfma_f32_16x16x32_bf16 v[56:59], a[40:43], a[12:15], v[56:59]
ds_read_b64_tr_b16 a[64:65], v162 offset:16384
s_setprio 1
v_mfma_f32_16x16x32_bf16 v[36:39], a[44:47], a[0:3], v[36:39]
ds_read_b64_tr_b16 a[66:67], v162 offset:17408
v_mfma_f32_16x16x32_bf16 v[44:47], a[44:47], a[4:7], v[44:47]
ds_read_b64_tr_b16 a[68:69], v163 offset:16384
v_mfma_f32_16x16x32_bf16 v[52:55], a[44:47], a[8:11], v[52:55]
ds_read_b64_tr_b16 a[70:71], v163 offset:17408
s_add_u32 m0, s57, 104448
s_mov_b32 exec_hi, 0xffff
buffer_load_dwordx4 v169, s[20:23], s52 offen lds
s_mov_b32 exec_hi, -1
v_mfma_f32_16x16x32_bf16 v[60:63], a[44:47], a[12:15], v[60:63]
v_mfma_f32_16x16x32_bf16 v[0:3], a[0:3], a[48:51], v[0:3]
ds_read_b64_tr_b16 a[72:73], v162 offset:20480
v_mfma_f32_16x16x32_bf16 v[4:7], a[4:7], a[48:51], v[4:7]
ds_read_b64_tr_b16 a[74:75], v162 offset:21504
s_setprio 0
v_mfma_f32_16x16x32_bf16 v[8:11], a[8:11], a[48:51], v[8:11]
ds_read_b64_tr_b16 a[76:77], v163 offset:20480
s_cmp_lg_u32 s87, 7
s_cbranch_scc1 k1_kernel_a_8
s_mov_b32 m0, 155648
s_nop 0
buffer_load_dword v173, s[32:35], s76 offen lds
k1_kernel_a_8:
s_add_u32 s76, s76, s59
v_mfma_f32_16x16x32_bf16 v[12:15], a[12:15], a[48:51], v[12:15]
ds_read_b64_tr_b16 a[78:79], v163 offset:21504
v_mfma_f32_16x16x32_bf16 v[16:19], a[0:3], a[52:55], v[16:19]
v_mfma_f32_16x16x32_bf16 v[20:23], a[4:7], a[52:55], v[20:23]
v_mfma_f32_16x16x32_bf16 v[24:27], a[8:11], a[52:55], v[24:27]
v_mfma_f32_16x16x32_bf16 v[28:31], a[12:15], a[52:55], v[28:31]
s_waitcnt vmcnt(8) lgkmcnt(0)
s_barrier
s_setprio 3
v_mfma_f32_16x16x32_bf16 v[64:67], a[56:59], a[16:19], v[64:67]
v_subrev_u32 v160, 0x8000, v160
v_mfma_f32_16x16x32_bf16 v[72:75], a[56:59], a[20:23], v[72:75]
ds_read_b128 a[0:3], v160 offset:0
v_mfma_f32_16x16x32_bf16 v[80:83], a[56:59], a[24:27], v[80:83]
ds_read_b128 a[4:7], v160 offset:2048
s_add_u32 m0, s58, 65536
s_add_u32 s52, s52, 196608
buffer_load_dwordx4 v164, s[16:19], s48 offen lds
v_mfma_f32_16x16x32_bf16 v[88:91], a[56:59], a[28:31], v[88:91]
ds_read_b128 a[8:11], v160 offset:4096
v_mfma_f32_16x16x32_bf16 v[68:71], a[60:63], a[16:19], v[68:71]
ds_read_b128 a[12:15], v160 offset:6144
v_mfma_f32_16x16x32_bf16 v[76:79], a[60:63], a[20:23], v[76:79]
s_setprio 2
v_mfma_f32_16x16x32_bf16 v[84:87], a[60:63], a[24:27], v[84:87]
ds_read_b64_tr_b16 a[32:33], v162 offset:24576
v_mfma_f32_16x16x32_bf16 v[92:95], a[60:63], a[28:31], v[92:95]
ds_read_b64_tr_b16 a[34:35], v162 offset:25600
s_add_u32 m0, s58, 66560
s_add_u32 s48, s48, 128
buffer_load_dwordx4 v165, s[16:19], s49 offen lds
v_mfma_f32_16x16x32_bf16 v[32:35], a[64:67], a[16:19], v[32:35]
ds_read_b64_tr_b16 a[36:37], v163 offset:24576
v_mfma_f32_16x16x32_bf16 v[40:43], a[64:67], a[20:23], v[40:43]
ds_read_b64_tr_b16 a[38:39], v163 offset:25600
v_mfma_f32_16x16x32_bf16 v[48:51], a[64:67], a[24:27], v[48:51]
v_mfma_f32_16x16x32_bf16 v[56:59], a[64:67], a[28:31], v[56:59]
ds_read_b64_tr_b16 a[40:41], v162 offset:28672
s_setprio 1
v_mfma_f32_16x16x32_bf16 v[36:39], a[68:71], a[16:19], v[36:39]
ds_read_b64_tr_b16 a[42:43], v162 offset:29696
s_add_u32 m0, s57, 110592
s_add_u32 s49, s49, 128
s_mov_b32 exec_hi, 0xffff
buffer_load_dwordx4 v170, s[20:23], s52 offen lds
s_mov_b32 exec_hi, -1
v_mfma_f32_16x16x32_bf16 v[44:47], a[68:71], a[20:23], v[44:47]
ds_read_b64_tr_b16 a[44:45], v163 offset:28672
v_mfma_f32_16x16x32_bf16 v[52:55], a[68:71], a[24:27], v[52:55]
ds_read_b64_tr_b16 a[46:47], v163 offset:29696
v_mfma_f32_16x16x32_bf16 v[60:63], a[68:71], a[28:31], v[60:63]
v_mfma_f32_16x16x32_bf16 v[0:3], a[16:19], a[72:75], v[0:3]
ds_read_b64_tr_b16 a[48:49], v162 offset:32768
v_mfma_f32_16x16x32_bf16 v[4:7], a[20:23], a[72:75], v[4:7]
ds_read_b64_tr_b16 a[50:51], v162 offset:33792
s_add_u32 m0, s57, 116736
s_mov_b32 exec_hi, 0xffff
buffer_load_dwordx4 v169, s[20:23], s52 offen lds
s_mov_b32 exec_hi, -1
s_setprio 0
v_mfma_f32_16x16x32_bf16 v[8:11], a[24:27], a[72:75], v[8:11]
ds_read_b64_tr_b16 a[52:53], v163 offset:32768
v_mfma_f32_16x16x32_bf16 v[12:15], a[28:31], a[72:75], v[12:15]
ds_read_b64_tr_b16 a[54:55], v163 offset:33792
v_mfma_f32_16x16x32_bf16 v[16:19], a[16:19], a[76:79], v[16:19]
v_mfma_f32_16x16x32_bf16 v[20:23], a[20:23], a[76:79], v[20:23]
v_mfma_f32_16x16x32_bf16 v[24:27], a[24:27], a[76:79], v[24:27]
v_mfma_f32_16x16x32_bf16 v[28:31], a[28:31], a[76:79], v[28:31]
s_waitcnt vmcnt(8) lgkmcnt(0)
s_barrier
s_setprio 3
v_mfma_f32_16x16x32_bf16 v[64:67], a[32:35], a[0:3], v[64:67]
v_subrev_u32 v161, 0x8000, v161
v_mfma_f32_16x16x32_bf16 v[72:75], a[32:35], a[4:7], v[72:75]
ds_read_b128 a[16:19], v161 offset:0
v_mfma_f32_16x16x32_bf16 v[80:83], a[32:35], a[8:11], v[80:83]
ds_read_b128 a[20:23], v161 offset:2048
s_add_u32 m0, s58, 67584
s_add_u32 s52, s52, 196608
buffer_load_dwordx4 v164, s[16:19], s50 offen lds
v_mfma_f32_16x16x32_bf16 v[88:91], a[32:35], a[12:15], v[88:91]
ds_read_b128 a[24:27], v161 offset:4096
v_mfma_f32_16x16x32_bf16 v[68:71], a[36:39], a[0:3], v[68:71]
ds_read_b128 a[28:31], v161 offset:6144
v_mfma_f32_16x16x32_bf16 v[76:79], a[36:39], a[4:7], v[76:79]
s_setprio 2
v_mfma_f32_16x16x32_bf16 v[84:87], a[36:39], a[8:11], v[84:87]
ds_read_b64_tr_b16 a[56:57], v162 offset:36864
s_add_u32 m0, s58, 68608
s_add_u32 s50, s50, 128
buffer_load_dwordx4 v165, s[16:19], s51 offen lds
v_mfma_f32_16x16x32_bf16 v[92:95], a[36:39], a[12:15], v[92:95]
ds_read_b64_tr_b16 a[58:59], v162 offset:37888
v_mfma_f32_16x16x32_bf16 v[32:35], a[40:43], a[0:3], v[32:35]
ds_read_b64_tr_b16 a[60:61], v163 offset:36864
v_mfma_f32_16x16x32_bf16 v[40:43], a[40:43], a[4:7], v[40:43]
ds_read_b64_tr_b16 a[62:63], v163 offset:37888
v_mfma_f32_16x16x32_bf16 v[48:51], a[40:43], a[8:11], v[48:51]
s_add_u32 m0, s57, 122880
s_add_u32 s51, s51, 128
s_mov_b32 exec_hi, 0xffff
buffer_load_dwordx4 v170, s[20:23], s52 offen lds
s_mov_b32 exec_hi, -1
v_mfma_f32_16x16x32_bf16 v[56:59], a[40:43], a[12:15], v[56:59]
ds_read_b64_tr_b16 a[64:65], v162 offset:40960
s_setprio 1
v_mfma_f32_16x16x32_bf16 v[36:39], a[44:47], a[0:3], v[36:39]
ds_read_b64_tr_b16 a[66:67], v162 offset:41984
v_mfma_f32_16x16x32_bf16 v[44:47], a[44:47], a[4:7], v[44:47]
ds_read_b64_tr_b16 a[68:69], v163 offset:40960
v_mfma_f32_16x16x32_bf16 v[52:55], a[44:47], a[8:11], v[52:55]
ds_read_b64_tr_b16 a[70:71], v163 offset:41984
s_add_u32 m0, s57, 129024
s_mov_b32 exec_hi, 0xffff
buffer_load_dwordx4 v169, s[20:23], s52 offen lds
s_mov_b32 exec_hi, -1
v_mfma_f32_16x16x32_bf16 v[60:63], a[44:47], a[12:15], v[60:63]
v_mfma_f32_16x16x32_bf16 v[0:3], a[0:3], a[48:51], v[0:3]
ds_read_b64_tr_b16 a[72:73], v162 offset:45056
v_mfma_f32_16x16x32_bf16 v[4:7], a[4:7], a[48:51], v[4:7]
ds_read_b64_tr_b16 a[74:75], v162 offset:46080
s_setprio 0
v_mfma_f32_16x16x32_bf16 v[8:11], a[8:11], a[48:51], v[8:11]
ds_read_b64_tr_b16 a[76:77], v163 offset:45056
s_cmp_lg_u32 s87, 0
s_cbranch_scc1 k1_kernel_a_9
s_mov_b32 m0, 155648
s_nop 0
buffer_load_dword v173, s[32:35], s76 offen lds
k1_kernel_a_9:
s_add_u32 s76, s76, s59
v_mfma_f32_16x16x32_bf16 v[12:15], a[12:15], a[48:51], v[12:15]
ds_read_b64_tr_b16 a[78:79], v163 offset:46080
v_mfma_f32_16x16x32_bf16 v[16:19], a[0:3], a[52:55], v[16:19]
v_mfma_f32_16x16x32_bf16 v[20:23], a[4:7], a[52:55], v[20:23]
v_mfma_f32_16x16x32_bf16 v[24:27], a[8:11], a[52:55], v[24:27]
v_mfma_f32_16x16x32_bf16 v[28:31], a[12:15], a[52:55], v[28:31]
s_waitcnt vmcnt(8) lgkmcnt(0)
s_barrier
s_setprio 3
v_mfma_f32_16x16x32_bf16 v[64:67], a[56:59], a[16:19], v[64:67]
ds_read_b128 a[0:3], v160 offset:32768
v_mfma_f32_16x16x32_bf16 v[72:75], a[56:59], a[20:23], v[72:75]
ds_read_b128 a[4:7], v160 offset:34816
v_mfma_f32_16x16x32_bf16 v[80:83], a[56:59], a[24:27], v[80:83]
ds_read_b128 a[8:11], v160 offset:36864
s_add_u32 m0, s58, 0
s_add_u32 s52, s52, 196608
buffer_load_dwordx4 v164, s[16:19], s48 offen lds
v_mfma_f32_16x16x32_bf16 v[88:91], a[56:59], a[28:31], v[88:91]
ds_read_b128 a[12:15], v160 offset:38912
v_mfma_f32_16x16x32_bf16 v[68:71], a[60:63], a[16:19], v[68:71]
v_mfma_f32_16x16x32_bf16 v[76:79], a[60:63], a[20:23], v[76:79]
ds_read_b64_tr_b16 a[32:33], v162 offset:0
s_setprio 2
v_mfma_f32_16x16x32_bf16 v[84:87], a[60:63], a[24:27], v[84:87]
ds_read_b64_tr_b16 a[34:35], v162 offset:1024
v_mfma_f32_16x16x32_bf16 v[92:95], a[60:63], a[28:31], v[92:95]
ds_read_b64_tr_b16 a[36:37], v163 offset:0
s_add_u32 m0, s58, 1024
s_add_u32 s48, s48, 128
buffer_load_dwordx4 v165, s[16:19], s49 offen lds
v_mfma_f32_16x16x32_bf16 v[32:35], a[64:67], a[16:19], v[32:35]
v_mfma_f32_16x16x32_bf16 v[40:43], a[64:67], a[20:23], v[40:43]
ds_read_b64_tr_b16 a[38:39], v163 offset:1024
v_mfma_f32_16x16x32_bf16 v[48:51], a[64:67], a[24:27], v[48:51]
ds_read_b64_tr_b16 a[40:41], v162 offset:4096
v_mfma_f32_16x16x32_bf16 v[56:59], a[64:67], a[28:31], v[56:59]
ds_read_b64_tr_b16 a[42:43], v162 offset:5120
s_setprio 1
v_mfma_f32_16x16x32_bf16 v[36:39], a[68:71], a[16:19], v[36:39]
s_add_u32 m0, s57, 135168
s_add_u32 s49, s49, 128
s_mov_b32 exec_hi, 0xffff
buffer_load_dwordx4 v170, s[20:23], s52 offen lds
s_mov_b32 exec_hi, -1
v_mfma_f32_16x16x32_bf16 v[44:47], a[68:71], a[20:23], v[44:47]
ds_read_b64_tr_b16 a[44:45], v163 offset:4096
v_mfma_f32_16x16x32_bf16 v[52:55], a[68:71], a[24:27], v[52:55]
ds_read_b64_tr_b16 a[46:47], v163 offset:5120
v_mfma_f32_16x16x32_bf16 v[60:63], a[68:71], a[28:31], v[60:63]
ds_read_b64_tr_b16 a[48:49], v162 offset:8192
v_mfma_f32_16x16x32_bf16 v[0:3], a[16:19], a[72:75], v[0:3]
v_mfma_f32_16x16x32_bf16 v[4:7], a[20:23], a[72:75], v[4:7]
ds_read_b64_tr_b16 a[50:51], v162 offset:9216
s_add_u32 m0, s57, 141312
s_mov_b32 exec_hi, 0xffff
buffer_load_dwordx4 v169, s[20:23], s52 offen lds
s_mov_b32 exec_hi, -1
s_setprio 0
v_mfma_f32_16x16x32_bf16 v[8:11], a[24:27], a[72:75], v[8:11]
ds_read_b64_tr_b16 a[52:53], v163 offset:8192
v_mfma_f32_16x16x32_bf16 v[12:15], a[28:31], a[72:75], v[12:15]
ds_read_b64_tr_b16 a[54:55], v163 offset:9216
v_mfma_f32_16x16x32_bf16 v[16:19], a[16:19], a[76:79], v[16:19]
v_mfma_f32_16x16x32_bf16 v[20:23], a[20:23], a[76:79], v[20:23]
v_mfma_f32_16x16x32_bf16 v[24:27], a[24:27], a[76:79], v[24:27]
v_mfma_f32_16x16x32_bf16 v[28:31], a[28:31], a[76:79], v[28:31]
s_waitcnt vmcnt(8) lgkmcnt(0)
s_barrier
s_setprio 3
v_mfma_f32_16x16x32_bf16 v[64:67], a[32:35], a[0:3], v[64:67]
ds_read_b128 a[16:19], v161 offset:32768
v_mfma_f32_16x16x32_bf16 v[72:75], a[32:35], a[4:7], v[72:75]
ds_read_b128 a[20:23], v161 offset:34816
v_mfma_f32_16x16x32_bf16 v[80:83], a[32:35], a[8:11], v[80:83]
ds_read_b128 a[24:27], v161 offset:36864
s_add_u32 m0, s58, 2048
s_add_u32 s52, s52, 196608
buffer_load_dwordx4 v164, s[16:19], s50 offen lds
v_mfma_f32_16x16x32_bf16 v[88:91], a[32:35], a[12:15], v[88:91]
ds_read_b128 a[28:31], v161 offset:38912
v_mfma_f32_16x16x32_bf16 v[68:71], a[36:39], a[0:3], v[68:71]
v_mfma_f32_16x16x32_bf16 v[76:79], a[36:39], a[4:7], v[76:79]
ds_read_b64_tr_b16 a[56:57], v162 offset:12288
s_setprio 2
v_mfma_f32_16x16x32_bf16 v[84:87], a[36:39], a[8:11], v[84:87]
ds_read_b64_tr_b16 a[58:59], v162 offset:13312
s_add_u32 m0, s58, 3072
s_add_u32 s50, s50, 128
buffer_load_dwordx4 v165, s[16:19], s51 offen lds
v_mfma_f32_16x16x32_bf16 v[92:95], a[36:39], a[12:15], v[92:95]
ds_read_b64_tr_b16 a[60:61], v163 offset:12288
v_mfma_f32_16x16x32_bf16 v[32:35], a[40:43], a[0:3], v[32:35]
v_mfma_f32_16x16x32_bf16 v[40:43], a[40:43], a[4:7], v[40:43]
ds_read_b64_tr_b16 a[62:63], v163 offset:13312
v_mfma_f32_16x16x32_bf16 v[48:51], a[40:43], a[8:11], v[48:51]
ds_read_b64_tr_b16 a[64:65], v162 offset:16384
s_add_u32 m0, s57, 98304
s_add_u32 s51, s51, 128
s_mov_b32 exec_hi, 0xffff
buffer_load_dwordx4 v170, s[20:23], s52 offen lds
s_mov_b32 exec_hi, -1
v_mfma_f32_16x16x32_bf16 v[56:59], a[40:43], a[12:15], v[56:59]
ds_read_b64_tr_b16 a[66:67], v162 offset:17408
s_setprio 1
v_mfma_f32_16x16x32_bf16 v[36:39], a[44:47], a[0:3], v[36:39]
v_mfma_f32_16x16x32_bf16 v[44:47], a[44:47], a[4:7], v[44:47]
ds_read_b64_tr_b16 a[68:69], v163 offset:16384
v_mfma_f32_16x16x32_bf16 v[52:55], a[44:47], a[8:11], v[52:55]
ds_read_b64_tr_b16 a[70:71], v163 offset:17408
s_add_u32 m0, s57, 104448
s_mov_b32 exec_hi, 0xffff
buffer_load_dwordx4 v169, s[20:23], s52 offen lds
s_mov_b32 exec_hi, -1
v_mfma_f32_16x16x32_bf16 v[60:63], a[44:47], a[12:15], v[60:63]
ds_read_b64_tr_b16 a[72:73], v162 offset:20480
v_mfma_f32_16x16x32_bf16 v[0:3], a[0:3], a[48:51], v[0:3]
v_mfma_f32_16x16x32_bf16 v[4:7], a[4:7], a[48:51], v[4:7]
ds_read_b64_tr_b16 a[74:75], v162 offset:21504
s_setprio 0
v_mfma_f32_16x16x32_bf16 v[8:11], a[8:11], a[48:51], v[8:11]
ds_read_b64_tr_b16 a[76:77], v163 offset:20480
s_cmp_lg_u32 s87, 1
s_cbranch_scc1 k1_kernel_a_10
s_mov_b32 m0, 155648
s_nop 0
buffer_load_dword v173, s[32:35], s76 offen lds
k1_kernel_a_10:
s_add_u32 s76, s76, s59
v_mfma_f32_16x16x32_bf16 v[12:15], a[12:15], a[48:51], v[12:15]
ds_read_b64_tr_b16 a[78:79], v163 offset:21504
v_mfma_f32_16x16x32_bf16 v[16:19], a[0:3], a[52:55], v[16:19]
v_mfma_f32_16x16x32_bf16 v[20:23], a[4:7], a[52:55], v[20:23]
v_mfma_f32_16x16x32_bf16 v[24:27], a[8:11], a[52:55], v[24:27]
v_mfma_f32_16x16x32_bf16 v[28:31], a[12:15], a[52:55], v[28:31]
s_waitcnt vmcnt(8) lgkmcnt(0)
s_barrier
s_setprio 3
v_mfma_f32_16x16x32_bf16 v[64:67], a[56:59], a[16:19], v[64:67]
v_add_u32 v160, 0x8000, v160
v_mfma_f32_16x16x32_bf16 v[72:75], a[56:59], a[20:23], v[72:75]
ds_read_b128 a[0:3], v160 offset:32768
v_mfma_f32_16x16x32_bf16 v[80:83], a[56:59], a[24:27], v[80:83]
ds_read_b128 a[4:7], v160 offset:34816
s_add_u32 m0, s58, 32768
s_add_u32 s52, s52, 196608
buffer_load_dwordx4 v164, s[16:19], s48 offen lds
v_mfma_f32_16x16x32_bf16 v[88:91], a[56:59], a[28:31], v[88:91]
ds_read_b128 a[8:11], v160 offset:36864
v_mfma_f32_16x16x32_bf16 v[68:71], a[60:63], a[16:19], v[68:71]
ds_read_b128 a[12:15], v160 offset:38912
v_mfma_f32_16x16x32_bf16 v[76:79], a[60:63], a[20:23], v[76:79]
s_setprio 2
v_mfma_f32_16x16x32_bf16 v[84:87], a[60:63], a[24:27], v[84:87]
ds_read_b64_tr_b16 a[32:33], v162 offset:24576
v_mfma_f32_16x16x32_bf16 v[92:95], a[60:63], a[28:31], v[92:95]
ds_read_b64_tr_b16 a[34:35], v162 offset:25600
s_add_u32 m0, s58, 33792
s_sub_u32 s48, s48, 896
buffer_load_dwordx4 v165, s[16:19], s49 offen lds
v_mfma_f32_16x16x32_bf16 v[32:35], a[64:67], a[16:19], v[32:35]
ds_read_b64_tr_b16 a[36:37], v163 offset:24576
v_mfma_f32_16x16x32_bf16 v[40:43], a[64:67], a[20:23], v[40:43]
ds_read_b64_tr_b16 a[38:39], v163 offset:25600
v_mfma_f32_16x16x32_bf16 v[48:51], a[64:67], a[24:27], v[48:51]
v_mfma_f32_16x16x32_bf16 v[56:59], a[64:67], a[28:31], v[56:59]
ds_read_b64_tr_b16 a[40:41], v162 offset:28672
s_setprio 1
v_mfma_f32_16x16x32_bf16 v[36:39], a[68:71], a[16:19], v[36:39]
ds_read_b64_tr_b16 a[42:43], v162 offset:29696
s_add_u32 m0, s57, 110592
s_sub_u32 s49, s49, 896
s_mov_b32 exec_hi, 0xffff
buffer_load_dwordx4 v170, s[20:23], s52 offen lds
s_mov_b32 exec_hi, -1
v_mfma_f32_16x16x32_bf16 v[44:47], a[68:71], a[20:23], v[44:47]
ds_read_b64_tr_b16 a[44:45], v163 offset:28672
v_mfma_f32_16x16x32_bf16 v[52:55], a[68:71], a[24:27], v[52:55]
ds_read_b64_tr_b16 a[46:47], v163 offset:29696
v_mfma_f32_16x16x32_bf16 v[60:63], a[68:71], a[28:31], v[60:63]
v_mfma_f32_16x16x32_bf16 v[0:3], a[16:19], a[72:75], v[0:3]
ds_read_b64_tr_b16 a[48:49], v162 offset:32768
v_mfma_f32_16x16x32_bf16 v[4:7], a[20:23], a[72:75], v[4:7]
ds_read_b64_tr_b16 a[50:51], v162 offset:33792
s_add_u32 m0, s57, 116736
s_mov_b32 exec_hi, 0xffff
buffer_load_dwordx4 v169, s[20:23], s52 offen lds
s_mov_b32 exec_hi, -1
s_setprio 0
v_mfma_f32_16x16x32_bf16 v[8:11], a[24:27], a[72:75], v[8:11]
ds_read_b64_tr_b16 a[52:53], v163 offset:32768
v_mfma_f32_16x16x32_bf16 v[12:15], a[28:31], a[72:75], v[12:15]
ds_read_b64_tr_b16 a[54:55], v163 offset:33792
v_mfma_f32_16x16x32_bf16 v[16:19], a[16:19], a[76:79], v[16:19]
v_mfma_f32_16x16x32_bf16 v[20:23], a[20:23], a[76:79], v[20:23]
v_mfma_f32_16x16x32_bf16 v[24:27], a[24:27], a[76:79], v[24:27]
v_mfma_f32_16x16x32_bf16 v[28:31], a[28:31], a[76:79], v[28:31]
s_waitcnt vmcnt(8) lgkmcnt(0)
s_barrier
s_setprio 3
v_mfma_f32_16x16x32_bf16 v[64:67], a[32:35], a[0:3], v[64:67]
v_add_u32 v161, 0x8000, v161
v_mfma_f32_16x16x32_bf16 v[72:75], a[32:35], a[4:7], v[72:75]
ds_read_b128 a[16:19], v161 offset:32768
v_mfma_f32_16x16x32_bf16 v[80:83], a[32:35], a[8:11], v[80:83]
ds_read_b128 a[20:23], v161 offset:34816
s_add_u32 m0, s58, 34816
s_add_u32 s52, s52, 196608
buffer_load_dwordx4 v164, s[16:19], s50 offen lds
v_mfma_f32_16x16x32_bf16 v[88:91], a[32:35], a[12:15], v[88:91]
ds_read_b128 a[24:27], v161 offset:36864
v_mfma_f32_16x16x32_bf16 v[68:71], a[36:39], a[0:3], v[68:71]
ds_read_b128 a[28:31], v161 offset:38912
v_mfma_f32_16x16x32_bf16 v[76:79], a[36:39], a[4:7], v[76:79]
s_setprio 2
v_mfma_f32_16x16x32_bf16 v[84:87], a[36:39], a[8:11], v[84:87]
ds_read_b64_tr_b16 a[56:57], v162 offset:36864
s_add_u32 m0, s58, 35840
s_sub_u32 s50, s50, 896
buffer_load_dwordx4 v165, s[16:19], s51 offen lds
v_mfma_f32_16x16x32_bf16 v[92:95], a[36:39], a[12:15], v[92:95]
ds_read_b64_tr_b16 a[58:59], v162 offset:37888
v_mfma_f32_16x16x32_bf16 v[32:35], a[40:43], a[0:3], v[32:35]
ds_read_b64_tr_b16 a[60:61], v163 offset:36864
v_mfma_f32_16x16x32_bf16 v[40:43], a[40:43], a[4:7], v[40:43]
ds_read_b64_tr_b16 a[62:63], v163 offset:37888
v_mfma_f32_16x16x32_bf16 v[48:51], a[40:43], a[8:11], v[48:51]
s_add_u32 m0, s57, 122880
s_sub_u32 s51, s51, 896
s_mov_b32 exec_hi, 0xffff
buffer_load_dwordx4 v170, s[20:23], s52 offen lds
s_mov_b32 exec_hi, -1
v_mfma_f32_16x16x32_bf16 v[56:59], a[40:43], a[12:15], v[56:59]
ds_read_b64_tr_b16 a[64:65], v162 offset:40960
s_setprio 1
v_mfma_f32_16x16x32_bf16 v[36:39], a[44:47], a[0:3], v[36:39]
ds_read_b64_tr_b16 a[66:67], v162 offset:41984
v_mfma_f32_16x16x32_bf16 v[44:47], a[44:47], a[4:7], v[44:47]
ds_read_b64_tr_b16 a[68:69], v163 offset:40960
v_mfma_f32_16x16x32_bf16 v[52:55], a[44:47], a[8:11], v[52:55]
ds_read_b64_tr_b16 a[70:71], v163 offset:41984
s_add_u32 m0, s57, 129024
s_mov_b32 exec_hi, 0xffff
buffer_load_dwordx4 v169, s[20:23], s52 offen lds
s_mov_b32 exec_hi, -1
v_mfma_f32_16x16x32_bf16 v[60:63], a[44:47], a[12:15], v[60:63]
v_mfma_f32_16x16x32_bf16 v[0:3], a[0:3], a[48:51], v[0:3]
ds_read_b64_tr_b16 a[72:73], v162 offset:45056
v_mfma_f32_16x16x32_bf16 v[4:7], a[4:7], a[48:51], v[4:7]
ds_read_b64_tr_b16 a[74:75], v162 offset:46080
s_setprio 0
v_mfma_f32_16x16x32_bf16 v[8:11], a[8:11], a[48:51], v[8:11]
ds_read_b64_tr_b16 a[76:77], v163 offset:45056
s_lshl_b32 s76, s2, 13
s_mov_b32 s32, s10
s_mov_b32 s33, s11
s_mov_b32 s34, 2097152
s_cmp_lg_u32 s87, 2
s_cbranch_scc1 k1_kernel_a_11
s_mov_b32 m0, 155648
s_nop 0
buffer_load_dword v173, s[32:35], s76 offen lds
k1_kernel_a_11:
s_add_u32 s76, s76, s59
v_mfma_f32_16x16x32_bf16 v[12:15], a[12:15], a[48:51], v[12:15]
ds_read_b64_tr_b16 a[78:79], v163 offset:46080
v_mfma_f32_16x16x32_bf16 v[16:19], a[0:3], a[52:55], v[16:19]
v_mfma_f32_16x16x32_bf16 v[20:23], a[4:7], a[52:55], v[20:23]
v_mfma_f32_16x16x32_bf16 v[24:27], a[8:11], a[52:55], v[24:27]
v_mfma_f32_16x16x32_bf16 v[28:31], a[12:15], a[52:55], v[28:31]
s_waitcnt vmcnt(8) lgkmcnt(0)
s_barrier
s_setprio 3
v_mfma_f32_16x16x32_bf16 v[64:67], a[56:59], a[16:19], v[64:67]
v_subrev_u32 v160, 0x8000, v160
v_mfma_f32_16x16x32_bf16 v[72:75], a[56:59], a[20:23], v[72:75]
ds_read_b128 a[0:3], v160 offset:0
v_mfma_f32_16x16x32_bf16 v[80:83], a[56:59], a[24:27], v[80:83]
ds_read_b128 a[4:7], v160 offset:2048
s_add_u32 m0, s57, 135168
s_add_u32 s52, s52, 196608
s_mov_b32 exec_hi, 0xffff
buffer_load_dwordx4 v170, s[20:23], s52 offen lds
s_mov_b32 exec_hi, -1
v_mfma_f32_16x16x32_bf16 v[88:91], a[56:59], a[28:31], v[88:91]
ds_read_b128 a[8:11], v160 offset:4096
v_mfma_f32_16x16x32_bf16 v[68:71], a[60:63], a[16:19], v[68:71]
ds_read_b128 a[12:15], v160 offset:6144
v_mfma_f32_16x16x32_bf16 v[76:79], a[60:63], a[20:23], v[76:79]
s_setprio 2
v_mfma_f32_16x16x32_bf16 v[84:87], a[60:63], a[24:27], v[84:87]
ds_read_b64_tr_b16 a[32:33], v162 offset:0
v_mfma_f32_16x16x32_bf16 v[92:95], a[60:63], a[28:31], v[92:95]
ds_read_b64_tr_b16 a[34:35], v162 offset:1024
v_mfma_f32_16x16x32_bf16 v[32:35], a[64:67], a[16:19], v[32:35]
ds_read_b64_tr_b16 a[36:37], v163 offset:0
v_mfma_f32_16x16x32_bf16 v[40:43], a[64:67], a[20:23], v[40:43]
ds_read_b64_tr_b16 a[38:39], v163 offset:1024
s_add_u32 m0, s57, 141312
s_mov_b32 exec_hi, 0xffff
buffer_load_dwordx4 v169, s[20:23], s52 offen lds
s_mov_b32 exec_hi, -1
v_mfma_f32_16x16x32_bf16 v[48:51], a[64:67], a[24:27], v[48:51]
v_mfma_f32_16x16x32_bf16 v[56:59], a[64:67], a[28:31], v[56:59]
ds_read_b64_tr_b16 a[40:41], v162 offset:4096
s_setprio 1
v_mfma_f32_16x16x32_bf16 v[36:39], a[68:71], a[16:19], v[36:39]
ds_read_b64_tr_b16 a[42:43], v162 offset:5120
v_mfma_f32_16x16x32_bf16 v[44:47], a[68:71], a[20:23], v[44:47]
ds_read_b64_tr_b16 a[44:45], v163 offset:4096
v_mfma_f32_16x16x32_bf16 v[52:55], a[68:71], a[24:27], v[52:55]
ds_read_b64_tr_b16 a[46:47], v163 offset:5120
v_mfma_f32_16x16x32_bf16 v[60:63], a[68:71], a[28:31], v[60:63]
v_mfma_f32_16x16x32_bf16 v[0:3], a[16:19], a[72:75], v[0:3]
ds_read_b64_tr_b16 a[48:49], v162 offset:8192
s_mov_b32 s32, s46
s_mov_b32 s33, s47
s_mov_b32 s34, 0x400000
s_cmp_lg_u32 s87, 5
s_cbranch_scc1 k1_kernel_a_12
s_mov_b32 m0, 155648
s_nop 0
buffer_load_dword off, s[32:35], s95 lds
k1_kernel_a_12:
v_mfma_f32_16x16x32_bf16 v[4:7], a[20:23], a[72:75], v[4:7]
ds_read_b64_tr_b16 a[50:51], v162 offset:9216
s_setprio 0
v_mfma_f32_16x16x32_bf16 v[8:11], a[24:27], a[72:75], v[8:11]
ds_read_b64_tr_b16 a[52:53], v163 offset:8192
v_mfma_f32_16x16x32_bf16 v[12:15], a[28:31], a[72:75], v[12:15]
ds_read_b64_tr_b16 a[54:55], v163 offset:9216
v_mfma_f32_16x16x32_bf16 v[16:19], a[16:19], a[76:79], v[16:19]
v_mfma_f32_16x16x32_bf16 v[20:23], a[20:23], a[76:79], v[20:23]
v_mfma_f32_16x16x32_bf16 v[24:27], a[24:27], a[76:79], v[24:27]
v_mfma_f32_16x16x32_bf16 v[28:31], a[28:31], a[76:79], v[28:31]
s_waitcnt vmcnt(6) lgkmcnt(0)
s_barrier
s_setprio 3
v_mfma_f32_16x16x32_bf16 v[64:67], a[32:35], a[0:3], v[64:67]
v_subrev_u32 v161, 0x8000, v161
v_mfma_f32_16x16x32_bf16 v[72:75], a[32:35], a[4:7], v[72:75]
ds_read_b128 a[16:19], v161 offset:0
v_mfma_f32_16x16x32_bf16 v[80:83], a[32:35], a[8:11], v[80:83]
ds_read_b128 a[20:23], v161 offset:2048
s_add_u32 m0, s62, 98304
s_add_u32 s52, s52, 196608
buffer_load_dwordx4 v166, s[28:31], s53 offen lds
v_mfma_f32_16x16x32_bf16 v[88:91], a[32:35], a[12:15], v[88:91]
ds_read_b128 a[24:27], v161 offset:4096
v_mfma_f32_16x16x32_bf16 v[68:71], a[36:39], a[0:3], v[68:71]
ds_read_b128 a[28:31], v161 offset:6144
v_mfma_f32_16x16x32_bf16 v[76:79], a[36:39], a[4:7], v[76:79]
s_setprio 2
v_mfma_f32_16x16x32_bf16 v[84:87], a[36:39], a[8:11], v[84:87]
ds_read_b64_tr_b16 a[56:57], v162 offset:12288
v_mfma_f32_16x16x32_bf16 v[92:95], a[36:39], a[12:15], v[92:95]
ds_read_b64_tr_b16 a[58:59], v162 offset:13312
v_mfma_f32_16x16x32_bf16 v[32:35], a[40:43], a[0:3], v[32:35]
ds_read_b64_tr_b16 a[60:61], v163 offset:12288
v_mfma_f32_16x16x32_bf16 v[40:43], a[40:43], a[4:7], v[40:43]
ds_read_b64_tr_b16 a[62:63], v163 offset:13312
v_mfma_f32_16x16x32_bf16 v[48:51], a[40:43], a[8:11], v[48:51]
v_mfma_f32_16x16x32_bf16 v[56:59], a[40:43], a[12:15], v[56:59]
ds_read_b64_tr_b16 a[64:65], v162 offset:16384
s_setprio 1
v_mfma_f32_16x16x32_bf16 v[36:39], a[44:47], a[0:3], v[36:39]
ds_read_b64_tr_b16 a[66:67], v162 offset:17408
v_mfma_f32_16x16x32_bf16 v[44:47], a[44:47], a[4:7], v[44:47]
ds_read_b64_tr_b16 a[68:69], v163 offset:16384
v_mfma_f32_16x16x32_bf16 v[52:55], a[44:47], a[8:11], v[52:55]
ds_read_b64_tr_b16 a[70:71], v163 offset:17408
v_mfma_f32_16x16x32_bf16 v[60:63], a[44:47], a[12:15], v[60:63]
v_mfma_f32_16x16x32_bf16 v[0:3], a[0:3], a[48:51], v[0:3]
ds_read_b64_tr_b16 a[72:73], v162 offset:20480
v_mfma_f32_16x16x32_bf16 v[4:7], a[4:7], a[48:51], v[4:7]
ds_read_b64_tr_b16 a[74:75], v162 offset:21504
s_setprio 0
v_mfma_f32_16x16x32_bf16 v[8:11], a[8:11], a[48:51], v[8:11]
ds_read_b64_tr_b16 a[76:77], v163 offset:20480
v_mfma_f32_16x16x32_bf16 v[12:15], a[12:15], a[48:51], v[12:15]
ds_read_b64_tr_b16 a[78:79], v163 offset:21504
v_mfma_f32_16x16x32_bf16 v[16:19], a[0:3], a[52:55], v[16:19]
v_mfma_f32_16x16x32_bf16 v[20:23], a[4:7], a[52:55], v[20:23]
v_mfma_f32_16x16x32_bf16 v[24:27], a[8:11], a[52:55], v[24:27]
v_mfma_f32_16x16x32_bf16 v[28:31], a[12:15], a[52:55], v[28:31]
s_waitcnt vmcnt(3) lgkmcnt(0)
s_barrier
s_cmp_lg_u32 s87, 0
s_cbranch_scc1 k1_kernel_a_c_pi
v_lshrrev_b32 v172, 2, v171
buffer_load_dword v172, v172, s[96:99], 0 offen sc1
k1_kernel_a_c_pi:
s_setprio 3
v_mfma_f32_16x16x32_bf16 v[64:67], a[56:59], a[16:19], v[64:67]
ds_read_b128 a[0:3], v160 offset:32768
s_mov_b32 s32, s60
v_mfma_f32_16x16x32_bf16 v[72:75], a[56:59], a[20:23], v[72:75]
ds_read_b128 a[4:7], v160 offset:34816
v_mfma_f32_16x16x32_bf16 v[80:83], a[56:59], a[24:27], v[80:83]
ds_read_b128 a[8:11], v160 offset:36864
s_mov_b32 s33, s61
s_add_u32 m0, s62, 106496
s_add_u32 s53, s53, 229376
buffer_load_dwordx4 v166, s[28:31], s53 offen lds
v_mfma_f32_16x16x32_bf16 v[88:91], a[56:59], a[28:31], v[88:91]
ds_read_b128 a[12:15], v160 offset:38912
v_mfma_f32_16x16x32_bf16 v[68:71], a[60:63], a[16:19], v[68:71]
s_mov_b32 s34, 7340032
v_mfma_f32_16x16x32_bf16 v[76:79], a[60:63], a[20:23], v[76:79]
ds_read_b64_tr_b16 a[32:33], v162 offset:24576
s_setprio 2
v_mfma_f32_16x16x32_bf16 v[84:87], a[60:63], a[24:27], v[84:87]
ds_read_b64_tr_b16 a[34:35], v162 offset:25600
s_mov_b32 s20, s10
v_mfma_f32_16x16x32_bf16 v[92:95], a[60:63], a[28:31], v[92:95]
ds_read_b64_tr_b16 a[36:37], v163 offset:24576
v_mfma_f32_16x16x32_bf16 v[32:35], a[64:67], a[16:19], v[32:35]
s_mov_b32 s21, s11
v_mfma_f32_16x16x32_bf16 v[40:43], a[64:67], a[20:23], v[40:43]
ds_read_b64_tr_b16 a[38:39], v163 offset:25600
v_mfma_f32_16x16x32_bf16 v[48:51], a[64:67], a[24:27], v[48:51]
ds_read_b64_tr_b16 a[40:41], v162 offset:28672
s_mov_b32 s22, 2097152
v_mfma_f32_16x16x32_bf16 v[56:59], a[64:67], a[28:31], v[56:59]
ds_read_b64_tr_b16 a[42:43], v162 offset:29696
s_setprio 1
v_mfma_f32_16x16x32_bf16 v[36:39], a[68:71], a[16:19], v[36:39]
s_mov_b32 s24, s46
s_add_u32 m0, s62, 114688
s_add_u32 s53, s53, 229376
buffer_load_dwordx4 v166, s[28:31], s53 offen lds
v_mfma_f32_16x16x32_bf16 v[44:47], a[68:71], a[20:23], v[44:47]
ds_read_b64_tr_b16 a[44:45], v163 offset:28672
v_mfma_f32_16x16x32_bf16 v[52:55], a[68:71], a[24:27], v[52:55]
ds_read_b64_tr_b16 a[46:47], v163 offset:29696
s_mov_b32 s25, s47
v_mfma_f32_16x16x32_bf16 v[60:63], a[68:71], a[28:31], v[60:63]
ds_read_b64_tr_b16 a[48:49], v162 offset:32768
v_mfma_f32_16x16x32_bf16 v[0:3], a[16:19], a[72:75], v[0:3]
s_mov_b32 s26, 0x400000
v_mfma_f32_16x16x32_bf16 v[4:7], a[20:23], a[72:75], v[4:7]
ds_read_b64_tr_b16 a[50:51], v162 offset:33792
s_setprio 0
v_mfma_f32_16x16x32_bf16 v[8:11], a[24:27], a[72:75], v[8:11]
ds_read_b64_tr_b16 a[52:53], v163 offset:32768
s_mov_b32 s27, 0x00020000
v_mfma_f32_16x16x32_bf16 v[12:15], a[28:31], a[72:75], v[12:15]
ds_read_b64_tr_b16 a[54:55], v163 offset:33792
v_mfma_f32_16x16x32_bf16 v[16:19], a[16:19], a[76:79], v[16:19]
v_mfma_f32_16x16x32_bf16 v[20:23], a[20:23], a[76:79], v[20:23]
v_mfma_f32_16x16x32_bf16 v[24:27], a[24:27], a[76:79], v[24:27]
v_mfma_f32_16x16x32_bf16 v[28:31], a[28:31], a[76:79], v[28:31]
s_waitcnt vmcnt(3) lgkmcnt(0)
s_barrier
s_setprio 3
v_mfma_f32_16x16x32_bf16 v[64:67], a[32:35], a[0:3], v[64:67]
ds_read_b128 a[16:19], v161 offset:32768
v_mfma_f32_16x16x32_bf16 v[72:75], a[32:35], a[4:7], v[72:75]
ds_read_b128 a[20:23], v161 offset:34816
v_mfma_f32_16x16x32_bf16 v[80:83], a[32:35], a[8:11], v[80:83]
ds_read_b128 a[24:27], v161 offset:36864
s_add_u32 m0, s62, 122880
s_add_u32 s53, s53, 229376
buffer_load_dwordx4 v166, s[28:31], s53 offen lds
v_mfma_f32_16x16x32_bf16 v[88:91], a[32:35], a[12:15], v[88:91]
ds_read_b128 a[28:31], v161 offset:38912
v_mfma_f32_16x16x32_bf16 v[68:71], a[36:39], a[0:3], v[68:71]
v_mfma_f32_16x16x32_bf16 v[76:79], a[36:39], a[4:7], v[76:79]
ds_read_b64_tr_b16 a[56:57], v162 offset:36864
s_setprio 2
v_mfma_f32_16x16x32_bf16 v[84:87], a[36:39], a[8:11], v[84:87]
ds_read_b64_tr_b16 a[58:59], v162 offset:37888
v_mfma_f32_16x16x32_bf16 v[92:95], a[36:39], a[12:15], v[92:95]
ds_read_b64_tr_b16 a[60:61], v163 offset:36864
v_mfma_f32_16x16x32_bf16 v[32:35], a[40:43], a[0:3], v[32:35]
v_mfma_f32_16x16x32_bf16 v[40:43], a[40:43], a[4:7], v[40:43]
ds_read_b64_tr_b16 a[62:63], v163 offset:37888
v_mfma_f32_16x16x32_bf16 v[48:51], a[40:43], a[8:11], v[48:51]
ds_read_b64_tr_b16 a[64:65], v162 offset:40960
v_mfma_f32_16x16x32_bf16 v[56:59], a[40:43], a[12:15], v[56:59]
ds_read_b64_tr_b16 a[66:67], v162 offset:41984
s_setprio 1
v_mfma_f32_16x16x32_bf16 v[36:39], a[44:47], a[0:3], v[36:39]
v_mfma_f32_16x16x32_bf16 v[44:47], a[44:47], a[4:7], v[44:47]
ds_read_b64_tr_b16 a[68:69], v163 offset:40960
v_mfma_f32_16x16x32_bf16 v[52:55], a[44:47], a[8:11], v[52:55]
ds_read_b64_tr_b16 a[70:71], v163 offset:41984
v_mfma_f32_16x16x32_bf16 v[60:63], a[44:47], a[12:15], v[60:63]
ds_read_b64_tr_b16 a[72:73], v162 offset:45056
v_mfma_f32_16x16x32_bf16 v[0:3], a[0:3], a[48:51], v[0:3]
v_mfma_f32_16x16x32_bf16 v[4:7], a[4:7], a[48:51], v[4:7]
ds_read_b64_tr_b16 a[74:75], v162 offset:46080
s_setprio 0
v_mfma_f32_16x16x32_bf16 v[8:11], a[8:11], a[48:51], v[8:11]
ds_read_b64_tr_b16 a[76:77], v163 offset:45056
v_mfma_f32_16x16x32_bf16 v[12:15], a[12:15], a[48:51], v[12:15]
ds_read_b64_tr_b16 a[78:79], v163 offset:46080
v_mfma_f32_16x16x32_bf16 v[16:19], a[0:3], a[52:55], v[16:19]
v_mfma_f32_16x16x32_bf16 v[20:23], a[4:7], a[52:55], v[20:23]
v_mfma_f32_16x16x32_bf16 v[24:27], a[8:11], a[52:55], v[24:27]
v_mfma_f32_16x16x32_bf16 v[28:31], a[12:15], a[52:55], v[28:31]
s_waitcnt vmcnt(3) lgkmcnt(0)
s_cmp_lg_u32 s87, 0
s_cbranch_scc1 k1_kernel_a_c_pc_rdy
s_waitcnt vmcnt(3)
v_cmp_le_u32 s[100:101], 4, v172
s_nop 0
s_cmp_eq_u64 s[100:101], -1
s_cbranch_scc1 k1_kernel_a_c_pc_rdy
s_mov_b32 s91, 40000
k1_kernel_a_c_pc_spin:
s_sleep 2
v_lshrrev_b32 v172, 2, v171
buffer_load_dword v172, v172, s[96:99], 0 offen sc1
s_waitcnt vmcnt(0)
v_cmp_le_u32 s[100:101], 4, v172
s_nop 0
s_cmp_eq_u64 s[100:101], -1
s_cbranch_scc1 k1_kernel_a_c_pc_rdy
s_sub_u32 s91, s91, 1
s_cmp_lg_u32 s91, 0
s_cbranch_scc1 k1_kernel_a_c_pc_spin
s_nop 0
k1_kernel_a_c_pc_rdy:
s_barrier
s_setprio 3
v_mfma_f32_16x16x32_bf16 v[64:67], a[56:59], a[16:19], v[64:67]
v_add_u32 v160, 0x8000, v160
v_mfma_f32_16x16x32_bf16 v[72:75], a[56:59], a[20:23], v[72:75]
ds_read_b128 a[0:3], v160 offset:32768
v_mfma_f32_16x16x32_bf16 v[80:83], a[56:59], a[24:27], v[80:83]
s_add_u32 m0, s62, 131072
s_add_u32 s53, s53, 229376
buffer_load_dwordx4 v166, s[28:31], s53 offen lds
v_mfma_f32_16x16x32_bf16 v[88:91], a[56:59], a[28:31], v[88:91]
ds_read_b128 a[4:7], v160 offset:34816
v_mfma_f32_16x16x32_bf16 v[68:71], a[60:63], a[16:19], v[68:71]
ds_read_b128 a[8:11], v160 offset:36864
v_mfma_f32_16x16x32_bf16 v[76:79], a[60:63], a[20:23], v[76:79]
s_setprio 2
v_mfma_f32_16x16x32_bf16 v[84:87], a[60:63], a[24:27], v[84:87]
ds_read_b128 a[12:15], v160 offset:38912
v_mfma_f32_16x16x32_bf16 v[92:95], a[60:63], a[28:31], v[92:95]
v_mfma_f32_16x16x32_bf16 v[32:35], a[64:67], a[16:19], v[32:35]
ds_read_b64_tr_b16 a[32:33], v162 offset:0
v_mfma_f32_16x16x32_bf16 v[40:43], a[64:67], a[20:23], v[40:43]
ds_read_b64_tr_b16 a[34:35], v162 offset:1024
v_mfma_f32_16x16x32_bf16 v[48:51], a[64:67], a[24:27], v[48:51]
v_mfma_f32_16x16x32_bf16 v[56:59], a[64:67], a[28:31], v[56:59]
ds_read_b64_tr_b16 a[36:37], v163 offset:0
s_setprio 1
v_mfma_f32_16x16x32_bf16 v[36:39], a[68:71], a[16:19], v[36:39]
ds_read_b64_tr_b16 a[38:39], v163 offset:1024
s_add_u32 m0, s62, 139264
s_add_u32 s53, s53, 229376
buffer_load_dwordx4 v166, s[28:31], s53 offen lds
v_mfma_f32_16x16x32_bf16 v[44:47], a[68:71], a[20:23], v[44:47]
v_mfma_f32_16x16x32_bf16 v[52:55], a[68:71], a[24:27], v[52:55]
ds_read_b64_tr_b16 a[40:41], v162 offset:4096
v_mfma_f32_16x16x32_bf16 v[60:63], a[68:71], a[28:31], v[60:63]
v_mfma_f32_16x16x32_bf16 v[0:3], a[16:19], a[72:75], v[0:3]
ds_read_b64_tr_b16 a[42:43], v162 offset:5120
v_mfma_f32_16x16x32_bf16 v[4:7], a[20:23], a[72:75], v[4:7]
ds_read_b64_tr_b16 a[44:45], v163 offset:4096
s_setprio 0
v_mfma_f32_16x16x32_bf16 v[8:11], a[24:27], a[72:75], v[8:11]
v_mfma_f32_16x16x32_bf16 v[12:15], a[28:31], a[72:75], v[12:15]
ds_read_b64_tr_b16 a[46:47], v163 offset:5120
v_mfma_f32_16x16x32_bf16 v[16:19], a[16:19], a[76:79], v[16:19]
v_mfma_f32_16x16x32_bf16 v[20:23], a[20:23], a[76:79], v[20:23]
v_mfma_f32_16x16x32_bf16 v[24:27], a[24:27], a[76:79], v[24:27]
v_mfma_f32_16x16x32_bf16 v[28:31], a[28:31], a[76:79], v[28:31]
s_waitcnt vmcnt(4) lgkmcnt(0)
s_barrier
s_setprio 3
v_mfma_f32_16x16x32_bf16 v[96:99], a[32:35], a[0:3], v[96:99]
v_add_u32 v161, 0x8000, v161
v_add_u32 v167, s74, v171
ds_read_b128 a[48:51], v167
ds_read_b128 a[52:55], v167 offset:1024
v_cvt_pk_bf16_f32 v32, v32, v33
v_cvt_pk_bf16_f32 v33, v34, v35
v_cvt_pk_bf16_f32 v34, v36, v37
v_mfma_f32_16x16x32_bf16 v[112:115], a[32:35], a[4:7], v[112:115]
ds_read_b128 a[16:19], v161 offset:32768
v_cvt_pk_bf16_f32 v35, v38, v39
v_cvt_pk_bf16_f32 v40, v40, v41
v_cvt_pk_bf16_f32 v41, v42, v43
v_cvt_pk_bf16_f32 v42, v44, v45
v_cvt_pk_bf16_f32 v43, v46, v47
v_cvt_pk_bf16_f32 v48, v48, v49
v_mfma_f32_16x16x32_bf16 v[128:131], a[32:35], a[8:11], v[128:131]
ds_read_b128 a[20:23], v161 offset:34816
s_add_u32 m0, s62, 98304
s_sub_u32 s53, s53, 3440640
buffer_load_dwordx4 v166, s[28:31], s53 offen lds
v_cvt_pk_bf16_f32 v49, v50, v51
v_cvt_pk_bf16_f32 v50, v52, v53
v_cvt_pk_bf16_f32 v51, v54, v55
v_cvt_pk_bf16_f32 v56, v56, v57
v_cvt_pk_bf16_f32 v57, v58, v59
v_cvt_pk_bf16_f32 v58, v60, v61
v_mfma_f32_16x16x32_bf16 v[144:147], a[32:35], a[12:15], v[144:147]
ds_read_b128 a[24:27], v161 offset:36864
v_cvt_pk_bf16_f32 v59, v62, v63
s_waitcnt lgkmcnt(3)
v_mfma_f32_16x16x32_bf16 v[52:55], a[48:51], v[32:35], 0
v_mfma_f32_16x16x32_bf16 v[60:63], a[52:55], v[32:35], 0
v_mfma_f32_16x16x32_bf16 v[36:39], a[48:51], v[40:43], 0
s_setprio 2
v_mfma_f32_16x16x32_bf16 v[100:103], a[36:39], a[0:3], v[100:103]
ds_read_b128 a[28:31], v161 offset:38912
v_mfma_f32_16x16x32_bf16 v[44:47], a[52:55], v[40:43], 0
v_cvt_pk_bf16_f32 v64, v64, v65
v_cvt_pk_bf16_f32 v65, v66, v67
v_cvt_pk_bf16_f32 v66, v68, v69
v_cvt_pk_bf16_f32 v67, v70, v71
v_mfma_f32_16x16x32_bf16 v[116:119], a[36:39], a[4:7], v[116:119]
ds_read_b64_tr_b16 a[56:57], v162 offset:8192
v_cvt_pk_bf16_f32 v72, v72, v73
v_cvt_pk_bf16_f32 v73, v74, v75
v_cvt_pk_bf16_f32 v74, v76, v77
v_cvt_pk_bf16_f32 v75, v78, v79
v_cvt_pk_bf16_f32 v80, v80, v81
v_cvt_pk_bf16_f32 v81, v82, v83
v_mfma_f32_16x16x32_bf16 v[132:135], a[36:39], a[8:11], v[132:135]
ds_read_b64_tr_b16 a[58:59], v162 offset:9216
v_cvt_pk_bf16_f32 v82, v84, v85
v_cvt_pk_bf16_f32 v83, v86, v87
v_cvt_pk_bf16_f32 v88, v88, v89
v_cvt_pk_bf16_f32 v89, v90, v91
v_cvt_pk_bf16_f32 v90, v92, v93
v_cvt_pk_bf16_f32 v91, v94, v95
v_mfma_f32_16x16x32_bf16 v[148:151], a[36:39], a[12:15], v[148:151]
ds_read_b64_tr_b16 a[60:61], v163 offset:8192
v_lshrrev_b32 v167, 4, v171
v_and_b32 v168, 15, v167
v_lshrrev_b32 v167, 4, v167
v_lshrrev_b32 v169, 2, v168
v_xor_b32 v167, v167, v169
v_and_b32 v169, 1, v168
s_setprio 1
v_mfma_f32_16x16x32_bf16 v[104:107], a[40:43], a[0:3], v[104:107]
ds_read_b64_tr_b16 a[62:63], v163 offset:9216
v_lshlrev_b32 v169, 4, v169
v_mov_b32 v170, 0x3f80
v_lshlrev_b32 v169, v169, v170
v_sub_u32 v167, v167, 1
v_ashrrev_i32 v167, 31, v167
v_and_b32 v169, v169, v167
v_mfma_f32_16x16x32_bf16 v[120:123], a[40:43], a[4:7], v[120:123]
ds_read_b64_tr_b16 a[64:65], v162 offset:12288
v_lshlrev_b32 v168, 30, v168
v_ashrrev_i32 v168, 31, v168
v_and_b32 v170, v169, v168
v_xor_b32 v169, v169, v170
s_and_b32 s57, s88, 1
s_sub_u32 s57, 0, s57
v_and_b32 v167, s57, v169
v_mfma_f32_16x16x32_bf16 v[136:139], a[40:43], a[8:11], v[136:139]
ds_read_b64_tr_b16 a[66:67], v162 offset:13312
v_and_b32 v168, s57, v170
v_xor_b32 v169, v169, v167
v_xor_b32 v170, v170, v168
v_accvgpr_write_b32 a72, v167
v_accvgpr_write_b32 a73, v168
v_accvgpr_write_b32 a74, v169
v_mfma_f32_16x16x32_bf16 v[152:155], a[40:43], a[12:15], v[152:155]
ds_read_b64_tr_b16 a[68:69], v163 offset:12288
v_accvgpr_write_b32 a75, v170
v_accvgpr_write_b32 a76, v167
v_accvgpr_write_b32 a77, v168
v_cvt_pk_bf16_f32 v0, v0, v1
v_cvt_pk_bf16_f32 v1, v2, v3
v_cvt_pk_bf16_f32 v2, v4, v5
s_setprio 0
v_mfma_f32_16x16x32_bf16 v[108:111], a[44:47], a[0:3], v[108:111]
ds_read_b64_tr_b16 a[70:71], v163 offset:13312
v_cvt_pk_bf16_f32 v3, v6, v7
v_cvt_pk_bf16_f32 v8, v8, v9
v_cvt_pk_bf16_f32 v9, v10, v11
v_cvt_pk_bf16_f32 v10, v12, v13
v_cvt_pk_bf16_f32 v11, v14, v15
v_cvt_pk_bf16_f32 v16, v16, v17
v_mfma_f32_16x16x32_bf16 v[124:127], a[44:47], a[4:7], v[124:127]
v_cvt_pk_bf16_f32 v17, v18, v19
v_cvt_pk_bf16_f32 v18, v20, v21
v_cvt_pk_bf16_f32 v19, v22, v23
v_cvt_pk_bf16_f32 v24, v24, v25
v_cvt_pk_bf16_f32 v25, v26, v27
v_cvt_pk_bf16_f32 v26, v28, v29
v_mfma_f32_16x16x32_bf16 v[140:143], a[44:47], a[8:11], v[140:143]
v_cvt_pk_bf16_f32 v27, v30, v31
v_mov_b32 v32, 0x3f803f80
v_mov_b32 v33, 0x3f803f80
v_mov_b32 v34, 0x3f803f80
v_mov_b32 v35, 0x3f803f80
v_max3_f32 v167, v52, v53, v54
v_mfma_f32_16x16x32_bf16 v[156:159], a[44:47], a[12:15], v[156:159]
v_max3_f32 v168, -v52, -v53, -v54
v_max3_f32 v167, v167, v55, v60
v_max3_f32 v168, v168, -v55, -v60
v_max3_f32 v167, v167, v61, v62
v_max3_f32 v168, v168, -v61, -v62
v_max_f32 v167, v167, v63
s_waitcnt vmcnt(4) lgkmcnt(0)
s_barrier
s_setprio 3
v_mfma_f32_16x16x32_bf16 v[96:99], a[56:59], a[16:19], v[96:99]
v_subrev_u32 v160, 0x8000, v160
v_max_f32 v168, v168, -v63
s_nop 1
v_permlane16_swap_b32 v167, v168
v_max_f32 v167, v167, v168
v_mov_b32 v168, v167
s_nop 1
v_permlane32_swap_b32 v167, v168
v_max_f32 v167, v167, v168
v_mfma_f32_16x16x32_bf16 v[112:115], a[56:59], a[20:23], v[112:115]
ds_read_b128 a[0:3], v160 offset:0
v_mul_f32 v167, s9, v167
v_mov_b32 v168, v167
s_nop 1
v_permlane16_swap_b32 v167, v168
v_fma_f32 v68, -v52, s9, -v168
v_fma_f32 v52, v52, s9, -v167
v_fma_f32 v69, -v53, s9, -v168
v_mfma_f32_16x16x32_bf16 v[128:131], a[56:59], a[24:27], v[128:131]
ds_read_b128 a[4:7], v160 offset:2048
s_add_u32 m0, s58, 65536
s_add_u32 s53, s53, 229376
buffer_load_dwordx4 v164, s[16:19], s48 offen lds
v_fma_f32 v53, v53, s9, -v167
v_fma_f32 v70, -v54, s9, -v168
v_fma_f32 v54, v54, s9, -v167
v_fma_f32 v71, -v55, s9, -v168
v_fma_f32 v55, v55, s9, -v167
v_fma_f32 v76, -v60, s9, -v168
v_mfma_f32_16x16x32_bf16 v[144:147], a[56:59], a[28:31], v[144:147]
ds_read_b128 a[8:11], v160 offset:4096
v_fma_f32 v60, v60, s9, -v167
v_fma_f32 v77, -v61, s9, -v168
v_fma_f32 v61, v61, s9, -v167
v_fma_f32 v78, -v62, s9, -v168
v_fma_f32 v62, v62, s9, -v167
v_fma_f32 v79, -v63, s9, -v168
s_setprio 2
v_mfma_f32_16x16x32_bf16 v[100:103], a[60:63], a[16:19], v[100:103]
ds_read_b128 a[12:15], v160 offset:6144
v_fma_f32 v63, v63, s9, -v167
v_exp_f32 v52, v52
v_exp_f32 v53, v53
v_exp_f32 v54, v54
v_mfma_f32_16x16x32_bf16 v[116:119], a[60:63], a[20:23], v[116:119]
ds_read_b64_tr_b16 a[32:33], v162 offset:16384
v_exp_f32 v55, v55
v_exp_f32 v60, v60
v_exp_f32 v61, v61
v_mfma_f32_16x16x32_bf16 v[132:135], a[60:63], a[24:27], v[132:135]
ds_read_b64_tr_b16 a[34:35], v162 offset:17408
s_add_u32 m0, s58, 66560
s_add_u32 s48, s48, 128
buffer_load_dwordx4 v165, s[16:19], s49 offen lds
v_exp_f32 v62, v62
v_exp_f32 v63, v63
v_cvt_pk_bf16_f32 v84, v52, v53
v_cvt_pk_bf16_f32 v85, v54, v55
v_mfma_f32_16x16x32_bf16 v[148:151], a[60:63], a[28:31], v[148:151]
ds_read_b64_tr_b16 a[36:37], v163 offset:16384
v_cvt_pk_bf16_f32 v86, v60, v61
v_cvt_pk_bf16_f32 v87, v62, v63
v_exp_f32 v68, v68
v_exp_f32 v69, v69
s_setprio 1
v_mfma_f32_16x16x32_bf16 v[104:107], a[64:67], a[16:19], v[104:107]
ds_read_b64_tr_b16 a[38:39], v163 offset:17408
v_mfma_f32_16x16x32_bf16 v[84:87], v[32:35], v[84:87], 0
v_exp_f32 v70, v70
v_exp_f32 v71, v71
v_mfma_f32_16x16x32_bf16 v[120:123], a[64:67], a[20:23], v[120:123]
ds_read_b64_tr_b16 a[40:41], v162 offset:20480
v_exp_f32 v76, v76
v_exp_f32 v77, v77
v_exp_f32 v78, v78
v_mfma_f32_16x16x32_bf16 v[136:139], a[64:67], a[24:27], v[136:139]
ds_read_b64_tr_b16 a[42:43], v162 offset:21504
s_add_u32 m0, s62, 106496
s_add_u32 s49, s49, 128
buffer_load_dwordx4 v166, s[28:31], s53 offen lds
v_exp_f32 v79, v79
v_cvt_pk_bf16_f32 v92, v68, v69
v_cvt_pk_bf16_f32 v93, v70, v71
v_cvt_pk_bf16_f32 v94, v76, v77
v_cvt_pk_bf16_f32 v95, v78, v79
v_mfma_f32_16x16x32_bf16 v[152:155], a[64:67], a[28:31], v[152:155]
ds_read_b64_tr_b16 a[44:45], v163 offset:20480
v_rcp_f32 v167, v84
v_mfma_f32_16x16x32_bf16 v[92:95], v[32:35], v[92:95], 0
v_mul_f32 v52, v52, v167
v_mul_f32 v53, v53, v167
s_setprio 0
v_mfma_f32_16x16x32_bf16 v[108:111], a[68:71], a[16:19], v[108:111]
ds_read_b64_tr_b16 a[46:47], v163 offset:21504
v_mul_f32 v54, v54, v167
v_mul_f32 v55, v55, v167
v_mul_f32 v60, v60, v167
v_mul_f32 v61, v61, v167
v_mul_f32 v62, v62, v167
v_mul_f32 v63, v63, v167
v_mfma_f32_16x16x32_bf16 v[124:127], a[68:71], a[20:23], v[124:127]
v_cvt_pk_bf16_f32 v52, v52, v53
v_cvt_pk_bf16_f32 v53, v54, v55
v_cvt_pk_bf16_f32 v54, v60, v61
v_cvt_pk_bf16_f32 v55, v62, v63
v_rcp_f32 v168, v92
v_mfma_f32_16x16x32_bf16 v[140:143], a[68:71], a[24:27], v[140:143]
v_mul_f32 v68, v68, v168
v_mul_f32 v69, v69, v168
v_mul_f32 v70, v70, v168
v_mul_f32 v71, v71, v168
v_mul_f32 v76, v76, v168
v_mul_f32 v77, v77, v168
v_mfma_f32_16x16x32_bf16 v[156:159], a[68:71], a[28:31], v[156:159]
v_mul_f32 v78, v78, v168
v_mul_f32 v79, v79, v168
v_cvt_pk_bf16_f32 v60, v68, v69
v_cvt_pk_bf16_f32 v61, v70, v71
v_cvt_pk_bf16_f32 v62, v76, v77
v_cvt_pk_bf16_f32 v63, v78, v79
s_waitcnt vmcnt(6) lgkmcnt(0)
s_barrier
s_setprio 3
v_mfma_f32_16x16x32_bf16 v[96:99], a[32:35], a[0:3], v[96:99]
v_subrev_u32 v161, 0x8000, v161
v_mfma_f32_16x16x32_bf16 v[68:71], v[52:55], a[74:77], 0
v_mfma_f32_16x16x32_bf16 v[76:79], v[52:55], a[72:75], 0
v_mfma_f32_16x16x32_bf16 v[84:87], v[60:63], a[74:77], 0
v_mfma_f32_16x16x32_bf16 v[112:115], a[32:35], a[4:7], v[112:115]
ds_read_b128 a[16:19], v161 offset:0
v_mfma_f32_16x16x32_bf16 v[92:95], v[60:63], a[72:75], 0
v_mfma_f32_16x16x32_bf16 v[52:55], a[48:51], v[48:51], 0
v_mfma_f32_16x16x32_bf16 v[60:63], a[52:55], v[48:51], 0
v_mfma_f32_16x16x32_bf16 v[128:131], a[32:35], a[8:11], v[128:131]
ds_read_b128 a[20:23], v161 offset:2048
s_add_u32 m0, s58, 67584
s_add_u32 s53, s53, 229376
buffer_load_dwordx4 v164, s[16:19], s50 offen lds
v_mfma_f32_16x16x32_bf16 v[144:147], a[32:35], a[12:15], v[144:147]
ds_read_b128 a[24:27], v161 offset:4096
s_setprio 2
v_mfma_f32_16x16x32_bf16 v[100:103], a[36:39], a[0:3], v[100:103]
ds_read_b128 a[28:31], v161 offset:6144
v_cvt_pk_bf16_f32 v4, v68, v69
v_cvt_pk_bf16_f32 v5, v70, v71
v_cvt_pk_bf16_f32 v12, v76, v77
v_cvt_pk_bf16_f32 v13, v78, v79
v_cvt_pk_bf16_f32 v20, v84, v85
v_cvt_pk_bf16_f32 v21, v86, v87
v_mfma_f32_16x16x32_bf16 v[116:119], a[36:39], a[4:7], v[116:119]
ds_read_b64_tr_b16 a[56:57], v162 offset:24576
v_cvt_pk_bf16_f32 v28, v92, v93
v_cvt_pk_bf16_f32 v29, v94, v95
v_max3_f32 v167, v36, v37, v38
v_max3_f32 v168, -v36, -v37, -v38
v_max3_f32 v167, v167, v39, v44
v_max3_f32 v168, v168, -v39, -v44
v_mfma_f32_16x16x32_bf16 v[132:135], a[36:39], a[8:11], v[132:135]
ds_read_b64_tr_b16 a[58:59], v162 offset:25600
s_add_u32 m0, s58, 68608
s_add_u32 s50, s50, 128
buffer_load_dwordx4 v165, s[16:19], s51 offen lds
v_max3_f32 v167, v167, v45, v46
v_max3_f32 v168, v168, -v45, -v46
v_max_f32 v167, v167, v47
v_max_f32 v168, v168, -v47
s_nop 1
v_permlane16_swap_b32 v167, v168
v_max_f32 v167, v167, v168
v_mfma_f32_16x16x32_bf16 v[148:151], a[36:39], a[12:15], v[148:151]
ds_read_b64_tr_b16 a[60:61], v163 offset:24576
v_mov_b32 v168, v167
s_nop 1
v_permlane32_swap_b32 v167, v168
v_max_f32 v167, v167, v168
v_mul_f32 v167, s9, v167
v_mov_b32 v168, v167
s_nop 1
v_permlane16_swap_b32 v167, v168
s_setprio 1
v_mfma_f32_16x16x32_bf16 v[104:107], a[40:43], a[0:3], v[104:107]
ds_read_b64_tr_b16 a[62:63], v163 offset:25600
v_fma_f32 v68, -v36, s9, -v168
v_fma_f32 v36, v36, s9, -v167
v_fma_f32 v69, -v37, s9, -v168
v_fma_f32 v37, v37, s9, -v167
v_fma_f32 v70, -v38, s9, -v168
v_fma_f32 v38, v38, s9, -v167
v_mfma_f32_16x16x32_bf16 v[120:123], a[40:43], a[4:7], v[120:123]
ds_read_b64_tr_b16 a[64:65], v162 offset:28672
v_fma_f32 v71, -v39, s9, -v168
v_fma_f32 v39, v39, s9, -v167
v_fma_f32 v76, -v44, s9, -v168
v_fma_f32 v44, v44, s9, -v167
v_fma_f32 v77, -v45, s9, -v168
v_fma_f32 v45, v45, s9, -v167
v_mfma_f32_16x16x32_bf16 v[136:139], a[40:43], a[8:11], v[136:139]
ds_read_b64_tr_b16 a[66:67], v162 offset:29696
s_add_u32 m0, s62, 114688
s_add_u32 s51, s51, 128
buffer_load_dwordx4 v166, s[28:31], s53 offen lds
v_fma_f32 v78, -v46, s9, -v168
v_fma_f32 v46, v46, s9, -v167
v_fma_f32 v79, -v47, s9, -v168
v_fma_f32 v47, v47, s9, -v167
v_exp_f32 v36, v36
v_mfma_f32_16x16x32_bf16 v[152:155], a[40:43], a[12:15], v[152:155]
ds_read_b64_tr_b16 a[68:69], v163 offset:28672
v_exp_f32 v37, v37
v_exp_f32 v38, v38
v_exp_f32 v39, v39
s_setprio 0
v_mfma_f32_16x16x32_bf16 v[108:111], a[44:47], a[0:3], v[108:111]
ds_read_b64_tr_b16 a[70:71], v163 offset:29696
v_exp_f32 v44, v44
v_exp_f32 v45, v45
v_exp_f32 v46, v46
v_mfma_f32_16x16x32_bf16 v[124:127], a[44:47], a[4:7], v[124:127]
v_exp_f32 v47, v47
v_cvt_pk_bf16_f32 v84, v36, v37
v_cvt_pk_bf16_f32 v85, v38, v39
v_cvt_pk_bf16_f32 v86, v44, v45
v_cvt_pk_bf16_f32 v87, v46, v47
v_mfma_f32_16x16x32_bf16 v[140:143], a[44:47], a[8:11], v[140:143]
v_exp_f32 v68, v68
v_exp_f32 v69, v69
v_mfma_f32_16x16x32_bf16 v[84:87], v[32:35], v[84:87], 0
v_mfma_f32_16x16x32_bf16 v[156:159], a[44:47], a[12:15], v[156:159]
v_exp_f32 v70, v70
v_exp_f32 v71, v71
v_exp_f32 v76, v76
s_waitcnt vmcnt(8) lgkmcnt(0)
s_barrier
s_setprio 3
v_mfma_f32_16x16x32_bf16 v[96:99], a[56:59], a[16:19], v[96:99]
ds_read_b128 a[0:3], v160 offset:32768
v_exp_f32 v77, v77
v_exp_f32 v78, v78
v_exp_f32 v79, v79
v_mfma_f32_16x16x32_bf16 v[112:115], a[56:59], a[20:23], v[112:115]
ds_read_b128 a[4:7], v160 offset:34816
v_cvt_pk_bf16_f32 v92, v68, v69
v_cvt_pk_bf16_f32 v93, v70, v71
v_cvt_pk_bf16_f32 v94, v76, v77
v_cvt_pk_bf16_f32 v95, v78, v79
v_rcp_f32 v167, v84
v_mfma_f32_16x16x32_bf16 v[128:131], a[56:59], a[24:27], v[128:131]
ds_read_b128 a[8:11], v160 offset:36864
s_add_u32 m0, s58, 0
s_add_u32 s53, s53, 229376
buffer_load_dwordx4 v164, s[16:19], s48 offen lds
v_mfma_f32_16x16x32_bf16 v[92:95], v[32:35], v[92:95], 0
v_mul_f32 v36, v36, v167
v_mul_f32 v37, v37, v167
v_mul_f32 v38, v38, v167
v_mul_f32 v39, v39, v167
v_mfma_f32_16x16x32_bf16 v[144:147], a[56:59], a[28:31], v[144:147]
ds_read_b128 a[12:15], v160 offset:38912
v_mul_f32 v44, v44, v167
v_mul_f32 v45, v45, v167
v_mul_f32 v46, v46, v167
v_mul_f32 v47, v47, v167
v_cvt_pk_bf16_f32 v36, v36, v37
v_cvt_pk_bf16_f32 v37, v38, v39
s_setprio 2
v_mfma_f32_16x16x32_bf16 v[100:103], a[60:63], a[16:19], v[100:103]
ds_read_b64_tr_b16 a[32:33], v162 offset:32768
v_cvt_pk_bf16_f32 v38, v44, v45
v_cvt_pk_bf16_f32 v39, v46, v47
v_rcp_f32 v168, v92
s_nop 0
v_mul_f32 v68, v68, v168
v_mul_f32 v69, v69, v168
v_mfma_f32_16x16x32_bf16 v[116:119], a[60:63], a[20:23], v[116:119]
ds_read_b64_tr_b16 a[34:35], v162 offset:33792
v_mul_f32 v70, v70, v168
v_mul_f32 v71, v71, v168
v_mul_f32 v76, v76, v168
v_mul_f32 v77, v77, v168
v_mul_f32 v78, v78, v168
v_mul_f32 v79, v79, v168
v_mfma_f32_16x16x32_bf16 v[132:135], a[60:63], a[24:27], v[132:135]
ds_read_b64_tr_b16 a[36:37], v163 offset:32768
s_add_u32 m0, s58, 1024
s_add_u32 s48, s48, 128
buffer_load_dwordx4 v165, s[16:19], s49 offen lds
v_cvt_pk_bf16_f32 v44, v68, v69
v_cvt_pk_bf16_f32 v45, v70, v71
v_cvt_pk_bf16_f32 v46, v76, v77
v_cvt_pk_bf16_f32 v47, v78, v79
v_mfma_f32_16x16x32_bf16 v[68:71], v[36:39], a[74:77], 0
v_mfma_f32_16x16x32_bf16 v[148:151], a[60:63], a[28:31], v[148:151]
ds_read_b64_tr_b16 a[38:39], v163 offset:33792
v_mfma_f32_16x16x32_bf16 v[76:79], v[36:39], a[72:75], 0
v_mfma_f32_16x16x32_bf16 v[84:87], v[44:47], a[74:77], 0
v_mfma_f32_16x16x32_bf16 v[92:95], v[44:47], a[72:75], 0
s_setprio 1
v_mfma_f32_16x16x32_bf16 v[104:107], a[64:67], a[16:19], v[104:107]
ds_read_b64_tr_b16 a[40:41], v162 offset:36864
v_mfma_f32_16x16x32_bf16 v[48:51], a[48:51], v[56:59], 0
v_mfma_f32_16x16x32_bf16 v[120:123], a[64:67], a[20:23], v[120:123]
ds_read_b64_tr_b16 a[42:43], v162 offset:37888
v_mfma_f32_16x16x32_bf16 v[136:139], a[64:67], a[24:27], v[136:139]
ds_read_b64_tr_b16 a[44:45], v163 offset:36864
s_add_u32 m0, s62, 122880
s_add_u32 s49, s49, 128
buffer_load_dwordx4 v166, s[28:31], s53 offen lds
v_cvt_pk_bf16_f32 v6, v68, v69
v_cvt_pk_bf16_f32 v7, v70, v71
v_cvt_pk_bf16_f32 v14, v76, v77
v_cvt_pk_bf16_f32 v15, v78, v79
v_cvt_pk_bf16_f32 v22, v84, v85
v_cvt_pk_bf16_f32 v23, v86, v87
v_mfma_f32_16x16x32_bf16 v[152:155], a[64:67], a[28:31], v[152:155]
ds_read_b64_tr_b16 a[46:47], v163 offset:37888
v_cvt_pk_bf16_f32 v30, v92, v93
v_cvt_pk_bf16_f32 v31, v94, v95
v_max3_f32 v167, v52, v53, v54
v_max3_f32 v168, -v52, -v53, -v54
v_max3_f32 v167, v167, v55, v60
v_max3_f32 v168, v168, -v55, -v60
s_setprio 0
v_mfma_f32_16x16x32_bf16 v[108:111], a[68:71], a[16:19], v[108:111]
v_max3_f32 v167, v167, v61, v62
v_max3_f32 v168, v168, -v61, -v62
v_max_f32 v167, v167, v63
v_max_f32 v168, v168, -v63
s_nop 1
v_permlane16_swap_b32 v167, v168
v_max_f32 v167, v167, v168
v_mfma_f32_16x16x32_bf16 v[124:127], a[68:71], a[20:23], v[124:127]
v_mov_b32 v168, v167
s_nop 1
v_permlane32_swap_b32 v167, v168
v_max_f32 v167, v167, v168
v_mul_f32 v167, s9, v167
v_mov_b32 v168, v167
s_nop 1
v_permlane16_swap_b32 v167, v168
v_mfma_f32_16x16x32_bf16 v[140:143], a[68:71], a[24:27], v[140:143]
v_fma_f32 v68, -v52, s9, -v168
v_fma_f32 v52, v52, s9, -v167
v_fma_f32 v69, -v53, s9, -v168
v_fma_f32 v53, v53, s9, -v167
v_fma_f32 v70, -v54, s9, -v168
v_fma_f32 v54, v54, s9, -v167
v_mfma_f32_16x16x32_bf16 v[156:159], a[68:71], a[28:31], v[156:159]
v_fma_f32 v71, -v55, s9, -v168
v_fma_f32 v55, v55, s9, -v167
v_fma_f32 v76, -v60, s9, -v168
v_fma_f32 v60, v60, s9, -v167
v_fma_f32 v77, -v61, s9, -v168
v_fma_f32 v61, v61, s9, -v167
s_waitcnt vmcnt(10) lgkmcnt(0)
s_barrier
s_setprio 3
v_mfma_f32_16x16x32_bf16 v[96:99], a[32:35], a[0:3], v[96:99]
ds_read_b128 a[16:19], v161 offset:32768
v_fma_f32 v78, -v62, s9, -v168
v_fma_f32 v62, v62, s9, -v167
v_fma_f32 v79, -v63, s9, -v168
v_fma_f32 v63, v63, s9, -v167
v_exp_f32 v52, v52
v_mfma_f32_16x16x32_bf16 v[112:115], a[32:35], a[4:7], v[112:115]
ds_read_b128 a[20:23], v161 offset:34816
v_exp_f32 v53, v53
v_exp_f32 v54, v54
v_exp_f32 v55, v55
v_mfma_f32_16x16x32_bf16 v[128:131], a[32:35], a[8:11], v[128:131]
ds_read_b128 a[24:27], v161 offset:36864
s_add_u32 m0, s58, 2048
s_add_u32 s53, s53, 229376
buffer_load_dwordx4 v164, s[16:19], s50 offen lds
v_exp_f32 v60, v60
v_exp_f32 v61, v61
v_exp_f32 v62, v62
v_mfma_f32_16x16x32_bf16 v[144:147], a[32:35], a[12:15], v[144:147]
ds_read_b128 a[28:31], v161 offset:38912
v_exp_f32 v63, v63
v_cvt_pk_bf16_f32 v84, v52, v53
v_cvt_pk_bf16_f32 v85, v54, v55
v_cvt_pk_bf16_f32 v86, v60, v61
v_cvt_pk_bf16_f32 v87, v62, v63
s_setprio 2
v_mfma_f32_16x16x32_bf16 v[100:103], a[36:39], a[0:3], v[100:103]
ds_read_b64_tr_b16 a[56:57], v162 offset:40960
v_exp_f32 v68, v68
v_exp_f32 v69, v69
v_mfma_f32_16x16x32_bf16 v[84:87], v[32:35], v[84:87], 0
v_mfma_f32_16x16x32_bf16 v[116:119], a[36:39], a[4:7], v[116:119]
ds_read_b64_tr_b16 a[58:59], v162 offset:41984
v_exp_f32 v70, v70
v_exp_f32 v71, v71
v_exp_f32 v76, v76
v_mfma_f32_16x16x32_bf16 v[132:135], a[36:39], a[8:11], v[132:135]
ds_read_b64_tr_b16 a[60:61], v163 offset:40960
s_add_u32 m0, s58, 3072
s_add_u32 s50, s50, 128
buffer_load_dwordx4 v165, s[16:19], s51 offen lds
v_exp_f32 v77, v77
v_exp_f32 v78, v78
v_exp_f32 v79, v79
v_mfma_f32_16x16x32_bf16 v[148:151], a[36:39], a[12:15], v[148:151]
ds_read_b64_tr_b16 a[62:63], v163 offset:41984
v_cvt_pk_bf16_f32 v92, v68, v69
v_cvt_pk_bf16_f32 v93, v70, v71
v_cvt_pk_bf16_f32 v94, v76, v77
v_cvt_pk_bf16_f32 v95, v78, v79
v_rcp_f32 v167, v84
s_setprio 1
v_mfma_f32_16x16x32_bf16 v[104:107], a[40:43], a[0:3], v[104:107]
ds_read_b64_tr_b16 a[64:65], v162 offset:45056
v_mfma_f32_16x16x32_bf16 v[92:95], v[32:35], v[92:95], 0
v_mul_f32 v52, v52, v167
v_mul_f32 v53, v53, v167
v_mul_f32 v54, v54, v167
v_mul_f32 v55, v55, v167
v_mfma_f32_16x16x32_bf16 v[120:123], a[40:43], a[4:7], v[120:123]
ds_read_b64_tr_b16 a[66:67], v162 offset:46080
v_mul_f32 v60, v60, v167
v_mul_f32 v61, v61, v167
v_mul_f32 v62, v62, v167
v_mul_f32 v63, v63, v167
v_cvt_pk_bf16_f32 v52, v52, v53
v_cvt_pk_bf16_f32 v53, v54, v55
v_mfma_f32_16x16x32_bf16 v[136:139], a[40:43], a[8:11], v[136:139]
ds_read_b64_tr_b16 a[68:69], v163 offset:45056
s_add_u32 m0, s62, 131072
s_add_u32 s51, s51, 128
buffer_load_dwordx4 v166, s[28:31], s53 offen lds
v_cvt_pk_bf16_f32 v54, v60, v61
v_cvt_pk_bf16_f32 v55, v62, v63
v_rcp_f32 v168, v92
s_nop 0
v_mul_f32 v68, v68, v168
v_mul_f32 v69, v69, v168
v_mfma_f32_16x16x32_bf16 v[152:155], a[40:43], a[12:15], v[152:155]
ds_read_b64_tr_b16 a[70:71], v163 offset:46080
v_mul_f32 v70, v70, v168
v_mul_f32 v71, v71, v168
v_mul_f32 v76, v76, v168
v_mul_f32 v77, v77, v168
v_mul_f32 v78, v78, v168
v_mul_f32 v79, v79, v168
s_setprio 0
v_mfma_f32_16x16x32_bf16 v[108:111], a[44:47], a[0:3], v[108:111]
v_cvt_pk_bf16_f32 v60, v68, v69
v_cvt_pk_bf16_f32 v61, v70, v71
v_cvt_pk_bf16_f32 v62, v76, v77
v_cvt_pk_bf16_f32 v63, v78, v79
v_mfma_f32_16x16x32_bf16 v[68:71], v[52:55], a[74:77], 0
v_mfma_f32_16x16x32_bf16 v[124:127], a[44:47], a[4:7], v[124:127]
v_mfma_f32_16x16x32_bf16 v[76:79], v[52:55], a[72:75], 0
v_mfma_f32_16x16x32_bf16 v[84:87], v[60:63], a[74:77], 0
v_mfma_f32_16x16x32_bf16 v[92:95], v[60:63], a[72:75], 0
v_mfma_f32_16x16x32_bf16 v[140:143], a[44:47], a[8:11], v[140:143]
v_mfma_f32_16x16x32_bf16 v[52:55], a[52:55], v[56:59], 0
v_mfma_f32_16x16x32_bf16 v[156:159], a[44:47], a[12:15], v[156:159]
s_waitcnt vmcnt(7) lgkmcnt(0)
s_barrier
s_setprio 3
v_mfma_f32_16x16x32_bf16 v[96:99], a[56:59], a[16:19], v[96:99]
v_add_u32 v160, 0x8000, v160
v_cvt_pk_bf16_f32 v32, v68, v69
v_cvt_pk_bf16_f32 v33, v70, v71
v_cvt_pk_bf16_f32 v36, v76, v77
v_cvt_pk_bf16_f32 v37, v78, v79
v_cvt_pk_bf16_f32 v40, v84, v85
v_cvt_pk_bf16_f32 v41, v86, v87
v_mfma_f32_16x16x32_bf16 v[112:115], a[56:59], a[20:23], v[112:115]
ds_read_b128 a[0:3], v160 offset:32768
v_cvt_pk_bf16_f32 v44, v92, v93
v_cvt_pk_bf16_f32 v45, v94, v95
v_mov_b32 v56, 0x3f803f80
v_mov_b32 v57, 0x3f803f80
v_mov_b32 v58, 0x3f803f80
v_mov_b32 v59, 0x3f803f80
v_mfma_f32_16x16x32_bf16 v[128:131], a[56:59], a[24:27], v[128:131]
ds_read_b128 a[4:7], v160 offset:34816
s_add_u32 m0, s58, 32768
s_add_u32 s53, s53, 229376
buffer_load_dwordx4 v164, s[16:19], s48 offen lds
v_max3_f32 v167, v48, v49, v50
v_max3_f32 v168, -v48, -v49, -v50
v_max3_f32 v167, v167, v51, v52
v_max3_f32 v168, v168, -v51, -v52
v_max3_f32 v167, v167, v53, v54
v_max3_f32 v168, v168, -v53, -v54
v_mfma_f32_16x16x32_bf16 v[144:147], a[56:59], a[28:31], v[144:147]
ds_read_b128 a[8:11], v160 offset:36864
v_max_f32 v167, v167, v55
v_max_f32 v168, v168, -v55
s_nop 1
v_permlane16_swap_b32 v167, v168
v_max_f32 v167, v167, v168
v_mov_b32 v168, v167
s_nop 1
v_permlane32_swap_b32 v167, v168
s_setprio 2
v_mfma_f32_16x16x32_bf16 v[100:103], a[60:63], a[16:19], v[100:103]
ds_read_b128 a[12:15], v160 offset:38912
v_max_f32 v167, v167, v168
v_mul_f32 v167, s9, v167
v_mov_b32 v168, v167
s_nop 1
v_permlane16_swap_b32 v167, v168
v_fma_f32 v68, -v48, s9, -v168
v_fma_f32 v48, v48, s9, -v167
v_mfma_f32_16x16x32_bf16 v[116:119], a[60:63], a[20:23], v[116:119]
ds_read_b64_tr_b16 a[32:33], v162 offset:0
v_fma_f32 v69, -v49, s9, -v168
v_fma_f32 v49, v49, s9, -v167
v_fma_f32 v70, -v50, s9, -v168
v_fma_f32 v50, v50, s9, -v167
v_fma_f32 v71, -v51, s9, -v168
v_fma_f32 v51, v51, s9, -v167
v_mfma_f32_16x16x32_bf16 v[132:135], a[60:63], a[24:27], v[132:135]
ds_read_b64_tr_b16 a[34:35], v162 offset:1024
s_add_u32 m0, s58, 33792
s_add_u32 s48, s48, 128
buffer_load_dwordx4 v165, s[16:19], s49 offen lds
v_fma_f32 v76, -v52, s9, -v168
v_fma_f32 v52, v52, s9, -v167
v_fma_f32 v77, -v53, s9, -v168
v_fma_f32 v53, v53, s9, -v167
v_fma_f32 v78, -v54, s9, -v168
v_fma_f32 v54, v54, s9, -v167
v_mfma_f32_16x16x32_bf16 v[148:151], a[60:63], a[28:31], v[148:151]
ds_read_b64_tr_b16 a[36:37], v163 offset:0
v_fma_f32 v79, -v55, s9, -v168
v_fma_f32 v55, v55, s9, -v167
v_exp_f32 v48, v48
v_exp_f32 v49, v49
s_setprio 1
v_mfma_f32_16x16x32_bf16 v[104:107], a[64:67], a[16:19], v[104:107]
ds_read_b64_tr_b16 a[38:39], v163 offset:1024
v_exp_f32 v50, v50
v_exp_f32 v51, v51
v_exp_f32 v52, v52
v_mfma_f32_16x16x32_bf16 v[120:123], a[64:67], a[20:23], v[120:123]
ds_read_b64_tr_b16 a[40:41], v162 offset:4096
v_exp_f32 v53, v53
v_exp_f32 v54, v54
v_exp_f32 v55, v55
v_mfma_f32_16x16x32_bf16 v[136:139], a[64:67], a[24:27], v[136:139]
ds_read_b64_tr_b16 a[42:43], v162 offset:5120
s_add_u32 m0, s62, 139264
s_add_u32 s49, s49, 128
buffer_load_dwordx4 v166, s[28:31], s53 offen lds
v_cvt_pk_bf16_f32 v84, v48, v49
v_cvt_pk_bf16_f32 v85, v50, v51
v_cvt_pk_bf16_f32 v86, v52, v53
v_cvt_pk_bf16_f32 v87, v54, v55
v_exp_f32 v68, v68
v_mfma_f32_16x16x32_bf16 v[152:155], a[64:67], a[28:31], v[152:155]
ds_read_b64_tr_b16 a[44:45], v163 offset:4096
v_exp_f32 v69, v69
v_mfma_f32_16x16x32_bf16 v[84:87], v[56:59], v[84:87], 0
v_exp_f32 v70, v70
s_setprio 0
v_mfma_f32_16x16x32_bf16 v[108:111], a[68:71], a[16:19], v[108:111]
ds_read_b64_tr_b16 a[46:47], v163 offset:5120
v_exp_f32 v71, v71
v_exp_f32 v76, v76
v_exp_f32 v77, v77
v_mfma_f32_16x16x32_bf16 v[124:127], a[68:71], a[20:23], v[124:127]
v_exp_f32 v78, v78
v_exp_f32 v79, v79
v_cvt_pk_bf16_f32 v92, v68, v69
v_cvt_pk_bf16_f32 v93, v70, v71
v_mfma_f32_16x16x32_bf16 v[140:143], a[68:71], a[24:27], v[140:143]
v_cvt_pk_bf16_f32 v94, v76, v77
v_cvt_pk_bf16_f32 v95, v78, v79
v_rcp_f32 v167, v84
s_nop 0
v_mfma_f32_16x16x32_bf16 v[92:95], v[56:59], v[92:95], 0
v_mfma_f32_16x16x32_bf16 v[156:159], a[68:71], a[28:31], v[156:159]
v_mul_f32 v48, v48, v167
v_mul_f32 v49, v49, v167
v_mul_f32 v50, v50, v167
v_mul_f32 v51, v51, v167
v_mul_f32 v52, v52, v167
v_mul_f32 v53, v53, v167
s_waitcnt vmcnt(10) lgkmcnt(0)
s_barrier
s_setprio 3
v_mfma_f32_16x16x32_bf16 v[96:99], a[32:35], a[0:3], v[96:99]
v_add_u32 v161, 0x8000, v161
v_mul_f32 v54, v54, v167
v_mul_f32 v55, v55, v167
v_cvt_pk_bf16_f32 v48, v48, v49
v_cvt_pk_bf16_f32 v49, v50, v51
v_cvt_pk_bf16_f32 v50, v52, v53
v_cvt_pk_bf16_f32 v51, v54, v55
v_mfma_f32_16x16x32_bf16 v[112:115], a[32:35], a[4:7], v[112:115]
ds_read_b128 a[16:19], v161 offset:32768
v_rcp_f32 v168, v92
s_nop 0
v_mul_f32 v68, v68, v168
v_mul_f32 v69, v69, v168
v_mul_f32 v70, v70, v168
v_mul_f32 v71, v71, v168
v_mfma_f32_16x16x32_bf16 v[128:131], a[32:35], a[8:11], v[128:131]
ds_read_b128 a[20:23], v161 offset:34816
s_add_u32 m0, s58, 34816
s_add_u32 s53, s53, 229376
buffer_load_dwordx4 v164, s[16:19], s50 offen lds
v_mul_f32 v76, v76, v168
v_mul_f32 v77, v77, v168
v_mul_f32 v78, v78, v168
v_mul_f32 v79, v79, v168
v_cvt_pk_bf16_f32 v52, v68, v69
v_cvt_pk_bf16_f32 v53, v70, v71
v_mfma_f32_16x16x32_bf16 v[144:147], a[32:35], a[12:15], v[144:147]
ds_read_b128 a[24:27], v161 offset:36864
v_cvt_pk_bf16_f32 v54, v76, v77
v_cvt_pk_bf16_f32 v55, v78, v79
v_mfma_f32_16x16x32_bf16 v[68:71], v[48:51], a[74:77], 0
v_mfma_f32_16x16x32_bf16 v[76:79], v[48:51], a[72:75], 0
s_setprio 2
v_mfma_f32_16x16x32_bf16 v[100:103], a[36:39], a[0:3], v[100:103]
ds_read_b128 a[28:31], v161 offset:38912
v_mfma_f32_16x16x32_bf16 v[84:87], v[52:55], a[74:77], 0
v_mfma_f32_16x16x32_bf16 v[92:95], v[52:55], a[72:75], 0
v_mfma_f32_16x16x32_bf16 v[116:119], a[36:39], a[4:7], v[116:119]
ds_read_b64_tr_b16 a[56:57], v162 offset:8192
v_mfma_f32_16x16x32_bf16 v[132:135], a[36:39], a[8:11], v[132:135]
ds_read_b64_tr_b16 a[58:59], v162 offset:9216
s_add_u32 m0, s58, 35840
s_add_u32 s50, s50, 128
buffer_load_dwordx4 v165, s[16:19], s51 offen lds
v_cvt_pk_bf16_f32 v34, v68, v69
v_cvt_pk_bf16_f32 v35, v70, v71
v_cvt_pk_bf16_f32 v38, v76, v77
v_cvt_pk_bf16_f32 v39, v78, v79
v_cvt_pk_bf16_f32 v42, v84, v85
v_cvt_pk_bf16_f32 v43, v86, v87
v_mfma_f32_16x16x32_bf16 v[148:151], a[36:39], a[12:15], v[148:151]
ds_read_b64_tr_b16 a[60:61], v163 offset:8192
v_cvt_pk_bf16_f32 v46, v92, v93
v_cvt_pk_bf16_f32 v47, v94, v95
v_mfma_f32_16x16x32_bf16 v[48:51], v[28:31], v[0:3], 0
v_mfma_f32_16x16x32_bf16 v[52:55], v[28:31], v[16:19], 0
s_setprio 1
v_mfma_f32_16x16x32_bf16 v[104:107], a[40:43], a[0:3], v[104:107]
ds_read_b64_tr_b16 a[62:63], v163 offset:9216
v_mfma_f32_16x16x32_bf16 v[48:51], v[44:47], v[8:11], v[48:51]
v_mfma_f32_16x16x32_bf16 v[52:55], v[44:47], v[24:27], v[52:55]
s_lshl_b32 s57, s87, 11
s_add_u32 s57, s57, 147456
v_add_u32 v173, s57, v171
v_mfma_f32_16x16x32_bf16 v[120:123], a[40:43], a[4:7], v[120:123]
ds_read_b64_tr_b16 a[64:65], v162 offset:12288
v_mfma_f32_16x16x32_bf16 v[68:71], v[56:59], v[4:7], 0
v_mfma_f32_16x16x32_bf16 v[76:79], v[56:59], v[12:15], 0
v_mfma_f32_16x16x32_bf16 v[84:87], v[56:59], v[20:23], 0
v_mfma_f32_16x16x32_bf16 v[136:139], a[40:43], a[8:11], v[136:139]
ds_read_b64_tr_b16 a[66:67], v162 offset:13312
s_add_u32 m0, s62, 98304
s_add_u32 s51, s51, 128
buffer_load_dwordx4 v166, s[28:31], s53 offen lds
v_mfma_f32_16x16x32_bf16 v[92:95], v[56:59], v[28:31], 0
v_mfma_f32_16x16x32_bf16 v[68:71], v[56:59], v[32:35], v[68:71]
v_mfma_f32_16x16x32_bf16 v[76:79], v[56:59], v[36:39], v[76:79]
v_mfma_f32_16x16x32_bf16 v[152:155], a[40:43], a[12:15], v[152:155]
ds_read_b64_tr_b16 a[68:69], v163 offset:12288
v_mfma_f32_16x16x32_bf16 v[84:87], v[56:59], v[40:43], v[84:87]
v_mfma_f32_16x16x32_bf16 v[92:95], v[56:59], v[44:47], v[92:95]
ds_write_b128 v173, v[48:51] offset:0
ds_write_b128 v173, v[52:55] offset:1024
s_setprio 0
v_mfma_f32_16x16x32_bf16 v[108:111], a[44:47], a[0:3], v[108:111]
ds_read_b64_tr_b16 a[70:71], v163 offset:13312
v_lshrrev_b32 v60, 2, v171
s_lshl_b32 s57, s88, 6
v_xor_b32 v60, s57, v60
v_xor_b32 v173, 2048, v173
v_mfma_f32_16x16x32_bf16 v[124:127], a[44:47], a[4:7], v[124:127]
v_mfma_f32_16x16x32_bf16 v[140:143], a[44:47], a[8:11], v[140:143]
v_mov_b32_dpp v68, v76 quad_perm:[0,1,2,3] row_mask:0x2 bank_mask:0xf
v_mov_b32_dpp v68, v84 quad_perm:[0,1,2,3] row_mask:0x4 bank_mask:0xf
v_mov_b32_dpp v68, v92 quad_perm:[0,1,2,3] row_mask:0x8 bank_mask:0xf
buffer_atomic_add_f32 v68, v60, s[40:43], s73 offen
v_mfma_f32_16x16x32_bf16 v[156:159], a[44:47], a[12:15], v[156:159]
s_waitcnt vmcnt(8) lgkmcnt(0)
s_barrier
s_setprio 3
v_mfma_f32_16x16x32_bf16 v[96:99], a[56:59], a[16:19], v[96:99]
v_subrev_u32 v160, 0x8000, v160
ds_read_b128 v[48:51], v173 offset:0
ds_read_b128 v[52:55], v173 offset:1024
v_xor_b32 v173, 2048, v173
v_mfma_f32_16x16x32_bf16 v[56:59], a[48:51], v[64:67], 0
v_mfma_f32_16x16x32_bf16 v[68:71], a[52:55], v[64:67], 0
v_mfma_f32_16x16x32_bf16 v[112:115], a[56:59], a[20:23], v[112:115]
ds_read_b128 a[0:3], v160 offset:0
v_mfma_f32_16x16x32_bf16 v[128:131], a[56:59], a[24:27], v[128:131]
ds_read_b128 a[4:7], v160 offset:2048
s_add_u32 m0, s58, 65536
s_add_u32 s53, s53, 229376
buffer_load_dwordx4 v164, s[16:19], s48 offen lds
v_mfma_f32_16x16x32_bf16 v[144:147], a[56:59], a[28:31], v[144:147]
ds_read_b128 a[8:11], v160 offset:4096
s_waitcnt lgkmcnt(3)
v_mfma_f32_16x16x32_bf16 v[48:51], v[20:23], v[0:3], v[48:51]
v_mfma_f32_16x16x32_bf16 v[52:55], v[20:23], v[16:19], v[52:55]
s_setprio 2
v_mfma_f32_16x16x32_bf16 v[100:103], a[60:63], a[16:19], v[100:103]
ds_read_b128 a[12:15], v160 offset:6144
v_mfma_f32_16x16x32_bf16 v[48:51], v[40:43], v[8:11], v[48:51]
v_mfma_f32_16x16x32_bf16 v[52:55], v[40:43], v[24:27], v[52:55]
v_mfma_f32_16x16x32_bf16 v[116:119], a[60:63], a[20:23], v[116:119]
ds_read_b64_tr_b16 a[32:33], v162 offset:16384
v_mov_b32 v60, 0x3f803f80
v_mov_b32 v61, 0x3f803f80
v_mov_b32 v62, 0x3f803f80
v_mfma_f32_16x16x32_bf16 v[132:135], a[60:63], a[24:27], v[132:135]
ds_read_b64_tr_b16 a[34:35], v162 offset:17408
s_add_u32 m0, s58, 66560
s_add_u32 s48, s48, 128
buffer_load_dwordx4 v165, s[16:19], s49 offen lds
v_mov_b32 v63, 0x3f803f80
v_max3_f32 v167, v56, v57, v58
v_max3_f32 v168, -v56, -v57, -v58
v_mfma_f32_16x16x32_bf16 v[148:151], a[60:63], a[28:31], v[148:151]
ds_read_b64_tr_b16 a[36:37], v163 offset:16384
v_max3_f32 v167, v167, v59, v68
v_max3_f32 v168, v168, -v59, -v68
v_max3_f32 v167, v167, v69, v70
s_setprio 1
v_mfma_f32_16x16x32_bf16 v[104:107], a[64:67], a[16:19], v[104:107]
ds_read_b64_tr_b16 a[38:39], v163 offset:17408
v_max3_f32 v168, v168, -v69, -v70
v_max_f32 v167, v167, v71
v_max_f32 v168, v168, -v71
v_mfma_f32_16x16x32_bf16 v[120:123], a[64:67], a[20:23], v[120:123]
ds_read_b64_tr_b16 a[40:41], v162 offset:20480
v_permlane16_swap_b32 v167, v168
v_max_f32 v167, v167, v168
v_mov_b32 v168, v167
v_mfma_f32_16x16x32_bf16 v[136:139], a[64:67], a[24:27], v[136:139]
ds_read_b64_tr_b16 a[42:43], v162 offset:21504
s_add_u32 m0, s62, 106496
s_add_u32 s49, s49, 128
buffer_load_dwordx4 v166, s[28:31], s53 offen lds
v_permlane32_swap_b32 v167, v168
v_max_f32 v167, v167, v168
v_mul_f32 v167, s9, v167
v_mfma_f32_16x16x32_bf16 v[152:155], a[64:67], a[28:31], v[152:155]
ds_read_b64_tr_b16 a[44:45], v163 offset:20480
v_mov_b32 v168, v167
s_nop 1
v_permlane16_swap_b32 v167, v168
v_fma_f32 v76, -v56, s9, -v168
s_setprio 0
v_mfma_f32_16x16x32_bf16 v[108:111], a[68:71], a[16:19], v[108:111]
ds_read_b64_tr_b16 a[46:47], v163 offset:21504
v_fma_f32 v56, v56, s9, -v167
v_fma_f32 v77, -v57, s9, -v168
v_fma_f32 v57, v57, s9, -v167
v_mfma_f32_16x16x32_bf16 v[124:127], a[68:71], a[20:23], v[124:127]
v_fma_f32 v78, -v58, s9, -v168
v_fma_f32 v58, v58, s9, -v167
v_fma_f32 v79, -v59, s9, -v168
v_mfma_f32_16x16x32_bf16 v[140:143], a[68:71], a[24:27], v[140:143]
v_fma_f32 v59, v59, s9, -v167
v_fma_f32 v84, -v68, s9, -v168
v_fma_f32 v68, v68, s9, -v167
v_mfma_f32_16x16x32_bf16 v[156:159], a[68:71], a[28:31], v[156:159]
v_fma_f32 v85, -v69, s9, -v168
v_fma_f32 v69, v69, s9, -v167
v_fma_f32 v86, -v70, s9, -v168
s_waitcnt vmcnt(11) lgkmcnt(0)
s_barrier
s_setprio 3
v_mfma_f32_16x16x32_bf16 v[96:99], a[32:35], a[0:3], v[96:99]
v_subrev_u32 v161, 0x8000, v161
ds_write_b128 v173, v[48:51] offset:0
ds_write_b128 v173, v[52:55] offset:1024
v_xor_b32 v173, 6144, v173
v_mfma_f32_16x16x32_bf16 v[112:115], a[32:35], a[4:7], v[112:115]
ds_read_b128 a[16:19], v161 offset:0
v_fma_f32 v70, v70, s9, -v167
v_fma_f32 v87, -v71, s9, -v168
v_fma_f32 v71, v71, s9, -v167
v_mfma_f32_16x16x32_bf16 v[128:131], a[32:35], a[8:11], v[128:131]
ds_read_b128 a[20:23], v161 offset:2048
s_add_u32 m0, s58, 67584
s_add_u32 s53, s53, 229376
buffer_load_dwordx4 v164, s[16:19], s50 offen lds
v_exp_f32 v76, v76
v_exp_f32 v77, v77
v_mfma_f32_16x16x32_bf16 v[144:147], a[32:35], a[12:15], v[144:147]
ds_read_b128 a[24:27], v161 offset:4096
v_exp_f32 v78, v78
v_exp_f32 v79, v79
s_setprio 2
v_mfma_f32_16x16x32_bf16 v[100:103], a[36:39], a[0:3], v[100:103]
ds_read_b128 a[28:31], v161 offset:6144
v_exp_f32 v84, v84
v_exp_f32 v85, v85
v_mfma_f32_16x16x32_bf16 v[116:119], a[36:39], a[4:7], v[116:119]
ds_read_b64_tr_b16 a[56:57], v162 offset:24576
v_exp_f32 v86, v86
v_exp_f32 v87, v87
v_mfma_f32_16x16x32_bf16 v[132:135], a[36:39], a[8:11], v[132:135]
ds_read_b64_tr_b16 a[58:59], v162 offset:25600
s_add_u32 m0, s58, 68608
s_add_u32 s50, s50, 128
buffer_load_dwordx4 v165, s[16:19], s51 offen lds
v_cvt_pk_bf16_f32 v92, v76, v77
v_cvt_pk_bf16_f32 v93, v78, v79
v_cvt_pk_bf16_f32 v94, v84, v85
v_mfma_f32_16x16x32_bf16 v[148:151], a[36:39], a[12:15], v[148:151]
ds_read_b64_tr_b16 a[60:61], v163 offset:24576
v_cvt_pk_bf16_f32 v95, v86, v87
v_exp_f32 v56, v56
s_setprio 1
v_mfma_f32_16x16x32_bf16 v[104:107], a[40:43], a[0:3], v[104:107]
ds_read_b64_tr_b16 a[62:63], v163 offset:25600
v_exp_f32 v57, v57
v_mfma_f32_16x16x32_bf16 v[92:95], v[60:63], v[92:95], 0
v_mfma_f32_16x16x32_bf16 v[120:123], a[40:43], a[4:7], v[120:123]
ds_read_b64_tr_b16 a[64:65], v162 offset:28672
v_exp_f32 v58, v58
v_exp_f32 v59, v59
v_mfma_f32_16x16x32_bf16 v[136:139], a[40:43], a[8:11], v[136:139]
ds_read_b64_tr_b16 a[66:67], v162 offset:29696
s_add_u32 m0, s62, 114688
s_add_u32 s51, s51, 128
buffer_load_dwordx4 v166, s[28:31], s53 offen lds
v_exp_f32 v68, v68
v_exp_f32 v69, v69
v_mfma_f32_16x16x32_bf16 v[152:155], a[40:43], a[12:15], v[152:155]
ds_read_b64_tr_b16 a[68:69], v163 offset:28672
v_exp_f32 v70, v70
v_exp_f32 v71, v71
s_setprio 0
v_mfma_f32_16x16x32_bf16 v[108:111], a[44:47], a[0:3], v[108:111]
ds_read_b64_tr_b16 a[70:71], v163 offset:29696
v_cvt_pk_bf16_f32 v64, v56, v57
v_cvt_pk_bf16_f32 v65, v58, v59
v_cvt_pk_bf16_f32 v66, v68, v69
v_mfma_f32_16x16x32_bf16 v[124:127], a[44:47], a[4:7], v[124:127]
v_cvt_pk_bf16_f32 v67, v70, v71
v_rcp_f32 v168, v92
v_mfma_f32_16x16x32_bf16 v[140:143], a[44:47], a[8:11], v[140:143]
v_mfma_f32_16x16x32_bf16 v[56:59], v[60:63], v[64:67], 0
v_mfma_f32_16x16x32_bf16 v[156:159], a[44:47], a[12:15], v[156:159]
s_waitcnt vmcnt(8) lgkmcnt(0)
s_barrier
s_setprio 3
v_mfma_f32_16x16x32_bf16 v[96:99], a[56:59], a[16:19], v[96:99]
ds_read_b128 a[0:3], v160 offset:32768
ds_read_b128 v[48:51], v173 offset:0
ds_read_b128 v[52:55], v173 offset:1024
v_xor_b32 v173, 6144, v173
v_mfma_f32_16x16x32_bf16 v[112:115], a[56:59], a[20:23], v[112:115]
ds_read_b128 a[4:7], v160 offset:34816
v_mul_f32 v168, v168, v56
v_mul_f32 v76, v76, v168
v_mul_f32 v77, v77, v168
v_mfma_f32_16x16x32_bf16 v[128:131], a[56:59], a[24:27], v[128:131]
ds_read_b128 a[8:11], v160 offset:36864
s_add_u32 m0, s58, 0
s_add_u32 s53, s53, 229376
buffer_load_dwordx4 v164, s[16:19], s48 offen lds
v_mul_f32 v78, v78, v168
v_mul_f32 v79, v79, v168
v_mul_f32 v84, v84, v168
v_mfma_f32_16x16x32_bf16 v[144:147], a[56:59], a[28:31], v[144:147]
ds_read_b128 a[12:15], v160 offset:38912
v_mul_f32 v85, v85, v168
v_mul_f32 v86, v86, v168
v_mul_f32 v87, v87, v168
s_setprio 2
v_mfma_f32_16x16x32_bf16 v[100:103], a[60:63], a[16:19], v[100:103]
ds_read_b64_tr_b16 a[32:33], v162 offset:32768
s_waitcnt lgkmcnt(4)
v_mfma_f32_16x16x32_bf16 v[48:51], v[12:15], v[0:3], v[48:51]
v_mfma_f32_16x16x32_bf16 v[52:55], v[12:15], v[16:19], v[52:55]
v_mfma_f32_16x16x32_bf16 v[116:119], a[60:63], a[20:23], v[116:119]
ds_read_b64_tr_b16 a[34:35], v162 offset:33792
v_mfma_f32_16x16x32_bf16 v[48:51], v[36:39], v[8:11], v[48:51]
v_mfma_f32_16x16x32_bf16 v[52:55], v[36:39], v[24:27], v[52:55]
v_mfma_f32_16x16x32_bf16 v[132:135], a[60:63], a[24:27], v[132:135]
ds_read_b64_tr_b16 a[36:37], v163 offset:32768
s_add_u32 m0, s58, 1024
s_add_u32 s48, s48, 0
buffer_load_dwordx4 v165, s[16:19], s49 offen lds
v_cvt_pk_bf16_f32 v68, v76, v77
v_cvt_pk_bf16_f32 v69, v78, v79
v_cvt_pk_bf16_f32 v70, v84, v85
v_mfma_f32_16x16x32_bf16 v[148:151], a[60:63], a[28:31], v[148:151]
ds_read_b64_tr_b16 a[38:39], v163 offset:33792
v_cvt_pk_bf16_f32 v71, v86, v87
v_mfma_f32_16x16x32_bf16 v[56:59], a[48:51], v[72:75], 0
s_setprio 1
v_mfma_f32_16x16x32_bf16 v[104:107], a[64:67], a[16:19], v[104:107]
ds_read_b64_tr_b16 a[40:41], v162 offset:36864
v_mfma_f32_16x16x32_bf16 v[76:79], a[52:55], v[72:75], 0
v_mfma_f32_16x16x32_bf16 v[120:123], a[64:67], a[20:23], v[120:123]
ds_read_b64_tr_b16 a[42:43], v162 offset:37888
v_mfma_f32_16x16x32_bf16 v[136:139], a[64:67], a[24:27], v[136:139]
ds_read_b64_tr_b16 a[44:45], v163 offset:36864
s_add_u32 m0, s62, 122880
s_add_u32 s49, s49, 0
buffer_load_dwordx4 v166, s[28:31], s53 offen lds
v_max3_f32 v167, v56, v57, v58
v_max3_f32 v168, -v56, -v57, -v58
v_max3_f32 v167, v167, v59, v76
v_mfma_f32_16x16x32_bf16 v[152:155], a[64:67], a[28:31], v[152:155]
ds_read_b64_tr_b16 a[46:47], v163 offset:37888
v_max3_f32 v168, v168, -v59, -v76
v_max3_f32 v167, v167, v77, v78
v_max3_f32 v168, v168, -v77, -v78
s_setprio 0
v_mfma_f32_16x16x32_bf16 v[108:111], a[68:71], a[16:19], v[108:111]
v_max_f32 v167, v167, v79
v_max_f32 v168, v168, -v79
s_nop 1
v_permlane16_swap_b32 v167, v168
v_mfma_f32_16x16x32_bf16 v[124:127], a[68:71], a[20:23], v[124:127]
v_max_f32 v167, v167, v168
v_mov_b32 v168, v167
s_nop 1
v_permlane32_swap_b32 v167, v168
v_mfma_f32_16x16x32_bf16 v[140:143], a[68:71], a[24:27], v[140:143]
v_max_f32 v167, v167, v168
v_mul_f32 v167, s9, v167
v_mov_b32 v168, v167
v_mfma_f32_16x16x32_bf16 v[156:159], a[68:71], a[28:31], v[156:159]
s_nop 0
v_permlane16_swap_b32 v167, v168
v_fma_f32 v84, -v56, s9, -v168
v_fma_f32 v56, v56, s9, -v167
s_waitcnt vmcnt(11) lgkmcnt(0)
s_barrier
s_cmp_lg_u32 s87, 0
s_cbranch_scc1 k1_kernel_a_g1_pi
v_lshrrev_b32 v172, 4, v171
v_min_u32 v172, 5, v172
v_and_b32 v174, 1, v172
v_lshlrev_b32 v172, 3, v172
v_lshlrev_b32 v174, 2, v174
v_sub_u32 v172, v172, v174
buffer_load_dword v172, v172, s[40:43], s66 offen offset:80 sc1
k1_kernel_a_g1_pi:
s_setprio 3
v_mfma_f32_16x16x32_bf16 v[96:99], a[32:35], a[0:3], v[96:99]
ds_read_b128 a[16:19], v161 offset:32768
ds_write_b128 v173, v[48:51] offset:0
ds_write_b128 v173, v[52:55] offset:1024
v_xor_b32 v173, 2048, v173
v_mfma_f32_16x16x32_bf16 v[112:115], a[32:35], a[4:7], v[112:115]
ds_read_b128 a[20:23], v161 offset:34816
v_fma_f32 v85, -v57, s9, -v168
v_fma_f32 v57, v57, s9, -v167
v_fma_f32 v86, -v58, s9, -v168
v_mfma_f32_16x16x32_bf16 v[128:131], a[32:35], a[8:11], v[128:131]
ds_read_b128 a[24:27], v161 offset:36864
s_add_u32 m0, s58, 2048
s_add_u32 s53, s53, 0
buffer_load_dwordx4 v164, s[16:19], s50 offen lds
v_fma_f32 v58, v58, s9, -v167
v_fma_f32 v87, -v59, s9, -v168
v_fma_f32 v59, v59, s9, -v167
v_mfma_f32_16x16x32_bf16 v[144:147], a[32:35], a[12:15], v[144:147]
ds_read_b128 a[28:31], v161 offset:38912
v_fma_f32 v92, -v76, s9, -v168
v_fma_f32 v76, v76, s9, -v167
v_fma_f32 v93, -v77, s9, -v168
s_setprio 2
v_mfma_f32_16x16x32_bf16 v[100:103], a[36:39], a[0:3], v[100:103]
ds_read_b64_tr_b16 a[56:57], v162 offset:40960
v_fma_f32 v77, v77, s9, -v167
v_fma_f32 v94, -v78, s9, -v168
v_fma_f32 v78, v78, s9, -v167
v_mfma_f32_16x16x32_bf16 v[116:119], a[36:39], a[4:7], v[116:119]
ds_read_b64_tr_b16 a[58:59], v162 offset:41984
v_fma_f32 v95, -v79, s9, -v168
v_fma_f32 v79, v79, s9, -v167
v_exp_f32 v84, v84
v_mfma_f32_16x16x32_bf16 v[132:135], a[36:39], a[8:11], v[132:135]
ds_read_b64_tr_b16 a[60:61], v163 offset:40960
v_exp_f32 v85, v85
v_exp_f32 v86, v86
v_mfma_f32_16x16x32_bf16 v[148:151], a[36:39], a[12:15], v[148:151]
ds_read_b64_tr_b16 a[62:63], v163 offset:41984
v_exp_f32 v87, v87
v_exp_f32 v92, v92
s_setprio 1
v_mfma_f32_16x16x32_bf16 v[104:107], a[40:43], a[0:3], v[104:107]
ds_read_b64_tr_b16 a[64:65], v162 offset:45056
s_add_u32 m0, s58, 3072
s_add_u32 s50, s50, 0
buffer_load_dwordx4 v165, s[16:19], s51 offen lds
v_exp_f32 v93, v93
v_exp_f32 v94, v94
v_mfma_f32_16x16x32_bf16 v[120:123], a[40:43], a[4:7], v[120:123]
ds_read_b64_tr_b16 a[66:67], v162 offset:46080
v_exp_f32 v95, v95
v_cvt_pk_bf16_f32 v28, v84, v85
v_mfma_f32_16x16x32_bf16 v[136:139], a[40:43], a[8:11], v[136:139]
ds_read_b64_tr_b16 a[68:69], v163 offset:45056
v_cvt_pk_bf16_f32 v29, v86, v87
v_cvt_pk_bf16_f32 v30, v92, v93
v_cvt_pk_bf16_f32 v31, v94, v95
v_mfma_f32_16x16x32_bf16 v[152:155], a[40:43], a[12:15], v[152:155]
ds_read_b64_tr_b16 a[70:71], v163 offset:46080
v_exp_f32 v56, v56
v_exp_f32 v57, v57
s_setprio 0
v_mfma_f32_16x16x32_bf16 v[108:111], a[44:47], a[0:3], v[108:111]
v_mfma_f32_16x16x32_bf16 v[28:31], v[60:63], v[28:31], 0
v_exp_f32 v58, v58
v_mfma_f32_16x16x32_bf16 v[124:127], a[44:47], a[4:7], v[124:127]
v_exp_f32 v59, v59
v_exp_f32 v76, v76
v_mfma_f32_16x16x32_bf16 v[140:143], a[44:47], a[8:11], v[140:143]
v_exp_f32 v77, v77
v_exp_f32 v78, v78
v_mfma_f32_16x16x32_bf16 v[156:159], a[44:47], a[12:15], v[156:159]
v_exp_f32 v79, v79
v_cvt_pk_bf16_f32 v72, v56, v57
s_waitcnt vmcnt(6) lgkmcnt(0)
s_barrier
s_setprio 3
v_mfma_f32_16x16x32_bf16 v[96:99], a[56:59], a[16:19], v[96:99]
v_add_u32 v160, 0x8000, v160
ds_read_b128 v[48:51], v173 offset:0
ds_read_b128 v[52:55], v173 offset:1024
v_xor_b32 v173, 2048, v173
v_mfma_f32_16x16x32_bf16 v[112:115], a[56:59], a[20:23], v[112:115]
ds_read_b128 a[0:3], v160 offset:32768
v_cvt_pk_bf16_f32 v73, v58, v59
v_cvt_pk_bf16_f32 v74, v76, v77
v_cvt_pk_bf16_f32 v75, v78, v79
v_mfma_f32_16x16x32_bf16 v[128:131], a[56:59], a[24:27], v[128:131]
ds_read_b128 a[4:7], v160 offset:34816
s_add_u32 m0, s62, 32768
s_add_u32 s51, s51, 0
buffer_load_dwordx4 v175, s[32:35], s64 offen lds
v_rcp_f32 v168, v28
v_mfma_f32_16x16x32_bf16 v[56:59], v[60:63], v[72:75], 0
v_mfma_f32_16x16x32_bf16 v[144:147], a[56:59], a[28:31], v[144:147]
ds_read_b128 a[8:11], v160 offset:36864
s_setprio 2
v_mfma_f32_16x16x32_bf16 v[100:103], a[60:63], a[16:19], v[100:103]
ds_read_b128 a[12:15], v160 offset:38912
s_waitcnt lgkmcnt(4)
v_mfma_f32_16x16x32_bf16 v[48:51], v[4:7], v[0:3], v[48:51]
v_mfma_f32_16x16x32_bf16 v[52:55], v[4:7], v[16:19], v[52:55]
v_mfma_f32_16x16x32_bf16 v[116:119], a[60:63], a[20:23], v[116:119]
ds_read_b64_tr_b16 a[32:33], v162 offset:0
v_mfma_f32_16x16x32_bf16 v[48:51], v[32:35], v[8:11], v[48:51]
v_mfma_f32_16x16x32_bf16 v[52:55], v[32:35], v[24:27], v[52:55]
v_mfma_f32_16x16x32_bf16 v[132:135], a[60:63], a[24:27], v[132:135]
ds_read_b64_tr_b16 a[34:35], v162 offset:1024
v_lshrrev_b32 v173, 2, v171
v_mul_f32 v168, v168, v56
v_mul_f32 v84, v84, v168
v_mfma_f32_16x16x32_bf16 v[148:151], a[60:63], a[28:31], v[148:151]
ds_read_b64_tr_b16 a[36:37], v163 offset:0
v_mul_f32 v85, v85, v168
v_mul_f32 v86, v86, v168
v_mul_f32 v87, v87, v168
s_setprio 1
v_mfma_f32_16x16x32_bf16 v[104:107], a[64:67], a[16:19], v[104:107]
ds_read_b64_tr_b16 a[38:39], v163 offset:1024
s_add_u32 m0, s62, 40960
s_add_u32 s64, s64, 65536
buffer_load_dwordx4 v175, s[32:35], s64 offen lds
buffer_atomic_add_f32 v48, v173, s[40:43], s72 offen offset:0
buffer_atomic_add_f32 v49, v173, s[40:43], s72 offen offset:256
buffer_atomic_add_f32 v50, v173, s[40:43], s72 offen offset:512
v_mfma_f32_16x16x32_bf16 v[120:123], a[64:67], a[20:23], v[120:123]
ds_read_b64_tr_b16 a[40:41], v162 offset:4096
buffer_atomic_add_f32 v51, v173, s[40:43], s72 offen offset:768
buffer_atomic_add_f32 v52, v173, s[40:43], s72 offen offset:1024
buffer_atomic_add_f32 v53, v173, s[40:43], s72 offen offset:1280
v_mfma_f32_16x16x32_bf16 v[136:139], a[64:67], a[24:27], v[136:139]
ds_read_b64_tr_b16 a[42:43], v162 offset:5120
buffer_atomic_add_f32 v54, v173, s[40:43], s72 offen offset:1536
buffer_atomic_add_f32 v55, v173, s[40:43], s72 offen offset:1792
v_mul_f32 v92, v92, v168
v_mfma_f32_16x16x32_bf16 v[152:155], a[64:67], a[28:31], v[152:155]
ds_read_b64_tr_b16 a[44:45], v163 offset:4096
v_mul_f32 v93, v93, v168
v_mul_f32 v94, v94, v168
v_mul_f32 v95, v95, v168
s_setprio 0
v_mfma_f32_16x16x32_bf16 v[108:111], a[68:71], a[16:19], v[108:111]
ds_read_b64_tr_b16 a[46:47], v163 offset:5120
v_cvt_pk_bf16_f32 v76, v84, v85
v_cvt_pk_bf16_f32 v77, v86, v87
v_cvt_pk_bf16_f32 v78, v92, v93
v_mfma_f32_16x16x32_bf16 v[124:127], a[68:71], a[20:23], v[124:127]
v_cvt_pk_bf16_f32 v79, v94, v95
v_mfma_f32_16x16x32_bf16 v[56:59], a[48:51], v[80:83], 0
v_mfma_f32_16x16x32_bf16 v[140:143], a[68:71], a[24:27], v[140:143]
v_mfma_f32_16x16x32_bf16 v[84:87], a[52:55], v[80:83], 0
v_mfma_f32_16x16x32_bf16 v[156:159], a[68:71], a[28:31], v[156:159]
s_waitcnt vmcnt(16) lgkmcnt(0)
s_cmp_lg_u32 s87, 0
s_cbranch_scc1 k1_kernel_a_g1_pc_rdy
s_waitcnt vmcnt(12)
v_cmp_le_u32 s[100:101], 1, v172
s_nop 0
s_cmp_eq_u64 s[100:101], -1
s_cbranch_scc1 k1_kernel_a_g1_pc_rdy
s_mov_b32 s91, 40000
k1_kernel_a_g1_pc_spin:
s_sleep 2
v_lshrrev_b32 v172, 4, v171
v_min_u32 v172, 5, v172
v_and_b32 v174, 1, v172
v_lshlrev_b32 v172, 3, v172
v_lshlrev_b32 v174, 2, v174
v_sub_u32 v172, v172, v174
buffer_load_dword v172, v172, s[40:43], s66 offen offset:80 sc1
s_waitcnt vmcnt(0)
v_cmp_le_u32 s[100:101], 1, v172
s_nop 0
s_cmp_eq_u64 s[100:101], -1
s_cbranch_scc1 k1_kernel_a_g1_pc_rdy
s_sub_u32 s91, s91, 1
s_cmp_lg_u32 s91, 0
s_cbranch_scc1 k1_kernel_a_g1_pc_spin
s_nop 0
k1_kernel_a_g1_pc_rdy:
s_barrier
buffer_load_dwordx4 v[8:11], v171, s[40:43], s68 offen sc1
buffer_load_dwordx4 v[40:43], v171, s[40:43], s69 offen sc1
s_add_u32 s68, s68, 6144
s_add_u32 s69, s69, 6144
s_setprio 3
v_mfma_f32_16x16x32_bf16 v[96:99], a[32:35], a[0:3], v[96:99]
v_add_u32 v161, 0x8000, v161
v_max3_f32 v167, v56, v57, v58
v_max3_f32 v168, -v56, -v57, -v58
v_max3_f32 v167, v167, v59, v84
v_mfma_f32_16x16x32_bf16 v[112:115], a[32:35], a[4:7], v[112:115]
ds_read_b128 a[16:19], v161 offset:32768
v_max3_f32 v168, v168, -v59, -v84
v_max3_f32 v167, v167, v85, v86
v_max3_f32 v168, v168, -v85, -v86
v_mfma_f32_16x16x32_bf16 v[128:131], a[32:35], a[8:11], v[128:131]
ds_read_b128 a[20:23], v161 offset:34816
s_add_u32 m0, s62, 49152
s_add_u32 s64, s64, 327680
buffer_load_dwordx4 v175, s[32:35], s64 offen lds
v_max_f32 v167, v167, v87
v_max_f32 v168, v168, -v87
s_nop 1
v_permlane16_swap_b32 v167, v168
v_mfma_f32_16x16x32_bf16 v[144:147], a[32:35], a[12:15], v[144:147]
ds_read_b128 a[24:27], v161 offset:36864
v_max_f32 v167, v167, v168
v_mov_b32 v168, v167
s_nop 1
v_permlane32_swap_b32 v167, v168
s_setprio 2
v_mfma_f32_16x16x32_bf16 v[100:103], a[36:39], a[0:3], v[100:103]
ds_read_b128 a[28:31], v161 offset:38912
v_max_f32 v167, v167, v168
v_mul_f32 v167, s9, v167
v_mov_b32 v168, v167
v_mfma_f32_16x16x32_bf16 v[116:119], a[36:39], a[4:7], v[116:119]
ds_read_b64_tr_b16 a[56:57], v162 offset:8192
v_permlane16_swap_b32 v167, v168
v_fma_f32 v92, -v56, s9, -v168
v_fma_f32 v56, v56, s9, -v167
v_mfma_f32_16x16x32_bf16 v[132:135], a[36:39], a[8:11], v[132:135]
ds_read_b64_tr_b16 a[58:59], v162 offset:9216
v_fma_f32 v93, -v57, s9, -v168
v_fma_f32 v57, v57, s9, -v167
v_fma_f32 v94, -v58, s9, -v168
v_mfma_f32_16x16x32_bf16 v[148:151], a[36:39], a[12:15], v[148:151]
ds_read_b64_tr_b16 a[60:61], v163 offset:8192
v_fma_f32 v58, v58, s9, -v167
v_fma_f32 v95, -v59, s9, -v168
v_fma_f32 v59, v59, s9, -v167
s_setprio 1
v_mfma_f32_16x16x32_bf16 v[104:107], a[40:43], a[0:3], v[104:107]
ds_read_b64_tr_b16 a[62:63], v163 offset:9216
s_add_u32 m0, s62, 57344
s_add_u32 s64, s64, 65536
buffer_load_dwordx4 v175, s[32:35], s64 offen lds
v_fma_f32 v28, -v84, s9, -v168
v_fma_f32 v84, v84, s9, -v167
v_fma_f32 v29, -v85, s9, -v168
v_mfma_f32_16x16x32_bf16 v[120:123], a[40:43], a[4:7], v[120:123]
ds_read_b64_tr_b16 a[64:65], v162 offset:12288
v_fma_f32 v85, v85, s9, -v167
v_fma_f32 v30, -v86, s9, -v168
v_fma_f32 v86, v86, s9, -v167
v_mfma_f32_16x16x32_bf16 v[136:139], a[40:43], a[8:11], v[136:139]
ds_read_b64_tr_b16 a[66:67], v162 offset:13312
v_fma_f32 v31, -v87, s9, -v168
v_fma_f32 v87, v87, s9, -v167
v_exp_f32 v92, v92
v_mfma_f32_16x16x32_bf16 v[152:155], a[40:43], a[12:15], v[152:155]
ds_read_b64_tr_b16 a[68:69], v163 offset:12288
v_exp_f32 v93, v93
v_exp_f32 v94, v94
s_setprio 0
v_mfma_f32_16x16x32_bf16 v[108:111], a[44:47], a[0:3], v[108:111]
ds_read_b64_tr_b16 a[70:71], v163 offset:13312
v_exp_f32 v95, v95
v_exp_f32 v28, v28
v_mfma_f32_16x16x32_bf16 v[124:127], a[44:47], a[4:7], v[124:127]
v_exp_f32 v29, v29
v_exp_f32 v30, v30
v_mfma_f32_16x16x32_bf16 v[140:143], a[44:47], a[8:11], v[140:143]
v_exp_f32 v31, v31
v_cvt_pk_bf16_f32 v44, v92, v93
v_mfma_f32_16x16x32_bf16 v[156:159], a[44:47], a[12:15], v[156:159]
v_cvt_pk_bf16_f32 v45, v94, v95
v_cvt_pk_bf16_f32 v46, v28, v29
v_cvt_pk_bf16_f32 v47, v30, v31
s_waitcnt vmcnt(14) lgkmcnt(0)
s_barrier
s_setprio 3
v_mfma_f32_16x16x32_bf16 v[96:99], a[56:59], a[16:19], v[96:99]
v_subrev_u32 v160, 0x8000, v160
v_exp_f32 v56, v56
v_exp_f32 v57, v57
v_mfma_f32_16x16x32_bf16 v[112:115], a[56:59], a[20:23], v[112:115]
ds_read_b128 a[0:3], v160 offset:0
v_mfma_f32_16x16x32_bf16 v[44:47], v[60:63], v[44:47], 0
v_exp_f32 v58, v58
v_mfma_f32_16x16x32_bf16 v[128:131], a[56:59], a[24:27], v[128:131]
ds_read_b128 a[4:7], v160 offset:2048
s_add_u32 m0, s62, 65536
s_sub_u32 s64, s64, 196608
buffer_load_dwordx4 v175, s[32:35], s64 offen lds
v_exp_f32 v59, v59
v_exp_f32 v84, v84
v_mfma_f32_16x16x32_bf16 v[144:147], a[56:59], a[28:31], v[144:147]
ds_read_b128 a[8:11], v160 offset:4096
v_exp_f32 v85, v85
v_exp_f32 v86, v86
s_setprio 2
v_mfma_f32_16x16x32_bf16 v[100:103], a[60:63], a[16:19], v[100:103]
ds_read_b128 a[12:15], v160 offset:6144
v_exp_f32 v87, v87
v_cvt_pk_bf16_f32 v80, v56, v57
v_mfma_f32_16x16x32_bf16 v[116:119], a[60:63], a[20:23], v[116:119]
ds_read_b64_tr_b16 a[32:33], v162 offset:16384
v_cvt_pk_bf16_f32 v81, v58, v59
v_cvt_pk_bf16_f32 v82, v84, v85
v_cvt_pk_bf16_f32 v83, v86, v87
v_mfma_f32_16x16x32_bf16 v[132:135], a[60:63], a[24:27], v[132:135]
ds_read_b64_tr_b16 a[34:35], v162 offset:17408
v_rcp_f32 v168, v44
v_mfma_f32_16x16x32_bf16 v[56:59], v[60:63], v[80:83], 0
v_mfma_f32_16x16x32_bf16 v[148:151], a[60:63], a[28:31], v[148:151]
ds_read_b64_tr_b16 a[36:37], v163 offset:16384
s_setprio 1
v_mfma_f32_16x16x32_bf16 v[104:107], a[64:67], a[16:19], v[104:107]
ds_read_b64_tr_b16 a[38:39], v163 offset:17408
s_add_u32 m0, s62, 73728
s_add_u32 s64, s64, 65536
buffer_load_dwordx4 v175, s[32:35], s64 offen lds
v_mfma_f32_16x16x32_bf16 v[120:123], a[64:67], a[20:23], v[120:123]
ds_read_b64_tr_b16 a[40:41], v162 offset:20480
v_mul_f32 v168, v168, v56
v_mul_f32 v92, v92, v168
v_mul_f32 v93, v93, v168
v_mfma_f32_16x16x32_bf16 v[136:139], a[64:67], a[24:27], v[136:139]
ds_read_b64_tr_b16 a[42:43], v162 offset:21504
v_mul_f32 v94, v94, v168
v_mul_f32 v95, v95, v168
v_mul_f32 v28, v28, v168
v_mfma_f32_16x16x32_bf16 v[152:155], a[64:67], a[28:31], v[152:155]
ds_read_b64_tr_b16 a[44:45], v163 offset:20480
v_mul_f32 v29, v29, v168
v_mul_f32 v30, v30, v168
v_mul_f32 v31, v31, v168
s_setprio 0
v_mfma_f32_16x16x32_bf16 v[108:111], a[68:71], a[16:19], v[108:111]
ds_read_b64_tr_b16 a[46:47], v163 offset:21504
v_cvt_pk_bf16_f32 v84, v92, v93
v_cvt_pk_bf16_f32 v85, v94, v95
v_cvt_pk_bf16_f32 v86, v28, v29
v_mfma_f32_16x16x32_bf16 v[124:127], a[68:71], a[20:23], v[124:127]
v_cvt_pk_bf16_f32 v87, v30, v31
v_mfma_f32_16x16x32_bf16 v[56:59], a[48:51], v[88:91], 0
v_mfma_f32_16x16x32_bf16 v[140:143], a[68:71], a[24:27], v[140:143]
v_mfma_f32_16x16x32_bf16 v[92:95], a[52:55], v[88:91], 0
v_mfma_f32_16x16x32_bf16 v[156:159], a[68:71], a[28:31], v[156:159]
s_waitcnt vmcnt(6) lgkmcnt(0)
s_barrier
s_cmp_lg_u32 s87, 0
s_cbranch_scc1 k1_kernel_a_kv_sg
v_mov_b32 v174, 1
s_mov_b64 exec, 1
buffer_store_dword v174, off, s[40:43], s93 sc1
s_mov_b64 exec, -1
k1_kernel_a_kv_sg:
s_setprio 3
v_mfma_f32_16x16x32_bf16 v[96:99], a[32:35], a[0:3], v[96:99]
v_subrev_u32 v161, 0x8000, v161
v_max3_f32 v167, v56, v57, v58
v_max3_f32 v168, -v56, -v57, -v58
v_max3_f32 v167, v167, v59, v92
v_mfma_f32_16x16x32_bf16 v[112:115], a[32:35], a[4:7], v[112:115]
ds_read_b128 a[16:19], v161 offset:0
v_max3_f32 v168, v168, -v59, -v92
v_max3_f32 v167, v167, v93, v94
v_max3_f32 v168, v168, -v93, -v94
v_mfma_f32_16x16x32_bf16 v[128:131], a[32:35], a[8:11], v[128:131]
ds_read_b128 a[20:23], v161 offset:2048
s_add_u32 m0, s62, 81920
s_add_u32 s64, s64, 589824
buffer_load_dwordx4 v175, s[32:35], s64 offen lds
v_max_f32 v167, v167, v95
v_max_f32 v168, v168, -v95
s_nop 1
v_permlane16_swap_b32 v167, v168
v_mfma_f32_16x16x32_bf16 v[144:147], a[32:35], a[12:15], v[144:147]
ds_read_b128 a[24:27], v161 offset:4096
v_max_f32 v167, v167, v168
v_mov_b32 v168, v167
s_nop 1
v_permlane32_swap_b32 v167, v168
s_setprio 2
v_mfma_f32_16x16x32_bf16 v[100:103], a[36:39], a[0:3], v[100:103]
ds_read_b128 a[28:31], v161 offset:6144
v_max_f32 v167, v167, v168
v_mul_f32 v167, s9, v167
v_mov_b32 v168, v167
v_mfma_f32_16x16x32_bf16 v[116:119], a[36:39], a[4:7], v[116:119]
ds_read_b64_tr_b16 a[56:57], v162 offset:24576
v_permlane16_swap_b32 v167, v168
v_fma_f32 v28, -v56, s9, -v168
v_fma_f32 v56, v56, s9, -v167
v_mfma_f32_16x16x32_bf16 v[132:135], a[36:39], a[8:11], v[132:135]
ds_read_b64_tr_b16 a[58:59], v162 offset:25600
v_fma_f32 v29, -v57, s9, -v168
v_fma_f32 v57, v57, s9, -v167
v_fma_f32 v30, -v58, s9, -v168
v_mfma_f32_16x16x32_bf16 v[148:151], a[36:39], a[12:15], v[148:151]
ds_read_b64_tr_b16 a[60:61], v163 offset:24576
v_fma_f32 v58, v58, s9, -v167
v_fma_f32 v31, -v59, s9, -v168
v_fma_f32 v59, v59, s9, -v167
s_setprio 1
v_mfma_f32_16x16x32_bf16 v[104:107], a[40:43], a[0:3], v[104:107]
ds_read_b64_tr_b16 a[62:63], v163 offset:25600
s_add_u32 m0, s62, 90112
s_add_u32 s64, s64, 65536
buffer_load_dwordx4 v175, s[32:35], s64 offen lds
v_fma_f32 v44, -v92, s9, -v168
v_fma_f32 v92, v92, s9, -v167
v_fma_f32 v45, -v93, s9, -v168
v_mfma_f32_16x16x32_bf16 v[120:123], a[40:43], a[4:7], v[120:123]
ds_read_b64_tr_b16 a[64:65], v162 offset:28672
v_fma_f32 v93, v93, s9, -v167
v_fma_f32 v46, -v94, s9, -v168
v_fma_f32 v94, v94, s9, -v167
v_mfma_f32_16x16x32_bf16 v[136:139], a[40:43], a[8:11], v[136:139]
ds_read_b64_tr_b16 a[66:67], v162 offset:29696
v_fma_f32 v47, -v95, s9, -v168
v_fma_f32 v95, v95, s9, -v167
v_exp_f32 v28, v28
v_mfma_f32_16x16x32_bf16 v[152:155], a[40:43], a[12:15], v[152:155]
ds_read_b64_tr_b16 a[68:69], v163 offset:28672
v_exp_f32 v29, v29
v_exp_f32 v30, v30
s_setprio 0
v_mfma_f32_16x16x32_bf16 v[108:111], a[44:47], a[0:3], v[108:111]
ds_read_b64_tr_b16 a[70:71], v163 offset:29696
v_exp_f32 v31, v31
v_exp_f32 v44, v44
v_mfma_f32_16x16x32_bf16 v[124:127], a[44:47], a[4:7], v[124:127]
v_exp_f32 v45, v45
v_exp_f32 v46, v46
v_mfma_f32_16x16x32_bf16 v[140:143], a[44:47], a[8:11], v[140:143]
v_exp_f32 v47, v47
v_cvt_pk_bf16_f32 v20, v28, v29
v_mfma_f32_16x16x32_bf16 v[156:159], a[44:47], a[12:15], v[156:159]
v_cvt_pk_bf16_f32 v21, v30, v31
v_cvt_pk_bf16_f32 v22, v44, v45
v_cvt_pk_bf16_f32 v23, v46, v47
buffer_load_dwordx4 a[0:3], v171, s[40:43], s68 offen sc1
buffer_load_dwordx4 a[4:7], v171, s[40:43], s69 offen sc1
s_sub_u32 s68, s68, 2048
s_sub_u32 s69, s69, 2048
buffer_load_dwordx4 a[8:11], v171, s[40:43], s68 offen sc1
buffer_load_dwordx4 a[12:15], v171, s[40:43], s69 offen sc1
s_add_u32 s68, s68, 10240
s_add_u32 s69, s69, 10240
s_waitcnt vmcnt(8) lgkmcnt(0)
s_barrier
buffer_load_dwordx4 a[32:35], v171, s[40:43], s68 offen sc1
buffer_load_dwordx4 a[36:39], v171, s[40:43], s69 offen sc1
s_add_u32 s68, s68, 6144
s_add_u32 s69, s69, 6144
s_setprio 3
v_mfma_f32_16x16x32_bf16 v[96:99], a[56:59], a[16:19], v[96:99]
v_lshrrev_b32 v164, 6, v171
v_lshrrev_b32 v165, 1, v164
v_and_b32 v165, 3, v165
v_lshrrev_b32 v166, 1, v171
v_and_b32 v166, 24, v166
v_lshl_add_u32 v166, v164, 7, v166
s_lshl_b32 s90, s89, 13
v_add_u32 v166, s90, v166
v_xor_b32 v164, 0, v165
v_lshl_add_u32 v160, v164, 5, v166
v_xor_b32 v164, 1, v165
v_lshl_add_u32 v161, v164, 5, v166
v_xor_b32 v164, 2, v165
v_lshl_add_u32 v162, v164, 5, v166
v_xor_b32 v164, 3, v165
v_lshl_add_u32 v163, v164, 5, v166
v_exp_f32 v56, v56
v_exp_f32 v57, v57
v_mfma_f32_16x16x32_bf16 v[112:115], a[56:59], a[20:23], v[112:115]
ds_read_b64_tr_b16 a[48:49], v160 offset:32768
ds_read_b64_tr_b16 a[50:51], v160 offset:34816
v_mfma_f32_16x16x32_bf16 v[20:23], v[60:63], v[20:23], 0
v_exp_f32 v58, v58
v_mfma_f32_16x16x32_bf16 v[128:131], a[56:59], a[24:27], v[128:131]
ds_read_b64_tr_b16 a[52:53], v161 offset:32768
ds_read_b64_tr_b16 a[54:55], v161 offset:34816
s_add_u32 m0, s62, 0
s_add_u32 s64, s64, 327680
buffer_load_dwordx4 v175, s[32:35], s64 offen lds
v_exp_f32 v59, v59
v_exp_f32 v92, v92
v_mfma_f32_16x16x32_bf16 v[144:147], a[56:59], a[28:31], v[144:147]
ds_read_b64_tr_b16 a[72:73], v162 offset:36864
ds_read_b64_tr_b16 a[74:75], v162 offset:38912
ds_read_b64_tr_b16 a[56:57], v162 offset:32768
ds_read_b64_tr_b16 a[58:59], v162 offset:34816
v_exp_f32 v93, v93
v_exp_f32 v94, v94
s_setprio 2
v_mfma_f32_16x16x32_bf16 v[100:103], a[60:63], a[16:19], v[100:103]
ds_read_b64_tr_b16 a[76:77], v163 offset:36864
ds_read_b64_tr_b16 a[78:79], v163 offset:38912
v_exp_f32 v95, v95
v_cvt_pk_bf16_f32 v88, v56, v57
v_mfma_f32_16x16x32_bf16 v[116:119], a[60:63], a[20:23], v[116:119]
s_add_u32 m0, s62, 8192
s_add_u32 s64, s64, 65536
buffer_load_dwordx4 v175, s[32:35], s64 offen lds
v_cvt_pk_bf16_f32 v89, v58, v59
v_cvt_pk_bf16_f32 v90, v92, v93
v_cvt_pk_bf16_f32 v91, v94, v95
v_mfma_f32_16x16x32_bf16 v[132:135], a[60:63], a[24:27], v[132:135]
v_rcp_f32 v168, v20
v_mfma_f32_16x16x32_bf16 v[56:59], v[60:63], v[88:91], 0
v_mfma_f32_16x16x32_bf16 v[148:151], a[60:63], a[28:31], v[148:151]
ds_read_b64_tr_b16 a[60:61], v163 offset:32768
ds_read_b64_tr_b16 a[62:63], v163 offset:34816
s_setprio 1
v_mfma_f32_16x16x32_bf16 v[104:107], a[64:67], a[16:19], v[104:107]
s_add_u32 m0, s62, 16384
s_sub_u32 s64, s64, 196608
buffer_load_dwordx4 v175, s[32:35], s64 offen lds
v_mfma_f32_16x16x32_bf16 v[120:123], a[64:67], a[20:23], v[120:123]
v_mul_f32 v168, v168, v56
v_mul_f32 v28, v28, v168
v_mul_f32 v29, v29, v168
v_mfma_f32_16x16x32_bf16 v[136:139], a[64:67], a[24:27], v[136:139]
v_mul_f32 v30, v30, v168
v_mul_f32 v31, v31, v168
v_mul_f32 v44, v44, v168
v_mfma_f32_16x16x32_bf16 v[152:155], a[64:67], a[28:31], v[152:155]
ds_read_b64_tr_b16 a[64:65], v160 offset:36864
ds_read_b64_tr_b16 a[66:67], v160 offset:38912
s_add_u32 m0, s62, 24576
s_add_u32 s64, s64, 65536
buffer_load_dwordx4 v175, s[32:35], s64 offen lds
v_mul_f32 v45, v45, v168
v_mul_f32 v46, v46, v168
v_mul_f32 v47, v47, v168
s_setprio 0
v_mfma_f32_16x16x32_bf16 v[108:111], a[68:71], a[16:19], v[108:111]
v_cvt_pk_bf16_f32 v92, v28, v29
v_cvt_pk_bf16_f32 v93, v30, v31
v_cvt_pk_bf16_f32 v94, v44, v45
v_mfma_f32_16x16x32_bf16 v[124:127], a[68:71], a[20:23], v[124:127]
v_cvt_pk_bf16_f32 v95, v46, v47
v_mfma_f32_16x16x32_bf16 v[140:143], a[68:71], a[24:27], v[140:143]
v_mfma_f32_16x16x32_bf16 v[156:159], a[68:71], a[28:31], v[156:159]
ds_read_b64_tr_b16 a[68:69], v161 offset:36864
ds_read_b64_tr_b16 a[70:71], v161 offset:38912
buffer_load_dwordx4 a[40:43], v171, s[40:43], s68 offen sc1
buffer_load_dwordx4 a[44:47], v171, s[40:43], s69 offen sc1
s_sub_u32 s68, s68, 2048
s_sub_u32 s69, s69, 2048
s_waitcnt vmcnt(18)
s_cmp_lg_u32 s87, 0
s_cbranch_scc1 k1_kernel_a_k_pi
v_lshrrev_b32 v173, 2, v171
v_min_u32 v173, 28, v173
buffer_load_dword v173, v173, s[40:43], s84 offen offset:0 sc1
k1_kernel_a_k_pi:
s_waitcnt lgkmcnt(2)
s_setprio 1
v_mfma_f32_16x16x32_bf16 v[16:19], a[64:67], v[8:11], 0
v_mov_b32 v164, 0xc0135761
v_mul_f32 v167, v96, v96
v_mul_f32 v168, v97, v97
v_mul_f32 v169, v98, v98
v_mul_f32 v170, v99, v99
v_fma_f32 v167, v167, s8, v164
v_mfma_f32_16x16x32_bf16 v[48:51], a[64:67], v[40:43], 0
v_fma_f32 v168, v168, s8, v164
v_fma_f32 v169, v169, s8, v164
v_fma_f32 v170, v170, s8, v164
v_mul_f32 v167, v167, v96
v_mul_f32 v168, v168, v97
v_mul_f32 v169, v169, v98
ds_read_b64_tr_b16 a[64:65], v160 offset:53248
ds_read_b64_tr_b16 a[66:67], v160 offset:55296
s_waitcnt lgkmcnt(2)
v_mfma_f32_16x16x32_bf16 v[20:23], a[68:71], v[8:11], 0
v_mul_f32 v170, v170, v99
v_exp_f32 v167, v167
v_mul_f32 v96, v96, v104
v_exp_f32 v168, v168
v_mfma_f32_16x16x32_bf16 v[52:55], a[68:71], v[40:43], 0
v_mul_f32 v97, v97, v105
v_exp_f32 v169, v169
v_mul_f32 v98, v98, v106
v_exp_f32 v170, v170
ds_read_b64_tr_b16 a[68:69], v161 offset:53248
ds_read_b64_tr_b16 a[70:71], v161 offset:55296
s_add_u32 m0, s62, 98304
s_add_u32 s64, s64, 589824
buffer_load_dwordx4 v175, s[32:35], s64 offen lds
s_waitcnt lgkmcnt(14)
v_mfma_f32_16x16x32_bf16 v[24:27], a[72:75], v[8:11], 0
v_mul_f32 v99, v99, v107
v_add_f32 v167, 1.0, v167
v_add_f32 v168, 1.0, v168
v_add_f32 v169, 1.0, v169
v_add_f32 v170, 1.0, v170
v_rcp_f32 v167, v167
v_mfma_f32_16x16x32_bf16 v[56:59], a[72:75], v[40:43], 0
v_rcp_f32 v168, v168
v_rcp_f32 v169, v169
v_rcp_f32 v170, v170
ds_read_b64_tr_b16 a[72:73], v162 offset:53248
ds_read_b64_tr_b16 a[74:75], v162 offset:55296
s_waitcnt lgkmcnt(12)
v_mfma_f32_16x16x32_bf16 v[28:31], a[76:79], v[8:11], 0
v_mul_f32 v96, v96, v167
v_mul_f32 v97, v97, v168
v_mul_f32 v98, v98, v169
v_mul_f32 v99, v99, v170
v_cvt_pk_bf16_f32 v104, v96, v97
v_cvt_pk_bf16_f32 v105, v98, v99
v_mfma_f32_16x16x32_bf16 v[60:63], a[76:79], v[40:43], 0
v_mul_f32 v167, v100, v100
v_mul_f32 v168, v101, v101
v_mul_f32 v169, v102, v102
v_mul_f32 v170, v103, v103
v_fma_f32 v167, v167, s8, v164
v_fma_f32 v168, v168, s8, v164
ds_read_b64_tr_b16 a[76:77], v163 offset:53248
ds_read_b64_tr_b16 a[78:79], v163 offset:55296
s_waitcnt lgkmcnt(15)
s_setprio 0
v_mfma_f32_16x16x32_bf16 v[0:3], a[48:51], v[8:11], 0
v_fma_f32 v169, v169, s8, v164
v_fma_f32 v170, v170, s8, v164
v_mul_f32 v167, v167, v100
v_mul_f32 v168, v168, v101
v_mul_f32 v169, v169, v102
v_mul_f32 v170, v170, v103
v_mfma_f32_16x16x32_bf16 v[32:35], a[48:51], v[40:43], 0
v_exp_f32 v167, v167
v_mul_f32 v100, v100, v108
v_exp_f32 v168, v168
v_mul_f32 v101, v101, v109
ds_read_b64_tr_b16 a[48:49], v160 offset:49152
ds_read_b64_tr_b16 a[50:51], v160 offset:51200
s_waitcnt lgkmcnt(15)
v_mfma_f32_16x16x32_bf16 v[4:7], a[52:55], v[8:11], 0
v_exp_f32 v169, v169
v_mul_f32 v102, v102, v110
v_exp_f32 v170, v170
v_mul_f32 v103, v103, v111
v_mfma_f32_16x16x32_bf16 v[36:39], a[52:55], v[40:43], 0
v_add_f32 v167, 1.0, v167
v_add_f32 v168, 1.0, v168
v_add_f32 v169, 1.0, v169
v_add_f32 v170, 1.0, v170
v_rcp_f32 v167, v167
ds_read_b64_tr_b16 a[52:53], v161 offset:49152
ds_read_b64_tr_b16 a[54:55], v161 offset:51200
s_add_u32 m0, s62, 106496
s_add_u32 s64, s64, 65536
buffer_load_dwordx4 v175, s[32:35], s64 offen lds
s_waitcnt lgkmcnt(15)
v_mfma_f32_16x16x32_bf16 v[12:15], a[60:63], v[8:11], 0
v_rcp_f32 v168, v168
v_rcp_f32 v169, v169
v_rcp_f32 v170, v170
v_mfma_f32_16x16x32_bf16 v[44:47], a[60:63], v[40:43], 0
v_mul_f32 v100, v100, v167
v_mul_f32 v101, v101, v168
v_mul_f32 v102, v102, v169
v_mul_f32 v103, v103, v170
v_cvt_pk_bf16_f32 v106, v100, v101
v_cvt_pk_bf16_f32 v107, v102, v103
ds_read_b64_tr_b16 a[60:61], v163 offset:49152
ds_read_b64_tr_b16 a[62:63], v163 offset:51200
s_waitcnt lgkmcnt(15)
v_mfma_f32_16x16x32_bf16 v[8:11], a[56:59], v[8:11], 0
buffer_store_dwordx4 v[104:107], v171, s[40:43], s94 offen sc1
s_add_u32 s94, s94, 147456
v_mul_f32 v167, v112, v112
v_mul_f32 v168, v113, v113
v_mul_f32 v169, v114, v114
v_mul_f32 v170, v115, v115
v_fma_f32 v167, v167, s8, v164
v_mfma_f32_16x16x32_bf16 v[40:43], a[56:59], v[40:43], 0
v_fma_f32 v168, v168, s8, v164
v_fma_f32 v169, v169, s8, v164
v_fma_f32 v170, v170, s8, v164
v_mul_f32 v167, v167, v112
v_mul_f32 v168, v168, v113
v_mul_f32 v169, v169, v114
ds_read_b64_tr_b16 a[56:57], v162 offset:49152
ds_read_b64_tr_b16 a[58:59], v162 offset:51200
buffer_load_dwordx4 a[16:19], v171, s[40:43], s68 offen sc1
buffer_load_dwordx4 a[20:23], v171, s[40:43], s69 offen sc1
s_add_u32 s68, s68, 10240
s_add_u32 s69, s69, 10240
s_waitcnt vmcnt(15) lgkmcnt(0)
s_barrier
v_xor_b32 v160, 0x10000, v160
v_xor_b32 v161, 0x10000, v161
v_xor_b32 v162, 0x10000, v162
v_xor_b32 v163, 0x10000, v163
s_setprio 3
v_mfma_f32_16x16x32_bf16 v[16:19], a[64:67], a[0:3], v[16:19]
v_mul_f32 v170, v170, v115
v_exp_f32 v167, v167
v_mul_f32 v112, v112, v120
v_exp_f32 v168, v168
v_mfma_f32_16x16x32_bf16 v[48:51], a[64:67], a[4:7], v[48:51]
v_mul_f32 v113, v113, v121
v_exp_f32 v169, v169
v_mul_f32 v114, v114, v122
v_exp_f32 v170, v170
ds_read_b64_tr_b16 a[64:65], v160 offset:4096
ds_read_b64_tr_b16 a[66:67], v160 offset:6144
v_mfma_f32_16x16x32_bf16 v[20:23], a[68:71], a[0:3], v[20:23]
v_mul_f32 v115, v115, v123
v_add_f32 v167, 1.0, v167
v_add_f32 v168, 1.0, v168
v_add_f32 v169, 1.0, v169
v_add_f32 v170, 1.0, v170
v_rcp_f32 v167, v167
v_mfma_f32_16x16x32_bf16 v[52:55], a[68:71], a[4:7], v[52:55]
v_rcp_f32 v168, v168
v_rcp_f32 v169, v169
v_rcp_f32 v170, v170
ds_read_b64_tr_b16 a[68:69], v161 offset:4096
ds_read_b64_tr_b16 a[70:71], v161 offset:6144
s_add_u32 m0, s62, 114688
s_add_u32 s64, s64, 327680
buffer_load_dwordx4 v175, s[32:35], s64 offen lds
v_mfma_f32_16x16x32_bf16 v[24:27], a[72:75], a[0:3], v[24:27]
v_mul_f32 v112, v112, v167
v_mul_f32 v113, v113, v168
v_mul_f32 v114, v114, v169
v_mul_f32 v115, v115, v170
v_cvt_pk_bf16_f32 v120, v112, v113
v_cvt_pk_bf16_f32 v121, v114, v115
v_mfma_f32_16x16x32_bf16 v[56:59], a[72:75], a[4:7], v[56:59]
v_mul_f32 v167, v116, v116
v_mul_f32 v168, v117, v117
v_mul_f32 v169, v118, v118
v_mul_f32 v170, v119, v119
v_fma_f32 v167, v167, s8, v164
v_fma_f32 v168, v168, s8, v164
ds_read_b64_tr_b16 a[72:73], v162 offset:4096
ds_read_b64_tr_b16 a[74:75], v162 offset:6144
v_mfma_f32_16x16x32_bf16 v[28:31], a[76:79], a[0:3], v[28:31]
v_fma_f32 v169, v169, s8, v164
v_fma_f32 v170, v170, s8, v164
v_mul_f32 v167, v167, v116
v_mul_f32 v168, v168, v117
v_mul_f32 v169, v169, v118
v_mul_f32 v170, v170, v119
v_mfma_f32_16x16x32_bf16 v[60:63], a[76:79], a[4:7], v[60:63]
v_exp_f32 v167, v167
v_mul_f32 v116, v116, v124
v_exp_f32 v168, v168
v_mul_f32 v117, v117, v125
ds_read_b64_tr_b16 a[76:77], v163 offset:4096
ds_read_b64_tr_b16 a[78:79], v163 offset:6144
s_setprio 2
v_mfma_f32_16x16x32_bf16 v[0:3], a[48:51], a[0:3], v[0:3]
v_exp_f32 v169, v169
v_mul_f32 v118, v118, v126
v_exp_f32 v170, v170
v_mul_f32 v119, v119, v127
v_mfma_f32_16x16x32_bf16 v[32:35], a[48:51], a[4:7], v[32:35]
v_add_f32 v167, 1.0, v167
v_add_f32 v168, 1.0, v168
v_add_f32 v169, 1.0, v169
v_add_f32 v170, 1.0, v170
v_rcp_f32 v167, v167
ds_read_b64_tr_b16 a[48:49], v160 offset:0
ds_read_b64_tr_b16 a[50:51], v160 offset:2048
v_mfma_f32_16x16x32_bf16 v[4:7], a[52:55], a[0:3], v[4:7]
v_rcp_f32 v168, v168
v_rcp_f32 v169, v169
v_rcp_f32 v170, v170
v_mfma_f32_16x16x32_bf16 v[36:39], a[52:55], a[4:7], v[36:39]
v_mul_f32 v116, v116, v167
v_mul_f32 v117, v117, v168
v_mul_f32 v118, v118, v169
v_mul_f32 v119, v119, v170
v_cvt_pk_bf16_f32 v122, v116, v117
v_cvt_pk_bf16_f32 v123, v118, v119
ds_read_b64_tr_b16 a[52:53], v161 offset:0
ds_read_b64_tr_b16 a[54:55], v161 offset:2048
s_add_u32 m0, s62, 122880
s_add_u32 s64, s64, 65536
buffer_load_dwordx4 v175, s[32:35], s64 offen lds
v_mfma_f32_16x16x32_bf16 v[8:11], a[56:59], a[0:3], v[8:11]
buffer_store_dwordx4 v[120:123], v171, s[40:43], s94 offen sc1
s_add_u32 s94, s94, 147456
v_mul_f32 v167, v128, v128
v_mul_f32 v168, v129, v129
v_mul_f32 v169, v130, v130
v_mul_f32 v170, v131, v131
v_fma_f32 v167, v167, s8, v164
v_mfma_f32_16x16x32_bf16 v[40:43], a[56:59], a[4:7], v[40:43]
v_fma_f32 v168, v168, s8, v164
v_fma_f32 v169, v169, s8, v164
v_fma_f32 v170, v170, s8, v164
v_mul_f32 v167, v167, v128
v_mul_f32 v168, v168, v129
v_mul_f32 v169, v169, v130
ds_read_b64_tr_b16 a[56:57], v162 offset:0
ds_read_b64_tr_b16 a[58:59], v162 offset:2048
v_mfma_f32_16x16x32_bf16 v[12:15], a[60:63], a[0:3], v[12:15]
v_mul_f32 v170, v170, v131
v_exp_f32 v167, v167
v_mul_f32 v128, v128, v136
v_exp_f32 v168, v168
v_mfma_f32_16x16x32_bf16 v[44:47], a[60:63], a[4:7], v[44:47]
v_mul_f32 v129, v129, v137
v_exp_f32 v169, v169
v_mul_f32 v130, v130, v138
v_exp_f32 v170, v170
ds_read_b64_tr_b16 a[60:61], v163 offset:0
ds_read_b64_tr_b16 a[62:63], v163 offset:2048
buffer_load_dwordx4 a[24:27], v171, s[40:43], s68 offen sc1
buffer_load_dwordx4 a[28:31], v171, s[40:43], s69 offen sc1
s_add_u32 s68, s68, 6144
s_add_u32 s69, s69, 6144
s_waitcnt vmcnt(18)
s_cmp_lg_u32 s87, 0
s_cbranch_scc1 k1_kernel_a_k_pc_rdy
s_waitcnt vmcnt(10)
v_cmp_le_u32 s[100:101], 1, v173
s_nop 0
s_cmp_eq_u64 s[100:101], -1
s_cbranch_scc1 k1_kernel_a_k_pc_rdy
s_mov_b32 s91, 40000
k1_kernel_a_k_pc_spin:
s_sleep 2
v_lshrrev_b32 v173, 2, v171
v_min_u32 v173, 28, v173
buffer_load_dword v173, v173, s[40:43], s84 offen offset:0 sc1
s_waitcnt vmcnt(0)
v_cmp_le_u32 s[100:101], 1, v173
s_nop 0
s_cmp_eq_u64 s[100:101], -1
s_cbranch_scc1 k1_kernel_a_k_pc_rdy
s_sub_u32 s91, s91, 1
s_cmp_lg_u32 s91, 0
s_cbranch_scc1 k1_kernel_a_k_pc_spin
s_nop 0
k1_kernel_a_k_pc_rdy:
s_barrier
s_waitcnt lgkmcnt(14)
s_setprio 1
v_mfma_f32_16x16x32_bf16 v[16:19], a[64:67], a[8:11], v[16:19]
v_lshrrev_b32 v120, 2, v171
v_lshrrev_b32 v121, 8, v171
v_lshlrev_b32 v121, 4, v121
s_lshr_b32 s57, s88, 1
s_lshl_b32 s57, s57, 7
v_add_u32 v121, s57, v121
v_xor_b32 v122, 128, v121
v_mfma_f32_16x16x32_bf16 v[48:51], a[64:67], a[12:15], v[48:51]
buffer_load_dword v96, v120, s[40:43], s72 offen offset:0 sc1
buffer_load_dword v97, v120, s[40:43], s72 offen offset:256 sc1
buffer_load_dword v98, v120, s[40:43], s72 offen offset:512 sc1
buffer_load_dword v99, v120, s[40:43], s72 offen offset:768 sc1
buffer_load_dword v100, v120, s[40:43], s72 offen offset:1024 sc1
buffer_load_dword v101, v120, s[40:43], s72 offen offset:1280 sc1
ds_read_b64_tr_b16 a[64:65], v160 offset:20480
ds_read_b64_tr_b16 a[66:67], v160 offset:22528
s_waitcnt lgkmcnt(14)
v_mfma_f32_16x16x32_bf16 v[20:23], a[68:71], a[8:11], v[20:23]
buffer_load_dword v102, v120, s[40:43], s72 offen offset:1536 sc1
buffer_load_dword v103, v120, s[40:43], s72 offen offset:1792 sc1
buffer_load_dwordx4 v[104:107], v121, s[40:43], s73 offen offset:0 sc1
buffer_load_dwordx4 v[108:111], v121, s[40:43], s73 offen offset:64 sc1
buffer_load_dwordx4 v[112:115], v122, s[40:43], s73 offen offset:0 sc1
buffer_load_dwordx4 v[116:119], v122, s[40:43], s73 offen offset:64 sc1
v_mfma_f32_16x16x32_bf16 v[52:55], a[68:71], a[12:15], v[52:55]
s_lshl_b32 s57, s89, 12
s_add_u32 s57, s57, 147456
s_lshr_b32 s59, s88, 1
s_lshl_b32 s59, s59, 10
s_add_u32 s57, s57, s59
v_add_u32 v123, s57, v171
s_and_b32 s59, s88, 1
s_lshl_b32 s59, s59, 3
v_add_u32 v120, s59, v123
v_and_b32 v124, 0x30, v171
ds_read_b64_tr_b16 a[68:69], v161 offset:20480
ds_read_b64_tr_b16 a[70:71], v161 offset:22528
s_add_u32 m0, s62, 32768
s_sub_u32 s64, s64, 196608
buffer_load_dwordx4 v175, s[32:35], s64 offen lds
s_waitcnt lgkmcnt(14)
v_mfma_f32_16x16x32_bf16 v[24:27], a[72:75], a[8:11], v[24:27]
v_xor_b32 v124, 16, v124
v_subrev_u32 v124, 1, v124
v_ashrrev_i32 v124, 31, v124
v_and_b32 v125, 0x3f803f80, v124
v_mul_f32 v131, v131, v139
v_add_f32 v167, 1.0, v167
v_mfma_f32_16x16x32_bf16 v[56:59], a[72:75], a[12:15], v[56:59]
v_add_f32 v168, 1.0, v168
v_add_f32 v169, 1.0, v169
v_add_f32 v170, 1.0, v170
v_rcp_f32 v167, v167
v_rcp_f32 v168, v168
ds_read_b64_tr_b16 a[72:73], v162 offset:20480
ds_read_b64_tr_b16 a[74:75], v162 offset:22528
s_waitcnt lgkmcnt(14)
v_mfma_f32_16x16x32_bf16 v[28:31], a[76:79], a[8:11], v[28:31]
v_rcp_f32 v169, v169
v_rcp_f32 v170, v170
v_mul_f32 v128, v128, v167
v_mul_f32 v129, v129, v168
v_mfma_f32_16x16x32_bf16 v[60:63], a[76:79], a[12:15], v[60:63]
v_mul_f32 v130, v130, v169
v_mul_f32 v131, v131, v170
v_cvt_pk_bf16_f32 v136, v128, v129
v_cvt_pk_bf16_f32 v137, v130, v131
v_mul_f32 v167, v132, v132
v_mul_f32 v168, v133, v133
ds_read_b64_tr_b16 a[76:77], v163 offset:20480
ds_read_b64_tr_b16 a[78:79], v163 offset:22528
s_waitcnt lgkmcnt(14)
s_setprio 0
v_mfma_f32_16x16x32_bf16 v[0:3], a[48:51], a[8:11], v[0:3]
v_mul_f32 v169, v134, v134
v_mul_f32 v170, v135, v135
v_fma_f32 v167, v167, s8, v164
v_fma_f32 v168, v168, s8, v164
v_fma_f32 v169, v169, s8, v164
v_fma_f32 v170, v170, s8, v164
v_mfma_f32_16x16x32_bf16 v[32:35], a[48:51], a[12:15], v[32:35]
v_mul_f32 v167, v167, v132
v_mul_f32 v168, v168, v133
v_mul_f32 v169, v169, v134
v_mul_f32 v170, v170, v135
v_exp_f32 v167, v167
ds_read_b64_tr_b16 a[48:49], v160 offset:16384
ds_read_b64_tr_b16 a[50:51], v160 offset:18432
s_waitcnt lgkmcnt(14)
v_mfma_f32_16x16x32_bf16 v[4:7], a[52:55], a[8:11], v[4:7]
v_mul_f32 v132, v132, v140
v_exp_f32 v168, v168
v_mul_f32 v133, v133, v141
v_exp_f32 v169, v169
v_mfma_f32_16x16x32_bf16 v[36:39], a[52:55], a[12:15], v[36:39]
v_mul_f32 v134, v134, v142
v_exp_f32 v170, v170
v_mul_f32 v135, v135, v143
v_add_f32 v167, 1.0, v167
v_add_f32 v168, 1.0, v168
ds_read_b64_tr_b16 a[52:53], v161 offset:16384
ds_read_b64_tr_b16 a[54:55], v161 offset:18432
s_add_u32 m0, s62, 40960
s_add_u32 s64, s64, 65536
buffer_load_dwordx4 v175, s[32:35], s64 offen lds
s_waitcnt lgkmcnt(14)
v_mfma_f32_16x16x32_bf16 v[8:11], a[56:59], a[8:11], v[8:11]
v_add_f32 v169, 1.0, v169
v_add_f32 v170, 1.0, v170
v_rcp_f32 v167, v167
v_rcp_f32 v168, v168
v_mfma_f32_16x16x32_bf16 v[40:43], a[56:59], a[12:15], v[40:43]
v_rcp_f32 v169, v169
v_rcp_f32 v170, v170
v_mul_f32 v132, v132, v167
v_mul_f32 v133, v133, v168
ds_read_b64_tr_b16 a[56:57], v162 offset:16384
ds_read_b64_tr_b16 a[58:59], v162 offset:18432
s_waitcnt lgkmcnt(14)
v_mfma_f32_16x16x32_bf16 v[12:15], a[60:63], a[8:11], v[12:15]
v_mul_f32 v134, v134, v169
v_mul_f32 v135, v135, v170
v_cvt_pk_bf16_f32 v138, v132, v133
v_cvt_pk_bf16_f32 v139, v134, v135
buffer_store_dwordx4 v[136:139], v171, s[40:43], s94 offen sc1
s_add_u32 s94, s94, 147456
v_mul_f32 v167, v144, v144
v_mfma_f32_16x16x32_bf16 v[44:47], a[60:63], a[12:15], v[44:47]
v_mul_f32 v168, v145, v145
v_mul_f32 v169, v146, v146
v_mul_f32 v170, v147, v147
v_fma_f32 v167, v167, s8, v164
v_fma_f32 v168, v168, s8, v164
v_fma_f32 v169, v169, s8, v164
ds_read_b64_tr_b16 a[60:61], v163 offset:16384
ds_read_b64_tr_b16 a[62:63], v163 offset:18432
buffer_load_dwordx4 a[0:3], v171, s[40:43], s68 offen sc1
buffer_load_dwordx4 a[4:7], v171, s[40:43], s69 offen sc1
s_sub_u32 s68, s68, 2048
s_sub_u32 s69, s69, 2048
s_waitcnt vmcnt(29) lgkmcnt(0)
s_barrier
v_xor_b32 v160, 0x10000, v160
v_xor_b32 v161, 0x10000, v161
v_xor_b32 v162, 0x10000, v162
v_xor_b32 v163, 0x10000, v163
s_setprio 3
v_mfma_f32_16x16x32_bf16 v[16:19], a[64:67], a[32:35], v[16:19]
v_fma_f32 v170, v170, s8, v164
v_mul_f32 v167, v167, v144
v_mul_f32 v168, v168, v145
v_mul_f32 v169, v169, v146
v_mul_f32 v170, v170, v147
v_exp_f32 v167, v167
v_mfma_f32_16x16x32_bf16 v[48:51], a[64:67], a[36:39], v[48:51]
v_mul_f32 v144, v144, v152
v_exp_f32 v168, v168
v_mul_f32 v145, v145, v153
v_exp_f32 v169, v169
ds_read_b64_tr_b16 a[64:65], v160 offset:4096
ds_read_b64_tr_b16 a[66:67], v160 offset:6144
v_mfma_f32_16x16x32_bf16 v[20:23], a[68:71], a[32:35], v[20:23]
v_mul_f32 v146, v146, v154
v_exp_f32 v170, v170
v_mul_f32 v147, v147, v155
v_add_f32 v167, 1.0, v167
v_add_f32 v168, 1.0, v168
v_mfma_f32_16x16x32_bf16 v[52:55], a[68:71], a[36:39], v[52:55]
v_add_f32 v169, 1.0, v169
v_add_f32 v170, 1.0, v170
v_rcp_f32 v167, v167
v_rcp_f32 v168, v168
ds_read_b64_tr_b16 a[68:69], v161 offset:4096
ds_read_b64_tr_b16 a[70:71], v161 offset:6144
s_add_u32 m0, s62, 49152
s_sub_u32 s64, s64, 1114112
buffer_load_dwordx4 v175, s[32:35], s64 offen lds
v_mfma_f32_16x16x32_bf16 v[24:27], a[72:75], a[32:35], v[24:27]
v_rcp_f32 v169, v169
v_rcp_f32 v170, v170
v_mul_f32 v144, v144, v167
v_mul_f32 v145, v145, v168
v_mfma_f32_16x16x32_bf16 v[56:59], a[72:75], a[36:39], v[56:59]
v_mul_f32 v146, v146, v169
v_mul_f32 v147, v147, v170
v_cvt_pk_bf16_f32 v152, v144, v145
v_cvt_pk_bf16_f32 v153, v146, v147
v_mul_f32 v167, v148, v148
v_mul_f32 v168, v149, v149
ds_read_b64_tr_b16 a[72:73], v162 offset:4096
ds_read_b64_tr_b16 a[74:75], v162 offset:6144
v_mfma_f32_16x16x32_bf16 v[28:31], a[76:79], a[32:35], v[28:31]
v_mul_f32 v169, v150, v150
v_mul_f32 v170, v151, v151
v_fma_f32 v167, v167, s8, v164
v_fma_f32 v168, v168, s8, v164
v_fma_f32 v169, v169, s8, v164
v_fma_f32 v170, v170, s8, v164
v_mfma_f32_16x16x32_bf16 v[60:63], a[76:79], a[36:39], v[60:63]
v_mul_f32 v167, v167, v148
v_mul_f32 v168, v168, v149
v_mul_f32 v169, v169, v150
v_mul_f32 v170, v170, v151
v_exp_f32 v167, v167
ds_read_b64_tr_b16 a[76:77], v163 offset:4096
ds_read_b64_tr_b16 a[78:79], v163 offset:6144
s_setprio 2
v_mfma_f32_16x16x32_bf16 v[0:3], a[48:51], a[32:35], v[0:3]
v_mul_f32 v148, v148, v156
v_exp_f32 v168, v168
v_mul_f32 v149, v149, v157
v_exp_f32 v169, v169
v_mfma_f32_16x16x32_bf16 v[32:35], a[48:51], a[36:39], v[32:35]
v_mul_f32 v150, v150, v158
v_exp_f32 v170, v170
v_mul_f32 v151, v151, v159
v_add_f32 v167, 1.0, v167
v_add_f32 v168, 1.0, v168
ds_read_b64_tr_b16 a[48:49], v160 offset:0
ds_read_b64_tr_b16 a[50:51], v160 offset:2048
v_mfma_f32_16x16x32_bf16 v[4:7], a[52:55], a[32:35], v[4:7]
v_add_f32 v169, 1.0, v169
v_add_f32 v170, 1.0, v170
v_rcp_f32 v167, v167
v_rcp_f32 v168, v168
v_mfma_f32_16x16x32_bf16 v[36:39], a[52:55], a[36:39], v[36:39]
v_rcp_f32 v169, v169
v_rcp_f32 v170, v170
v_mul_f32 v148, v148, v167
v_mul_f32 v149, v149, v168
ds_read_b64_tr_b16 a[52:53], v161 offset:0
ds_read_b64_tr_b16 a[54:55], v161 offset:2048
s_add_u32 m0, s62, 57344
s_add_u32 s64, s64, 65536
buffer_load_dwordx4 v175, s[32:35], s64 offen lds
v_mfma_f32_16x16x32_bf16 v[8:11], a[56:59], a[32:35], v[8:11]
s_waitcnt vmcnt(11)
v_cvt_pk_bf16_f32 v96, v96, v97
v_cvt_pk_bf16_f32 v97, v98, v99
ds_write_b64 v120, v[96:97] offset:0
v_cvt_pk_bf16_f32 v100, v100, v101
v_cvt_pk_bf16_f32 v101, v102, v103
ds_write_b64 v120, v[100:101] offset:2048
v_mfma_f32_16x16x32_bf16 v[40:43], a[56:59], a[36:39], v[40:43]
s_waitcnt vmcnt(7)
v_cvt_pk_bf16_f32 v104, v104, v105
v_cvt_pk_bf16_f32 v105, v106, v107
v_cvt_pk_bf16_f32 v106, v108, v109
v_cvt_pk_bf16_f32 v107, v110, v111
v_bfi_b32 v104, v124, v125, v104
v_bfi_b32 v105, v124, v125, v105
ds_read_b64_tr_b16 a[56:57], v162 offset:0
ds_read_b64_tr_b16 a[58:59], v162 offset:2048
v_mfma_f32_16x16x32_bf16 v[12:15], a[60:63], a[32:35], v[12:15]
v_bfi_b32 v106, v124, v125, v106
v_bfi_b32 v107, v124, v125, v107
v_cvt_pk_bf16_f32 v112, v112, v113
v_cvt_pk_bf16_f32 v113, v114, v115
v_cvt_pk_bf16_f32 v114, v116, v117
v_cvt_pk_bf16_f32 v115, v118, v119
v_mfma_f32_16x16x32_bf16 v[44:47], a[60:63], a[36:39], v[44:47]
v_bfi_b32 v112, v124, 0, v112
v_bfi_b32 v113, v124, 0, v113
v_bfi_b32 v114, v124, 0, v114
v_bfi_b32 v115, v124, 0, v115
v_xor_b32 v122, 1024, v123
s_lshl_b32 s57, s86, 2
s_add_u32 s57, s57, s88
ds_read_b64_tr_b16 a[60:61], v163 offset:0
ds_read_b64_tr_b16 a[62:63], v163 offset:2048
buffer_load_dwordx4 a[8:11], v171, s[40:43], s68 offen sc1
buffer_load_dwordx4 a[12:15], v171, s[40:43], s69 offen sc1
s_sub_u32 s68, s68, 16384
s_sub_u32 s69, s69, 16384
s_waitcnt vmcnt(31)
s_cmp_lg_u32 s87, 0
s_cbranch_scc1 k1_kernel_a_g2p_pi
v_lshrrev_b32 v172, 4, v171
v_min_u32 v172, 3, v172
v_and_b32 v174, 1, v172
v_lshlrev_b32 v172, 3, v172
v_lshlrev_b32 v174, 2, v174
v_sub_u32 v172, v172, v174
buffer_load_dword v172, v172, s[40:43], s66 offen offset:96 sc1
k1_kernel_a_g2p_pi:
s_waitcnt lgkmcnt(15)
s_setprio 1
v_mfma_f32_16x16x32_bf16 v[16:19], a[64:67], a[40:43], v[16:19]
s_lshl_b32 s57, s57, 8
s_add_u32 s57, s57, 29368320
v_and_b32 v108, 0xf0, v171
buffer_load_dwordx4 v[108:111], v108, s[40:43], s57 offen sc1
v_mul_f32 v150, v150, v169
v_mul_f32 v151, v151, v170
v_cvt_pk_bf16_f32 v154, v148, v149
v_mfma_f32_16x16x32_bf16 v[48:51], a[64:67], a[44:47], v[48:51]
v_cvt_pk_bf16_f32 v155, v150, v151
buffer_store_dwordx4 v[152:155], v171, s[40:43], s94 offen sc1
ds_read_b64_tr_b16 a[64:65], v160 offset:20480
ds_read_b64_tr_b16 a[66:67], v160 offset:22528
s_waitcnt lgkmcnt(15)
v_mfma_f32_16x16x32_bf16 v[20:23], a[68:71], a[40:43], v[20:23]
v_mfma_f32_16x16x32_bf16 v[52:55], a[68:71], a[44:47], v[52:55]
ds_read_b64_tr_b16 a[68:69], v161 offset:20480
ds_read_b64_tr_b16 a[70:71], v161 offset:22528
s_add_u32 m0, s62, 65536
s_add_u32 s64, s64, 327680
buffer_load_dwordx4 v175, s[32:35], s64 offen lds
s_waitcnt lgkmcnt(15)
v_mfma_f32_16x16x32_bf16 v[24:27], a[72:75], a[40:43], v[24:27]
v_mfma_f32_16x16x32_bf16 v[56:59], a[72:75], a[44:47], v[56:59]
ds_read_b64_tr_b16 a[72:73], v162 offset:20480
ds_read_b64_tr_b16 a[74:75], v162 offset:22528
s_waitcnt lgkmcnt(15)
v_mfma_f32_16x16x32_bf16 v[28:31], a[76:79], a[40:43], v[28:31]
v_mfma_f32_16x16x32_bf16 v[60:63], a[76:79], a[44:47], v[60:63]
ds_read_b64_tr_b16 a[76:77], v163 offset:20480
ds_read_b64_tr_b16 a[78:79], v163 offset:22528
s_waitcnt lgkmcnt(15)
s_setprio 0
v_mfma_f32_16x16x32_bf16 v[0:3], a[48:51], a[40:43], v[0:3]
v_mfma_f32_16x16x32_bf16 v[32:35], a[48:51], a[44:47], v[32:35]
ds_read_b64_tr_b16 a[48:49], v160 offset:16384
ds_read_b64_tr_b16 a[50:51], v160 offset:18432
s_waitcnt lgkmcnt(15)
v_mfma_f32_16x16x32_bf16 v[4:7], a[52:55], a[40:43], v[4:7]
v_mfma_f32_16x16x32_bf16 v[36:39], a[52:55], a[44:47], v[36:39]
ds_read_b64_tr_b16 a[52:53], v161 offset:16384
ds_read_b64_tr_b16 a[54:55], v161 offset:18432
s_add_u32 m0, s62, 73728
s_add_u32 s64, s64, 65536
buffer_load_dwordx4 v175, s[32:35], s64 offen lds
s_waitcnt lgkmcnt(14)
v_mfma_f32_16x16x32_bf16 v[8:11], a[56:59], a[40:43], v[8:11]
v_mfma_f32_16x16x32_bf16 v[40:43], a[56:59], a[44:47], v[40:43]
ds_read_b64_tr_b16 a[56:57], v162 offset:16384
ds_read_b64_tr_b16 a[58:59], v162 offset:18432
s_waitcnt lgkmcnt(14)
v_mfma_f32_16x16x32_bf16 v[12:15], a[60:63], a[40:43], v[12:15]
v_mfma_f32_16x16x32_bf16 v[44:47], a[60:63], a[44:47], v[44:47]
ds_read_b64_tr_b16 a[60:61], v163 offset:16384
ds_read_b64_tr_b16 a[62:63], v163 offset:18432
s_waitcnt vmcnt(28) lgkmcnt(0)
s_barrier
v_xor_b32 v160, 0x10000, v160
v_xor_b32 v161, 0x10000, v161
v_xor_b32 v162, 0x10000, v162
v_xor_b32 v163, 0x10000, v163
s_setprio 3
v_mfma_f32_16x16x32_bf16 v[16:19], a[64:67], a[16:19], v[16:19]
ds_read_b128 v[124:127], v123 offset:0
ds_read_b128 v[128:131], v122 offset:0
ds_read_b128 v[132:135], v123 offset:2048
ds_read_b128 v[136:139], v122 offset:2048
v_mfma_f32_16x16x32_bf16 v[48:51], a[64:67], a[20:23], v[48:51]
ds_read_b64_tr_b16 a[64:65], v160 offset:36864
ds_read_b64_tr_b16 a[66:67], v160 offset:38912
v_mfma_f32_16x16x32_bf16 v[20:23], a[68:71], a[16:19], v[20:23]
v_mfma_f32_16x16x32_bf16 v[52:55], a[68:71], a[20:23], v[52:55]
s_waitcnt lgkmcnt(2)
v_mfma_f32_16x16x32_bf16 v[140:143], v[124:127], v[64:67], 0
v_mfma_f32_16x16x32_bf16 v[144:147], v[132:135], v[64:67], 0
v_mfma_f32_16x16x32_bf16 v[148:151], v[104:107], v[64:67], 0
ds_read_b64_tr_b16 a[68:69], v161 offset:36864
ds_read_b64_tr_b16 a[70:71], v161 offset:38912
s_add_u32 m0, s62, 81920
s_add_u32 s64, s64, 458752
buffer_load_dwordx4 v175, s[32:35], s64 offen lds
v_mfma_f32_16x16x32_bf16 v[24:27], a[72:75], a[16:19], v[24:27]
v_mfma_f32_16x16x32_bf16 v[140:143], v[128:131], v[68:71], v[140:143]
v_mfma_f32_16x16x32_bf16 v[144:147], v[136:139], v[68:71], v[144:147]
v_mfma_f32_16x16x32_bf16 v[148:151], v[112:115], v[68:71], v[148:151]
v_mfma_f32_16x16x32_bf16 v[56:59], a[72:75], a[20:23], v[56:59]
v_mfma_f32_16x16x32_bf16 v[152:155], v[124:127], v[72:75], 0
v_mfma_f32_16x16x32_bf16 v[156:159], v[132:135], v[72:75], 0
v_mfma_f32_16x16x32_bf16 v[96:99], v[104:107], v[72:75], 0
ds_read_b64_tr_b16 a[72:73], v162 offset:36864
ds_read_b64_tr_b16 a[74:75], v162 offset:38912
v_mfma_f32_16x16x32_bf16 v[28:31], a[76:79], a[16:19], v[28:31]
v_mfma_f32_16x16x32_bf16 v[152:155], v[128:131], v[76:79], v[152:155]
v_mfma_f32_16x16x32_bf16 v[156:159], v[136:139], v[76:79], v[156:159]
v_mfma_f32_16x16x32_bf16 v[96:99], v[112:115], v[76:79], v[96:99]
v_mfma_f32_16x16x32_bf16 v[60:63], a[76:79], a[20:23], v[60:63]
v_rcp_f32 v150, v149
s_nop 0
v_mul_f32 v148, v148, v150
v_cvt_pk_bf16_f32 v149, v148, v148
v_lshlrev_b32 v149, 16, v149
v_add_f32 v149, 0x358637bd, v149
ds_read_b64_tr_b16 a[76:77], v163 offset:36864
ds_read_b64_tr_b16 a[78:79], v163 offset:38912
s_setprio 2
v_mfma_f32_16x16x32_bf16 v[0:3], a[48:51], a[16:19], v[0:3]
v_cvt_pk_bf16_f32 v149, v149, v149
v_lshlrev_b32 v149, 16, v149
v_rcp_f32 v149, v149
s_nop 0
v_mul_f32 v149, v149, v150
s_waitcnt vmcnt(4)
v_mul_f32 v149, v149, v108
v_mfma_f32_16x16x32_bf16 v[32:35], a[48:51], a[20:23], v[32:35]
v_mul_f32 v140, v140, v149
v_mul_f32 v141, v141, v149
v_mul_f32 v142, v142, v149
v_mul_f32 v143, v143, v149
v_mul_f32 v144, v144, v149
v_mul_f32 v145, v145, v149
ds_read_b64_tr_b16 a[48:49], v160 offset:32768
ds_read_b64_tr_b16 a[50:51], v160 offset:34816
v_mfma_f32_16x16x32_bf16 v[4:7], a[52:55], a[16:19], v[4:7]
v_mul_f32 v146, v146, v149
v_mul_f32 v147, v147, v149
v_cvt_pk_bf16_f32 v64, v140, v141
v_cvt_pk_bf16_f32 v65, v142, v143
v_cvt_pk_bf16_f32 v66, v144, v145
v_cvt_pk_bf16_f32 v67, v146, v147
v_mfma_f32_16x16x32_bf16 v[36:39], a[52:55], a[20:23], v[36:39]
buffer_store_dwordx4 v[64:67], v171, s[40:43], s65 offen sc1
s_add_u32 s65, s65, 147456
v_mfma_f32_16x16x32_bf16 v[140:143], v[124:127], v[80:83], 0
v_mfma_f32_16x16x32_bf16 v[144:147], v[132:135], v[80:83], 0
v_mfma_f32_16x16x32_bf16 v[148:151], v[104:107], v[80:83], 0
ds_read_b64_tr_b16 a[52:53], v161 offset:32768
ds_read_b64_tr_b16 a[54:55], v161 offset:34816
s_add_u32 m0, s62, 90112
s_add_u32 s64, s64, 65536
buffer_load_dwordx4 v175, s[32:35], s64 offen lds
v_mfma_f32_16x16x32_bf16 v[8:11], a[56:59], a[16:19], v[8:11]
v_mfma_f32_16x16x32_bf16 v[140:143], v[128:131], v[84:87], v[140:143]
v_mfma_f32_16x16x32_bf16 v[144:147], v[136:139], v[84:87], v[144:147]
v_mfma_f32_16x16x32_bf16 v[148:151], v[112:115], v[84:87], v[148:151]
v_mfma_f32_16x16x32_bf16 v[40:43], a[56:59], a[20:23], v[40:43]
v_rcp_f32 v98, v97
s_nop 0
v_mul_f32 v96, v96, v98
v_cvt_pk_bf16_f32 v97, v96, v96
v_lshlrev_b32 v97, 16, v97
v_add_f32 v97, 0x358637bd, v97
ds_read_b64_tr_b16 a[56:57], v162 offset:32768
ds_read_b64_tr_b16 a[58:59], v162 offset:34816
v_mfma_f32_16x16x32_bf16 v[12:15], a[60:63], a[16:19], v[12:15]
v_cvt_pk_bf16_f32 v97, v97, v97
v_lshlrev_b32 v97, 16, v97
v_rcp_f32 v97, v97
s_nop 0
v_mul_f32 v97, v97, v98
v_mul_f32 v97, v97, v109
v_mfma_f32_16x16x32_bf16 v[44:47], a[60:63], a[20:23], v[44:47]
v_mul_f32 v152, v152, v97
v_mul_f32 v153, v153, v97
v_mul_f32 v154, v154, v97
v_mul_f32 v155, v155, v97
v_mul_f32 v156, v156, v97
v_mul_f32 v157, v157, v97
ds_read_b64_tr_b16 a[60:61], v163 offset:32768
ds_read_b64_tr_b16 a[62:63], v163 offset:34816
s_waitcnt vmcnt(5)
s_cmp_lg_u32 s87, 0
s_cbranch_scc1 k1_kernel_a_g2p_pc_rdy
s_waitcnt vmcnt(7)
v_cmp_le_u32 s[100:101], 3, v172
s_nop 0
s_cmp_eq_u64 s[100:101], -1
s_cbranch_scc1 k1_kernel_a_g2p_pc_rdy
s_mov_b32 s91, 40000
k1_kernel_a_g2p_pc_spin:
s_sleep 2
v_lshrrev_b32 v172, 4, v171
v_min_u32 v172, 3, v172
v_and_b32 v174, 1, v172
v_lshlrev_b32 v172, 3, v172
v_lshlrev_b32 v174, 2, v174
v_sub_u32 v172, v172, v174
buffer_load_dword v172, v172, s[40:43], s66 offen offset:96 sc1
s_waitcnt vmcnt(0)
v_cmp_le_u32 s[100:101], 3, v172
s_nop 0
s_cmp_eq_u64 s[100:101], -1
s_cbranch_scc1 k1_kernel_a_g2p_pc_rdy
s_sub_u32 s91, s91, 1
s_cmp_lg_u32 s91, 0
s_cbranch_scc1 k1_kernel_a_g2p_pc_spin
s_nop 0
k1_kernel_a_g2p_pc_rdy:
s_barrier
s_cmp_lg_u32 s87, 0
s_cbranch_scc1 k1_kernel_a_h2_sg
v_mov_b32 v174, 3
s_mov_b64 exec, 1
buffer_store_dword v174, off, s[40:43], s81 sc1
s_mov_b64 exec, -1
k1_kernel_a_h2_sg:
buffer_load_dwordx4 a[32:35], v171, s[40:43], s68 offen sc1
buffer_load_dwordx4 a[36:39], v171, s[40:43], s69 offen sc1
s_add_u32 s68, s68, 6144
s_add_u32 s69, s69, 6144
buffer_load_dwordx4 a[40:43], v171, s[40:43], s68 offen sc1
buffer_load_dwordx4 a[44:47], v171, s[40:43], s69 offen sc1
s_add_u32 s68, s68, 8192
s_add_u32 s69, s69, 8192
s_waitcnt lgkmcnt(14)
s_setprio 1
v_mfma_f32_16x16x32_bf16 v[16:19], a[64:67], a[24:27], v[16:19]
v_mul_f32 v158, v158, v97
v_mul_f32 v159, v159, v97
v_cvt_pk_bf16_f32 v72, v152, v153
v_cvt_pk_bf16_f32 v73, v154, v155
v_cvt_pk_bf16_f32 v74, v156, v157
v_cvt_pk_bf16_f32 v75, v158, v159
v_mfma_f32_16x16x32_bf16 v[48:51], a[64:67], a[28:31], v[48:51]
buffer_store_dwordx4 v[72:75], v171, s[40:43], s65 offen sc1
s_add_u32 s65, s65, 147456
v_mfma_f32_16x16x32_bf16 v[152:155], v[124:127], v[88:91], 0
v_mfma_f32_16x16x32_bf16 v[156:159], v[132:135], v[88:91], 0
v_mfma_f32_16x16x32_bf16 v[96:99], v[104:107], v[88:91], 0
ds_read_b64_tr_b16 a[64:65], v160 offset:53248
ds_read_b64_tr_b16 a[66:67], v160 offset:55296
s_waitcnt lgkmcnt(14)
v_mfma_f32_16x16x32_bf16 v[20:23], a[68:71], a[24:27], v[20:23]
v_mfma_f32_16x16x32_bf16 v[152:155], v[128:131], v[92:95], v[152:155]
v_mfma_f32_16x16x32_bf16 v[156:159], v[136:139], v[92:95], v[156:159]
v_mfma_f32_16x16x32_bf16 v[96:99], v[112:115], v[92:95], v[96:99]
v_mfma_f32_16x16x32_bf16 v[52:55], a[68:71], a[28:31], v[52:55]
v_rcp_f32 v150, v149
s_nop 0
v_mul_f32 v148, v148, v150
v_cvt_pk_bf16_f32 v149, v148, v148
v_lshlrev_b32 v149, 16, v149
v_add_f32 v149, 0x358637bd, v149
ds_read_b64_tr_b16 a[68:69], v161 offset:53248
ds_read_b64_tr_b16 a[70:71], v161 offset:55296
s_add_u32 m0, s62, 0
s_add_u32 s64, s64, 327680
buffer_load_dwordx4 v175, s[32:35], s64 offen lds
s_waitcnt lgkmcnt(14)
v_mfma_f32_16x16x32_bf16 v[24:27], a[72:75], a[24:27], v[24:27]
v_cvt_pk_bf16_f32 v149, v149, v149
v_lshlrev_b32 v149, 16, v149
v_rcp_f32 v149, v149
s_nop 0
v_mul_f32 v149, v149, v150
v_mul_f32 v149, v149, v110
v_mfma_f32_16x16x32_bf16 v[56:59], a[72:75], a[28:31], v[56:59]
v_mul_f32 v140, v140, v149
v_mul_f32 v141, v141, v149
v_mul_f32 v142, v142, v149
v_mul_f32 v143, v143, v149
v_mul_f32 v144, v144, v149
v_mul_f32 v145, v145, v149
ds_read_b64_tr_b16 a[72:73], v162 offset:53248
ds_read_b64_tr_b16 a[74:75], v162 offset:55296
s_waitcnt lgkmcnt(14)
v_mfma_f32_16x16x32_bf16 v[28:31], a[76:79], a[24:27], v[28:31]
v_mul_f32 v146, v146, v149
v_mul_f32 v147, v147, v149
v_cvt_pk_bf16_f32 v80, v140, v141
v_cvt_pk_bf16_f32 v81, v142, v143
v_cvt_pk_bf16_f32 v82, v144, v145
v_cvt_pk_bf16_f32 v83, v146, v147
v_mfma_f32_16x16x32_bf16 v[60:63], a[76:79], a[28:31], v[60:63]
buffer_store_dwordx4 v[80:83], v171, s[40:43], s65 offen sc1
s_add_u32 s65, s65, 147456
v_rcp_f32 v98, v97
s_nop 0
v_mul_f32 v96, v96, v98
v_cvt_pk_bf16_f32 v97, v96, v96
v_lshlrev_b32 v97, 16, v97
ds_read_b64_tr_b16 a[76:77], v163 offset:53248
ds_read_b64_tr_b16 a[78:79], v163 offset:55296
s_waitcnt lgkmcnt(14)
s_setprio 0
v_mfma_f32_16x16x32_bf16 v[0:3], a[48:51], a[24:27], v[0:3]
v_add_f32 v97, 0x358637bd, v97
v_cvt_pk_bf16_f32 v97, v97, v97
v_lshlrev_b32 v97, 16, v97
v_rcp_f32 v97, v97
s_nop 0
v_mul_f32 v97, v97, v98
v_mfma_f32_16x16x32_bf16 v[32:35], a[48:51], a[28:31], v[32:35]
v_mul_f32 v97, v97, v111
v_mul_f32 v152, v152, v97
v_mul_f32 v153, v153, v97
v_mul_f32 v154, v154, v97
v_mul_f32 v155, v155, v97
v_mul_f32 v156, v156, v97
ds_read_b64_tr_b16 a[48:49], v160 offset:49152
ds_read_b64_tr_b16 a[50:51], v160 offset:51200
s_waitcnt lgkmcnt(14)
v_mfma_f32_16x16x32_bf16 v[4:7], a[52:55], a[24:27], v[4:7]
v_mul_f32 v157, v157, v97
v_mul_f32 v158, v158, v97
v_mul_f32 v159, v159, v97
v_cvt_pk_bf16_f32 v88, v152, v153
v_cvt_pk_bf16_f32 v89, v154, v155
v_cvt_pk_bf16_f32 v90, v156, v157
v_mfma_f32_16x16x32_bf16 v[36:39], a[52:55], a[28:31], v[36:39]
v_cvt_pk_bf16_f32 v91, v158, v159
buffer_store_dwordx4 v[88:91], v171, s[40:43], s65 offen sc1
ds_read_b64_tr_b16 a[52:53], v161 offset:49152
ds_read_b64_tr_b16 a[54:55], v161 offset:51200
s_add_u32 m0, s62, 8192
s_add_u32 s64, s64, 65536
buffer_load_dwordx4 v175, s[32:35], s64 offen lds
s_waitcnt lgkmcnt(14)
v_mfma_f32_16x16x32_bf16 v[8:11], a[56:59], a[24:27], v[8:11]
v_mfma_f32_16x16x32_bf16 v[40:43], a[56:59], a[28:31], v[40:43]
ds_read_b64_tr_b16 a[56:57], v162 offset:49152
ds_read_b64_tr_b16 a[58:59], v162 offset:51200
s_waitcnt lgkmcnt(14)
v_mfma_f32_16x16x32_bf16 v[12:15], a[60:63], a[24:27], v[12:15]
v_mfma_f32_16x16x32_bf16 v[44:47], a[60:63], a[28:31], v[44:47]
ds_read_b64_tr_b16 a[60:61], v163 offset:49152
ds_read_b64_tr_b16 a[62:63], v163 offset:51200
buffer_load_dwordx4 a[16:19], v171, s[40:43], s68 offen sc1
buffer_load_dwordx4 a[20:23], v171, s[40:43], s69 offen sc1
s_add_u32 s68, s68, 6144
s_add_u32 s69, s69, 6144
s_waitcnt vmcnt(20) lgkmcnt(0)
s_barrier
v_xor_b32 v160, 0x10000, v160
v_xor_b32 v161, 0x10000, v161
v_xor_b32 v162, 0x10000, v162
v_xor_b32 v163, 0x10000, v163
s_setprio 3
v_mfma_f32_16x16x32_bf16 v[16:19], a[64:67], a[0:3], v[16:19]
v_mfma_f32_16x16x32_bf16 v[48:51], a[64:67], a[4:7], v[48:51]
ds_read_b64_tr_b16 a[64:65], v160 offset:36864
ds_read_b64_tr_b16 a[66:67], v160 offset:38912
v_mfma_f32_16x16x32_bf16 v[20:23], a[68:71], a[0:3], v[20:23]
v_mfma_f32_16x16x32_bf16 v[52:55], a[68:71], a[4:7], v[52:55]
ds_read_b64_tr_b16 a[68:69], v161 offset:36864
ds_read_b64_tr_b16 a[70:71], v161 offset:38912
s_add_u32 m0, s62, 16384
s_sub_u32 s64, s64, 2686976
buffer_load_dwordx4 v175, s[32:35], s64 offen lds
v_mfma_f32_16x16x32_bf16 v[24:27], a[72:75], a[0:3], v[24:27]
v_mfma_f32_16x16x32_bf16 v[56:59], a[72:75], a[4:7], v[56:59]
ds_read_b64_tr_b16 a[72:73], v162 offset:36864
ds_read_b64_tr_b16 a[74:75], v162 offset:38912
v_mfma_f32_16x16x32_bf16 v[28:31], a[76:79], a[0:3], v[28:31]
v_mfma_f32_16x16x32_bf16 v[60:63], a[76:79], a[4:7], v[60:63]
ds_read_b64_tr_b16 a[76:77], v163 offset:36864
ds_read_b64_tr_b16 a[78:79], v163 offset:38912
s_setprio 2
v_mfma_f32_16x16x32_bf16 v[0:3], a[48:51], a[0:3], v[0:3]
v_mfma_f32_16x16x32_bf16 v[32:35], a[48:51], a[4:7], v[32:35]
ds_read_b64_tr_b16 a[48:49], v160 offset:32768
ds_read_b64_tr_b16 a[50:51], v160 offset:34816
v_mfma_f32_16x16x32_bf16 v[4:7], a[52:55], a[0:3], v[4:7]
v_mfma_f32_16x16x32_bf16 v[36:39], a[52:55], a[4:7], v[36:39]
ds_read_b64_tr_b16 a[52:53], v161 offset:32768
ds_read_b64_tr_b16 a[54:55], v161 offset:34816
s_add_u32 m0, s62, 24576
s_add_u32 s64, s64, 65536
buffer_load_dwordx4 v175, s[32:35], s64 offen lds
v_mfma_f32_16x16x32_bf16 v[8:11], a[56:59], a[0:3], v[8:11]
v_mfma_f32_16x16x32_bf16 v[40:43], a[56:59], a[4:7], v[40:43]
ds_read_b64_tr_b16 a[56:57], v162 offset:32768
ds_read_b64_tr_b16 a[58:59], v162 offset:34816
v_mfma_f32_16x16x32_bf16 v[12:15], a[60:63], a[0:3], v[12:15]
v_mfma_f32_16x16x32_bf16 v[44:47], a[60:63], a[4:7], v[44:47]
ds_read_b64_tr_b16 a[60:61], v163 offset:32768
ds_read_b64_tr_b16 a[62:63], v163 offset:34816
buffer_load_dwordx4 a[24:27], v171, s[40:43], s68 offen sc1
buffer_load_dwordx4 a[28:31], v171, s[40:43], s69 offen sc1
s_sub_u32 s68, s68, 40960
s_sub_u32 s69, s69, 40960
s_waitcnt vmcnt(22)
s_cmp_lg_u32 s87, 0
s_cbranch_scc1 k1_kernel_a_g3p_pi
v_lshrrev_b32 v172, 4, v171
v_min_u32 v172, 7, v172
v_and_b32 v174, 1, v172
v_lshlrev_b32 v172, 3, v172
v_lshlrev_b32 v174, 2, v174
v_sub_u32 v172, v172, v174
buffer_load_dword v172, v172, s[40:43], s66 offen offset:72 sc1
k1_kernel_a_g3p_pi:
s_waitcnt lgkmcnt(14)
s_setprio 1
v_mfma_f32_16x16x32_bf16 v[16:19], a[64:67], a[8:11], v[16:19]
v_mfma_f32_16x16x32_bf16 v[48:51], a[64:67], a[12:15], v[48:51]
ds_read_b64_tr_b16 a[64:65], v160 offset:53248
ds_read_b64_tr_b16 a[66:67], v160 offset:55296
s_waitcnt lgkmcnt(14)
v_mfma_f32_16x16x32_bf16 v[20:23], a[68:71], a[8:11], v[20:23]
v_mfma_f32_16x16x32_bf16 v[52:55], a[68:71], a[12:15], v[52:55]
ds_read_b64_tr_b16 a[68:69], v161 offset:53248
ds_read_b64_tr_b16 a[70:71], v161 offset:55296
s_add_u32 m0, s62, 98304
s_add_u32 s64, s64, 65536
buffer_load_dwordx4 v175, s[32:35], s64 offen lds
s_waitcnt lgkmcnt(14)
v_mfma_f32_16x16x32_bf16 v[24:27], a[72:75], a[8:11], v[24:27]
v_mfma_f32_16x16x32_bf16 v[56:59], a[72:75], a[12:15], v[56:59]
ds_read_b64_tr_b16 a[72:73], v162 offset:53248
ds_read_b64_tr_b16 a[74:75], v162 offset:55296
s_waitcnt lgkmcnt(14)
v_mfma_f32_16x16x32_bf16 v[28:31], a[76:79], a[8:11], v[28:31]
v_mfma_f32_16x16x32_bf16 v[60:63], a[76:79], a[12:15], v[60:63]
ds_read_b64_tr_b16 a[76:77], v163 offset:53248
ds_read_b64_tr_b16 a[78:79], v163 offset:55296
s_waitcnt lgkmcnt(14)
s_setprio 0
v_mfma_f32_16x16x32_bf16 v[0:3], a[48:51], a[8:11], v[0:3]
v_mfma_f32_16x16x32_bf16 v[32:35], a[48:51], a[12:15], v[32:35]
ds_read_b64_tr_b16 a[48:49], v160 offset:49152
ds_read_b64_tr_b16 a[50:51], v160 offset:51200
s_waitcnt lgkmcnt(14)
v_mfma_f32_16x16x32_bf16 v[4:7], a[52:55], a[8:11], v[4:7]
v_mfma_f32_16x16x32_bf16 v[36:39], a[52:55], a[12:15], v[36:39]
ds_read_b64_tr_b16 a[52:53], v161 offset:49152
ds_read_b64_tr_b16 a[54:55], v161 offset:51200
s_add_u32 m0, s62, 106496
s_add_u32 s64, s64, 65536
buffer_load_dwordx4 v175, s[32:35], s64 offen lds
s_waitcnt lgkmcnt(14)
v_mfma_f32_16x16x32_bf16 v[8:11], a[56:59], a[8:11], v[8:11]
v_mfma_f32_16x16x32_bf16 v[40:43], a[56:59], a[12:15], v[40:43]
ds_read_b64_tr_b16 a[56:57], v162 offset:49152
ds_read_b64_tr_b16 a[58:59], v162 offset:51200
s_waitcnt lgkmcnt(14)
v_mfma_f32_16x16x32_bf16 v[12:15], a[60:63], a[8:11], v[12:15]
v_mfma_f32_16x16x32_bf16 v[44:47], a[60:63], a[12:15], v[44:47]
ds_read_b64_tr_b16 a[60:61], v163 offset:49152
ds_read_b64_tr_b16 a[62:63], v163 offset:51200
s_waitcnt vmcnt(15) lgkmcnt(0)
s_barrier
v_xor_b32 v160, 0x10000, v160
v_xor_b32 v161, 0x10000, v161
v_xor_b32 v162, 0x10000, v162
v_xor_b32 v163, 0x10000, v163
s_setprio 3
v_mfma_f32_16x16x32_bf16 v[16:19], a[64:67], a[32:35], v[16:19]
v_mfma_f32_16x16x32_bf16 v[48:51], a[64:67], a[36:39], v[48:51]
ds_read_b64_tr_b16 a[64:65], v160 offset:4096
ds_read_b64_tr_b16 a[66:67], v160 offset:6144
v_mfma_f32_16x16x32_bf16 v[20:23], a[68:71], a[32:35], v[20:23]
v_mfma_f32_16x16x32_bf16 v[52:55], a[68:71], a[36:39], v[52:55]
ds_read_b64_tr_b16 a[68:69], v161 offset:4096
ds_read_b64_tr_b16 a[70:71], v161 offset:6144
s_add_u32 m0, s62, 114688
s_add_u32 s64, s64, 720896
buffer_load_dwordx4 v175, s[32:35], s64 offen lds
v_mfma_f32_16x16x32_bf16 v[24:27], a[72:75], a[32:35], v[24:27]
v_mfma_f32_16x16x32_bf16 v[56:59], a[72:75], a[36:39], v[56:59]
ds_read_b64_tr_b16 a[72:73], v162 offset:4096
ds_read_b64_tr_b16 a[74:75], v162 offset:6144
v_mfma_f32_16x16x32_bf16 v[28:31], a[76:79], a[32:35], v[28:31]
v_mfma_f32_16x16x32_bf16 v[60:63], a[76:79], a[36:39], v[60:63]
ds_read_b64_tr_b16 a[76:77], v163 offset:4096
ds_read_b64_tr_b16 a[78:79], v163 offset:6144
s_setprio 2
v_mfma_f32_16x16x32_bf16 v[0:3], a[48:51], a[32:35], v[0:3]
v_mfma_f32_16x16x32_bf16 v[32:35], a[48:51], a[36:39], v[32:35]
ds_read_b64_tr_b16 a[48:49], v160 offset:0
ds_read_b64_tr_b16 a[50:51], v160 offset:2048
v_mfma_f32_16x16x32_bf16 v[4:7], a[52:55], a[32:35], v[4:7]
v_mfma_f32_16x16x32_bf16 v[36:39], a[52:55], a[36:39], v[36:39]
ds_read_b64_tr_b16 a[52:53], v161 offset:0
ds_read_b64_tr_b16 a[54:55], v161 offset:2048
s_add_u32 m0, s62, 122880
s_add_u32 s64, s64, 65536
buffer_load_dwordx4 v175, s[32:35], s64 offen lds
v_mfma_f32_16x16x32_bf16 v[8:11], a[56:59], a[32:35], v[8:11]
v_mfma_f32_16x16x32_bf16 v[40:43], a[56:59], a[36:39], v[40:43]
ds_read_b64_tr_b16 a[56:57], v162 offset:0
ds_read_b64_tr_b16 a[58:59], v162 offset:2048
v_mfma_f32_16x16x32_bf16 v[12:15], a[60:63], a[32:35], v[12:15]
v_mfma_f32_16x16x32_bf16 v[44:47], a[60:63], a[36:39], v[44:47]
ds_read_b64_tr_b16 a[60:61], v163 offset:0
ds_read_b64_tr_b16 a[62:63], v163 offset:2048
s_waitcnt vmcnt(11)
s_cmp_lg_u32 s87, 0
s_cbranch_scc1 k1_kernel_a_g3p_pc_rdy
s_waitcnt vmcnt(4)
v_cmp_le_u32 s[100:101], 3, v172
s_nop 0
s_cmp_eq_u64 s[100:101], -1
s_cbranch_scc1 k1_kernel_a_g3p_pc_rdy
s_mov_b32 s91, 40000
k1_kernel_a_g3p_pc_spin:
s_sleep 2
v_lshrrev_b32 v172, 4, v171
v_min_u32 v172, 7, v172
v_and_b32 v174, 1, v172
v_lshlrev_b32 v172, 3, v172
v_lshlrev_b32 v174, 2, v174
v_sub_u32 v172, v172, v174
buffer_load_dword v172, v172, s[40:43], s66 offen offset:72 sc1
s_waitcnt vmcnt(0)
v_cmp_le_u32 s[100:101], 3, v172
s_nop 0
s_cmp_eq_u64 s[100:101], -1
s_cbranch_scc1 k1_kernel_a_g3p_pc_rdy
s_sub_u32 s91, s91, 1
s_cmp_lg_u32 s91, 0
s_cbranch_scc1 k1_kernel_a_g3p_pc_spin
s_nop 0
k1_kernel_a_g3p_pc_rdy:
s_barrier
s_cmp_lg_u32 s87, 0
s_cbranch_scc1 k1_kernel_a_o_sg
v_mov_b32 v174, 1
s_mov_b64 exec, 1
buffer_store_dword v174, off, s[40:43], s79 sc1
s_mov_b64 exec, -1
k1_kernel_a_o_sg:
buffer_load_dwordx4 a[0:3], v171, s[40:43], s68 offen sc1
buffer_load_dwordx4 a[4:7], v171, s[40:43], s69 offen sc1
s_add_u32 s68, s68, 2048
s_add_u32 s69, s69, 2048
buffer_load_dwordx4 a[8:11], v171, s[40:43], s68 offen sc1
buffer_load_dwordx4 a[12:15], v171, s[40:43], s69 offen sc1
s_add_u32 s68, s68, 12288
s_add_u32 s69, s69, 12288
s_waitcnt lgkmcnt(14)
s_setprio 1
v_mfma_f32_16x16x32_bf16 v[16:19], a[64:67], a[40:43], v[16:19]
v_mfma_f32_16x16x32_bf16 v[48:51], a[64:67], a[44:47], v[48:51]
ds_read_b64_tr_b16 a[64:65], v160 offset:20480
ds_read_b64_tr_b16 a[66:67], v160 offset:22528
s_waitcnt lgkmcnt(14)
v_mfma_f32_16x16x32_bf16 v[20:23], a[68:71], a[40:43], v[20:23]
v_mfma_f32_16x16x32_bf16 v[52:55], a[68:71], a[44:47], v[52:55]
ds_read_b64_tr_b16 a[68:69], v161 offset:20480
ds_read_b64_tr_b16 a[70:71], v161 offset:22528
s_add_u32 m0, s62, 32768
s_add_u32 s64, s64, 65536
buffer_load_dwordx4 v175, s[32:35], s64 offen lds
s_waitcnt lgkmcnt(14)
v_mfma_f32_16x16x32_bf16 v[24:27], a[72:75], a[40:43], v[24:27]
v_mfma_f32_16x16x32_bf16 v[56:59], a[72:75], a[44:47], v[56:59]
ds_read_b64_tr_b16 a[72:73], v162 offset:20480
ds_read_b64_tr_b16 a[74:75], v162 offset:22528
s_waitcnt lgkmcnt(14)
v_mfma_f32_16x16x32_bf16 v[28:31], a[76:79], a[40:43], v[28:31]
v_mfma_f32_16x16x32_bf16 v[60:63], a[76:79], a[44:47], v[60:63]
ds_read_b64_tr_b16 a[76:77], v163 offset:20480
ds_read_b64_tr_b16 a[78:79], v163 offset:22528
s_waitcnt lgkmcnt(14)
s_setprio 0
v_mfma_f32_16x16x32_bf16 v[0:3], a[48:51], a[40:43], v[0:3]
v_mfma_f32_16x16x32_bf16 v[32:35], a[48:51], a[44:47], v[32:35]
ds_read_b64_tr_b16 a[48:49], v160 offset:16384
ds_read_b64_tr_b16 a[50:51], v160 offset:18432
s_waitcnt lgkmcnt(14)
v_mfma_f32_16x16x32_bf16 v[4:7], a[52:55], a[40:43], v[4:7]
v_mfma_f32_16x16x32_bf16 v[36:39], a[52:55], a[44:47], v[36:39]
ds_read_b64_tr_b16 a[52:53], v161 offset:16384
ds_read_b64_tr_b16 a[54:55], v161 offset:18432
s_add_u32 m0, s62, 40960
s_add_u32 s64, s64, 65536
buffer_load_dwordx4 v175, s[32:35], s64 offen lds
s_waitcnt lgkmcnt(14)
v_mfma_f32_16x16x32_bf16 v[8:11], a[56:59], a[40:43], v[8:11]
v_mfma_f32_16x16x32_bf16 v[40:43], a[56:59], a[44:47], v[40:43]
ds_read_b64_tr_b16 a[56:57], v162 offset:16384
ds_read_b64_tr_b16 a[58:59], v162 offset:18432
s_waitcnt lgkmcnt(14)
v_mfma_f32_16x16x32_bf16 v[12:15], a[60:63], a[40:43], v[12:15]
v_mfma_f32_16x16x32_bf16 v[44:47], a[60:63], a[44:47], v[44:47]
ds_read_b64_tr_b16 a[60:61], v163 offset:16384
ds_read_b64_tr_b16 a[62:63], v163 offset:18432
buffer_load_dwordx4 a[32:35], v171, s[40:43], s68 offen sc1
buffer_load_dwordx4 a[36:39], v171, s[40:43], s69 offen sc1
s_add_u32 s68, s68, 2048
s_add_u32 s69, s69, 2048
s_waitcnt vmcnt(14) lgkmcnt(0)
s_barrier
v_xor_b32 v160, 0x10000, v160
v_xor_b32 v161, 0x10000, v161
v_xor_b32 v162, 0x10000, v162
v_xor_b32 v163, 0x10000, v163
s_setprio 3
v_mfma_f32_16x16x32_bf16 v[16:19], a[64:67], a[16:19], v[16:19]
v_mfma_f32_16x16x32_bf16 v[48:51], a[64:67], a[20:23], v[48:51]
ds_read_b64_tr_b16 a[64:65], v160 offset:4096
ds_read_b64_tr_b16 a[66:67], v160 offset:6144
v_mfma_f32_16x16x32_bf16 v[20:23], a[68:71], a[16:19], v[20:23]
v_mfma_f32_16x16x32_bf16 v[52:55], a[68:71], a[20:23], v[52:55]
ds_read_b64_tr_b16 a[68:69], v161 offset:4096
ds_read_b64_tr_b16 a[70:71], v161 offset:6144
s_add_u32 m0, s62, 49152
s_add_u32 s64, s64, 720896
buffer_load_dwordx4 v175, s[32:35], s64 offen lds
v_mfma_f32_16x16x32_bf16 v[24:27], a[72:75], a[16:19], v[24:27]
v_mfma_f32_16x16x32_bf16 v[56:59], a[72:75], a[20:23], v[56:59]
ds_read_b64_tr_b16 a[72:73], v162 offset:4096
ds_read_b64_tr_b16 a[74:75], v162 offset:6144
v_mfma_f32_16x16x32_bf16 v[28:31], a[76:79], a[16:19], v[28:31]
v_mfma_f32_16x16x32_bf16 v[60:63], a[76:79], a[20:23], v[60:63]
ds_read_b64_tr_b16 a[76:77], v163 offset:4096
ds_read_b64_tr_b16 a[78:79], v163 offset:6144
s_setprio 2
v_mfma_f32_16x16x32_bf16 v[0:3], a[48:51], a[16:19], v[0:3]
v_mfma_f32_16x16x32_bf16 v[32:35], a[48:51], a[20:23], v[32:35]
ds_read_b64_tr_b16 a[48:49], v160 offset:0
ds_read_b64_tr_b16 a[50:51], v160 offset:2048
v_mfma_f32_16x16x32_bf16 v[4:7], a[52:55], a[16:19], v[4:7]
v_mfma_f32_16x16x32_bf16 v[36:39], a[52:55], a[20:23], v[36:39]
ds_read_b64_tr_b16 a[52:53], v161 offset:0
ds_read_b64_tr_b16 a[54:55], v161 offset:2048
s_add_u32 m0, s62, 57344
s_add_u32 s64, s64, 65536
buffer_load_dwordx4 v175, s[32:35], s64 offen lds
v_mfma_f32_16x16x32_bf16 v[8:11], a[56:59], a[16:19], v[8:11]
v_mfma_f32_16x16x32_bf16 v[40:43], a[56:59], a[20:23], v[40:43]
ds_read_b64_tr_b16 a[56:57], v162 offset:0
ds_read_b64_tr_b16 a[58:59], v162 offset:2048
v_mfma_f32_16x16x32_bf16 v[12:15], a[60:63], a[16:19], v[12:15]
v_mfma_f32_16x16x32_bf16 v[44:47], a[60:63], a[20:23], v[44:47]
ds_read_b64_tr_b16 a[60:61], v163 offset:0
ds_read_b64_tr_b16 a[62:63], v163 offset:2048
buffer_load_dwordx4 a[40:43], v171, s[40:43], s68 offen sc1
buffer_load_dwordx4 a[44:47], v171, s[40:43], s69 offen sc1
s_add_u32 s68, s68, 12288
s_add_u32 s69, s69, 12288
s_waitcnt vmcnt(16)
s_waitcnt lgkmcnt(14)
s_setprio 1
v_mfma_f32_16x16x32_bf16 v[16:19], a[64:67], a[24:27], v[16:19]
v_mfma_f32_16x16x32_bf16 v[48:51], a[64:67], a[28:31], v[48:51]
ds_read_b64_tr_b16 a[64:65], v160 offset:20480
ds_read_b64_tr_b16 a[66:67], v160 offset:22528
s_waitcnt lgkmcnt(14)
v_mfma_f32_16x16x32_bf16 v[20:23], a[68:71], a[24:27], v[20:23]
v_mfma_f32_16x16x32_bf16 v[52:55], a[68:71], a[28:31], v[52:55]
ds_read_b64_tr_b16 a[68:69], v161 offset:20480
ds_read_b64_tr_b16 a[70:71], v161 offset:22528
s_add_u32 m0, s62, 65536
s_add_u32 s64, s64, 65536
buffer_load_dwordx4 v175, s[32:35], s64 offen lds
s_waitcnt lgkmcnt(14)
v_mfma_f32_16x16x32_bf16 v[24:27], a[72:75], a[24:27], v[24:27]
v_mfma_f32_16x16x32_bf16 v[56:59], a[72:75], a[28:31], v[56:59]
ds_read_b64_tr_b16 a[72:73], v162 offset:20480
ds_read_b64_tr_b16 a[74:75], v162 offset:22528
s_waitcnt lgkmcnt(14)
v_mfma_f32_16x16x32_bf16 v[28:31], a[76:79], a[24:27], v[28:31]
v_mfma_f32_16x16x32_bf16 v[60:63], a[76:79], a[28:31], v[60:63]
ds_read_b64_tr_b16 a[76:77], v163 offset:20480
ds_read_b64_tr_b16 a[78:79], v163 offset:22528
s_waitcnt lgkmcnt(14)
s_setprio 0
v_mfma_f32_16x16x32_bf16 v[0:3], a[48:51], a[24:27], v[0:3]
v_mfma_f32_16x16x32_bf16 v[32:35], a[48:51], a[28:31], v[32:35]
ds_read_b64_tr_b16 a[48:49], v160 offset:16384
ds_read_b64_tr_b16 a[50:51], v160 offset:18432
s_waitcnt lgkmcnt(14)
v_mfma_f32_16x16x32_bf16 v[4:7], a[52:55], a[24:27], v[4:7]
v_mfma_f32_16x16x32_bf16 v[36:39], a[52:55], a[28:31], v[36:39]
ds_read_b64_tr_b16 a[52:53], v161 offset:16384
ds_read_b64_tr_b16 a[54:55], v161 offset:18432
s_add_u32 m0, s62, 73728
s_add_u32 s64, s64, 65536
buffer_load_dwordx4 v175, s[32:35], s64 offen lds
s_waitcnt lgkmcnt(14)
v_mfma_f32_16x16x32_bf16 v[8:11], a[56:59], a[24:27], v[8:11]
v_mfma_f32_16x16x32_bf16 v[40:43], a[56:59], a[28:31], v[40:43]
ds_read_b64_tr_b16 a[56:57], v162 offset:16384
ds_read_b64_tr_b16 a[58:59], v162 offset:18432
s_waitcnt lgkmcnt(14)
v_mfma_f32_16x16x32_bf16 v[12:15], a[60:63], a[24:27], v[12:15]
v_mfma_f32_16x16x32_bf16 v[44:47], a[60:63], a[28:31], v[44:47]
ds_read_b64_tr_b16 a[60:61], v163 offset:16384
ds_read_b64_tr_b16 a[62:63], v163 offset:18432
buffer_load_dwordx4 a[16:19], v171, s[40:43], s68 offen sc1
buffer_load_dwordx4 a[20:23], v171, s[40:43], s69 offen sc1
s_add_u32 s68, s68, 2048
s_add_u32 s69, s69, 2048
s_waitcnt vmcnt(14) lgkmcnt(0)
s_barrier
v_xor_b32 v160, 0x10000, v160
v_xor_b32 v161, 0x10000, v161
v_xor_b32 v162, 0x10000, v162
v_xor_b32 v163, 0x10000, v163
s_setprio 3
v_mfma_f32_16x16x32_bf16 v[16:19], a[64:67], a[0:3], v[16:19]
v_mfma_f32_16x16x32_bf16 v[48:51], a[64:67], a[4:7], v[48:51]
ds_read_b64_tr_b16 a[64:65], v160 offset:36864
ds_read_b64_tr_b16 a[66:67], v160 offset:38912
v_mfma_f32_16x16x32_bf16 v[20:23], a[68:71], a[0:3], v[20:23]
v_mfma_f32_16x16x32_bf16 v[52:55], a[68:71], a[4:7], v[52:55]
ds_read_b64_tr_b16 a[68:69], v161 offset:36864
ds_read_b64_tr_b16 a[70:71], v161 offset:38912
s_add_u32 m0, s62, 81920
s_add_u32 s64, s64, 720896
buffer_load_dwordx4 v175, s[32:35], s64 offen lds
v_mfma_f32_16x16x32_bf16 v[24:27], a[72:75], a[0:3], v[24:27]
v_mfma_f32_16x16x32_bf16 v[56:59], a[72:75], a[4:7], v[56:59]
ds_read_b64_tr_b16 a[72:73], v162 offset:36864
ds_read_b64_tr_b16 a[74:75], v162 offset:38912
v_mfma_f32_16x16x32_bf16 v[28:31], a[76:79], a[0:3], v[28:31]
v_mfma_f32_16x16x32_bf16 v[60:63], a[76:79], a[4:7], v[60:63]
ds_read_b64_tr_b16 a[76:77], v163 offset:36864
ds_read_b64_tr_b16 a[78:79], v163 offset:38912
s_setprio 2
v_mfma_f32_16x16x32_bf16 v[0:3], a[48:51], a[0:3], v[0:3]
v_mfma_f32_16x16x32_bf16 v[32:35], a[48:51], a[4:7], v[32:35]
ds_read_b64_tr_b16 a[48:49], v160 offset:32768
ds_read_b64_tr_b16 a[50:51], v160 offset:34816
v_mfma_f32_16x16x32_bf16 v[4:7], a[52:55], a[0:3], v[4:7]
v_mfma_f32_16x16x32_bf16 v[36:39], a[52:55], a[4:7], v[36:39]
ds_read_b64_tr_b16 a[52:53], v161 offset:32768
ds_read_b64_tr_b16 a[54:55], v161 offset:34816
s_add_u32 m0, s62, 90112
s_add_u32 s64, s64, 65536
buffer_load_dwordx4 v175, s[32:35], s64 offen lds
v_mfma_f32_16x16x32_bf16 v[8:11], a[56:59], a[0:3], v[8:11]
v_mfma_f32_16x16x32_bf16 v[40:43], a[56:59], a[4:7], v[40:43]
ds_read_b64_tr_b16 a[56:57], v162 offset:32768
ds_read_b64_tr_b16 a[58:59], v162 offset:34816
v_mfma_f32_16x16x32_bf16 v[12:15], a[60:63], a[0:3], v[12:15]
v_mfma_f32_16x16x32_bf16 v[44:47], a[60:63], a[4:7], v[44:47]
ds_read_b64_tr_b16 a[60:61], v163 offset:32768
ds_read_b64_tr_b16 a[62:63], v163 offset:34816
buffer_load_dwordx4 a[24:27], v171, s[40:43], s68 offen sc1
buffer_load_dwordx4 a[28:31], v171, s[40:43], s69 offen sc1
s_add_u32 s68, s68, 12288
s_add_u32 s69, s69, 12288
s_waitcnt vmcnt(16)
s_waitcnt lgkmcnt(14)
s_setprio 1
v_mfma_f32_16x16x32_bf16 v[16:19], a[64:67], a[8:11], v[16:19]
v_mfma_f32_16x16x32_bf16 v[48:51], a[64:67], a[12:15], v[48:51]
ds_read_b64_tr_b16 a[64:65], v160 offset:53248
ds_read_b64_tr_b16 a[66:67], v160 offset:55296
s_waitcnt lgkmcnt(14)
v_mfma_f32_16x16x32_bf16 v[20:23], a[68:71], a[8:11], v[20:23]
v_mfma_f32_16x16x32_bf16 v[52:55], a[68:71], a[12:15], v[52:55]
ds_read_b64_tr_b16 a[68:69], v161 offset:53248
ds_read_b64_tr_b16 a[70:71], v161 offset:55296
s_add_u32 m0, s62, 0
s_add_u32 s64, s64, 65536
buffer_load_dwordx4 v175, s[32:35], s64 offen lds
s_waitcnt lgkmcnt(14)
v_mfma_f32_16x16x32_bf16 v[24:27], a[72:75], a[8:11], v[24:27]
v_mfma_f32_16x16x32_bf16 v[56:59], a[72:75], a[12:15], v[56:59]
ds_read_b64_tr_b16 a[72:73], v162 offset:53248
ds_read_b64_tr_b16 a[74:75], v162 offset:55296
s_waitcnt lgkmcnt(14)
v_mfma_f32_16x16x32_bf16 v[28:31], a[76:79], a[8:11], v[28:31]
v_mfma_f32_16x16x32_bf16 v[60:63], a[76:79], a[12:15], v[60:63]
ds_read_b64_tr_b16 a[76:77], v163 offset:53248
ds_read_b64_tr_b16 a[78:79], v163 offset:55296
s_waitcnt lgkmcnt(14)
s_setprio 0
v_mfma_f32_16x16x32_bf16 v[0:3], a[48:51], a[8:11], v[0:3]
v_mfma_f32_16x16x32_bf16 v[32:35], a[48:51], a[12:15], v[32:35]
ds_read_b64_tr_b16 a[48:49], v160 offset:49152
ds_read_b64_tr_b16 a[50:51], v160 offset:51200
s_waitcnt lgkmcnt(14)
v_mfma_f32_16x16x32_bf16 v[4:7], a[52:55], a[8:11], v[4:7]
v_mfma_f32_16x16x32_bf16 v[36:39], a[52:55], a[12:15], v[36:39]
ds_read_b64_tr_b16 a[52:53], v161 offset:49152
ds_read_b64_tr_b16 a[54:55], v161 offset:51200
s_add_u32 m0, s62, 8192
s_add_u32 s64, s64, 65536
buffer_load_dwordx4 v175, s[32:35], s64 offen lds
s_waitcnt lgkmcnt(14)
v_mfma_f32_16x16x32_bf16 v[8:11], a[56:59], a[8:11], v[8:11]
v_mfma_f32_16x16x32_bf16 v[40:43], a[56:59], a[12:15], v[40:43]
ds_read_b64_tr_b16 a[56:57], v162 offset:49152
ds_read_b64_tr_b16 a[58:59], v162 offset:51200
s_waitcnt lgkmcnt(14)
v_mfma_f32_16x16x32_bf16 v[12:15], a[60:63], a[8:11], v[12:15]
v_mfma_f32_16x16x32_bf16 v[44:47], a[60:63], a[12:15], v[44:47]
ds_read_b64_tr_b16 a[60:61], v163 offset:49152
ds_read_b64_tr_b16 a[62:63], v163 offset:51200
buffer_load_dwordx4 a[0:3], v171, s[40:43], s68 offen sc1
buffer_load_dwordx4 a[4:7], v171, s[40:43], s69 offen sc1
s_add_u32 s68, s68, 2048
s_add_u32 s69, s69, 2048
s_waitcnt vmcnt(14) lgkmcnt(0)
s_barrier
s_cmp_lg_u32 s87, 0
s_cbranch_scc1 k1_kernel_a_op_pi
v_lshrrev_b32 v172, 2, v171
v_min_u32 v172, 60, v172
buffer_load_dword v172, v172, s[40:43], s71 offen offset:0 sc1
k1_kernel_a_op_pi:
v_xor_b32 v160, 0x10000, v160
v_xor_b32 v161, 0x10000, v161
v_xor_b32 v162, 0x10000, v162
v_xor_b32 v163, 0x10000, v163
s_setprio 3
v_mfma_f32_16x16x32_bf16 v[16:19], a[64:67], a[32:35], v[16:19]
v_mfma_f32_16x16x32_bf16 v[48:51], a[64:67], a[36:39], v[48:51]
ds_read_b64_tr_b16 a[64:65], v160 offset:36864
ds_read_b64_tr_b16 a[66:67], v160 offset:38912
v_mfma_f32_16x16x32_bf16 v[20:23], a[68:71], a[32:35], v[20:23]
v_mfma_f32_16x16x32_bf16 v[52:55], a[68:71], a[36:39], v[52:55]
ds_read_b64_tr_b16 a[68:69], v161 offset:36864
ds_read_b64_tr_b16 a[70:71], v161 offset:38912
s_add_u32 m0, s62, 16384
s_sub_u32 s64, s64, 7012352
buffer_load_dwordx4 v175, s[20:23], s64 offen lds
v_mfma_f32_16x16x32_bf16 v[24:27], a[72:75], a[32:35], v[24:27]
v_mfma_f32_16x16x32_bf16 v[56:59], a[72:75], a[36:39], v[56:59]
ds_read_b64_tr_b16 a[72:73], v162 offset:36864
ds_read_b64_tr_b16 a[74:75], v162 offset:38912
v_mfma_f32_16x16x32_bf16 v[28:31], a[76:79], a[32:35], v[28:31]
v_mfma_f32_16x16x32_bf16 v[60:63], a[76:79], a[36:39], v[60:63]
ds_read_b64_tr_b16 a[76:77], v163 offset:36864
ds_read_b64_tr_b16 a[78:79], v163 offset:38912
s_setprio 2
v_mfma_f32_16x16x32_bf16 v[0:3], a[48:51], a[32:35], v[0:3]
v_mfma_f32_16x16x32_bf16 v[32:35], a[48:51], a[36:39], v[32:35]
ds_read_b64_tr_b16 a[48:49], v160 offset:32768
ds_read_b64_tr_b16 a[50:51], v160 offset:34816
v_mfma_f32_16x16x32_bf16 v[4:7], a[52:55], a[32:35], v[4:7]
v_mfma_f32_16x16x32_bf16 v[36:39], a[52:55], a[36:39], v[36:39]
ds_read_b64_tr_b16 a[52:53], v161 offset:32768
ds_read_b64_tr_b16 a[54:55], v161 offset:34816
s_add_u32 m0, s62, 24576
s_add_u32 s64, s64, 65536
buffer_load_dwordx4 v175, s[20:23], s64 offen lds
v_mfma_f32_16x16x32_bf16 v[8:11], a[56:59], a[32:35], v[8:11]
v_mfma_f32_16x16x32_bf16 v[40:43], a[56:59], a[36:39], v[40:43]
ds_read_b64_tr_b16 a[56:57], v162 offset:32768
ds_read_b64_tr_b16 a[58:59], v162 offset:34816
v_mfma_f32_16x16x32_bf16 v[12:15], a[60:63], a[32:35], v[12:15]
v_mfma_f32_16x16x32_bf16 v[44:47], a[60:63], a[36:39], v[44:47]
ds_read_b64_tr_b16 a[60:61], v163 offset:32768
ds_read_b64_tr_b16 a[62:63], v163 offset:34816
buffer_load_dwordx4 a[8:11], v171, s[40:43], s68 offen sc1
buffer_load_dwordx4 a[12:15], v171, s[40:43], s69 offen sc1
s_add_u32 s68, s68, 6144
s_add_u32 s69, s69, 6144
s_waitcnt vmcnt(16)
s_waitcnt lgkmcnt(14)
s_setprio 1
v_mfma_f32_16x16x32_bf16 v[16:19], a[64:67], a[40:43], v[16:19]
v_mfma_f32_16x16x32_bf16 v[48:51], a[64:67], a[44:47], v[48:51]
ds_read_b64_tr_b16 a[64:65], v160 offset:53248
ds_read_b64_tr_b16 a[66:67], v160 offset:55296
s_waitcnt lgkmcnt(14)
v_mfma_f32_16x16x32_bf16 v[20:23], a[68:71], a[40:43], v[20:23]
v_mfma_f32_16x16x32_bf16 v[52:55], a[68:71], a[44:47], v[52:55]
ds_read_b64_tr_b16 a[68:69], v161 offset:53248
ds_read_b64_tr_b16 a[70:71], v161 offset:55296
s_add_u32 m0, s62, 98304
s_nop 0
buffer_load_dwordx4 v175, s[20:23], s67 offen lds
s_waitcnt lgkmcnt(14)
v_mfma_f32_16x16x32_bf16 v[24:27], a[72:75], a[40:43], v[24:27]
v_mfma_f32_16x16x32_bf16 v[56:59], a[72:75], a[44:47], v[56:59]
ds_read_b64_tr_b16 a[72:73], v162 offset:53248
ds_read_b64_tr_b16 a[74:75], v162 offset:55296
s_waitcnt lgkmcnt(14)
v_mfma_f32_16x16x32_bf16 v[28:31], a[76:79], a[40:43], v[28:31]
v_mfma_f32_16x16x32_bf16 v[60:63], a[76:79], a[44:47], v[60:63]
ds_read_b64_tr_b16 a[76:77], v163 offset:53248
ds_read_b64_tr_b16 a[78:79], v163 offset:55296
s_waitcnt lgkmcnt(14)
s_setprio 0
v_mfma_f32_16x16x32_bf16 v[0:3], a[48:51], a[40:43], v[0:3]
v_mfma_f32_16x16x32_bf16 v[32:35], a[48:51], a[44:47], v[32:35]
ds_read_b64_tr_b16 a[48:49], v160 offset:49152
ds_read_b64_tr_b16 a[50:51], v160 offset:51200
s_waitcnt lgkmcnt(14)
v_mfma_f32_16x16x32_bf16 v[4:7], a[52:55], a[40:43], v[4:7]
v_mfma_f32_16x16x32_bf16 v[36:39], a[52:55], a[44:47], v[36:39]
ds_read_b64_tr_b16 a[52:53], v161 offset:49152
ds_read_b64_tr_b16 a[54:55], v161 offset:51200
s_add_u32 m0, s62, 106496
s_add_u32 s67, s67, 131072
buffer_load_dwordx4 v175, s[20:23], s67 offen lds
s_waitcnt lgkmcnt(14)
v_mfma_f32_16x16x32_bf16 v[8:11], a[56:59], a[40:43], v[8:11]
v_mfma_f32_16x16x32_bf16 v[40:43], a[56:59], a[44:47], v[40:43]
ds_read_b64_tr_b16 a[56:57], v162 offset:49152
ds_read_b64_tr_b16 a[58:59], v162 offset:51200
s_waitcnt lgkmcnt(14)
v_mfma_f32_16x16x32_bf16 v[12:15], a[60:63], a[40:43], v[12:15]
v_mfma_f32_16x16x32_bf16 v[44:47], a[60:63], a[44:47], v[44:47]
ds_read_b64_tr_b16 a[60:61], v163 offset:49152
ds_read_b64_tr_b16 a[62:63], v163 offset:51200
s_waitcnt vmcnt(12) lgkmcnt(0)
s_cmp_lg_u32 s87, 0
s_cbranch_scc1 k1_kernel_a_op_pc_rdy
s_waitcnt vmcnt(6)
v_cmp_le_u32 s[100:101], 1, v172
s_nop 0
s_cmp_eq_u64 s[100:101], -1
s_cbranch_scc1 k1_kernel_a_op_pc_rdy
s_mov_b32 s91, 40000
k1_kernel_a_op_pc_spin:
s_sleep 2
v_lshrrev_b32 v172, 2, v171
v_min_u32 v172, 60, v172
buffer_load_dword v172, v172, s[40:43], s71 offen offset:0 sc1
s_waitcnt vmcnt(0)
v_cmp_le_u32 s[100:101], 1, v172
s_nop 0
s_cmp_eq_u64 s[100:101], -1
s_cbranch_scc1 k1_kernel_a_op_pc_rdy
s_sub_u32 s91, s91, 1
s_cmp_lg_u32 s91, 0
s_cbranch_scc1 k1_kernel_a_op_pc_spin
s_nop 0
k1_kernel_a_op_pc_rdy:
s_barrier
v_xor_b32 v160, 0x10000, v160
v_xor_b32 v161, 0x10000, v161
v_xor_b32 v162, 0x10000, v162
v_xor_b32 v163, 0x10000, v163
buffer_load_dwordx4 a[32:35], v171, s[40:43], s68 offen sc1
buffer_load_dwordx4 a[36:39], v171, s[40:43], s69 offen sc1
s_add_u32 s68, s68, 0
s_add_u32 s69, s69, 0
s_setprio 3
v_mfma_f32_16x16x32_bf16 v[16:19], a[64:67], a[16:19], v[16:19]
v_mfma_f32_16x16x32_bf16 v[48:51], a[64:67], a[20:23], v[48:51]
ds_read_b64_tr_b16 a[64:65], v160 offset:4096
ds_read_b64_tr_b16 a[66:67], v160 offset:6144
v_mfma_f32_16x16x32_bf16 v[20:23], a[68:71], a[16:19], v[20:23]
v_mfma_f32_16x16x32_bf16 v[52:55], a[68:71], a[20:23], v[52:55]
ds_read_b64_tr_b16 a[68:69], v161 offset:4096
ds_read_b64_tr_b16 a[70:71], v161 offset:6144
s_add_u32 m0, s62, 114688
s_add_u32 s67, s67, 131072
buffer_load_dwordx4 v175, s[20:23], s67 offen lds
v_mfma_f32_16x16x32_bf16 v[24:27], a[72:75], a[16:19], v[24:27]
v_mfma_f32_16x16x32_bf16 v[56:59], a[72:75], a[20:23], v[56:59]
ds_read_b64_tr_b16 a[72:73], v162 offset:4096
ds_read_b64_tr_b16 a[74:75], v162 offset:6144
v_mfma_f32_16x16x32_bf16 v[28:31], a[76:79], a[16:19], v[28:31]
v_mfma_f32_16x16x32_bf16 v[60:63], a[76:79], a[20:23], v[60:63]
ds_read_b64_tr_b16 a[76:77], v163 offset:4096
ds_read_b64_tr_b16 a[78:79], v163 offset:6144
s_setprio 2
v_mfma_f32_16x16x32_bf16 v[0:3], a[48:51], a[16:19], v[0:3]
v_mfma_f32_16x16x32_bf16 v[32:35], a[48:51], a[20:23], v[32:35]
ds_read_b64_tr_b16 a[48:49], v160 offset:0
ds_read_b64_tr_b16 a[50:51], v160 offset:2048
v_mfma_f32_16x16x32_bf16 v[4:7], a[52:55], a[16:19], v[4:7]
v_mfma_f32_16x16x32_bf16 v[36:39], a[52:55], a[20:23], v[36:39]
ds_read_b64_tr_b16 a[52:53], v161 offset:0
ds_read_b64_tr_b16 a[54:55], v161 offset:2048
s_add_u32 m0, s62, 122880
s_add_u32 s67, s67, 131072
buffer_load_dwordx4 v175, s[20:23], s67 offen lds
v_mfma_f32_16x16x32_bf16 v[8:11], a[56:59], a[16:19], v[8:11]
v_mfma_f32_16x16x32_bf16 v[40:43], a[56:59], a[20:23], v[40:43]
ds_read_b64_tr_b16 a[56:57], v162 offset:0
ds_read_b64_tr_b16 a[58:59], v162 offset:2048
v_mfma_f32_16x16x32_bf16 v[12:15], a[60:63], a[16:19], v[12:15]
v_mfma_f32_16x16x32_bf16 v[44:47], a[60:63], a[20:23], v[44:47]
ds_read_b64_tr_b16 a[60:61], v163 offset:0
ds_read_b64_tr_b16 a[62:63], v163 offset:2048
buffer_load_dwordx4 a[40:43], v171, s[40:43], s54 offen sc1
buffer_load_dwordx4 a[44:47], v171, s[40:43], s55 offen sc1
s_add_u32 s54, s54, 2048
s_add_u32 s55, s55, 2048
s_waitcnt vmcnt(16)
s_waitcnt lgkmcnt(14)
s_setprio 1
v_mfma_f32_16x16x32_bf16 v[16:19], a[64:67], a[24:27], v[16:19]
v_mfma_f32_16x16x32_bf16 v[48:51], a[64:67], a[28:31], v[48:51]
ds_read_b64_tr_b16 a[64:65], v160 offset:20480
ds_read_b64_tr_b16 a[66:67], v160 offset:22528
s_waitcnt lgkmcnt(14)
v_mfma_f32_16x16x32_bf16 v[20:23], a[68:71], a[24:27], v[20:23]
v_mfma_f32_16x16x32_bf16 v[52:55], a[68:71], a[28:31], v[52:55]
ds_read_b64_tr_b16 a[68:69], v161 offset:20480
ds_read_b64_tr_b16 a[70:71], v161 offset:22528
s_add_u32 m0, s62, 32768
s_add_u32 s67, s67, 131072
buffer_load_dwordx4 v175, s[20:23], s67 offen lds
s_waitcnt lgkmcnt(14)
v_mfma_f32_16x16x32_bf16 v[24:27], a[72:75], a[24:27], v[24:27]
v_mfma_f32_16x16x32_bf16 v[56:59], a[72:75], a[28:31], v[56:59]
ds_read_b64_tr_b16 a[72:73], v162 offset:20480
ds_read_b64_tr_b16 a[74:75], v162 offset:22528
s_waitcnt lgkmcnt(14)
v_mfma_f32_16x16x32_bf16 v[28:31], a[76:79], a[24:27], v[28:31]
v_mfma_f32_16x16x32_bf16 v[60:63], a[76:79], a[28:31], v[60:63]
ds_read_b64_tr_b16 a[76:77], v163 offset:20480
ds_read_b64_tr_b16 a[78:79], v163 offset:22528
s_waitcnt lgkmcnt(14)
s_setprio 0
v_mfma_f32_16x16x32_bf16 v[0:3], a[48:51], a[24:27], v[0:3]
v_mfma_f32_16x16x32_bf16 v[32:35], a[48:51], a[28:31], v[32:35]
ds_read_b64_tr_b16 a[48:49], v160 offset:16384
ds_read_b64_tr_b16 a[50:51], v160 offset:18432
s_waitcnt lgkmcnt(14)
v_mfma_f32_16x16x32_bf16 v[4:7], a[52:55], a[24:27], v[4:7]
v_mfma_f32_16x16x32_bf16 v[36:39], a[52:55], a[28:31], v[36:39]
ds_read_b64_tr_b16 a[52:53], v161 offset:16384
ds_read_b64_tr_b16 a[54:55], v161 offset:18432
s_add_u32 m0, s62, 40960
s_add_u32 s67, s67, 131072
buffer_load_dwordx4 v175, s[20:23], s67 offen lds
s_waitcnt lgkmcnt(14)
v_mfma_f32_16x16x32_bf16 v[8:11], a[56:59], a[24:27], v[8:11]
v_mfma_f32_16x16x32_bf16 v[40:43], a[56:59], a[28:31], v[40:43]
ds_read_b64_tr_b16 a[56:57], v162 offset:16384
ds_read_b64_tr_b16 a[58:59], v162 offset:18432
s_waitcnt lgkmcnt(14)
v_mfma_f32_16x16x32_bf16 v[12:15], a[60:63], a[24:27], v[12:15]
v_mfma_f32_16x16x32_bf16 v[44:47], a[60:63], a[28:31], v[44:47]
ds_read_b64_tr_b16 a[60:61], v163 offset:16384
ds_read_b64_tr_b16 a[62:63], v163 offset:18432
buffer_load_dwordx4 a[16:19], v171, s[40:43], s54 offen sc1
buffer_load_dwordx4 a[20:23], v171, s[40:43], s55 offen sc1
s_add_u32 s54, s54, 2048
s_add_u32 s55, s55, 2048
s_waitcnt vmcnt(14) lgkmcnt(0)
s_barrier
v_xor_b32 v160, 0x10000, v160
v_xor_b32 v161, 0x10000, v161
v_xor_b32 v162, 0x10000, v162
v_xor_b32 v163, 0x10000, v163
s_setprio 3
v_mfma_f32_16x16x32_bf16 v[16:19], a[64:67], a[0:3], v[16:19]
v_mfma_f32_16x16x32_bf16 v[48:51], a[64:67], a[4:7], v[48:51]
ds_read_b64_tr_b16 a[64:65], v160 offset:4096
ds_read_b64_tr_b16 a[66:67], v160 offset:6144
v_mfma_f32_16x16x32_bf16 v[20:23], a[68:71], a[0:3], v[20:23]
v_mfma_f32_16x16x32_bf16 v[52:55], a[68:71], a[4:7], v[52:55]
ds_read_b64_tr_b16 a[68:69], v161 offset:4096
ds_read_b64_tr_b16 a[70:71], v161 offset:6144
s_add_u32 m0, s62, 49152
s_add_u32 s67, s67, 131072
buffer_load_dwordx4 v175, s[20:23], s67 offen lds
v_mfma_f32_16x16x32_bf16 v[24:27], a[72:75], a[0:3], v[24:27]
v_mfma_f32_16x16x32_bf16 v[56:59], a[72:75], a[4:7], v[56:59]
ds_read_b64_tr_b16 a[72:73], v162 offset:4096
ds_read_b64_tr_b16 a[74:75], v162 offset:6144
v_mfma_f32_16x16x32_bf16 v[28:31], a[76:79], a[0:3], v[28:31]
v_mfma_f32_16x16x32_bf16 v[60:63], a[76:79], a[4:7], v[60:63]
ds_read_b64_tr_b16 a[76:77], v163 offset:4096
ds_read_b64_tr_b16 a[78:79], v163 offset:6144
s_setprio 2
v_mfma_f32_16x16x32_bf16 v[0:3], a[48:51], a[0:3], v[0:3]
v_mfma_f32_16x16x32_bf16 v[32:35], a[48:51], a[4:7], v[32:35]
ds_read_b64_tr_b16 a[48:49], v160 offset:0
ds_read_b64_tr_b16 a[50:51], v160 offset:2048
v_mfma_f32_16x16x32_bf16 v[4:7], a[52:55], a[0:3], v[4:7]
v_mfma_f32_16x16x32_bf16 v[36:39], a[52:55], a[4:7], v[36:39]
ds_read_b64_tr_b16 a[52:53], v161 offset:0
ds_read_b64_tr_b16 a[54:55], v161 offset:2048
s_add_u32 m0, s62, 57344
s_add_u32 s67, s67, 131072
buffer_load_dwordx4 v175, s[20:23], s67 offen lds
v_mfma_f32_16x16x32_bf16 v[8:11], a[56:59], a[0:3], v[8:11]
v_mfma_f32_16x16x32_bf16 v[40:43], a[56:59], a[4:7], v[40:43]
ds_read_b64_tr_b16 a[56:57], v162 offset:0
ds_read_b64_tr_b16 a[58:59], v162 offset:2048
v_mfma_f32_16x16x32_bf16 v[12:15], a[60:63], a[0:3], v[12:15]
v_mfma_f32_16x16x32_bf16 v[44:47], a[60:63], a[4:7], v[44:47]
ds_read_b64_tr_b16 a[60:61], v163 offset:0
ds_read_b64_tr_b16 a[62:63], v163 offset:2048
buffer_load_dwordx4 a[24:27], v171, s[40:43], s54 offen sc1
buffer_load_dwordx4 a[28:31], v171, s[40:43], s55 offen sc1
s_add_u32 s54, s54, 2048
s_add_u32 s55, s55, 2048
s_waitcnt vmcnt(16)
s_waitcnt lgkmcnt(14)
s_setprio 1
v_mfma_f32_16x16x32_bf16 v[16:19], a[64:67], a[8:11], v[16:19]
v_mfma_f32_16x16x32_bf16 v[48:51], a[64:67], a[12:15], v[48:51]
ds_read_b64_tr_b16 a[64:65], v160 offset:20480
ds_read_b64_tr_b16 a[66:67], v160 offset:22528
s_waitcnt lgkmcnt(14)
v_mfma_f32_16x16x32_bf16 v[20:23], a[68:71], a[8:11], v[20:23]
v_mfma_f32_16x16x32_bf16 v[52:55], a[68:71], a[12:15], v[52:55]
ds_read_b64_tr_b16 a[68:69], v161 offset:20480
ds_read_b64_tr_b16 a[70:71], v161 offset:22528
s_add_u32 m0, s62, 65536
s_add_u32 s67, s67, 131072
buffer_load_dwordx4 v175, s[20:23], s67 offen lds
s_waitcnt lgkmcnt(14)
v_mfma_f32_16x16x32_bf16 v[24:27], a[72:75], a[8:11], v[24:27]
v_mfma_f32_16x16x32_bf16 v[56:59], a[72:75], a[12:15], v[56:59]
ds_read_b64_tr_b16 a[72:73], v162 offset:20480
ds_read_b64_tr_b16 a[74:75], v162 offset:22528
s_waitcnt lgkmcnt(14)
v_mfma_f32_16x16x32_bf16 v[28:31], a[76:79], a[8:11], v[28:31]
v_mfma_f32_16x16x32_bf16 v[60:63], a[76:79], a[12:15], v[60:63]
ds_read_b64_tr_b16 a[76:77], v163 offset:20480
ds_read_b64_tr_b16 a[78:79], v163 offset:22528
s_waitcnt lgkmcnt(14)
s_setprio 0
v_mfma_f32_16x16x32_bf16 v[0:3], a[48:51], a[8:11], v[0:3]
v_mfma_f32_16x16x32_bf16 v[32:35], a[48:51], a[12:15], v[32:35]
ds_read_b64_tr_b16 a[48:49], v160 offset:16384
ds_read_b64_tr_b16 a[50:51], v160 offset:18432
s_waitcnt lgkmcnt(14)
v_mfma_f32_16x16x32_bf16 v[4:7], a[52:55], a[8:11], v[4:7]
v_mfma_f32_16x16x32_bf16 v[36:39], a[52:55], a[12:15], v[36:39]
ds_read_b64_tr_b16 a[52:53], v161 offset:16384
ds_read_b64_tr_b16 a[54:55], v161 offset:18432
s_add_u32 m0, s62, 73728
s_add_u32 s67, s67, 131072
buffer_load_dwordx4 v175, s[20:23], s67 offen lds
s_waitcnt lgkmcnt(14)
v_mfma_f32_16x16x32_bf16 v[8:11], a[56:59], a[8:11], v[8:11]
v_mfma_f32_16x16x32_bf16 v[40:43], a[56:59], a[12:15], v[40:43]
ds_read_b64_tr_b16 a[56:57], v162 offset:16384
ds_read_b64_tr_b16 a[58:59], v162 offset:18432
s_waitcnt lgkmcnt(14)
v_mfma_f32_16x16x32_bf16 v[12:15], a[60:63], a[8:11], v[12:15]
v_mfma_f32_16x16x32_bf16 v[44:47], a[60:63], a[12:15], v[44:47]
ds_read_b64_tr_b16 a[60:61], v163 offset:16384
ds_read_b64_tr_b16 a[62:63], v163 offset:18432
buffer_load_dwordx4 a[0:3], v171, s[40:43], s54 offen sc1
buffer_load_dwordx4 a[4:7], v171, s[40:43], s55 offen sc1
s_add_u32 s54, s54, 2048
s_add_u32 s55, s55, 2048
s_waitcnt vmcnt(14) lgkmcnt(0)
s_barrier
s_lshl_b32 s90, s87, 12
s_add_u32 s90, s90, 131072
v_add_u32 v167, s90, v171
s_xor_b32 s90, s90, 16384
v_add_u32 v168, s90, v171
v_lshrrev_b32 v164, 4, v171
v_and_b32 v164, 15, v164
v_lshrrev_b32 v166, 8, v171
v_lshlrev_b32 v166, 3, v166
v_lshl_add_u32 v166, v164, 11, v166
v_add_u32 v166, s95, v166
v_lshlrev_b32 v164, 2, v164
v_subrev_u32 v160, s63, v160
v_subrev_u32 v161, s63, v161
v_subrev_u32 v162, s63, v162
v_subrev_u32 v163, s63, v163
v_xor_b32 v160, 0x10000, v160
v_xor_b32 v161, 0x10000, v161
v_xor_b32 v162, 0x10000, v162
v_xor_b32 v163, 0x10000, v163
s_setprio 3
v_mfma_f32_16x16x32_bf16 v[16:19], a[64:67], a[32:35], v[16:19]
v_mfma_f32_16x16x32_bf16 v[48:51], a[64:67], a[36:39], v[48:51]
ds_read_b64_tr_b16 a[64:65], v160 offset:32768
ds_read_b64_tr_b16 a[66:67], v160 offset:34816
v_mfma_f32_16x16x32_bf16 v[20:23], a[68:71], a[32:35], v[20:23]
v_mfma_f32_16x16x32_bf16 v[52:55], a[68:71], a[36:39], v[52:55]
ds_read_b64_tr_b16 a[68:69], v161 offset:32768
ds_read_b64_tr_b16 a[70:71], v161 offset:34816
s_add_u32 m0, s62, 81920
s_add_u32 s67, s67, 131072
buffer_load_dwordx4 v175, s[20:23], s67 offen lds
v_mfma_f32_16x16x32_bf16 v[24:27], a[72:75], a[32:35], v[24:27]
v_mfma_f32_16x16x32_bf16 v[56:59], a[72:75], a[36:39], v[56:59]
ds_read_b64_tr_b16 a[72:73], v162 offset:32768
ds_read_b64_tr_b16 a[74:75], v162 offset:34816
v_mfma_f32_16x16x32_bf16 v[28:31], a[76:79], a[32:35], v[28:31]
v_mfma_f32_16x16x32_bf16 v[60:63], a[76:79], a[36:39], v[60:63]
ds_read_b64_tr_b16 a[76:77], v163 offset:32768
ds_read_b64_tr_b16 a[78:79], v163 offset:34816
s_setprio 2
v_mfma_f32_16x16x32_bf16 v[0:3], a[48:51], a[32:35], v[0:3]
v_mfma_f32_16x16x32_bf16 v[32:35], a[48:51], a[36:39], v[32:35]
v_mfma_f32_16x16x32_bf16 v[4:7], a[52:55], a[32:35], v[4:7]
ds_write_b128 v167, v[48:51] offset:0
v_mfma_f32_16x16x32_bf16 v[36:39], a[52:55], a[36:39], v[36:39]
ds_write_b128 v167, v[52:55] offset:1024
s_add_u32 m0, s62, 90112
s_add_u32 s67, s67, 131072
buffer_load_dwordx4 v175, s[20:23], s67 offen lds
v_mfma_f32_16x16x32_bf16 v[8:11], a[56:59], a[32:35], v[8:11]
ds_write_b128 v167, v[56:59] offset:2048
v_mfma_f32_16x16x32_bf16 v[40:43], a[56:59], a[36:39], v[40:43]
ds_write_b128 v167, v[60:63] offset:3072
v_mfma_f32_16x16x32_bf16 v[12:15], a[60:63], a[32:35], v[12:15]
v_mfma_f32_16x16x32_bf16 v[44:47], a[60:63], a[36:39], v[44:47]
buffer_load_dwordx4 a[8:11], v171, s[40:43], s54 offen sc1
buffer_load_dwordx4 a[12:15], v171, s[40:43], s55 offen sc1
s_add_u32 s54, s54, 2048
s_add_u32 s55, s55, 2048
s_waitcnt vmcnt(16) lgkmcnt(0)
s_barrier
s_setprio 2
v_mfma_f32_16x16x32_bf16 v[0:3], a[64:67], a[40:43], v[0:3]
ds_read_b64_tr_b16 a[48:49], v160 offset:40960
ds_read_b64_tr_b16 a[50:51], v160 offset:43008
ds_read_b128 v[128:131], v168 offset:0
v_mfma_f32_16x16x32_bf16 v[32:35], a[64:67], a[44:47], v[32:35]
ds_read_b128 v[132:135], v168 offset:1024
v_mfma_f32_16x16x32_bf16 v[4:7], a[68:71], a[40:43], v[4:7]
ds_read_b64_tr_b16 a[52:53], v161 offset:40960
ds_read_b64_tr_b16 a[54:55], v161 offset:43008
ds_read_b128 v[136:139], v168 offset:2048
v_mfma_f32_16x16x32_bf16 v[36:39], a[68:71], a[44:47], v[36:39]
ds_read_b128 v[140:143], v168 offset:3072
s_add_u32 m0, s62, 0
s_add_u32 s67, s67, 131072
buffer_load_dwordx4 v175, s[20:23], s67 offen lds
v_mfma_f32_16x16x32_bf16 v[8:11], a[72:75], a[40:43], v[8:11]
ds_read_b64_tr_b16 a[56:57], v162 offset:40960
ds_read_b64_tr_b16 a[58:59], v162 offset:43008
v_mfma_f32_16x16x32_bf16 v[40:43], a[72:75], a[44:47], v[40:43]
v_mfma_f32_16x16x32_bf16 v[12:15], a[76:79], a[40:43], v[12:15]
ds_read_b64_tr_b16 a[60:61], v163 offset:40960
ds_read_b64_tr_b16 a[62:63], v163 offset:43008
v_mfma_f32_16x16x32_bf16 v[44:47], a[76:79], a[44:47], v[44:47]
buffer_load_dwordx4 a[32:35], v171, s[40:43], s54 offen sc1
buffer_load_dwordx4 a[36:39], v171, s[40:43], s55 offen sc1
s_add_u32 s54, s54, 2048
s_add_u32 s55, s55, 2048
s_waitcnt vmcnt(15)
buffer_load_dword v165, v164, s[40:43], s70 offen sc1
s_waitcnt lgkmcnt(4)
s_waitcnt lgkmcnt(10)
s_setprio 1
v_mfma_f32_16x16x32_bf16 v[0:3], a[48:51], a[16:19], v[0:3]
ds_read_b64_tr_b16 a[64:65], v160 offset:49152
ds_read_b64_tr_b16 a[66:67], v160 offset:51200
v_add_f32 v16, v16, v128
v_add_f32 v17, v17, v129
v_add_f32 v18, v18, v130
v_add_f32 v19, v19, v131
buffer_store_dwordx4 v[16:19], v171, s[40:43], s44 offen offset:0 sc1
v_mfma_f32_16x16x32_bf16 v[32:35], a[48:51], a[20:23], v[32:35]
v_add_f32 v20, v20, v132
v_add_f32 v21, v21, v133
v_add_f32 v22, v22, v134
v_add_f32 v23, v23, v135
buffer_store_dwordx4 v[20:23], v171, s[40:43], s44 offen offset:1024 sc1
s_waitcnt lgkmcnt(8)
v_mfma_f32_16x16x32_bf16 v[4:7], a[52:55], a[16:19], v[4:7]
ds_read_b64_tr_b16 a[68:69], v161 offset:49152
ds_read_b64_tr_b16 a[70:71], v161 offset:51200
v_add_f32 v24, v24, v136
v_add_f32 v25, v25, v137
v_add_f32 v26, v26, v138
v_add_f32 v27, v27, v139
buffer_store_dwordx4 v[24:27], v171, s[40:43], s44 offen offset:2048 sc1
v_mfma_f32_16x16x32_bf16 v[36:39], a[52:55], a[20:23], v[36:39]
v_add_f32 v28, v28, v140
v_add_f32 v29, v29, v141
v_add_f32 v30, v30, v142
v_add_f32 v31, v31, v143
buffer_store_dwordx4 v[28:31], v171, s[40:43], s44 offen offset:3072 sc1
s_waitcnt lgkmcnt(6)
v_mfma_f32_16x16x32_bf16 v[8:11], a[56:59], a[16:19], v[8:11]
ds_read_b64_tr_b16 a[72:73], v162 offset:49152
ds_read_b64_tr_b16 a[74:75], v162 offset:51200
v_mfma_f32_16x16x32_bf16 v[40:43], a[56:59], a[20:23], v[40:43]
s_waitcnt lgkmcnt(6)
v_mfma_f32_16x16x32_bf16 v[12:15], a[60:63], a[16:19], v[12:15]
ds_read_b64_tr_b16 a[76:77], v163 offset:49152
ds_read_b64_tr_b16 a[78:79], v163 offset:51200
v_mfma_f32_16x16x32_bf16 v[44:47], a[60:63], a[20:23], v[44:47]
buffer_load_dwordx4 a[40:43], v171, s[40:43], s54 offen sc1
buffer_load_dwordx4 a[44:47], v171, s[40:43], s55 offen sc1
s_add_u32 s54, s54, 2048
s_add_u32 s55, s55, 2048
s_waitcnt vmcnt(18)
s_waitcnt lgkmcnt(6)
s_setprio 0
v_mfma_f32_16x16x32_bf16 v[0:3], a[64:67], a[24:27], v[0:3]
ds_read_b64_tr_b16 a[48:49], v160 offset:57344
ds_read_b64_tr_b16 a[50:51], v160 offset:59392
v_mfma_f32_16x16x32_bf16 v[32:35], a[64:67], a[28:31], v[32:35]
s_waitcnt lgkmcnt(6)
v_mfma_f32_16x16x32_bf16 v[4:7], a[68:71], a[24:27], v[4:7]
ds_read_b64_tr_b16 a[52:53], v161 offset:57344
ds_read_b64_tr_b16 a[54:55], v161 offset:59392
v_mfma_f32_16x16x32_bf16 v[36:39], a[68:71], a[28:31], v[36:39]
s_waitcnt lgkmcnt(6)
v_mfma_f32_16x16x32_bf16 v[8:11], a[72:75], a[24:27], v[8:11]
ds_read_b64_tr_b16 a[56:57], v162 offset:57344
ds_read_b64_tr_b16 a[58:59], v162 offset:59392
v_mfma_f32_16x16x32_bf16 v[40:43], a[72:75], a[28:31], v[40:43]
s_waitcnt lgkmcnt(6)
v_mfma_f32_16x16x32_bf16 v[12:15], a[76:79], a[24:27], v[12:15]
ds_read_b64_tr_b16 a[60:61], v163 offset:57344
ds_read_b64_tr_b16 a[62:63], v163 offset:59392
v_mfma_f32_16x16x32_bf16 v[44:47], a[76:79], a[28:31], v[44:47]
buffer_load_dwordx4 a[16:19], v171, s[40:43], s54 offen sc1
buffer_load_dwordx4 a[20:23], v171, s[40:43], s55 offen sc1
s_add_u32 s54, s54, 2048
s_add_u32 s55, s55, 2048
s_waitcnt vmcnt(16) lgkmcnt(0)
s_barrier
v_xor_b32 v160, 0x10000, v160
v_xor_b32 v161, 0x10000, v161
v_xor_b32 v162, 0x10000, v162
v_xor_b32 v163, 0x10000, v163
s_setprio 3
v_mfma_f32_16x16x32_bf16 v[0:3], a[48:51], a[0:3], v[0:3]
ds_read_b64_tr_b16 a[64:65], v160 offset:32768
ds_read_b64_tr_b16 a[66:67], v160 offset:34816
v_mfma_f32_16x16x32_bf16 v[32:35], a[48:51], a[4:7], v[32:35]
v_mfma_f32_16x16x32_bf16 v[4:7], a[52:55], a[0:3], v[4:7]
ds_read_b64_tr_b16 a[68:69], v161 offset:32768
ds_read_b64_tr_b16 a[70:71], v161 offset:34816
v_mfma_f32_16x16x32_bf16 v[36:39], a[52:55], a[4:7], v[36:39]
v_mfma_f32_16x16x32_bf16 v[8:11], a[56:59], a[0:3], v[8:11]
ds_read_b64_tr_b16 a[72:73], v162 offset:32768
ds_read_b64_tr_b16 a[74:75], v162 offset:34816
v_mfma_f32_16x16x32_bf16 v[40:43], a[56:59], a[4:7], v[40:43]
v_mfma_f32_16x16x32_bf16 v[12:15], a[60:63], a[0:3], v[12:15]
ds_read_b64_tr_b16 a[76:77], v163 offset:32768
ds_read_b64_tr_b16 a[78:79], v163 offset:34816
v_mfma_f32_16x16x32_bf16 v[44:47], a[60:63], a[4:7], v[44:47]
buffer_load_dwordx4 a[24:27], v171, s[40:43], s54 offen sc1
buffer_load_dwordx4 a[28:31], v171, s[40:43], s55 offen sc1
s_add_u32 s54, s54, 2048
s_add_u32 s55, s55, 2048
s_waitcnt vmcnt(6)
s_barrier
s_cmp_lg_u32 s87, 0
s_cbranch_scc1 k1_kernel_a_p_sg
v_mov_b32 v174, 1
s_mov_b64 exec, 1
buffer_store_dword v174, off, s[40:43], s80 sc1
s_mov_b64 exec, -1
k1_kernel_a_p_sg:
s_waitcnt lgkmcnt(6)
s_setprio 2
v_mfma_f32_16x16x32_bf16 v[0:3], a[64:67], a[8:11], v[0:3]
ds_read_b64_tr_b16 a[48:49], v160 offset:40960
ds_read_b64_tr_b16 a[50:51], v160 offset:43008
v_mfma_f32_16x16x32_bf16 v[32:35], a[64:67], a[12:15], v[32:35]
s_waitcnt lgkmcnt(6)
v_mfma_f32_16x16x32_bf16 v[4:7], a[68:71], a[8:11], v[4:7]
ds_read_b64_tr_b16 a[52:53], v161 offset:40960
ds_read_b64_tr_b16 a[54:55], v161 offset:43008
v_mfma_f32_16x16x32_bf16 v[36:39], a[68:71], a[12:15], v[36:39]
s_waitcnt lgkmcnt(6)
v_mfma_f32_16x16x32_bf16 v[8:11], a[72:75], a[8:11], v[8:11]
ds_read_b64_tr_b16 a[56:57], v162 offset:40960
ds_read_b64_tr_b16 a[58:59], v162 offset:43008
v_mfma_f32_16x16x32_bf16 v[40:43], a[72:75], a[12:15], v[40:43]
s_waitcnt lgkmcnt(6)
v_mfma_f32_16x16x32_bf16 v[12:15], a[76:79], a[8:11], v[12:15]
ds_read_b64_tr_b16 a[60:61], v163 offset:40960
ds_read_b64_tr_b16 a[62:63], v163 offset:43008
v_mfma_f32_16x16x32_bf16 v[44:47], a[76:79], a[12:15], v[44:47]
buffer_load_dwordx4 a[0:3], v171, s[40:43], s54 offen sc1
buffer_load_dwordx4 a[4:7], v171, s[40:43], s55 offen sc1
s_add_u32 s54, s54, 2048
s_add_u32 s55, s55, 2048
s_waitcnt vmcnt(13)
s_waitcnt lgkmcnt(6)
s_setprio 1
v_mfma_f32_16x16x32_bf16 v[0:3], a[48:51], a[32:35], v[0:3]
ds_read_b64_tr_b16 a[64:65], v160 offset:49152
ds_read_b64_tr_b16 a[66:67], v160 offset:51200
v_mfma_f32_16x16x32_bf16 v[32:35], a[48:51], a[36:39], v[32:35]
s_waitcnt lgkmcnt(6)
v_mfma_f32_16x16x32_bf16 v[4:7], a[52:55], a[32:35], v[4:7]
ds_read_b64_tr_b16 a[68:69], v161 offset:49152
ds_read_b64_tr_b16 a[70:71], v161 offset:51200
v_mfma_f32_16x16x32_bf16 v[36:39], a[52:55], a[36:39], v[36:39]
s_waitcnt lgkmcnt(6)
v_mfma_f32_16x16x32_bf16 v[8:11], a[56:59], a[32:35], v[8:11]
ds_read_b64_tr_b16 a[72:73], v162 offset:49152
ds_read_b64_tr_b16 a[74:75], v162 offset:51200
v_mfma_f32_16x16x32_bf16 v[40:43], a[56:59], a[36:39], v[40:43]
s_waitcnt lgkmcnt(6)
v_mfma_f32_16x16x32_bf16 v[12:15], a[60:63], a[32:35], v[12:15]
ds_read_b64_tr_b16 a[76:77], v163 offset:49152
ds_read_b64_tr_b16 a[78:79], v163 offset:51200
v_mfma_f32_16x16x32_bf16 v[44:47], a[60:63], a[36:39], v[44:47]
s_lshr_b32 s55, s63, 2
s_sub_u32 s54, s54, s55
s_add_u32 s55, s54, 1024
buffer_load_dwordx4 a[8:11], v171, s[40:43], s54 offen sc1
buffer_load_dwordx4 a[12:15], v171, s[40:43], s55 offen sc1
s_add_u32 s54, s54, 2048
s_add_u32 s55, s55, 2048
s_waitcnt vmcnt(8)
s_waitcnt lgkmcnt(6)
s_setprio 0
v_mfma_f32_16x16x32_bf16 v[0:3], a[64:67], a[40:43], v[0:3]
ds_read_b64_tr_b16 a[48:49], v160 offset:57344
ds_read_b64_tr_b16 a[50:51], v160 offset:59392
v_mfma_f32_16x16x32_bf16 v[32:35], a[64:67], a[44:47], v[32:35]
s_waitcnt lgkmcnt(6)
v_mfma_f32_16x16x32_bf16 v[4:7], a[68:71], a[40:43], v[4:7]
ds_read_b64_tr_b16 a[52:53], v161 offset:57344
ds_read_b64_tr_b16 a[54:55], v161 offset:59392
v_mfma_f32_16x16x32_bf16 v[36:39], a[68:71], a[44:47], v[36:39]
s_waitcnt lgkmcnt(6)
v_mfma_f32_16x16x32_bf16 v[8:11], a[72:75], a[40:43], v[8:11]
ds_read_b64_tr_b16 a[56:57], v162 offset:57344
ds_read_b64_tr_b16 a[58:59], v162 offset:59392
v_mfma_f32_16x16x32_bf16 v[40:43], a[72:75], a[44:47], v[40:43]
s_waitcnt lgkmcnt(6)
v_mfma_f32_16x16x32_bf16 v[12:15], a[76:79], a[40:43], v[12:15]
ds_read_b64_tr_b16 a[60:61], v163 offset:57344
ds_read_b64_tr_b16 a[62:63], v163 offset:59392
v_mfma_f32_16x16x32_bf16 v[44:47], a[76:79], a[44:47], v[44:47]
buffer_load_dwordx4 a[32:35], v171, s[40:43], s54 offen sc1
buffer_load_dwordx4 a[36:39], v171, s[40:43], s55 offen sc1
s_add_u32 s54, s54, 2048
s_add_u32 s55, s55, 2048
s_waitcnt vmcnt(8) lgkmcnt(0)
s_barrier
v_xor_b32 v160, 0x10000, v160
v_xor_b32 v161, 0x10000, v161
v_xor_b32 v162, 0x10000, v162
v_xor_b32 v163, 0x10000, v163
s_setprio 3
v_mfma_f32_16x16x32_bf16 v[0:3], a[48:51], a[16:19], v[0:3]
ds_read_b64_tr_b16 a[64:65], v160 offset:0
ds_read_b64_tr_b16 a[66:67], v160 offset:2048
v_mfma_f32_16x16x32_bf16 v[32:35], a[48:51], a[20:23], v[32:35]
v_mfma_f32_16x16x32_bf16 v[4:7], a[52:55], a[16:19], v[4:7]
ds_read_b64_tr_b16 a[68:69], v161 offset:0
ds_read_b64_tr_b16 a[70:71], v161 offset:2048
v_mfma_f32_16x16x32_bf16 v[36:39], a[52:55], a[20:23], v[36:39]
v_mfma_f32_16x16x32_bf16 v[8:11], a[56:59], a[16:19], v[8:11]
ds_read_b64_tr_b16 a[72:73], v162 offset:0
ds_read_b64_tr_b16 a[74:75], v162 offset:2048
v_mfma_f32_16x16x32_bf16 v[40:43], a[56:59], a[20:23], v[40:43]
v_mfma_f32_16x16x32_bf16 v[12:15], a[60:63], a[16:19], v[12:15]
ds_read_b64_tr_b16 a[76:77], v163 offset:0
ds_read_b64_tr_b16 a[78:79], v163 offset:2048
v_mfma_f32_16x16x32_bf16 v[44:47], a[60:63], a[20:23], v[44:47]
buffer_load_dwordx4 a[40:43], v171, s[40:43], s54 offen sc1
buffer_load_dwordx4 a[44:47], v171, s[40:43], s55 offen sc1
s_add_u32 s54, s54, 2048
s_add_u32 s55, s55, 2048
s_waitcnt vmcnt(8)
s_cmp_lg_u32 s87, 0
s_cbranch_scc1 k1_kernel_a_pp_pi
v_lshrrev_b32 v172, 2, v171
v_min_u32 v172, 4, v172
buffer_load_dword v172, v172, s[40:43], s56 offen offset:0 sc1
k1_kernel_a_pp_pi:
s_waitcnt lgkmcnt(6)
s_setprio 2
v_mfma_f32_16x16x32_bf16 v[0:3], a[64:67], a[24:27], v[0:3]
ds_read_b64_tr_b16 a[48:49], v160 offset:8192
ds_read_b64_tr_b16 a[50:51], v160 offset:10240
v_mfma_f32_16x16x32_bf16 v[32:35], a[64:67], a[28:31], v[32:35]
s_waitcnt lgkmcnt(6)
v_mfma_f32_16x16x32_bf16 v[4:7], a[68:71], a[24:27], v[4:7]
ds_read_b64_tr_b16 a[52:53], v161 offset:8192
ds_read_b64_tr_b16 a[54:55], v161 offset:10240
v_mfma_f32_16x16x32_bf16 v[36:39], a[68:71], a[28:31], v[36:39]
s_waitcnt lgkmcnt(6)
v_mfma_f32_16x16x32_bf16 v[8:11], a[72:75], a[24:27], v[8:11]
ds_read_b64_tr_b16 a[56:57], v162 offset:8192
ds_read_b64_tr_b16 a[58:59], v162 offset:10240
v_mfma_f32_16x16x32_bf16 v[40:43], a[72:75], a[28:31], v[40:43]
s_waitcnt lgkmcnt(6)
v_mfma_f32_16x16x32_bf16 v[12:15], a[76:79], a[24:27], v[12:15]
ds_read_b64_tr_b16 a[60:61], v163 offset:8192
ds_read_b64_tr_b16 a[62:63], v163 offset:10240
v_mfma_f32_16x16x32_bf16 v[44:47], a[76:79], a[28:31], v[44:47]
s_waitcnt vmcnt(6)
v_subrev_u32 v160, s63, v160
v_subrev_u32 v161, s63, v161
v_subrev_u32 v162, s63, v162
v_subrev_u32 v163, s63, v163
s_waitcnt lgkmcnt(6)
s_setprio 1
v_mfma_f32_16x16x32_bf16 v[0:3], a[48:51], a[0:3], v[0:3]
ds_read_b64_tr_b16 a[64:65], v160 offset:20480
ds_read_b64_tr_b16 a[66:67], v160 offset:22528
v_mfma_f32_16x16x32_bf16 v[32:35], a[48:51], a[4:7], v[32:35]
ds_read_b64_tr_b16 a[48:49], v160 offset:16384
ds_read_b64_tr_b16 a[50:51], v160 offset:18432
s_waitcnt lgkmcnt(8)
v_mfma_f32_16x16x32_bf16 v[4:7], a[52:55], a[0:3], v[4:7]
ds_read_b64_tr_b16 a[68:69], v161 offset:20480
ds_read_b64_tr_b16 a[70:71], v161 offset:22528
v_mfma_f32_16x16x32_bf16 v[36:39], a[52:55], a[4:7], v[36:39]
ds_read_b64_tr_b16 a[52:53], v161 offset:16384
ds_read_b64_tr_b16 a[54:55], v161 offset:18432
s_waitcnt lgkmcnt(10)
v_mfma_f32_16x16x32_bf16 v[8:11], a[56:59], a[0:3], v[8:11]
ds_read_b64_tr_b16 a[72:73], v162 offset:20480
ds_read_b64_tr_b16 a[74:75], v162 offset:22528
v_mfma_f32_16x16x32_bf16 v[40:43], a[56:59], a[4:7], v[40:43]
ds_read_b64_tr_b16 a[56:57], v162 offset:16384
ds_read_b64_tr_b16 a[58:59], v162 offset:18432
s_waitcnt lgkmcnt(12)
v_mfma_f32_16x16x32_bf16 v[12:15], a[60:63], a[0:3], v[12:15]
ds_read_b64_tr_b16 a[76:77], v163 offset:20480
ds_read_b64_tr_b16 a[78:79], v163 offset:22528
v_mfma_f32_16x16x32_bf16 v[44:47], a[60:63], a[4:7], v[44:47]
ds_read_b64_tr_b16 a[60:61], v163 offset:16384
ds_read_b64_tr_b16 a[62:63], v163 offset:18432
s_waitcnt vmcnt(4)
s_cmp_lg_u32 s87, 0
s_cbranch_scc1 k1_kernel_a_pp_pc_rdy
s_waitcnt vmcnt(0)
v_cmp_le_u32 s[100:101], 1, v172
s_nop 0
s_cmp_eq_u64 s[100:101], -1
s_cbranch_scc1 k1_kernel_a_pp_pc_rdy
s_mov_b32 s91, 40000
k1_kernel_a_pp_pc_spin:
s_sleep 2
v_lshrrev_b32 v172, 2, v171
v_min_u32 v172, 4, v172
buffer_load_dword v172, v172, s[40:43], s56 offen offset:0 sc1
s_waitcnt vmcnt(0)
v_cmp_le_u32 s[100:101], 1, v172
s_nop 0
s_cmp_eq_u64 s[100:101], -1
s_cbranch_scc1 k1_kernel_a_pp_pc_rdy
s_sub_u32 s91, s91, 1
s_cmp_lg_u32 s91, 0
s_cbranch_scc1 k1_kernel_a_pp_pc_spin
s_nop 0
k1_kernel_a_pp_pc_rdy:
s_barrier
s_waitcnt lgkmcnt(12)
s_setprio 0
v_mfma_f32_16x16x32_bf16 v[0:3], a[48:51], a[8:11], v[0:3]
ds_read_b64_tr_b16 a[48:49], v160 offset:24576
ds_read_b64_tr_b16 a[50:51], v160 offset:26624
buffer_load_dwordx4 v[144:147], v171, s[40:43], s45 offen offset:0 sc1
s_waitcnt lgkmcnt(10)
v_mfma_f32_16x16x32_bf16 v[4:7], a[52:55], a[8:11], v[4:7]
ds_read_b64_tr_b16 a[52:53], v161 offset:24576
ds_read_b64_tr_b16 a[54:55], v161 offset:26624
buffer_load_dwordx4 v[148:151], v171, s[40:43], s45 offen offset:1024 sc1
s_waitcnt lgkmcnt(8)
v_mfma_f32_16x16x32_bf16 v[8:11], a[56:59], a[8:11], v[8:11]
ds_read_b64_tr_b16 a[56:57], v162 offset:24576
ds_read_b64_tr_b16 a[58:59], v162 offset:26624
buffer_load_dwordx4 v[152:155], v171, s[40:43], s45 offen offset:2048 sc1
s_waitcnt lgkmcnt(6)
v_mfma_f32_16x16x32_bf16 v[12:15], a[60:63], a[8:11], v[12:15]
ds_read_b64_tr_b16 a[60:61], v163 offset:24576
ds_read_b64_tr_b16 a[62:63], v163 offset:26624
buffer_load_dwordx4 v[156:159], v171, s[40:43], s45 offen offset:3072 sc1
s_waitcnt lgkmcnt(15)
v_mfma_f32_16x16x32_bf16 v[0:3], a[64:67], a[12:15], v[0:3]
ds_read_b64_tr_b16 a[64:65], v160 offset:28672
ds_read_b64_tr_b16 a[66:67], v160 offset:30720
ds_write_b128 v167, v[32:35] offset:0
s_waitcnt lgkmcnt(15)
v_mfma_f32_16x16x32_bf16 v[4:7], a[68:71], a[12:15], v[4:7]
ds_read_b64_tr_b16 a[68:69], v161 offset:28672
ds_read_b64_tr_b16 a[70:71], v161 offset:30720
ds_write_b128 v167, v[36:39] offset:1024
s_waitcnt lgkmcnt(15)
v_mfma_f32_16x16x32_bf16 v[8:11], a[72:75], a[12:15], v[8:11]
ds_read_b64_tr_b16 a[72:73], v162 offset:28672
ds_read_b64_tr_b16 a[74:75], v162 offset:30720
ds_write_b128 v167, v[40:43] offset:2048
s_waitcnt lgkmcnt(15)
v_mfma_f32_16x16x32_bf16 v[12:15], a[76:79], a[12:15], v[12:15]
ds_read_b64_tr_b16 a[76:77], v163 offset:28672
ds_read_b64_tr_b16 a[78:79], v163 offset:30720
ds_write_b128 v167, v[44:47] offset:3072
s_waitcnt vmcnt(6) lgkmcnt(0)
s_barrier
v_xor_b32 v160, 0x10000, v160
v_xor_b32 v161, 0x10000, v161
v_xor_b32 v162, 0x10000, v162
v_xor_b32 v163, 0x10000, v163
s_setprio 3
v_mfma_f32_16x16x32_bf16 v[0:3], a[48:51], a[32:35], v[0:3]
ds_read_b64_tr_b16 a[48:49], v160 offset:0
ds_read_b64_tr_b16 a[50:51], v160 offset:2048
ds_read_b128 v[128:131], v168 offset:0
v_mfma_f32_16x16x32_bf16 v[4:7], a[52:55], a[32:35], v[4:7]
ds_read_b64_tr_b16 a[52:53], v161 offset:0
ds_read_b64_tr_b16 a[54:55], v161 offset:2048
ds_read_b128 v[132:135], v168 offset:1024
v_mfma_f32_16x16x32_bf16 v[8:11], a[56:59], a[32:35], v[8:11]
ds_read_b64_tr_b16 a[56:57], v162 offset:0
ds_read_b64_tr_b16 a[58:59], v162 offset:2048
ds_read_b128 v[136:139], v168 offset:2048
v_mfma_f32_16x16x32_bf16 v[12:15], a[60:63], a[32:35], v[12:15]
ds_read_b64_tr_b16 a[60:61], v163 offset:0
ds_read_b64_tr_b16 a[62:63], v163 offset:2048
ds_read_b128 v[140:143], v168 offset:3072
v_mfma_f32_16x16x32_bf16 v[0:3], a[64:67], a[36:39], v[0:3]
ds_read_b64_tr_b16 a[64:65], v160 offset:4096
ds_read_b64_tr_b16 a[66:67], v160 offset:6144
v_mfma_f32_16x16x32_bf16 v[4:7], a[68:71], a[36:39], v[4:7]
ds_read_b64_tr_b16 a[68:69], v161 offset:4096
ds_read_b64_tr_b16 a[70:71], v161 offset:6144
v_mfma_f32_16x16x32_bf16 v[8:11], a[72:75], a[36:39], v[8:11]
ds_read_b64_tr_b16 a[72:73], v162 offset:4096
ds_read_b64_tr_b16 a[74:75], v162 offset:6144
v_mfma_f32_16x16x32_bf16 v[12:15], a[76:79], a[36:39], v[12:15]
ds_read_b64_tr_b16 a[76:77], v163 offset:4096
ds_read_b64_tr_b16 a[78:79], v163 offset:6144
s_waitcnt vmcnt(4)
s_waitcnt vmcnt(0) lgkmcnt(8)
s_waitcnt lgkmcnt(15)
s_setprio 2
v_mfma_f32_16x16x32_bf16 v[0:3], a[48:51], a[40:43], v[0:3]
v_add_f32 v128, v128, v144
v_add_f32 v129, v129, v145
v_add_f32 v130, v130, v146
v_add_f32 v131, v131, v147
v_mul_f32 v128, v128, v165
v_mul_f32 v129, v129, v165
v_mul_f32 v130, v130, v165
v_mul_f32 v131, v131, v165
s_waitcnt lgkmcnt(15)
v_mfma_f32_16x16x32_bf16 v[4:7], a[52:55], a[40:43], v[4:7]
v_add_f32 v132, v132, v148
v_add_f32 v133, v133, v149
v_add_f32 v134, v134, v150
v_add_f32 v135, v135, v151
v_mul_f32 v132, v132, v165
v_mul_f32 v133, v133, v165
v_mul_f32 v134, v134, v165
v_mul_f32 v135, v135, v165
s_waitcnt lgkmcnt(12)
v_mfma_f32_16x16x32_bf16 v[8:11], a[56:59], a[40:43], v[8:11]
v_add_f32 v136, v136, v152
v_add_f32 v137, v137, v153
v_add_f32 v138, v138, v154
v_add_f32 v139, v139, v155
v_mul_f32 v136, v136, v165
v_mul_f32 v137, v137, v165
v_mul_f32 v138, v138, v165
v_mul_f32 v139, v139, v165
s_waitcnt lgkmcnt(9)
v_mfma_f32_16x16x32_bf16 v[12:15], a[60:63], a[40:43], v[12:15]
v_add_f32 v140, v140, v156
v_add_f32 v141, v141, v157
v_add_f32 v142, v142, v158
v_add_f32 v143, v143, v159
v_mul_f32 v140, v140, v165
v_mul_f32 v141, v141, v165
v_mul_f32 v142, v142, v165
v_mul_f32 v143, v143, v165
s_waitcnt lgkmcnt(6)
v_mfma_f32_16x16x32_bf16 v[0:3], a[64:67], a[44:47], v[0:3]
s_waitcnt lgkmcnt(4)
v_mfma_f32_16x16x32_bf16 v[4:7], a[68:71], a[44:47], v[4:7]
s_waitcnt lgkmcnt(2)
v_mfma_f32_16x16x32_bf16 v[8:11], a[72:75], a[44:47], v[8:11]
s_waitcnt lgkmcnt(0)
v_mfma_f32_16x16x32_bf16 v[12:15], a[76:79], a[44:47], v[12:15]
s_nop 1
v_fmac_f32 v128, v0, v165
v_fmac_f32 v129, v1, v165
v_fmac_f32 v130, v2, v165
v_fmac_f32 v131, v3, v165
v_cvt_pk_bf16_f32 v128, v128, v129
v_cvt_pk_bf16_f32 v129, v130, v131
buffer_store_dwordx2 v[128:129], v166, s[24:27], 0 offen offset:0 nt
v_fmac_f32 v132, v4, v165
v_fmac_f32 v133, v5, v165
v_fmac_f32 v134, v6, v165
v_fmac_f32 v135, v7, v165
v_cvt_pk_bf16_f32 v132, v132, v133
v_cvt_pk_bf16_f32 v133, v134, v135
buffer_store_dwordx2 v[132:133], v166, s[24:27], 0 offen offset:32 nt
v_fmac_f32 v136, v8, v165
v_fmac_f32 v137, v9, v165
v_fmac_f32 v138, v10, v165
v_fmac_f32 v139, v11, v165
v_cvt_pk_bf16_f32 v136, v136, v137
v_cvt_pk_bf16_f32 v137, v138, v139
buffer_store_dwordx2 v[136:137], v166, s[24:27], 0 offen offset:64 nt
v_fmac_f32 v140, v12, v165
v_fmac_f32 v141, v13, v165
v_fmac_f32 v142, v14, v165
v_fmac_f32 v143, v15, v165
v_cvt_pk_bf16_f32 v140, v140, v141
v_cvt_pk_bf16_f32 v141, v142, v143
buffer_store_dwordx2 v[140:141], v166, s[24:27], 0 offen offset:96 nt
s_endpgm

k1_kernel_end:

.section .rodata,"a"
.p2align 6
.amdhsa_kernel k1_kernel
  .amdhsa_next_free_vgpr 256
  .amdhsa_next_free_sgpr 102
  .amdhsa_accum_offset 176
  .amdhsa_group_segment_fixed_size 0
  .amdhsa_kernarg_size 96
  .amdhsa_user_sgpr_count 2
  .amdhsa_user_sgpr_kernarg_segment_ptr 1
  .amdhsa_system_sgpr_workgroup_id_x 1
.end_amdhsa_kernel
```
